```python
import torch

def _softmax(x, axis=-1):
    return torch.softmax(x, dim=axis)

def _gelu(x):
    return torch.nn.functional.gelu(x, approximate='tanh')

def _silu(x):
    return torch.nn.functional.silu(x)

def _sigmoid(x):
    return torch.sigmoid(x)

def _layernorm(x, axis=-1, eps=1e-05):
    m = x.mean(dim=axis, keepdim=True)
    v = x.var(dim=axis, keepdim=True, unbiased=False)
    return (x - m) / torch.sqrt(v + eps)

def _scatter_add(tgt, idx, src, axis=0):
    return tgt.clone().index_add_(axis, idx, src)

def _segment_sum(src, seg, n):
    out = torch.zeros((n,) + src.shape[1:], dtype=src.dtype)
    return out.index_add_(0, seg, src)

def _pad(x, pw):
    flat = tuple((v for pair in reversed(pw) for v in pair))
    return torch.nn.functional.pad(x, flat)
kernel_name = 'concat_heads__memory_aug_recurrent_mem_tr__sliding_block__prompt'

def setup_inputs():

    _w = lambda a: (lambda t: t.to(torch.bfloat16) if t.is_floating_point() else t)(torch.as_tensor(a))

    def _A_setup():
        B, S, Dm = (1, 2048, 640)
        H, Dh = (32, 128)
        M, seg = (8, 32)
        seg = min(seg, S)
        S = S // seg * seg
        return {'x': _w((lambda *s: torch.randn(*s, dtype=torch.bfloat16) * 0.05)(B, S, Dm)), 'mem0': _w((lambda *s: torch.randn(*s, dtype=torch.bfloat16) * 1.6)(B, M, Dm)), 'Wq': _w((lambda *s: torch.randn(*s, dtype=torch.bfloat16) * 0.8)(Dm, H, Dh) * Dm ** (-0.5)), 'Wk': _w((lambda *s: torch.randn(*s, dtype=torch.bfloat16) * 0.8)(Dm, H, Dh) * Dm ** (-0.5)), 'Wv': _w((lambda *s: torch.randn(*s, dtype=torch.bfloat16) * 1.6)(Dm, H, Dh) * Dm ** (-0.5)), 'Wo': _w((lambda *s: torch.randn(*s, dtype=torch.bfloat16) * 1.6)(H, Dh, Dm) * (H * Dh) ** (-0.5)), 'seg_len': seg}
    _A_in = _A_setup()

    def _B_setup():
        B, S, D = (1, 2048, 640)
        return {'x': _w((lambda *s: torch.randn(*s, dtype=torch.bfloat16) * 0.2)(B, S, D)), 'wqkv': _w((lambda *s: torch.randn(*s, dtype=torch.bfloat16) * 0.2)(D, 3 * D)), 'wo': _w((lambda *s: torch.randn(*s, dtype=torch.bfloat16) * 0.05)(D, D))}
    _B_in = _B_setup()
    return {'A_x': _A_in['x'], 'A_mem0': _A_in['mem0'], 'A_Wq': _A_in['Wq'], 'A_Wk': _A_in['Wk'], 'A_Wv': _A_in['Wv'], 'A_Wo': _A_in['Wo'], 'A_seg_len': _A_in['seg_len'], 'B_x': _B_in['x'], 'B_wqkv': _B_in['wqkv'], 'B_wo': _B_in['wo']}

def reference(A_x, A_mem0, A_Wq, A_Wk, A_Wv, A_Wo, A_seg_len, B_x, B_wqkv, B_wo):

    def _A_ref(x, mem0, Wq, Wk, Wv, Wo, seg_len):
        B, S, Dm = x.shape
        H, Dh = (Wq.shape[1], Wq.shape[2])
        M = mem0.shape[1]
        scale = Dh ** (-0.5)
        n_seg = S // seg_len
        L = M + seg_len
        idx = torch.arange(L)
        mask = (idx[:, None] < M) | (idx[:, None] >= idx[None, :])
        mem = mem0
        outs = []
        for s in range(n_seg):
            xs = x[:, s * seg_len:(s + 1) * seg_len, :].clone()
            h = torch.concatenate([mem, xs], axis=1)
            q = torch.einsum('btd,dhe->bhte', h, Wq)
            k = torch.einsum('btd,dhe->bhte', h, Wk)
            v = torch.einsum('btd,dhe->bhte', h, Wv)
            scores = torch.einsum('bhqe,bhke->bhqk', q, k) * scale
            scores = torch.where(mask[None, None], scores, -1000000000.0)
            p = _softmax(scores, axis=-1)
            o = torch.einsum('bhqk,bhke->bhqe', p, v)
            o = torch.einsum('bhte,hed->btd', o, Wo)
            mem = o[:, :M, :].clone()
            outs.append(o[:, M:, :])
        return torch.concatenate(outs, axis=1)

    def _B_ref(x, wqkv, wo):
        B, S, D = x.shape
        H = 32
        Dh = D // H
        W = 256
        qkv = (lambda x, *d: x.permute(*d))((x @ wqkv).reshape(B, S, 3, H, Dh), 2, 0, 3, 1, 4)
        q, k, v = (qkv[0], qkv[1], qkv[2])
        scores = torch.einsum('bhqd,bhkd->bhqk', q, k) * Dh ** (-0.5)
        idx = torch.arange(S)
        mask = (idx[:, None] - idx[None, :] >= 0) & (idx[:, None] - idx[None, :] < W)
        scores = torch.where(mask[None, None], scores, -1000000000.0)
        p = _softmax(scores, axis=-1)
        o = torch.einsum('bhqk,bhkd->bhqd', p, v)
        return (lambda x, *d: x.permute(*d))(o, 0, 2, 1, 3).reshape(B, S, D) @ wo
    a = _A_ref(A_x, A_mem0, A_Wq, A_Wk, A_Wv, A_Wo, A_seg_len)
    b = _B_ref(B_x, B_wqkv, B_wo)
    return torch.concatenate([a, b], axis=-1)
```

```asm
; @launch grid=(256,1,1) block=(256,1,1) lds=163840
.amdgcn_target "amdgcn-amd-amdhsa--gfx950"
.text
.globl concat_heads__memory_aug_recurrent_mem_tr__sliding_block__prompt_kernel
.p2align 8
.type concat_heads__memory_aug_recurrent_mem_tr__sliding_block__prompt_kernel,@function
concat_heads__memory_aug_recurrent_mem_tr__sliding_block__prompt_kernel:
  s_cmp_ge_u32 s2, 256
  s_cbranch_scc1 L_exit
  s_load_dword s39, s[0:1], 0
  s_load_dwordx2 s[4:5], s[0:1], 96
  s_load_dwordx2 s[84:85], s[0:1], 88
  v_lshrrev_b32 v1, 6, v0
  s_nop 0
  v_readfirstlane_b32 s10, v1
  v_and_b32 v0, 63, v0
  s_mov_b32 s12, 65536
  s_getreg_b32 s38, hwreg(HW_REG_XCC_ID)
  s_and_b32 s38, s38, 7
  s_waitcnt lgkmcnt(0)
  s_mov_b32 s6, 268435456
  s_mov_b32 s7, 0x20000
  s_mov_b32 s86, 256
  s_mov_b32 s87, 0x20000
  s_lshl_b32 s3, s38, 5
  s_lshr_b32 s36, s2, 3
  s_add_u32 s3, s3, s36
L_dispatch:
  s_lshr_b32 s36, s3, 5
  s_cmp_eq_u32 s36, 5
  s_cbranch_scc1 L_chain
  s_cmp_eq_u32 s36, 7
  s_cbranch_scc1 L_chain
  s_branch L_worker
L_exit:
  s_endpgm
L_chain:
  s_cmp_eq_u32 s36, 7
  s_cselect_b32 s8, 1, 0
  s_and_b32 s9, s3, 31
  s_load_dwordx2 s[88:89], s[0:1], 16
  s_load_dwordx2 s[92:93], s[0:1], 24
  s_load_dwordx2 s[96:97], s[0:1], 32
  s_load_dwordx2 s[80:81], s[0:1], 40
  s_mov_b32 s11, 0
L_ct0:
  s_waitcnt lgkmcnt(0)
  s_mov_b32 s90, 5242880
  s_mov_b32 s91, 0x20000
  s_mov_b32 s94, 5242880
  s_mov_b32 s95, 0x20000
  s_mov_b32 s98, 5242880
  s_mov_b32 s99, 0x20000
  s_mov_b32 s82, 5242880
  s_mov_b32 s83, 0x20000
  s_cmp_eq_u32 s8, 1
  s_cbranch_scc1 L_load1
  v_mov_b32 v86, v0
  v_lshrrev_b32 v84, 5, v86
  v_bfe_u32 v85, v86, 4, 1
  v_lshl_add_u32 v84, v84, 3, v85
  v_lshlrev_b32 v84, 13, v84
  v_lshrrev_b32 v85, 3, v86
  v_and_b32 v85, 6, v85
  v_xor_b32 v85, v85, v86
  v_and_b32 v85, 15, v85
  v_lshl_add_u32 v64, v85, 4, v84
  v_xor_b32 v65, 128, v64
  s_mul_i32 s41, s10, 34816
  s_add_u32 s41, s41, 24576
  s_lshl_b32 s36, s9, 8
  s_lshl_b32 s37, s10, 17
  s_add_u32 s36, s36, s37
  s_mul_i32 s37, s8, 2621440
  s_add_u32 s67, s36, s37
  s_sub_u32 s37, 2621440, s37
  s_add_u32 s77, s36, s37
  s_add_u32 m0, s41, 20480
  s_add_u32 s36, s67, 0
  buffer_load_dwordx4 v64, s[88:91], s36 offen lds
  s_add_u32 m0, s41, 21504
  s_add_u32 s36, s67, 16384
  buffer_load_dwordx4 v64, s[88:91], s36 offen lds
  s_add_u32 m0, s41, 22528
  s_add_u32 s36, s67, 32768
  buffer_load_dwordx4 v65, s[88:91], s36 offen lds
  s_add_u32 m0, s41, 23552
  s_add_u32 s36, s67, 49152
  buffer_load_dwordx4 v65, s[88:91], s36 offen lds
  v_mov_b32 v61, 0
  s_bitcmp1_b32 s2, 31
  s_cbranch_scc1 L_cask_1
  s_cmp_lg_u32 s10, 0
  s_cbranch_scc1 L_cask_1
  s_lshr_b32 s38, s3, 5
  s_lshr_b32 s36, 160, s38
  s_and_b32 s36, s36, 1
  s_lshl_b32 s36, s36, 5
  s_add_u32 s38, s38, s36
  s_lshl_b32 s38, s38, 2
  s_and_b32 s37, s3, 31
  s_lshl_b32 s36, 1, s37
  v_mov_b32 v60, s36
  s_mov_b64 exec, 1
  buffer_atomic_or v60, v61, s[84:87], s38 offen sc0
  s_mov_b64 exec, -1
L_cask_1:
  s_add_u32 m0, s41, 24576
  s_add_u32 s36, s67, 0
  buffer_load_dwordx4 v64, s[92:95], s36 offen lds
  s_add_u32 m0, s41, 25600
  s_add_u32 s36, s67, 16384
  buffer_load_dwordx4 v64, s[92:95], s36 offen lds
  s_add_u32 m0, s41, 26624
  s_add_u32 s36, s67, 32768
  buffer_load_dwordx4 v65, s[92:95], s36 offen lds
  s_add_u32 m0, s41, 27648
  s_add_u32 s36, s67, 49152
  buffer_load_dwordx4 v65, s[92:95], s36 offen lds
  s_add_u32 m0, s41, 28672
  s_add_u32 s36, s67, 524288
  buffer_load_dwordx4 v64, s[88:91], s36 offen lds
  s_add_u32 m0, s41, 29696
  s_add_u32 s36, s67, 540672
  buffer_load_dwordx4 v64, s[88:91], s36 offen lds
  s_add_u32 m0, s41, 30720
  s_add_u32 s36, s67, 557056
  buffer_load_dwordx4 v65, s[88:91], s36 offen lds
  s_add_u32 m0, s41, 31744
  s_add_u32 s36, s67, 573440
  buffer_load_dwordx4 v65, s[88:91], s36 offen lds
  s_add_u32 m0, s41, 0
  s_add_u32 s36, s67, 524288
  buffer_load_dwordx4 v64, s[92:95], s36 offen lds
  s_add_u32 m0, s41, 1024
  s_add_u32 s36, s67, 540672
  buffer_load_dwordx4 v64, s[92:95], s36 offen lds
  s_add_u32 m0, s41, 2048
  s_add_u32 s36, s67, 557056
  buffer_load_dwordx4 v65, s[92:95], s36 offen lds
  s_add_u32 m0, s41, 3072
  s_add_u32 s36, s67, 573440
  buffer_load_dwordx4 v65, s[92:95], s36 offen lds
  s_add_u32 m0, s41, 4096
  s_add_u32 s36, s67, 1048576
  buffer_load_dwordx4 v64, s[88:91], s36 offen lds
  s_add_u32 m0, s41, 5120
  s_add_u32 s36, s67, 1064960
  buffer_load_dwordx4 v64, s[88:91], s36 offen lds
  s_add_u32 m0, s41, 6144
  s_add_u32 s36, s67, 1081344
  buffer_load_dwordx4 v65, s[88:91], s36 offen lds
  s_add_u32 m0, s41, 7168
  s_add_u32 s36, s67, 1097728
  buffer_load_dwordx4 v65, s[88:91], s36 offen lds
  s_add_u32 m0, s41, 8192
  s_add_u32 s36, s67, 1048576
  buffer_load_dwordx4 v64, s[92:95], s36 offen lds
  s_add_u32 m0, s41, 9216
  s_add_u32 s36, s67, 1064960
  buffer_load_dwordx4 v64, s[92:95], s36 offen lds
  s_add_u32 m0, s41, 10240
  s_add_u32 s36, s67, 1081344
  buffer_load_dwordx4 v65, s[92:95], s36 offen lds
  s_add_u32 m0, s41, 11264
  s_add_u32 s36, s67, 1097728
  buffer_load_dwordx4 v65, s[92:95], s36 offen lds
  s_add_u32 m0, s41, 12288
  s_add_u32 s36, s67, 1572864
  buffer_load_dwordx4 v64, s[88:91], s36 offen lds
  s_add_u32 m0, s41, 13312
  s_add_u32 s36, s67, 1589248
  buffer_load_dwordx4 v64, s[88:91], s36 offen lds
  s_add_u32 m0, s41, 14336
  s_add_u32 s36, s67, 1605632
  buffer_load_dwordx4 v65, s[88:91], s36 offen lds
  s_add_u32 m0, s41, 15360
  s_add_u32 s36, s67, 1622016
  buffer_load_dwordx4 v65, s[88:91], s36 offen lds
  s_add_u32 m0, s41, 16384
  s_add_u32 s36, s67, 1572864
  buffer_load_dwordx4 v64, s[92:95], s36 offen lds
  s_add_u32 m0, s41, 17408
  s_add_u32 s36, s67, 1589248
  buffer_load_dwordx4 v64, s[92:95], s36 offen lds
  s_add_u32 m0, s41, 18432
  s_add_u32 s36, s67, 1605632
  buffer_load_dwordx4 v65, s[92:95], s36 offen lds
  s_add_u32 m0, s41, 19456
  s_add_u32 s36, s67, 1622016
  buffer_load_dwordx4 v65, s[92:95], s36 offen lds
  s_bitcmp1_b32 s2, 31
  s_cbranch_scc1 L_cdone_2
  s_cmp_lg_u32 s10, 0
  s_cbranch_scc1 L_cwait_3
  s_lshr_b32 s38, s3, 5
  s_lshr_b32 s36, 160, s38
  s_and_b32 s36, s36, 1
  s_lshl_b32 s36, s36, 5
  s_add_u32 s38, s38, s36
  s_lshl_b32 s38, s38, 2
  s_and_b32 s37, s3, 31
  s_lshl_b32 s36, 1, s37
  s_mov_b64 exec, 1
  s_waitcnt vmcnt(28)
  s_branch L_cans_10
L_ctry_4:
  s_lshl_b32 s36, 1, s37
  v_mov_b32 v60, s36
  s_mov_b64 exec, 1
  buffer_atomic_or v60, v61, s[84:87], s38 offen sc0
  s_waitcnt vmcnt(0)
L_cans_10:
  v_readfirstlane_b32 s39, v60
  s_mov_b64 exec, -1
  s_and_b32 s36, s36, s39
  s_cbranch_scc0 L_cgot_5
  s_cmp_eq_u32 s39, -1
  s_cbranch_scc1 L_covf_6
  s_mul_i32 s37, s2, 37
  s_lshr_b32 s37, s37, 3
  s_and_b32 s37, s37, 31
  s_mov_b32 vcc_lo, s39
  s_mov_b32 vcc_hi, s39
  s_lshr_b64 vcc, vcc, s37
  s_ff0_i32_b32 s36, vcc_lo
  s_add_u32 s37, s37, s36
  s_and_b32 s37, s37, 31
  s_branch L_ctry_4
L_cgot_5:
  s_and_b32 s36, s3, 0xe0
  s_add_u32 s37, s37, s36
  s_branch L_chave_9
L_covf_6:
  v_mov_b32 v60, 1
  s_mov_b64 exec, 1
  buffer_atomic_add v60, v61, s[84:87], 36 offen sc0
  s_waitcnt vmcnt(0)
  v_readfirstlane_b32 s38, v60
  s_mov_b64 exec, -1
  v_lshlrev_b32 v61, 2, v0
L_clp_7:
  s_sub_u32 s12, s12, 1
  s_cbranch_scc1 L_abort
  buffer_load_dword v60, v61, s[84:87], 0 offen sc1
  s_waitcnt vmcnt(0)
  v_readlane_b32 s37, v60, 9
  v_readlane_b32 s36, v60, 0
  s_bcnt1_i32_b32 s36, s36
  s_add_u32 s37, s37, s36
  v_readlane_b32 s36, v60, 1
  s_bcnt1_i32_b32 s36, s36
  s_add_u32 s37, s37, s36
  v_readlane_b32 s36, v60, 2
  s_bcnt1_i32_b32 s36, s36
  s_add_u32 s37, s37, s36
  v_readlane_b32 s36, v60, 3
  s_bcnt1_i32_b32 s36, s36
  s_add_u32 s37, s37, s36
  v_readlane_b32 s36, v60, 4
  s_bcnt1_i32_b32 s36, s36
  s_add_u32 s37, s37, s36
  v_readlane_b32 s36, v60, 37
  s_bcnt1_i32_b32 s36, s36
  s_add_u32 s37, s37, s36
  v_readlane_b32 s36, v60, 6
  s_bcnt1_i32_b32 s36, s36
  s_add_u32 s37, s37, s36
  v_readlane_b32 s36, v60, 39
  s_bcnt1_i32_b32 s36, s36
  s_add_u32 s37, s37, s36
  s_cmp_lt_u32 s37, 256
  s_cbranch_scc1 L_clp_7
  v_readlane_b32 s39, v60, 0
  s_mov_b32 s37, 0
  s_bcnt0_i32_b32 s36, s39
  s_cmp_lt_u32 s38, s36
  s_cbranch_scc1 L_csel_8
  s_sub_u32 s38, s38, s36
  v_readlane_b32 s39, v60, 1
  s_mov_b32 s37, 32
  s_bcnt0_i32_b32 s36, s39
  s_cmp_lt_u32 s38, s36
  s_cbranch_scc1 L_csel_8
  s_sub_u32 s38, s38, s36
  v_readlane_b32 s39, v60, 2
  s_mov_b32 s37, 64
  s_bcnt0_i32_b32 s36, s39
  s_cmp_lt_u32 s38, s36
  s_cbranch_scc1 L_csel_8
  s_sub_u32 s38, s38, s36
  v_readlane_b32 s39, v60, 3
  s_mov_b32 s37, 96
  s_bcnt0_i32_b32 s36, s39
  s_cmp_lt_u32 s38, s36
  s_cbranch_scc1 L_csel_8
  s_sub_u32 s38, s38, s36
  v_readlane_b32 s39, v60, 4
  s_mov_b32 s37, 128
  s_bcnt0_i32_b32 s36, s39
  s_cmp_lt_u32 s38, s36
  s_cbranch_scc1 L_csel_8
  s_sub_u32 s38, s38, s36
  v_readlane_b32 s39, v60, 37
  s_mov_b32 s37, 160
  s_bcnt0_i32_b32 s36, s39
  s_cmp_lt_u32 s38, s36
  s_cbranch_scc1 L_csel_8
  s_sub_u32 s38, s38, s36
  v_readlane_b32 s39, v60, 6
  s_mov_b32 s37, 192
  s_bcnt0_i32_b32 s36, s39
  s_cmp_lt_u32 s38, s36
  s_cbranch_scc1 L_csel_8
  s_sub_u32 s38, s38, s36
  v_readlane_b32 s39, v60, 39
  s_mov_b32 s37, 224
  s_bcnt0_i32_b32 s36, s39
  s_cmp_lt_u32 s38, s36
  s_cbranch_scc1 L_csel_8
  s_sub_u32 s38, s38, s36
  s_branch L_abort
L_csel_8:
  s_ff0_i32_b32 s36, s39
  s_bitset1_b32 s39, s36
  s_sub_u32 s38, s38, 1
  s_cbranch_scc0 L_csel_8
  s_add_u32 s37, s37, s36
L_chave_9:
  v_mov_b32 v60, s37
  v_mov_b32 v61, 22912
  ds_write_b32 v61, v60
  s_waitcnt lgkmcnt(0)
L_cwait_3:
  s_barrier
  v_mov_b32 v61, 22912
  ds_read_b32 v60, v61
  s_waitcnt lgkmcnt(0)
  v_readfirstlane_b32 s36, v60
  s_bitset1_b32 s2, 31
  s_and_b32 s36, s36, 255
  s_cmp_eq_u32 s36, s3
  s_cbranch_scc1 L_cdone_2
  s_mov_b32 s3, s36
  s_waitcnt vmcnt(0)
  s_barrier
  s_branch L_dispatch
L_cdone_2:
  v_bfe_u32 v84, v86, 3, 1
  v_lshrrev_b32 v85, 5, v86
  v_lshl_add_u32 v84, v85, 1, v84
  v_bfe_u32 v85, v86, 4, 1
  v_lshl_add_u32 v84, v85, 5, v84
  v_mul_u32_u24 v84, 1280, v84
  v_lshlrev_b32 v85, 1, v85
  v_xor_b32 v85, v85, v86
  v_and_b32 v85, 7, v85
  v_lshl_add_u32 v66, v85, 4, v84
  v_xor_b32 v67, 64, v66
  s_mul_i32 s36, s9, 163840
  s_mul_i32 s37, s8, 640
  s_add_u32 s36, s36, s37
  s_lshr_b32 s37, s10, 1
  s_mul_i32 s37, s37, 81920
  s_add_u32 s36, s36, s37
  s_and_b32 s37, s10, 1
  s_mul_i32 s37, s37, 10240
  s_add_u32 s40, s36, s37
  v_bfe_u32 v87, v86, 2, 3
  v_lshrrev_b32 v84, 5, v86
  v_mul_u32_u24 v84, 34816, v84
  v_bfe_u32 v85, v86, 2, 2
  v_lshl_add_u32 v84, v85, 8, v84
  v_bfe_u32 v85, v86, 4, 1
  v_lshl_add_u32 v84, v85, 11, v84
  v_and_b32 v85, 3, v86
  v_lshl_add_u32 v84, v85, 3, v84
  s_lshl_b32 s36, s10, 1
  v_xor_b32 v85, s36, v87
  v_lshl_add_u32 v84, v85, 5, v84
  v_add_u32 v68, 24576, v84
  v_add_u32 v69, 94208, v84
  v_xor_b32 v70, 32, v68
  v_xor_b32 v71, 32, v69
  v_lshrrev_b32 v84, 4, v86
  v_lshlrev_b32 v84, 10, v84
  v_bfe_u32 v85, v86, 2, 2
  v_lshl_add_u32 v84, v85, 7, v84
  v_and_b32 v85, 3, v86
  v_lshl_add_u32 v84, v85, 3, v84
  v_bfe_u32 v85, v86, 3, 2
  v_xor_b32 v85, s10, v85
  v_lshl_add_u32 v84, v85, 5, v84
  v_add_u32 v72, 24576, v84
  v_add_u32 v73, 59392, v84
  v_add_u32 v74, 94208, v84
  v_add_u32 v75, 129024, v84
  v_lshrrev_b32 v20, 4, v0
  v_and_b32 v21, 15, v0
  v_and_b32 v22, 2, v21
  v_cmp_ne_u32 vcc, 0, v22
  v_mov_b32 v23, 0x44444444
  v_mov_b32 v24, 0xeeeeeeee
  v_cndmask_b32 v1, v23, v24, vcc
  s_lshl_b32 s36, s10, 6
  s_add_u32 s36, s36, 18560
  v_mul_u32_u24 v22, 1088, v20
  v_lshl_add_u32 v22, v21, 2, v22
  v_add_u32 v2, s36, v22
  s_lshl_b32 s36, s10, 9
  s_add_u32 s36, s36, 5120
  v_lshlrev_b32 v22, 2, v20
  v_lshl_add_u32 v22, v21, 4, v22
  v_add_u32 v11, s36, v22
  v_and_b32 v22, 7, v21
  v_mul_u32_u24 v22, 544, v22
  v_lshlrev_b32 v23, 1, v21
  v_xor_b32 v23, v23, v21
  v_and_b32 v23, 8, v23
  v_lshl_add_u32 v22, v23, 4, v22
  v_lshl_add_u32 v22, v20, 4, v22
  v_add_u32 v3, 18560, v22
  v_lshrrev_b32 v24, 2, v21
  v_lshlrev_b32 v24, 1, v24
  v_and_b32 v23, 1, v21
  v_or_b32 v24, v24, v23
  v_and_b32 v23, 2, v21
  v_mul_u32_u24 v22, 544, v24
  v_lshl_add_u32 v22, v23, 6, v22
  v_lshl_add_u32 v22, v20, 4, v22
  v_add_u32 v4, 18816, v22
  v_mul_u32_u24 v22, 2112, v23
  v_lshl_add_u32 v22, v20, 9, v22
  v_lshl_add_u32 v8, v24, 4, v22
  s_and_b32 s36, s10, 1
  s_lshl_b32 s36, s36, 6
  v_add_u32 v24, s36, v0
  v_and_b32 v22, 7, v24
  v_mul_u32_u24 v22, 544, v22
  v_lshrrev_b32 v23, 3, v24
  v_lshl_add_u32 v22, v23, 4, v22
  v_add_u32 v22, 18816, v22
  v_lshlrev_b32 v23, 4, v24
  v_add_u32 v23, 5120, v23
  s_cmp_eq_u32 s8, 0
  s_cselect_b64 vcc, -1, 0
  v_cndmask_b32 v10, v23, v22, vcc
  s_lshr_b32 s36, s10, 1
  s_lshl_b32 s36, s36, 10
  s_and_b32 s37, s10, 1
  s_lshl_b32 s37, s37, 5
  s_add_u32 s36, s36, s37
  s_add_u32 s36, s36, 0
  v_and_b32 v22, 6, v21
  v_lshlrev_b32 v22, 5, v22
  v_and_b32 v23, 1, v21
  v_lshl_add_u32 v22, v23, 4, v22
  v_lshl_add_u32 v22, v20, 8, v22
  v_lshlrev_b32 v23, 1, v21
  v_xor_b32 v23, v23, v21
  v_and_b32 v23, 8, v23
  v_xor_b32 v23, 8, v23
  v_add_u32 v22, v22, v23
  v_add_u32 v5, s36, v22
  v_lshlrev_b32 v22, 11, v20
  v_lshl_add_u32 v6, v21, 2, v22
  v_and_b32 v22, 2, v21
  v_lshlrev_b32 v22, 4, v22
  v_lshl_add_u32 v22, v20, 4, v22
  v_and_b32 v23, 1, v21
  v_lshl_add_u32 v22, v23, 3, v22
  v_and_b32 v23, 44, v0
  v_cmp_eq_u32 vcc, 0, v23
  v_mov_b32 v23, 0x40000000
  s_nop 0
  v_cndmask_b32 v7, v23, v22, vcc
  v_and_b32 v22, 1, v20
  v_lshlrev_b32 v22, 10, v22
  v_and_b32 v23, 2, v20
  v_lshl_add_u32 v22, v23, 8, v22
  v_lshl_add_u32 v22, v21, 4, v22
  s_lshl_b32 s36, s10, 11
  s_add_u32 s36, s36, 16384
  v_add_u32 v9, s36, v22
  s_lshr_b32 s36, s10, 1
  s_lshl_b32 s36, s36, 14
  s_and_b32 s37, s10, 1
  s_lshl_b32 s37, s37, 12
  s_add_u32 s56, s36, s37
  s_mov_b32 s28, 0x11111111
  s_mov_b32 s29, 0x11111111
  s_mov_b32 s30, 0x22222222
  s_mov_b32 s31, 0x22222222
  s_mov_b32 s32, 0x44444444
  s_mov_b32 s33, 0x44444444
  s_mov_b32 s34, 0x88888888
  s_mov_b32 s35, 0x88888888
  v_lshlrev_b32 v0, 4, v0
  s_mul_i32 s36, s10, 34816
  s_add_u32 s36, s36, 24576
  v_add_u32 v12, s36, v0
  s_mov_b32 s26, 0xf00ff00f
  s_mov_b32 s27, 0xf00ff00f
  s_mov_b32 s24, 0x3e0293ee
  s_mov_b32 s25, 0x7f817f81
  s_mov_b32 s68, 0x7f817f81
  s_mov_b32 s69, 0x7f817f81
  s_mov_b32 s59, 0x3f80
  s_mov_b32 s58, 0x2b800000
  s_mov_b32 s62, 0x28000000
  s_lshl_b32 s38, s9, 1
  s_add_u32 s38, s38, s10
  s_add_u32 s38, s38, 16
  s_cmp_lt_u32 s10, 2
  s_cselect_b32 s61, s38, s9
  s_cselect_b32 s23, 1, 0
  s_lshl_b32 s36, s10, 5
  s_add_u32 s36, s36, s9
  s_cmp_lt_u32 s36, 80
  s_cselect_b32 s23, 1, 0
  s_cselect_b32 s60, 0, 0x80000000
  s_mul_i32 s36, s8, 327680
  s_add_u32 s36, s36, 60817408
  s_lshl_b32 s37, s61, 11
  s_add_u32 s15, s36, s37
  s_mov_b32 s52, 0x80000000
  s_mov_b32 s63, 0x80000000
  s_mov_b32 s64, 0
  s_mov_b32 s65, 0
  s_mov_b32 s66, 0
  s_mov_b32 s54, 0x80000000
  s_lshl_b32 s37, s9, 6
  s_add_u32 s36, s36, s37
  s_lshl_b32 s37, s10, 13
  s_add_u32 s13, s36, s37
  s_lshl_b32 s36, s61, 6
  v_add_u32 v7, s36, v7
  s_lshl_b32 s36, s8, 15
  s_add_u32 s42, s36, 61865984
  s_lshl_b32 s36, s9, 15
  s_add_u32 s21, s36, 134217728
  s_and_b32 s36, s9, 3
  s_lshl_b32 s36, s36, 11
  s_lshl_b32 s37, s10, 10
  s_add_u32 s36, s36, s37
  s_lshr_b32 s37, s9, 2
  s_lshl_b32 s37, s37, 14
  s_add_u32 s36, s36, s37
  s_lshl_b32 s37, s8, 17
  s_add_u32 s36, s36, s37
  s_add_u32 s22, s36, 201064448
  s_cmp_lt_u32 s10, 2
  s_cselect_b32 s22, s22, 0x80000000
  s_cselect_b32 s74, 262144, 0
  s_cselect_b32 s51, 8192, 0
  s_cselect_b64 s[70:71], -1, 1
  s_lshl_b32 s36, s9, 1
  s_add_u32 s36, s36, s8
  s_lshl_b32 s36, s36, 7
  s_add_u32 s36, s36, 218120192
  s_cmp_eq_u32 s10, 2
  s_cselect_b32 s22, s36, s22
  s_cselect_b64 s[72:73], 1, 0
  s_lshl_b32 s36, s9, 7
  s_add_u32 s76, s36, 218103808
  s_mov_b32 s75, 0
  s_mov_b32 s43, 163840
  s_mov_b32 s17, s42
  s_lshl_b32 s55, s10, 11
  s_waitcnt vmcnt(28)
  s_barrier
  ds_read_b64_tr_b16 v[88:89], v68 offset:20480
  ds_read_b64_tr_b16 v[90:91], v68 offset:21504
  ds_read_b64_tr_b16 v[92:93], v69 offset:20480
  ds_read_b64_tr_b16 v[94:95], v69 offset:21504
  ds_read_b64_tr_b16 v[168:169], v70 offset:20480
  ds_read_b64_tr_b16 v[170:171], v70 offset:21504
  ds_read_b64_tr_b16 v[172:173], v71 offset:20480
  ds_read_b64_tr_b16 v[174:175], v71 offset:21504
  s_waitcnt lgkmcnt(0)
  s_waitcnt vmcnt(24)
  s_barrier
  s_add_u32 m0, s41, 20480
  s_add_u32 s36, s67, 2097152
  buffer_load_dwordx4 v64, s[88:91], s36 offen lds
  s_add_u32 m0, s41, 21504
  s_add_u32 s36, s67, 2113536
  buffer_load_dwordx4 v64, s[88:91], s36 offen lds
  s_add_u32 m0, s41, 22528
  s_add_u32 s36, s67, 2129920
  buffer_load_dwordx4 v65, s[88:91], s36 offen lds
  s_add_u32 m0, s41, 23552
  s_add_u32 s36, s67, 2146304
  buffer_load_dwordx4 v65, s[88:91], s36 offen lds
  ds_read_b64_tr_b16 v[248:249], v68 offset:24576
  ds_read_b64_tr_b16 v[250:251], v68 offset:25600
  ds_read_b64_tr_b16 v[252:253], v69 offset:24576
  ds_read_b64_tr_b16 v[254:255], v69 offset:25600
  ds_read_b64_tr_b16 a[72:73], v70 offset:24576
  ds_read_b64_tr_b16 a[74:75], v70 offset:25600
  ds_read_b64_tr_b16 a[76:77], v71 offset:24576
  ds_read_b64_tr_b16 a[78:79], v71 offset:25600
  s_waitcnt lgkmcnt(0)
  s_waitcnt vmcnt(24)
  s_barrier
  s_add_u32 m0, s41, 24576
  s_add_u32 s36, s67, 2097152
  buffer_load_dwordx4 v64, s[92:95], s36 offen lds
  s_add_u32 m0, s41, 25600
  s_add_u32 s36, s67, 2113536
  buffer_load_dwordx4 v64, s[92:95], s36 offen lds
  s_add_u32 m0, s41, 26624
  s_add_u32 s36, s67, 2129920
  buffer_load_dwordx4 v65, s[92:95], s36 offen lds
  s_add_u32 m0, s41, 27648
  s_add_u32 s36, s67, 2146304
  buffer_load_dwordx4 v65, s[92:95], s36 offen lds
  ds_read_b64_tr_b16 v[96:97], v68 offset:28672
  ds_read_b64_tr_b16 v[98:99], v68 offset:29696
  ds_read_b64_tr_b16 v[100:101], v69 offset:28672
  ds_read_b64_tr_b16 v[102:103], v69 offset:29696
  ds_read_b64_tr_b16 v[176:177], v70 offset:28672
  ds_read_b64_tr_b16 v[178:179], v70 offset:29696
  ds_read_b64_tr_b16 v[180:181], v71 offset:28672
  ds_read_b64_tr_b16 v[182:183], v71 offset:29696
  s_waitcnt lgkmcnt(0)
  s_waitcnt vmcnt(24)
  s_barrier
  s_add_u32 m0, s41, 28672
  s_add_u32 s36, s67, 2097152
  buffer_load_dwordx4 v64, s[96:99], s36 offen lds
  s_add_u32 m0, s41, 29696
  s_add_u32 s36, s67, 2113536
  buffer_load_dwordx4 v64, s[96:99], s36 offen lds
  s_add_u32 m0, s41, 30720
  s_add_u32 s36, s67, 2129920
  buffer_load_dwordx4 v65, s[96:99], s36 offen lds
  s_add_u32 m0, s41, 31744
  s_add_u32 s36, s67, 2146304
  buffer_load_dwordx4 v65, s[96:99], s36 offen lds
  ds_read_b64_tr_b16 a[0:1], v68 offset:0
  ds_read_b64_tr_b16 a[2:3], v68 offset:1024
  ds_read_b64_tr_b16 a[4:5], v69 offset:0
  ds_read_b64_tr_b16 a[6:7], v69 offset:1024
  ds_read_b64_tr_b16 a[80:81], v70 offset:0
  ds_read_b64_tr_b16 a[82:83], v70 offset:1024
  ds_read_b64_tr_b16 a[84:85], v71 offset:0
  ds_read_b64_tr_b16 a[86:87], v71 offset:1024
  s_waitcnt lgkmcnt(0)
  s_waitcnt vmcnt(24)
  s_barrier
  s_add_u32 m0, s41, 0
  s_add_u32 s36, s77, 0
  buffer_load_dwordx4 v64, s[88:91], s36 offen lds
  s_add_u32 m0, s41, 1024
  s_add_u32 s36, s77, 16384
  buffer_load_dwordx4 v64, s[88:91], s36 offen lds
  s_add_u32 m0, s41, 2048
  s_add_u32 s36, s77, 32768
  buffer_load_dwordx4 v65, s[88:91], s36 offen lds
  s_add_u32 m0, s41, 3072
  s_add_u32 s36, s77, 49152
  buffer_load_dwordx4 v65, s[88:91], s36 offen lds
  ds_read_b64_tr_b16 v[104:105], v68 offset:4096
  ds_read_b64_tr_b16 v[106:107], v68 offset:5120
  ds_read_b64_tr_b16 v[108:109], v69 offset:4096
  ds_read_b64_tr_b16 v[110:111], v69 offset:5120
  ds_read_b64_tr_b16 v[184:185], v70 offset:4096
  ds_read_b64_tr_b16 v[186:187], v70 offset:5120
  ds_read_b64_tr_b16 v[188:189], v71 offset:4096
  ds_read_b64_tr_b16 v[190:191], v71 offset:5120
  s_waitcnt lgkmcnt(0)
  s_waitcnt vmcnt(24)
  s_barrier
  s_add_u32 m0, s41, 4096
  s_add_u32 s36, s77, 0
  buffer_load_dwordx4 v64, s[92:95], s36 offen lds
  s_add_u32 m0, s41, 5120
  s_add_u32 s36, s77, 16384
  buffer_load_dwordx4 v64, s[92:95], s36 offen lds
  s_add_u32 m0, s41, 6144
  s_add_u32 s36, s77, 32768
  buffer_load_dwordx4 v65, s[92:95], s36 offen lds
  s_add_u32 m0, s41, 7168
  s_add_u32 s36, s77, 49152
  buffer_load_dwordx4 v65, s[92:95], s36 offen lds
  ds_read_b64_tr_b16 a[8:9], v68 offset:8192
  ds_read_b64_tr_b16 a[10:11], v68 offset:9216
  ds_read_b64_tr_b16 a[12:13], v69 offset:8192
  ds_read_b64_tr_b16 a[14:15], v69 offset:9216
  ds_read_b64_tr_b16 a[88:89], v70 offset:8192
  ds_read_b64_tr_b16 a[90:91], v70 offset:9216
  ds_read_b64_tr_b16 a[92:93], v71 offset:8192
  ds_read_b64_tr_b16 a[94:95], v71 offset:9216
  s_waitcnt lgkmcnt(0)
  s_waitcnt vmcnt(24)
  s_barrier
  s_add_u32 m0, s41, 8192
  s_add_u32 s36, s77, 0
  buffer_load_dwordx4 v64, s[96:99], s36 offen lds
  s_add_u32 m0, s41, 9216
  s_add_u32 s36, s77, 16384
  buffer_load_dwordx4 v64, s[96:99], s36 offen lds
  s_add_u32 m0, s41, 10240
  s_add_u32 s36, s77, 32768
  buffer_load_dwordx4 v65, s[96:99], s36 offen lds
  s_add_u32 m0, s41, 11264
  s_add_u32 s36, s77, 49152
  buffer_load_dwordx4 v65, s[96:99], s36 offen lds
  ds_read_b64_tr_b16 v[112:113], v68 offset:12288
  ds_read_b64_tr_b16 v[114:115], v68 offset:13312
  ds_read_b64_tr_b16 v[116:117], v69 offset:12288
  ds_read_b64_tr_b16 v[118:119], v69 offset:13312
  ds_read_b64_tr_b16 v[192:193], v70 offset:12288
  ds_read_b64_tr_b16 v[194:195], v70 offset:13312
  ds_read_b64_tr_b16 v[196:197], v71 offset:12288
  ds_read_b64_tr_b16 v[198:199], v71 offset:13312
  s_waitcnt lgkmcnt(0)
  s_waitcnt vmcnt(24)
  s_barrier
  s_add_u32 m0, s41, 12288
  s_add_u32 s36, s77, 524288
  buffer_load_dwordx4 v64, s[88:91], s36 offen lds
  s_add_u32 m0, s41, 13312
  s_add_u32 s36, s77, 540672
  buffer_load_dwordx4 v64, s[88:91], s36 offen lds
  s_add_u32 m0, s41, 14336
  s_add_u32 s36, s77, 557056
  buffer_load_dwordx4 v65, s[88:91], s36 offen lds
  s_add_u32 m0, s41, 15360
  s_add_u32 s36, s77, 573440
  buffer_load_dwordx4 v65, s[88:91], s36 offen lds
  ds_read_b64_tr_b16 a[16:17], v68 offset:16384
  ds_read_b64_tr_b16 a[18:19], v68 offset:17408
  ds_read_b64_tr_b16 a[20:21], v69 offset:16384
  ds_read_b64_tr_b16 a[22:23], v69 offset:17408
  ds_read_b64_tr_b16 a[96:97], v70 offset:16384
  ds_read_b64_tr_b16 a[98:99], v70 offset:17408
  ds_read_b64_tr_b16 a[100:101], v71 offset:16384
  ds_read_b64_tr_b16 a[102:103], v71 offset:17408
  s_waitcnt lgkmcnt(0)
  s_waitcnt vmcnt(24)
  s_barrier
  s_add_u32 m0, s41, 16384
  s_add_u32 s36, s77, 524288
  buffer_load_dwordx4 v64, s[92:95], s36 offen lds
  s_add_u32 m0, s41, 17408
  s_add_u32 s36, s77, 540672
  buffer_load_dwordx4 v64, s[92:95], s36 offen lds
  s_add_u32 m0, s41, 18432
  s_add_u32 s36, s77, 557056
  buffer_load_dwordx4 v65, s[92:95], s36 offen lds
  s_add_u32 m0, s41, 19456
  s_add_u32 s36, s77, 573440
  buffer_load_dwordx4 v65, s[92:95], s36 offen lds
  ds_read_b64_tr_b16 v[120:121], v68 offset:20480
  ds_read_b64_tr_b16 v[122:123], v68 offset:21504
  ds_read_b64_tr_b16 v[124:125], v69 offset:20480
  ds_read_b64_tr_b16 v[126:127], v69 offset:21504
  ds_read_b64_tr_b16 v[200:201], v70 offset:20480
  ds_read_b64_tr_b16 v[202:203], v70 offset:21504
  ds_read_b64_tr_b16 v[204:205], v71 offset:20480
  ds_read_b64_tr_b16 v[206:207], v71 offset:21504
  s_waitcnt lgkmcnt(0)
  s_waitcnt vmcnt(24)
  s_barrier
  s_add_u32 m0, s41, 20480
  s_add_u32 s36, s77, 524288
  buffer_load_dwordx4 v64, s[96:99], s36 offen lds
  s_add_u32 m0, s41, 21504
  s_add_u32 s36, s77, 540672
  buffer_load_dwordx4 v64, s[96:99], s36 offen lds
  s_add_u32 m0, s41, 22528
  s_add_u32 s36, s77, 557056
  buffer_load_dwordx4 v65, s[96:99], s36 offen lds
  s_add_u32 m0, s41, 23552
  s_add_u32 s36, s77, 573440
  buffer_load_dwordx4 v65, s[96:99], s36 offen lds
  ds_read_b64_tr_b16 a[24:25], v68 offset:24576
  ds_read_b64_tr_b16 a[26:27], v68 offset:25600
  ds_read_b64_tr_b16 a[28:29], v69 offset:24576
  ds_read_b64_tr_b16 a[30:31], v69 offset:25600
  ds_read_b64_tr_b16 a[104:105], v70 offset:24576
  ds_read_b64_tr_b16 a[106:107], v70 offset:25600
  ds_read_b64_tr_b16 a[108:109], v71 offset:24576
  ds_read_b64_tr_b16 a[110:111], v71 offset:25600
  s_waitcnt lgkmcnt(0)
  s_waitcnt vmcnt(24)
  s_barrier
  s_add_u32 m0, s41, 24576
  s_add_u32 s36, s77, 1048576
  buffer_load_dwordx4 v64, s[88:91], s36 offen lds
  s_add_u32 m0, s41, 25600
  s_add_u32 s36, s77, 1064960
  buffer_load_dwordx4 v64, s[88:91], s36 offen lds
  s_add_u32 m0, s41, 26624
  s_add_u32 s36, s77, 1081344
  buffer_load_dwordx4 v65, s[88:91], s36 offen lds
  s_add_u32 m0, s41, 27648
  s_add_u32 s36, s77, 1097728
  buffer_load_dwordx4 v65, s[88:91], s36 offen lds
  ds_read_b64_tr_b16 v[16:17], v68 offset:28672
  ds_read_b64_tr_b16 v[18:19], v68 offset:29696
  ds_read_b64_tr_b16 v[20:21], v69 offset:28672
  ds_read_b64_tr_b16 v[22:23], v69 offset:29696
  ds_read_b64_tr_b16 a[192:193], v70 offset:28672
  ds_read_b64_tr_b16 a[194:195], v70 offset:29696
  ds_read_b64_tr_b16 a[196:197], v71 offset:28672
  ds_read_b64_tr_b16 a[198:199], v71 offset:29696
  s_waitcnt lgkmcnt(0)
  s_waitcnt vmcnt(24)
  s_barrier
  ds_write_b128 v12, v[16:19] offset:32768
  ds_write_b128 v12, v[20:23] offset:33792
  s_add_u32 m0, s41, 28672
  s_add_u32 s36, s77, 1048576
  buffer_load_dwordx4 v64, s[92:95], s36 offen lds
  s_add_u32 m0, s41, 29696
  s_add_u32 s36, s77, 1064960
  buffer_load_dwordx4 v64, s[92:95], s36 offen lds
  s_add_u32 m0, s41, 30720
  s_add_u32 s36, s77, 1081344
  buffer_load_dwordx4 v65, s[92:95], s36 offen lds
  s_add_u32 m0, s41, 31744
  s_add_u32 s36, s77, 1097728
  buffer_load_dwordx4 v65, s[92:95], s36 offen lds
  ds_read_b64_tr_b16 v[128:129], v68 offset:0
  ds_read_b64_tr_b16 v[130:131], v68 offset:1024
  ds_read_b64_tr_b16 v[132:133], v69 offset:0
  ds_read_b64_tr_b16 v[134:135], v69 offset:1024
  ds_read_b64_tr_b16 v[208:209], v70 offset:0
  ds_read_b64_tr_b16 v[210:211], v70 offset:1024
  ds_read_b64_tr_b16 v[212:213], v71 offset:0
  ds_read_b64_tr_b16 v[214:215], v71 offset:1024
  s_waitcnt lgkmcnt(0)
  s_waitcnt vmcnt(24)
  s_barrier
  s_add_u32 m0, s41, 0
  s_add_u32 s36, s77, 1048576
  buffer_load_dwordx4 v64, s[96:99], s36 offen lds
  s_add_u32 m0, s41, 1024
  s_add_u32 s36, s77, 1064960
  buffer_load_dwordx4 v64, s[96:99], s36 offen lds
  s_add_u32 m0, s41, 2048
  s_add_u32 s36, s77, 1081344
  buffer_load_dwordx4 v65, s[96:99], s36 offen lds
  s_add_u32 m0, s41, 3072
  s_add_u32 s36, s77, 1097728
  buffer_load_dwordx4 v65, s[96:99], s36 offen lds
  ds_read_b64_tr_b16 a[32:33], v68 offset:4096
  ds_read_b64_tr_b16 a[34:35], v68 offset:5120
  ds_read_b64_tr_b16 a[36:37], v69 offset:4096
  ds_read_b64_tr_b16 a[38:39], v69 offset:5120
  ds_read_b64_tr_b16 a[112:113], v70 offset:4096
  ds_read_b64_tr_b16 a[114:115], v70 offset:5120
  ds_read_b64_tr_b16 a[116:117], v71 offset:4096
  ds_read_b64_tr_b16 a[118:119], v71 offset:5120
  s_waitcnt lgkmcnt(0)
  s_waitcnt vmcnt(24)
  s_barrier
  s_add_u32 m0, s41, 4096
  s_add_u32 s36, s77, 1572864
  buffer_load_dwordx4 v64, s[88:91], s36 offen lds
  s_add_u32 m0, s41, 5120
  s_add_u32 s36, s77, 1589248
  buffer_load_dwordx4 v64, s[88:91], s36 offen lds
  s_add_u32 m0, s41, 6144
  s_add_u32 s36, s77, 1605632
  buffer_load_dwordx4 v65, s[88:91], s36 offen lds
  s_add_u32 m0, s41, 7168
  s_add_u32 s36, s77, 1622016
  buffer_load_dwordx4 v65, s[88:91], s36 offen lds
  ds_read_b64_tr_b16 a[152:153], v68 offset:8192
  ds_read_b64_tr_b16 a[154:155], v68 offset:9216
  ds_read_b64_tr_b16 a[156:157], v69 offset:8192
  ds_read_b64_tr_b16 a[158:159], v69 offset:9216
  ds_read_b64_tr_b16 a[200:201], v70 offset:8192
  ds_read_b64_tr_b16 a[202:203], v70 offset:9216
  ds_read_b64_tr_b16 a[204:205], v71 offset:8192
  ds_read_b64_tr_b16 a[206:207], v71 offset:9216
  s_waitcnt lgkmcnt(0)
  s_waitcnt vmcnt(24)
  s_barrier
  s_add_u32 m0, s41, 8192
  s_add_u32 s36, s77, 1572864
  buffer_load_dwordx4 v64, s[92:95], s36 offen lds
  s_add_u32 m0, s41, 9216
  s_add_u32 s36, s77, 1589248
  buffer_load_dwordx4 v64, s[92:95], s36 offen lds
  s_add_u32 m0, s41, 10240
  s_add_u32 s36, s77, 1605632
  buffer_load_dwordx4 v65, s[92:95], s36 offen lds
  s_add_u32 m0, s41, 11264
  s_add_u32 s36, s77, 1622016
  buffer_load_dwordx4 v65, s[92:95], s36 offen lds
  ds_read_b64_tr_b16 v[136:137], v68 offset:12288
  ds_read_b64_tr_b16 v[138:139], v68 offset:13312
  ds_read_b64_tr_b16 v[140:141], v69 offset:12288
  ds_read_b64_tr_b16 v[142:143], v69 offset:13312
  ds_read_b64_tr_b16 v[216:217], v70 offset:12288
  ds_read_b64_tr_b16 v[218:219], v70 offset:13312
  ds_read_b64_tr_b16 v[220:221], v71 offset:12288
  ds_read_b64_tr_b16 v[222:223], v71 offset:13312
  s_waitcnt lgkmcnt(0)
  s_waitcnt vmcnt(24)
  s_barrier
  s_add_u32 m0, s41, 12288
  s_add_u32 s36, s77, 1572864
  buffer_load_dwordx4 v64, s[96:99], s36 offen lds
  s_add_u32 m0, s41, 13312
  s_add_u32 s36, s77, 1589248
  buffer_load_dwordx4 v64, s[96:99], s36 offen lds
  s_add_u32 m0, s41, 14336
  s_add_u32 s36, s77, 1605632
  buffer_load_dwordx4 v65, s[96:99], s36 offen lds
  s_add_u32 m0, s41, 15360
  s_add_u32 s36, s77, 1622016
  buffer_load_dwordx4 v65, s[96:99], s36 offen lds
  ds_read_b64_tr_b16 a[40:41], v68 offset:16384
  ds_read_b64_tr_b16 a[42:43], v68 offset:17408
  ds_read_b64_tr_b16 a[44:45], v69 offset:16384
  ds_read_b64_tr_b16 a[46:47], v69 offset:17408
  ds_read_b64_tr_b16 a[120:121], v70 offset:16384
  ds_read_b64_tr_b16 a[122:123], v70 offset:17408
  ds_read_b64_tr_b16 a[124:125], v71 offset:16384
  ds_read_b64_tr_b16 a[126:127], v71 offset:17408
  s_waitcnt lgkmcnt(0)
  s_waitcnt vmcnt(24)
  s_barrier
  s_add_u32 m0, s41, 16384
  s_add_u32 s36, s77, 2097152
  buffer_load_dwordx4 v64, s[88:91], s36 offen lds
  s_add_u32 m0, s41, 17408
  s_add_u32 s36, s77, 2113536
  buffer_load_dwordx4 v64, s[88:91], s36 offen lds
  s_add_u32 m0, s41, 18432
  s_add_u32 s36, s77, 2129920
  buffer_load_dwordx4 v65, s[88:91], s36 offen lds
  s_add_u32 m0, s41, 19456
  s_add_u32 s36, s77, 2146304
  buffer_load_dwordx4 v65, s[88:91], s36 offen lds
  ds_read_b64_tr_b16 a[160:161], v68 offset:20480
  ds_read_b64_tr_b16 a[162:163], v68 offset:21504
  ds_read_b64_tr_b16 a[164:165], v69 offset:20480
  ds_read_b64_tr_b16 a[166:167], v69 offset:21504
  ds_read_b64_tr_b16 a[208:209], v70 offset:20480
  ds_read_b64_tr_b16 a[210:211], v70 offset:21504
  ds_read_b64_tr_b16 a[212:213], v71 offset:20480
  ds_read_b64_tr_b16 a[214:215], v71 offset:21504
  s_waitcnt lgkmcnt(0)
  s_waitcnt vmcnt(24)
  s_barrier
  s_add_u32 m0, s41, 20480
  s_add_u32 s36, s77, 2097152
  buffer_load_dwordx4 v64, s[92:95], s36 offen lds
  s_add_u32 m0, s41, 21504
  s_add_u32 s36, s77, 2113536
  buffer_load_dwordx4 v64, s[92:95], s36 offen lds
  s_add_u32 m0, s41, 22528
  s_add_u32 s36, s77, 2129920
  buffer_load_dwordx4 v65, s[92:95], s36 offen lds
  s_add_u32 m0, s41, 23552
  s_add_u32 s36, s77, 2146304
  buffer_load_dwordx4 v65, s[92:95], s36 offen lds
  ds_read_b64_tr_b16 v[144:145], v68 offset:24576
  ds_read_b64_tr_b16 v[146:147], v68 offset:25600
  ds_read_b64_tr_b16 v[148:149], v69 offset:24576
  ds_read_b64_tr_b16 v[150:151], v69 offset:25600
  ds_read_b64_tr_b16 v[224:225], v70 offset:24576
  ds_read_b64_tr_b16 v[226:227], v70 offset:25600
  ds_read_b64_tr_b16 v[228:229], v71 offset:24576
  ds_read_b64_tr_b16 v[230:231], v71 offset:25600
  s_waitcnt lgkmcnt(0)
  s_waitcnt vmcnt(24)
  s_barrier
  s_add_u32 m0, s41, 24576
  s_add_u32 s36, s77, 2097152
  buffer_load_dwordx4 v64, s[96:99], s36 offen lds
  s_add_u32 m0, s41, 25600
  s_add_u32 s36, s77, 2113536
  buffer_load_dwordx4 v64, s[96:99], s36 offen lds
  s_add_u32 m0, s41, 26624
  s_add_u32 s36, s77, 2129920
  buffer_load_dwordx4 v65, s[96:99], s36 offen lds
  s_add_u32 m0, s41, 27648
  s_add_u32 s36, s77, 2146304
  buffer_load_dwordx4 v65, s[96:99], s36 offen lds
  v_lshrrev_b32 v15, 2, v0
  buffer_load_dword v62, v15, s[84:87], 0 offen sc1
  ds_read_b64_tr_b16 a[48:49], v68 offset:28672
  ds_read_b64_tr_b16 a[50:51], v68 offset:29696
  ds_read_b64_tr_b16 a[52:53], v69 offset:28672
  ds_read_b64_tr_b16 a[54:55], v69 offset:29696
  ds_read_b64_tr_b16 a[128:129], v70 offset:28672
  ds_read_b64_tr_b16 a[130:131], v70 offset:29696
  ds_read_b64_tr_b16 a[132:133], v71 offset:28672
  ds_read_b64_tr_b16 a[134:135], v71 offset:29696
  s_waitcnt lgkmcnt(0)
  s_waitcnt vmcnt(24)
  s_barrier
  s_add_u32 m0, s41, 28672
  s_add_u32 s36, s40, 256
  buffer_load_dwordx4 v66, s[80:83], s36 offen lds
  s_add_u32 m0, s41, 29696
  s_add_u32 s36, s40, 20736
  buffer_load_dwordx4 v67, s[80:83], s36 offen lds
  s_add_u32 m0, s41, 30720
  s_add_u32 s36, s40, 5376
  buffer_load_dwordx4 v66, s[80:83], s36 offen lds
  s_add_u32 m0, s41, 31744
  s_add_u32 s36, s40, 25856
  buffer_load_dwordx4 v67, s[80:83], s36 offen lds
  ds_read_b64_tr_b16 a[168:169], v68 offset:0
  ds_read_b64_tr_b16 a[170:171], v68 offset:1024
  ds_read_b64_tr_b16 a[172:173], v69 offset:0
  ds_read_b64_tr_b16 a[174:175], v69 offset:1024
  ds_read_b64_tr_b16 a[216:217], v70 offset:0
  ds_read_b64_tr_b16 a[218:219], v70 offset:1024
  ds_read_b64_tr_b16 a[220:221], v71 offset:0
  ds_read_b64_tr_b16 a[222:223], v71 offset:1024
  s_waitcnt lgkmcnt(0)
  s_waitcnt vmcnt(24)
  s_barrier
  s_add_u32 m0, s41, 0
  s_add_u32 s36, s67, 0
  buffer_load_dwordx4 v64, s[96:99], s36 offen lds
  s_add_u32 m0, s41, 1024
  s_add_u32 s36, s67, 16384
  buffer_load_dwordx4 v64, s[96:99], s36 offen lds
  s_add_u32 m0, s41, 2048
  s_add_u32 s36, s67, 32768
  buffer_load_dwordx4 v65, s[96:99], s36 offen lds
  s_add_u32 m0, s41, 3072
  s_add_u32 s36, s67, 49152
  buffer_load_dwordx4 v65, s[96:99], s36 offen lds
  s_load_dwordx2 s[88:89], s[0:1], 8
  s_waitcnt lgkmcnt(0)
  s_mov_b32 s90, 10240
  s_mov_b32 s91, 0x20000
  v_bfe_u32 v60, v0, 6, 2
  v_bfe_u32 v61, v0, 4, 1
  v_lshl_add_u32 v60, v60, 1, v61
  v_mul_u32_u24 v60, 1280, v60
  v_lshrrev_b32 v61, 8, v0
  v_lshl_add_u32 v60, v61, 5, v60
  v_bfe_u32 v61, v0, 5, 1
  v_lshl_add_u32 v60, v61, 4, v60
  s_add_u32 s36, s10, 0
  s_min_u32 s36, s36, 9
  s_lshl_b32 m0, s36, 10
  s_mul_i32 s37, s8, 5
  s_add_u32 s36, s36, s37
  s_sub_u32 s37, s36, 10
  s_cselect_b32 s36, s36, s37
  s_lshl_b32 s36, s36, 7
  buffer_load_dwordx4 v60, s[88:91], s36 offen lds
  s_add_u32 s36, s10, 4
  s_min_u32 s36, s36, 9
  s_lshl_b32 m0, s36, 10
  s_mul_i32 s37, s8, 5
  s_add_u32 s36, s36, s37
  s_sub_u32 s37, s36, 10
  s_cselect_b32 s36, s36, s37
  s_lshl_b32 s36, s36, 7
  buffer_load_dwordx4 v60, s[88:91], s36 offen lds
  s_add_u32 s36, s10, 8
  s_min_u32 s36, s36, 9
  s_lshl_b32 m0, s36, 10
  s_mul_i32 s37, s8, 5
  s_add_u32 s36, s36, s37
  s_sub_u32 s37, s36, 10
  s_cselect_b32 s36, s36, s37
  s_lshl_b32 s36, s36, 7
  buffer_load_dwordx4 v60, s[88:91], s36 offen lds
  ds_read_b64_tr_b16 v[152:153], v68 offset:4096
  ds_read_b64_tr_b16 v[154:155], v68 offset:5120
  ds_read_b64_tr_b16 v[156:157], v69 offset:4096
  ds_read_b64_tr_b16 v[158:159], v69 offset:5120
  ds_read_b64_tr_b16 v[232:233], v70 offset:4096
  ds_read_b64_tr_b16 v[234:235], v70 offset:5120
  ds_read_b64_tr_b16 v[236:237], v71 offset:4096
  ds_read_b64_tr_b16 v[238:239], v71 offset:5120
  s_waitcnt lgkmcnt(0)
  s_waitcnt vmcnt(24)
  s_barrier
  s_add_u32 m0, s41, 4096
  s_add_u32 s36, s67, 524288
  buffer_load_dwordx4 v64, s[96:99], s36 offen lds
  s_add_u32 m0, s41, 5120
  s_add_u32 s36, s67, 540672
  buffer_load_dwordx4 v64, s[96:99], s36 offen lds
  s_add_u32 m0, s41, 6144
  s_add_u32 s36, s67, 557056
  buffer_load_dwordx4 v65, s[96:99], s36 offen lds
  s_add_u32 m0, s41, 7168
  s_add_u32 s36, s67, 573440
  buffer_load_dwordx4 v65, s[96:99], s36 offen lds
  ds_read_b64_tr_b16 a[56:57], v68 offset:8192
  ds_read_b64_tr_b16 a[58:59], v68 offset:9216
  ds_read_b64_tr_b16 a[60:61], v69 offset:8192
  ds_read_b64_tr_b16 a[62:63], v69 offset:9216
  ds_read_b64_tr_b16 a[136:137], v70 offset:8192
  ds_read_b64_tr_b16 a[138:139], v70 offset:9216
  ds_read_b64_tr_b16 a[140:141], v71 offset:8192
  ds_read_b64_tr_b16 a[142:143], v71 offset:9216
  s_waitcnt lgkmcnt(0)
  s_waitcnt vmcnt(24)
  s_barrier
  s_add_u32 m0, s41, 8192
  s_add_u32 s36, s67, 1048576
  buffer_load_dwordx4 v64, s[96:99], s36 offen lds
  s_add_u32 m0, s41, 9216
  s_add_u32 s36, s67, 1064960
  buffer_load_dwordx4 v64, s[96:99], s36 offen lds
  s_add_u32 m0, s41, 10240
  s_add_u32 s36, s67, 1081344
  buffer_load_dwordx4 v65, s[96:99], s36 offen lds
  s_add_u32 m0, s41, 11264
  s_add_u32 s36, s67, 1097728
  buffer_load_dwordx4 v65, s[96:99], s36 offen lds
  ds_read_b64_tr_b16 a[176:177], v68 offset:12288
  ds_read_b64_tr_b16 a[178:179], v68 offset:13312
  ds_read_b64_tr_b16 a[180:181], v69 offset:12288
  ds_read_b64_tr_b16 a[182:183], v69 offset:13312
  ds_read_b64_tr_b16 a[224:225], v70 offset:12288
  ds_read_b64_tr_b16 a[226:227], v70 offset:13312
  ds_read_b64_tr_b16 a[228:229], v71 offset:12288
  ds_read_b64_tr_b16 a[230:231], v71 offset:13312
  s_waitcnt lgkmcnt(0)
  s_waitcnt vmcnt(24)
  s_barrier
  s_add_u32 m0, s41, 12288
  s_add_u32 s36, s67, 1572864
  buffer_load_dwordx4 v64, s[96:99], s36 offen lds
  s_add_u32 m0, s41, 13312
  s_add_u32 s36, s67, 1589248
  buffer_load_dwordx4 v64, s[96:99], s36 offen lds
  s_add_u32 m0, s41, 14336
  s_add_u32 s36, s67, 1605632
  buffer_load_dwordx4 v65, s[96:99], s36 offen lds
  s_add_u32 m0, s41, 15360
  s_add_u32 s36, s67, 1622016
  buffer_load_dwordx4 v65, s[96:99], s36 offen lds
  ds_read_b64_tr_b16 v[160:161], v68 offset:16384
  ds_read_b64_tr_b16 v[162:163], v68 offset:17408
  ds_read_b64_tr_b16 v[164:165], v69 offset:16384
  ds_read_b64_tr_b16 v[166:167], v69 offset:17408
  ds_read_b64_tr_b16 v[240:241], v70 offset:16384
  ds_read_b64_tr_b16 v[242:243], v70 offset:17408
  ds_read_b64_tr_b16 v[244:245], v71 offset:16384
  ds_read_b64_tr_b16 v[246:247], v71 offset:17408
  s_waitcnt lgkmcnt(0)
  s_waitcnt vmcnt(24)
  s_barrier
  s_add_u32 m0, s41, 16384
  s_add_u32 s36, s40, 0
  buffer_load_dwordx4 v66, s[80:83], s36 offen lds
  s_add_u32 m0, s41, 17408
  s_add_u32 s36, s40, 20480
  buffer_load_dwordx4 v67, s[80:83], s36 offen lds
  s_add_u32 m0, s41, 18432
  s_add_u32 s36, s40, 5120
  buffer_load_dwordx4 v66, s[80:83], s36 offen lds
  s_add_u32 m0, s41, 19456
  s_add_u32 s36, s40, 25600
  buffer_load_dwordx4 v67, s[80:83], s36 offen lds
  ds_read_b64_tr_b16 a[64:65], v68 offset:20480
  ds_read_b64_tr_b16 a[66:67], v68 offset:21504
  ds_read_b64_tr_b16 a[68:69], v69 offset:20480
  ds_read_b64_tr_b16 a[70:71], v69 offset:21504
  ds_read_b64_tr_b16 a[144:145], v70 offset:20480
  ds_read_b64_tr_b16 a[146:147], v70 offset:21504
  ds_read_b64_tr_b16 a[148:149], v71 offset:20480
  ds_read_b64_tr_b16 a[150:151], v71 offset:21504
  s_waitcnt lgkmcnt(0)
  s_waitcnt vmcnt(24)
  s_barrier
  s_add_u32 m0, s41, 20480
  s_add_u32 s36, s40, 128
  buffer_load_dwordx4 v66, s[80:83], s36 offen lds
  s_add_u32 m0, s41, 21504
  s_add_u32 s36, s40, 20608
  buffer_load_dwordx4 v67, s[80:83], s36 offen lds
  s_add_u32 m0, s41, 22528
  s_add_u32 s36, s40, 5248
  buffer_load_dwordx4 v66, s[80:83], s36 offen lds
  s_add_u32 m0, s41, 23552
  s_add_u32 s36, s40, 25728
  buffer_load_dwordx4 v67, s[80:83], s36 offen lds
  ds_read_b64_tr_b16 a[184:185], v68 offset:24576
  ds_read_b64_tr_b16 a[186:187], v68 offset:25600
  ds_read_b64_tr_b16 a[188:189], v69 offset:24576
  ds_read_b64_tr_b16 a[190:191], v69 offset:25600
  ds_read_b64_tr_b16 a[232:233], v70 offset:24576
  ds_read_b64_tr_b16 a[234:235], v70 offset:25600
  ds_read_b64_tr_b16 a[236:237], v71 offset:24576
  ds_read_b64_tr_b16 a[238:239], v71 offset:25600
  s_waitcnt lgkmcnt(0)
  s_waitcnt vmcnt(24)
  s_barrier
  s_add_u32 m0, s41, 24576
  s_add_u32 s36, s40, 384
  buffer_load_dwordx4 v66, s[80:83], s36 offen lds
  s_add_u32 m0, s41, 25600
  s_add_u32 s36, s40, 20864
  buffer_load_dwordx4 v67, s[80:83], s36 offen lds
  s_add_u32 m0, s41, 26624
  s_add_u32 s36, s40, 5504
  buffer_load_dwordx4 v66, s[80:83], s36 offen lds
  s_add_u32 m0, s41, 27648
  s_add_u32 s36, s40, 25984
  buffer_load_dwordx4 v67, s[80:83], s36 offen lds
  s_branch L_hs1_12
L_hs_11:
  s_sub_u32 s12, s12, 1
  s_cbranch_scc1 L_cabort
  buffer_load_dword v62, v15, s[84:87], 0 offen sc1
  s_waitcnt vmcnt(0)
L_hs1_12:
  v_readlane_b32 s77, v62, 10
  s_cmp_lt_u32 s77, 192
  s_cbranch_scc1 L_hs_11
  v_readlane_b32 s37, v62, 9
  v_readlane_b32 s36, v62, 0
  s_bcnt1_i32_b32 s36, s36
  s_add_u32 s37, s37, s36
  v_readlane_b32 s36, v62, 1
  s_bcnt1_i32_b32 s36, s36
  s_add_u32 s37, s37, s36
  v_readlane_b32 s36, v62, 2
  s_bcnt1_i32_b32 s36, s36
  s_add_u32 s37, s37, s36
  v_readlane_b32 s36, v62, 3
  s_bcnt1_i32_b32 s36, s36
  s_add_u32 s37, s37, s36
  v_readlane_b32 s36, v62, 4
  s_bcnt1_i32_b32 s36, s36
  s_add_u32 s37, s37, s36
  v_readlane_b32 s36, v62, 37
  s_bcnt1_i32_b32 s36, s36
  s_add_u32 s37, s37, s36
  v_readlane_b32 s36, v62, 6
  s_bcnt1_i32_b32 s36, s36
  s_add_u32 s37, s37, s36
  v_readlane_b32 s36, v62, 39
  s_bcnt1_i32_b32 s36, s36
  s_add_u32 s37, s37, s36
  s_cmp_lt_u32 s37, 256
  s_cbranch_scc1 L_hs_11
  v_readlane_b32 s90, v62, 48
  v_readlane_b32 s91, v62, 49
  s_cmp_lt_u32 s91, 134217728
  s_cbranch_scc1 L_hs_11
  s_bitcmp1_b64 s[90:91], 40
  s_cselect_b32 s36, 8192, 0
  s_add_u32 s76, s76, s36
  s_andn2_b32 s36, s36, s51
  s_add_u32 s22, s22, s36
  s_bitcmp1_b64 s[90:91], 0
  s_cselect_b32 s36, 8192, 0
  s_add_u32 s20, s21, s36
  s_add_u32 s16, s20, 1048576
  s_add_u32 s21, s21, 1048576
  s_lshr_b32 s38, s91, 16
  s_and_b32 s36, s38, 3
  s_lshl_b32 s36, s36, 13
  s_add_u32 s36, s36, 130023424
  s_and_b32 s37, s38, 12
  s_lshl_b32 s37, s37, 11
  s_add_u32 s37, s37, 132120576
  s_cmp_eq_u32 s8, 0
  s_cselect_b32 s19, s36, s37
  s_cselect_b32 s18, s37, s36
  v_lshlrev_b32 v60, 3, v0
  s_mov_b32 m0, 23424
  s_lshl_b32 s36, s10, 13
  s_add_u32 s36, s36, s42
  s_mov_b32 exec_hi, 0xff
  buffer_load_dword v60, s[4:7], s36 offen sc1 lds
  s_mov_b64 exec, 0xffff
  s_add_u32 s36, s15, 163840
  buffer_load_dword v60, s[4:7], s15 offen sc1 lds
  buffer_load_dword v60, s[4:7], s36 offen sc1 lds
  s_mov_b64 exec, -1
  v_readlane_b32 s36, v62, 37
  v_readlane_b32 s37, v62, 39
  s_cmp_eq_u32 s8, 0
  s_cselect_b32 s77, s36, s37
  ds_read_b64_tr_b16 a[240:241], v72 offset:28672
  ds_read_b64_tr_b16 a[242:243], v72 offset:29184
  ds_read_b64_tr_b16 a[244:245], v73 offset:28672
  ds_read_b64_tr_b16 a[246:247], v73 offset:29184
  ds_read_b64_tr_b16 a[248:249], v74 offset:28672
  ds_read_b64_tr_b16 a[250:251], v74 offset:29184
  ds_read_b64_tr_b16 a[252:253], v75 offset:28672
  ds_read_b64_tr_b16 a[254:255], v75 offset:29184
  s_waitcnt lgkmcnt(0)
  s_waitcnt vmcnt(24)
  s_barrier
  s_add_u32 m0, s41, 28672
  s_add_u32 s36, s40, 512
  buffer_load_dwordx4 v66, s[80:83], s36 offen lds
  s_add_u32 m0, s41, 29696
  s_add_u32 s36, s40, 20992
  buffer_load_dwordx4 v67, s[80:83], s36 offen lds
  s_add_u32 m0, s41, 30720
  s_add_u32 s36, s40, 5632
  buffer_load_dwordx4 v66, s[80:83], s36 offen lds
  s_add_u32 m0, s41, 31744
  s_add_u32 s36, s40, 26112
  buffer_load_dwordx4 v67, s[80:83], s36 offen lds
  v_lshrrev_b32 v60, 2, v0
  v_and_b32 v60, 12, v60
  buffer_load_dword v61, v60, s[4:7], s76 offen sc1
  v_lshrrev_b32 v60, 2, v60
  ds_read_b64_tr_b16 v[32:33], v68 offset:0
  ds_read_b64_tr_b16 v[34:35], v68 offset:1024
  ds_read_b64_tr_b16 v[36:37], v69 offset:0
  ds_read_b64_tr_b16 v[38:39], v69 offset:1024
  ds_read_b64_tr_b16 v[40:41], v70 offset:0
  ds_read_b64_tr_b16 v[42:43], v70 offset:1024
  ds_read_b64_tr_b16 v[44:45], v71 offset:0
  ds_read_b64_tr_b16 v[46:47], v71 offset:1024
  s_waitcnt lgkmcnt(0)
  s_waitcnt vmcnt(24)
  s_barrier
  ds_write_b128 v12, v[32:35] offset:0
  ds_write_b128 v12, v[36:39] offset:1024
  ds_write_b128 v12, v[40:43] offset:2048
  ds_write_b128 v12, v[44:47] offset:3072
  ds_read_b64_tr_b16 v[16:17], v68 offset:4096
  ds_read_b64_tr_b16 v[18:19], v68 offset:5120
  ds_read_b64_tr_b16 v[20:21], v69 offset:4096
  ds_read_b64_tr_b16 v[22:23], v69 offset:5120
  ds_read_b64_tr_b16 v[24:25], v70 offset:4096
  ds_read_b64_tr_b16 v[26:27], v70 offset:5120
  ds_read_b64_tr_b16 v[28:29], v71 offset:4096
  ds_read_b64_tr_b16 v[30:31], v71 offset:5120
  s_waitcnt lgkmcnt(0)
  s_waitcnt vmcnt(20)
  s_barrier
  ds_write_b128 v12, v[16:19] offset:4096
  ds_write_b128 v12, v[20:23] offset:5120
  ds_write_b128 v12, v[24:27] offset:6144
  ds_write_b128 v12, v[28:31] offset:7168
  ds_read_b64_tr_b16 v[32:33], v68 offset:8192
  ds_read_b64_tr_b16 v[34:35], v68 offset:9216
  ds_read_b64_tr_b16 v[36:37], v69 offset:8192
  ds_read_b64_tr_b16 v[38:39], v69 offset:9216
  ds_read_b64_tr_b16 v[40:41], v70 offset:8192
  ds_read_b64_tr_b16 v[42:43], v70 offset:9216
  ds_read_b64_tr_b16 v[44:45], v71 offset:8192
  ds_read_b64_tr_b16 v[46:47], v71 offset:9216
  s_waitcnt lgkmcnt(0)
  s_waitcnt vmcnt(16)
  s_barrier
  ds_write_b128 v12, v[32:35] offset:8192
  ds_write_b128 v12, v[36:39] offset:9216
  ds_write_b128 v12, v[40:43] offset:10240
  ds_write_b128 v12, v[44:47] offset:11264
  ds_read_b64_tr_b16 v[16:17], v68 offset:12288
  ds_read_b64_tr_b16 v[18:19], v68 offset:13312
  ds_read_b64_tr_b16 v[20:21], v69 offset:12288
  ds_read_b64_tr_b16 v[22:23], v69 offset:13312
  ds_read_b64_tr_b16 v[24:25], v70 offset:12288
  ds_read_b64_tr_b16 v[26:27], v70 offset:13312
  ds_read_b64_tr_b16 v[28:29], v71 offset:12288
  ds_read_b64_tr_b16 v[30:31], v71 offset:13312
  s_waitcnt lgkmcnt(0)
  s_waitcnt vmcnt(12)
  s_barrier
  ds_write_b128 v12, v[16:19] offset:12288
  ds_write_b128 v12, v[20:23] offset:13312
  ds_write_b128 v12, v[24:27] offset:14336
  ds_write_b128 v12, v[28:31] offset:15360
  ds_read_b64_tr_b16 v[32:33], v72 offset:16384
  ds_read_b64_tr_b16 v[34:35], v72 offset:16896
  ds_read_b64_tr_b16 v[36:37], v73 offset:16384
  ds_read_b64_tr_b16 v[38:39], v73 offset:16896
  ds_read_b64_tr_b16 v[40:41], v74 offset:16384
  ds_read_b64_tr_b16 v[42:43], v74 offset:16896
  ds_read_b64_tr_b16 v[44:45], v75 offset:16384
  ds_read_b64_tr_b16 v[46:47], v75 offset:16896
  s_waitcnt lgkmcnt(0)
  s_waitcnt vmcnt(8)
  s_barrier
  ds_write_b128 v12, v[32:35] offset:16384
  ds_write_b128 v12, v[36:39] offset:17408
  ds_write_b128 v12, v[40:43] offset:18432
  ds_write_b128 v12, v[44:47] offset:19456
  ds_read_b64_tr_b16 v[16:17], v72 offset:20480
  ds_read_b64_tr_b16 v[18:19], v72 offset:20992
  ds_read_b64_tr_b16 v[20:21], v73 offset:20480
  ds_read_b64_tr_b16 v[22:23], v73 offset:20992
  ds_read_b64_tr_b16 v[24:25], v74 offset:20480
  ds_read_b64_tr_b16 v[26:27], v74 offset:20992
  ds_read_b64_tr_b16 v[28:29], v75 offset:20480
  ds_read_b64_tr_b16 v[30:31], v75 offset:20992
  s_waitcnt lgkmcnt(0)
  s_waitcnt vmcnt(4)
  s_barrier
  ds_write_b128 v12, v[16:19] offset:20480
  ds_write_b128 v12, v[20:23] offset:21504
  ds_write_b128 v12, v[24:27] offset:22528
  ds_write_b128 v12, v[28:31] offset:23552
  ds_read_b64_tr_b16 v[32:33], v72 offset:24576
  ds_read_b64_tr_b16 v[34:35], v72 offset:25088
  ds_read_b64_tr_b16 v[36:37], v73 offset:24576
  ds_read_b64_tr_b16 v[38:39], v73 offset:25088
  ds_read_b64_tr_b16 v[40:41], v74 offset:24576
  ds_read_b64_tr_b16 v[42:43], v74 offset:25088
  ds_read_b64_tr_b16 v[44:45], v75 offset:24576
  ds_read_b64_tr_b16 v[46:47], v75 offset:25088
  s_waitcnt lgkmcnt(0)
  s_waitcnt vmcnt(0)
  s_barrier
  ds_write_b128 v12, v[32:35] offset:24576
  ds_write_b128 v12, v[36:39] offset:25600
  ds_write_b128 v12, v[40:43] offset:26624
  ds_write_b128 v12, v[44:47] offset:27648
  s_mov_b32 s39, 0
  s_branch L_rdya_14
L_rdy_13:
  s_sub_u32 s12, s12, 1
  s_cbranch_scc1 L_cabort
  v_lshrrev_b32 v60, 2, v0
  v_and_b32 v60, 12, v60
  buffer_load_dword v61, v60, s[4:7], s76 offen sc1
  v_lshrrev_b32 v60, 2, v60
L_rdya_14:
  s_waitcnt vmcnt(0)
  v_mad_u32_u24 v61, v61, 3, v60
  s_nop 0
  v_readlane_b32 s75, v61, 0
  v_readlane_b32 s36, v61, 1
  s_min_u32 s75, s75, s36
  v_readlane_b32 s36, v61, 2
  s_min_u32 s75, s75, s36
  s_cmp_ge_u32 s75, 64
  s_cselect_b32 s75, 128, s75
  s_cmp_ge_u32 s39, s75
  s_cbranch_scc1 L_rdy_13
  ds_read_b64_tr_b16 v[16:17], v72 offset:28672
  ds_read_b64_tr_b16 v[18:19], v72 offset:29184
  ds_read_b64_tr_b16 v[20:21], v73 offset:28672
  ds_read_b64_tr_b16 v[22:23], v73 offset:29184
  ds_read_b64_tr_b16 v[24:25], v74 offset:28672
  ds_read_b64_tr_b16 v[26:27], v74 offset:29184
  ds_read_b64_tr_b16 v[28:29], v75 offset:28672
  ds_read_b64_tr_b16 v[30:31], v75 offset:29184
  s_waitcnt lgkmcnt(0)
  s_barrier
  ds_write_b128 v12, v[16:19] offset:28672
  ds_write_b128 v12, v[20:23] offset:29696
  ds_write_b128 v12, v[24:27] offset:30720
  ds_write_b128 v12, v[28:31] offset:31744
  s_waitcnt lgkmcnt(0)
  s_branch L_loaded
L_load1:
  v_mov_b32 v86, v0
  v_lshrrev_b32 v84, 5, v86
  v_bfe_u32 v85, v86, 4, 1
  v_lshl_add_u32 v84, v84, 3, v85
  v_lshlrev_b32 v84, 13, v84
  v_lshrrev_b32 v85, 3, v86
  v_and_b32 v85, 6, v85
  v_xor_b32 v85, v85, v86
  v_and_b32 v85, 15, v85
  v_lshl_add_u32 v64, v85, 4, v84
  v_xor_b32 v65, 128, v64
  s_mul_i32 s41, s10, 34816
  s_add_u32 s41, s41, 24576
  s_lshl_b32 s36, s9, 8
  s_lshl_b32 s37, s10, 17
  s_add_u32 s36, s36, s37
  s_mul_i32 s37, s8, 2621440
  s_add_u32 s67, s36, s37
  s_sub_u32 s37, 2621440, s37
  s_add_u32 s77, s36, s37
  s_add_u32 m0, s41, 20480
  s_add_u32 s36, s77, 0
  buffer_load_dwordx4 v64, s[88:91], s36 offen lds
  s_add_u32 m0, s41, 21504
  s_add_u32 s36, s77, 16384
  buffer_load_dwordx4 v64, s[88:91], s36 offen lds
  s_add_u32 m0, s41, 22528
  s_add_u32 s36, s77, 32768
  buffer_load_dwordx4 v65, s[88:91], s36 offen lds
  s_add_u32 m0, s41, 23552
  s_add_u32 s36, s77, 49152
  buffer_load_dwordx4 v65, s[88:91], s36 offen lds
  v_mov_b32 v61, 0
  s_bitcmp1_b32 s2, 31
  s_cbranch_scc1 L_cask_15
  s_cmp_lg_u32 s10, 0
  s_cbranch_scc1 L_cask_15
  s_lshr_b32 s38, s3, 5
  s_lshr_b32 s36, 160, s38
  s_and_b32 s36, s36, 1
  s_lshl_b32 s36, s36, 5
  s_add_u32 s38, s38, s36
  s_lshl_b32 s38, s38, 2
  s_and_b32 s37, s3, 31
  s_lshl_b32 s36, 1, s37
  v_mov_b32 v60, s36
  s_mov_b64 exec, 1
  buffer_atomic_or v60, v61, s[84:87], s38 offen sc0
  s_mov_b64 exec, -1
L_cask_15:
  s_add_u32 m0, s41, 24576
  s_add_u32 s36, s77, 0
  buffer_load_dwordx4 v64, s[92:95], s36 offen lds
  s_add_u32 m0, s41, 25600
  s_add_u32 s36, s77, 16384
  buffer_load_dwordx4 v64, s[92:95], s36 offen lds
  s_add_u32 m0, s41, 26624
  s_add_u32 s36, s77, 32768
  buffer_load_dwordx4 v65, s[92:95], s36 offen lds
  s_add_u32 m0, s41, 27648
  s_add_u32 s36, s77, 49152
  buffer_load_dwordx4 v65, s[92:95], s36 offen lds
  s_add_u32 m0, s41, 28672
  s_add_u32 s36, s77, 0
  buffer_load_dwordx4 v64, s[96:99], s36 offen lds
  s_add_u32 m0, s41, 29696
  s_add_u32 s36, s77, 16384
  buffer_load_dwordx4 v64, s[96:99], s36 offen lds
  s_add_u32 m0, s41, 30720
  s_add_u32 s36, s77, 32768
  buffer_load_dwordx4 v65, s[96:99], s36 offen lds
  s_add_u32 m0, s41, 31744
  s_add_u32 s36, s77, 49152
  buffer_load_dwordx4 v65, s[96:99], s36 offen lds
  s_add_u32 m0, s41, 0
  s_add_u32 s36, s77, 524288
  buffer_load_dwordx4 v64, s[88:91], s36 offen lds
  s_add_u32 m0, s41, 1024
  s_add_u32 s36, s77, 540672
  buffer_load_dwordx4 v64, s[88:91], s36 offen lds
  s_add_u32 m0, s41, 2048
  s_add_u32 s36, s77, 557056
  buffer_load_dwordx4 v65, s[88:91], s36 offen lds
  s_add_u32 m0, s41, 3072
  s_add_u32 s36, s77, 573440
  buffer_load_dwordx4 v65, s[88:91], s36 offen lds
  s_add_u32 m0, s41, 4096
  s_add_u32 s36, s77, 524288
  buffer_load_dwordx4 v64, s[92:95], s36 offen lds
  s_add_u32 m0, s41, 5120
  s_add_u32 s36, s77, 540672
  buffer_load_dwordx4 v64, s[92:95], s36 offen lds
  s_add_u32 m0, s41, 6144
  s_add_u32 s36, s77, 557056
  buffer_load_dwordx4 v65, s[92:95], s36 offen lds
  s_add_u32 m0, s41, 7168
  s_add_u32 s36, s77, 573440
  buffer_load_dwordx4 v65, s[92:95], s36 offen lds
  s_add_u32 m0, s41, 8192
  s_add_u32 s36, s77, 524288
  buffer_load_dwordx4 v64, s[96:99], s36 offen lds
  s_add_u32 m0, s41, 9216
  s_add_u32 s36, s77, 540672
  buffer_load_dwordx4 v64, s[96:99], s36 offen lds
  s_add_u32 m0, s41, 10240
  s_add_u32 s36, s77, 557056
  buffer_load_dwordx4 v65, s[96:99], s36 offen lds
  s_add_u32 m0, s41, 11264
  s_add_u32 s36, s77, 573440
  buffer_load_dwordx4 v65, s[96:99], s36 offen lds
  s_add_u32 m0, s41, 12288
  s_add_u32 s36, s77, 1048576
  buffer_load_dwordx4 v64, s[88:91], s36 offen lds
  s_add_u32 m0, s41, 13312
  s_add_u32 s36, s77, 1064960
  buffer_load_dwordx4 v64, s[88:91], s36 offen lds
  s_add_u32 m0, s41, 14336
  s_add_u32 s36, s77, 1081344
  buffer_load_dwordx4 v65, s[88:91], s36 offen lds
  s_add_u32 m0, s41, 15360
  s_add_u32 s36, s77, 1097728
  buffer_load_dwordx4 v65, s[88:91], s36 offen lds
  s_add_u32 m0, s41, 16384
  s_add_u32 s36, s77, 1048576
  buffer_load_dwordx4 v64, s[92:95], s36 offen lds
  s_add_u32 m0, s41, 17408
  s_add_u32 s36, s77, 1064960
  buffer_load_dwordx4 v64, s[92:95], s36 offen lds
  s_add_u32 m0, s41, 18432
  s_add_u32 s36, s77, 1081344
  buffer_load_dwordx4 v65, s[92:95], s36 offen lds
  s_add_u32 m0, s41, 19456
  s_add_u32 s36, s77, 1097728
  buffer_load_dwordx4 v65, s[92:95], s36 offen lds
  s_bitcmp1_b32 s2, 31
  s_cbranch_scc1 L_cdone_16
  s_cmp_lg_u32 s10, 0
  s_cbranch_scc1 L_cwait_17
  s_lshr_b32 s38, s3, 5
  s_lshr_b32 s36, 160, s38
  s_and_b32 s36, s36, 1
  s_lshl_b32 s36, s36, 5
  s_add_u32 s38, s38, s36
  s_lshl_b32 s38, s38, 2
  s_and_b32 s37, s3, 31
  s_lshl_b32 s36, 1, s37
  s_mov_b64 exec, 1
  s_waitcnt vmcnt(28)
  s_branch L_cans_24
L_ctry_18:
  s_lshl_b32 s36, 1, s37
  v_mov_b32 v60, s36
  s_mov_b64 exec, 1
  buffer_atomic_or v60, v61, s[84:87], s38 offen sc0
  s_waitcnt vmcnt(0)
L_cans_24:
  v_readfirstlane_b32 s39, v60
  s_mov_b64 exec, -1
  s_and_b32 s36, s36, s39
  s_cbranch_scc0 L_cgot_19
  s_cmp_eq_u32 s39, -1
  s_cbranch_scc1 L_covf_20
  s_mul_i32 s37, s2, 37
  s_lshr_b32 s37, s37, 3
  s_and_b32 s37, s37, 31
  s_mov_b32 vcc_lo, s39
  s_mov_b32 vcc_hi, s39
  s_lshr_b64 vcc, vcc, s37
  s_ff0_i32_b32 s36, vcc_lo
  s_add_u32 s37, s37, s36
  s_and_b32 s37, s37, 31
  s_branch L_ctry_18
L_cgot_19:
  s_and_b32 s36, s3, 0xe0
  s_add_u32 s37, s37, s36
  s_branch L_chave_23
L_covf_20:
  v_mov_b32 v60, 1
  s_mov_b64 exec, 1
  buffer_atomic_add v60, v61, s[84:87], 36 offen sc0
  s_waitcnt vmcnt(0)
  v_readfirstlane_b32 s38, v60
  s_mov_b64 exec, -1
  v_lshlrev_b32 v61, 2, v0
L_clp_21:
  s_sub_u32 s12, s12, 1
  s_cbranch_scc1 L_abort
  buffer_load_dword v60, v61, s[84:87], 0 offen sc1
  s_waitcnt vmcnt(0)
  v_readlane_b32 s37, v60, 9
  v_readlane_b32 s36, v60, 0
  s_bcnt1_i32_b32 s36, s36
  s_add_u32 s37, s37, s36
  v_readlane_b32 s36, v60, 1
  s_bcnt1_i32_b32 s36, s36
  s_add_u32 s37, s37, s36
  v_readlane_b32 s36, v60, 2
  s_bcnt1_i32_b32 s36, s36
  s_add_u32 s37, s37, s36
  v_readlane_b32 s36, v60, 3
  s_bcnt1_i32_b32 s36, s36
  s_add_u32 s37, s37, s36
  v_readlane_b32 s36, v60, 4
  s_bcnt1_i32_b32 s36, s36
  s_add_u32 s37, s37, s36
  v_readlane_b32 s36, v60, 37
  s_bcnt1_i32_b32 s36, s36
  s_add_u32 s37, s37, s36
  v_readlane_b32 s36, v60, 6
  s_bcnt1_i32_b32 s36, s36
  s_add_u32 s37, s37, s36
  v_readlane_b32 s36, v60, 39
  s_bcnt1_i32_b32 s36, s36
  s_add_u32 s37, s37, s36
  s_cmp_lt_u32 s37, 256
  s_cbranch_scc1 L_clp_21
  v_readlane_b32 s39, v60, 0
  s_mov_b32 s37, 0
  s_bcnt0_i32_b32 s36, s39
  s_cmp_lt_u32 s38, s36
  s_cbranch_scc1 L_csel_22
  s_sub_u32 s38, s38, s36
  v_readlane_b32 s39, v60, 1
  s_mov_b32 s37, 32
  s_bcnt0_i32_b32 s36, s39
  s_cmp_lt_u32 s38, s36
  s_cbranch_scc1 L_csel_22
  s_sub_u32 s38, s38, s36
  v_readlane_b32 s39, v60, 2
  s_mov_b32 s37, 64
  s_bcnt0_i32_b32 s36, s39
  s_cmp_lt_u32 s38, s36
  s_cbranch_scc1 L_csel_22
  s_sub_u32 s38, s38, s36
  v_readlane_b32 s39, v60, 3
  s_mov_b32 s37, 96
  s_bcnt0_i32_b32 s36, s39
  s_cmp_lt_u32 s38, s36
  s_cbranch_scc1 L_csel_22
  s_sub_u32 s38, s38, s36
  v_readlane_b32 s39, v60, 4
  s_mov_b32 s37, 128
  s_bcnt0_i32_b32 s36, s39
  s_cmp_lt_u32 s38, s36
  s_cbranch_scc1 L_csel_22
  s_sub_u32 s38, s38, s36
  v_readlane_b32 s39, v60, 37
  s_mov_b32 s37, 160
  s_bcnt0_i32_b32 s36, s39
  s_cmp_lt_u32 s38, s36
  s_cbranch_scc1 L_csel_22
  s_sub_u32 s38, s38, s36
  v_readlane_b32 s39, v60, 6
  s_mov_b32 s37, 192
  s_bcnt0_i32_b32 s36, s39
  s_cmp_lt_u32 s38, s36
  s_cbranch_scc1 L_csel_22
  s_sub_u32 s38, s38, s36
  v_readlane_b32 s39, v60, 39
  s_mov_b32 s37, 224
  s_bcnt0_i32_b32 s36, s39
  s_cmp_lt_u32 s38, s36
  s_cbranch_scc1 L_csel_22
  s_sub_u32 s38, s38, s36
  s_branch L_abort
L_csel_22:
  s_ff0_i32_b32 s36, s39
  s_bitset1_b32 s39, s36
  s_sub_u32 s38, s38, 1
  s_cbranch_scc0 L_csel_22
  s_add_u32 s37, s37, s36
L_chave_23:
  v_mov_b32 v60, s37
  v_mov_b32 v61, 22912
  ds_write_b32 v61, v60
  s_waitcnt lgkmcnt(0)
L_cwait_17:
  s_barrier
  v_mov_b32 v61, 22912
  ds_read_b32 v60, v61
  s_waitcnt lgkmcnt(0)
  v_readfirstlane_b32 s36, v60
  s_bitset1_b32 s2, 31
  s_and_b32 s36, s36, 255
  s_cmp_eq_u32 s36, s3
  s_cbranch_scc1 L_cdone_16
  s_mov_b32 s3, s36
  s_waitcnt vmcnt(0)
  s_barrier
  s_branch L_dispatch
L_cdone_16:
  v_bfe_u32 v84, v86, 3, 1
  v_lshrrev_b32 v85, 5, v86
  v_lshl_add_u32 v84, v85, 1, v84
  v_bfe_u32 v85, v86, 4, 1
  v_lshl_add_u32 v84, v85, 5, v84
  v_mul_u32_u24 v84, 1280, v84
  v_lshlrev_b32 v85, 1, v85
  v_xor_b32 v85, v85, v86
  v_and_b32 v85, 7, v85
  v_lshl_add_u32 v66, v85, 4, v84
  v_xor_b32 v67, 64, v66
  s_mul_i32 s36, s9, 163840
  s_mul_i32 s37, s8, 640
  s_add_u32 s36, s36, s37
  s_lshr_b32 s37, s10, 1
  s_mul_i32 s37, s37, 81920
  s_add_u32 s36, s36, s37
  s_and_b32 s37, s10, 1
  s_mul_i32 s37, s37, 10240
  s_add_u32 s40, s36, s37
  v_bfe_u32 v87, v86, 2, 3
  v_lshrrev_b32 v84, 5, v86
  v_mul_u32_u24 v84, 34816, v84
  v_bfe_u32 v85, v86, 2, 2
  v_lshl_add_u32 v84, v85, 8, v84
  v_bfe_u32 v85, v86, 4, 1
  v_lshl_add_u32 v84, v85, 11, v84
  v_and_b32 v85, 3, v86
  v_lshl_add_u32 v84, v85, 3, v84
  s_lshl_b32 s36, s10, 1
  v_xor_b32 v85, s36, v87
  v_lshl_add_u32 v84, v85, 5, v84
  v_add_u32 v68, 24576, v84
  v_add_u32 v69, 94208, v84
  v_xor_b32 v70, 32, v68
  v_xor_b32 v71, 32, v69
  v_lshrrev_b32 v84, 4, v86
  v_lshlrev_b32 v84, 10, v84
  v_bfe_u32 v85, v86, 2, 2
  v_lshl_add_u32 v84, v85, 7, v84
  v_and_b32 v85, 3, v86
  v_lshl_add_u32 v84, v85, 3, v84
  v_bfe_u32 v85, v86, 3, 2
  v_xor_b32 v85, s10, v85
  v_lshl_add_u32 v84, v85, 5, v84
  v_add_u32 v72, 24576, v84
  v_add_u32 v73, 59392, v84
  v_add_u32 v74, 94208, v84
  v_add_u32 v75, 129024, v84
  v_lshrrev_b32 v20, 4, v0
  v_and_b32 v21, 15, v0
  v_and_b32 v22, 2, v21
  v_cmp_ne_u32 vcc, 0, v22
  v_mov_b32 v23, 0x44444444
  v_mov_b32 v24, 0xeeeeeeee
  v_cndmask_b32 v1, v23, v24, vcc
  s_lshl_b32 s36, s10, 6
  s_add_u32 s36, s36, 18560
  v_mul_u32_u24 v22, 1088, v20
  v_lshl_add_u32 v22, v21, 2, v22
  v_add_u32 v2, s36, v22
  s_lshl_b32 s36, s10, 9
  s_add_u32 s36, s36, 5120
  v_lshlrev_b32 v22, 2, v20
  v_lshl_add_u32 v22, v21, 4, v22
  v_add_u32 v11, s36, v22
  v_and_b32 v22, 7, v21
  v_mul_u32_u24 v22, 544, v22
  v_lshlrev_b32 v23, 1, v21
  v_xor_b32 v23, v23, v21
  v_and_b32 v23, 8, v23
  v_lshl_add_u32 v22, v23, 4, v22
  v_lshl_add_u32 v22, v20, 4, v22
  v_add_u32 v3, 18560, v22
  v_lshrrev_b32 v24, 2, v21
  v_lshlrev_b32 v24, 1, v24
  v_and_b32 v23, 1, v21
  v_or_b32 v24, v24, v23
  v_and_b32 v23, 2, v21
  v_mul_u32_u24 v22, 544, v24
  v_lshl_add_u32 v22, v23, 6, v22
  v_lshl_add_u32 v22, v20, 4, v22
  v_add_u32 v4, 18816, v22
  v_mul_u32_u24 v22, 2112, v23
  v_lshl_add_u32 v22, v20, 9, v22
  v_lshl_add_u32 v8, v24, 4, v22
  s_and_b32 s36, s10, 1
  s_lshl_b32 s36, s36, 6
  v_add_u32 v24, s36, v0
  v_and_b32 v22, 7, v24
  v_mul_u32_u24 v22, 544, v22
  v_lshrrev_b32 v23, 3, v24
  v_lshl_add_u32 v22, v23, 4, v22
  v_add_u32 v22, 18816, v22
  v_lshlrev_b32 v23, 4, v24
  v_add_u32 v23, 5120, v23
  s_cmp_eq_u32 s8, 0
  s_cselect_b64 vcc, -1, 0
  v_cndmask_b32 v10, v23, v22, vcc
  s_lshr_b32 s36, s10, 1
  s_lshl_b32 s36, s36, 10
  s_and_b32 s37, s10, 1
  s_lshl_b32 s37, s37, 5
  s_add_u32 s36, s36, s37
  s_add_u32 s36, s36, 0
  v_and_b32 v22, 6, v21
  v_lshlrev_b32 v22, 5, v22
  v_and_b32 v23, 1, v21
  v_lshl_add_u32 v22, v23, 4, v22
  v_lshl_add_u32 v22, v20, 8, v22
  v_lshlrev_b32 v23, 1, v21
  v_xor_b32 v23, v23, v21
  v_and_b32 v23, 8, v23
  v_xor_b32 v23, 8, v23
  v_add_u32 v22, v22, v23
  v_add_u32 v5, s36, v22
  v_lshlrev_b32 v22, 11, v20
  v_lshl_add_u32 v6, v21, 2, v22
  v_and_b32 v22, 2, v21
  v_lshlrev_b32 v22, 4, v22
  v_lshl_add_u32 v22, v20, 4, v22
  v_and_b32 v23, 1, v21
  v_lshl_add_u32 v22, v23, 3, v22
  v_and_b32 v23, 44, v0
  v_cmp_eq_u32 vcc, 0, v23
  v_mov_b32 v23, 0x40000000
  s_nop 0
  v_cndmask_b32 v7, v23, v22, vcc
  v_and_b32 v22, 1, v20
  v_lshlrev_b32 v22, 10, v22
  v_and_b32 v23, 2, v20
  v_lshl_add_u32 v22, v23, 8, v22
  v_lshl_add_u32 v22, v21, 4, v22
  s_lshl_b32 s36, s10, 11
  s_add_u32 s36, s36, 16384
  v_add_u32 v9, s36, v22
  s_lshr_b32 s36, s10, 1
  s_lshl_b32 s36, s36, 14
  s_and_b32 s37, s10, 1
  s_lshl_b32 s37, s37, 12
  s_add_u32 s56, s36, s37
  s_mov_b32 s28, 0x11111111
  s_mov_b32 s29, 0x11111111
  s_mov_b32 s30, 0x22222222
  s_mov_b32 s31, 0x22222222
  s_mov_b32 s32, 0x44444444
  s_mov_b32 s33, 0x44444444
  s_mov_b32 s34, 0x88888888
  s_mov_b32 s35, 0x88888888
  v_lshlrev_b32 v0, 4, v0
  s_mul_i32 s36, s10, 34816
  s_add_u32 s36, s36, 24576
  v_add_u32 v12, s36, v0
  s_mov_b32 s26, 0xf00ff00f
  s_mov_b32 s27, 0xf00ff00f
  s_mov_b32 s24, 0x3e0293ee
  s_mov_b32 s25, 0x7f817f81
  s_mov_b32 s68, 0x7f817f81
  s_mov_b32 s69, 0x7f817f81
  s_mov_b32 s59, 0x3f80
  s_mov_b32 s58, 0x2b800000
  s_mov_b32 s62, 0x28000000
  s_lshl_b32 s38, s9, 1
  s_add_u32 s38, s38, s10
  s_add_u32 s38, s38, 16
  s_cmp_lt_u32 s10, 2
  s_cselect_b32 s61, s38, s9
  s_cselect_b32 s23, 1, 0
  s_lshl_b32 s36, s10, 5
  s_add_u32 s36, s36, s9
  s_cmp_lt_u32 s36, 80
  s_cselect_b32 s23, 1, 0
  s_cselect_b32 s60, 0, 0x80000000
  s_mul_i32 s36, s8, 327680
  s_add_u32 s36, s36, 60817408
  s_lshl_b32 s37, s61, 11
  s_add_u32 s15, s36, s37
  s_mov_b32 s52, 0x80000000
  s_mov_b32 s63, 0x80000000
  s_mov_b32 s64, 0
  s_mov_b32 s65, 0
  s_mov_b32 s66, 0
  s_mov_b32 s54, 0x80000000
  s_lshl_b32 s37, s9, 6
  s_add_u32 s36, s36, s37
  s_lshl_b32 s37, s10, 13
  s_add_u32 s13, s36, s37
  s_lshl_b32 s36, s61, 6
  v_add_u32 v7, s36, v7
  s_lshl_b32 s36, s8, 15
  s_add_u32 s42, s36, 61865984
  s_lshl_b32 s36, s9, 15
  s_add_u32 s21, s36, 134217728
  s_and_b32 s36, s9, 3
  s_lshl_b32 s36, s36, 11
  s_lshl_b32 s37, s10, 10
  s_add_u32 s36, s36, s37
  s_lshr_b32 s37, s9, 2
  s_lshl_b32 s37, s37, 14
  s_add_u32 s36, s36, s37
  s_lshl_b32 s37, s8, 17
  s_add_u32 s36, s36, s37
  s_add_u32 s22, s36, 201064448
  s_cmp_lt_u32 s10, 2
  s_cselect_b32 s22, s22, 0x80000000
  s_cselect_b32 s74, 262144, 0
  s_cselect_b32 s51, 8192, 0
  s_cselect_b64 s[70:71], -1, 1
  s_lshl_b32 s36, s9, 1
  s_add_u32 s36, s36, s8
  s_lshl_b32 s36, s36, 7
  s_add_u32 s36, s36, 218120192
  s_cmp_eq_u32 s10, 2
  s_cselect_b32 s22, s36, s22
  s_cselect_b64 s[72:73], 1, 0
  s_lshl_b32 s36, s9, 7
  s_add_u32 s76, s36, 218103808
  s_mov_b32 s75, 0
  s_mov_b32 s43, 163840
  s_mov_b32 s17, s42
  s_lshl_b32 s55, s10, 11
  s_waitcnt vmcnt(28)
  s_barrier
  ds_read_b64_tr_b16 v[128:129], v68 offset:20480
  ds_read_b64_tr_b16 v[130:131], v68 offset:21504
  ds_read_b64_tr_b16 v[132:133], v69 offset:20480
  ds_read_b64_tr_b16 v[134:135], v69 offset:21504
  ds_read_b64_tr_b16 v[208:209], v70 offset:20480
  ds_read_b64_tr_b16 v[210:211], v70 offset:21504
  ds_read_b64_tr_b16 v[212:213], v71 offset:20480
  ds_read_b64_tr_b16 v[214:215], v71 offset:21504
  s_waitcnt lgkmcnt(0)
  s_waitcnt vmcnt(24)
  s_barrier
  s_add_u32 m0, s41, 20480
  s_add_u32 s36, s77, 1048576
  buffer_load_dwordx4 v64, s[96:99], s36 offen lds
  s_add_u32 m0, s41, 21504
  s_add_u32 s36, s77, 1064960
  buffer_load_dwordx4 v64, s[96:99], s36 offen lds
  s_add_u32 m0, s41, 22528
  s_add_u32 s36, s77, 1081344
  buffer_load_dwordx4 v65, s[96:99], s36 offen lds
  s_add_u32 m0, s41, 23552
  s_add_u32 s36, s77, 1097728
  buffer_load_dwordx4 v65, s[96:99], s36 offen lds
  ds_read_b64_tr_b16 a[32:33], v68 offset:24576
  ds_read_b64_tr_b16 a[34:35], v68 offset:25600
  ds_read_b64_tr_b16 a[36:37], v69 offset:24576
  ds_read_b64_tr_b16 a[38:39], v69 offset:25600
  ds_read_b64_tr_b16 a[112:113], v70 offset:24576
  ds_read_b64_tr_b16 a[114:115], v70 offset:25600
  ds_read_b64_tr_b16 a[116:117], v71 offset:24576
  ds_read_b64_tr_b16 a[118:119], v71 offset:25600
  s_waitcnt lgkmcnt(0)
  s_waitcnt vmcnt(24)
  s_barrier
  s_add_u32 m0, s41, 24576
  s_add_u32 s36, s77, 1572864
  buffer_load_dwordx4 v64, s[88:91], s36 offen lds
  s_add_u32 m0, s41, 25600
  s_add_u32 s36, s77, 1589248
  buffer_load_dwordx4 v64, s[88:91], s36 offen lds
  s_add_u32 m0, s41, 26624
  s_add_u32 s36, s77, 1605632
  buffer_load_dwordx4 v65, s[88:91], s36 offen lds
  s_add_u32 m0, s41, 27648
  s_add_u32 s36, s77, 1622016
  buffer_load_dwordx4 v65, s[88:91], s36 offen lds
  ds_read_b64_tr_b16 a[152:153], v68 offset:28672
  ds_read_b64_tr_b16 a[154:155], v68 offset:29696
  ds_read_b64_tr_b16 a[156:157], v69 offset:28672
  ds_read_b64_tr_b16 a[158:159], v69 offset:29696
  ds_read_b64_tr_b16 a[200:201], v70 offset:28672
  ds_read_b64_tr_b16 a[202:203], v70 offset:29696
  ds_read_b64_tr_b16 a[204:205], v71 offset:28672
  ds_read_b64_tr_b16 a[206:207], v71 offset:29696
  s_waitcnt lgkmcnt(0)
  s_waitcnt vmcnt(24)
  s_barrier
  s_add_u32 m0, s41, 28672
  s_add_u32 s36, s77, 1572864
  buffer_load_dwordx4 v64, s[92:95], s36 offen lds
  s_add_u32 m0, s41, 29696
  s_add_u32 s36, s77, 1589248
  buffer_load_dwordx4 v64, s[92:95], s36 offen lds
  s_add_u32 m0, s41, 30720
  s_add_u32 s36, s77, 1605632
  buffer_load_dwordx4 v65, s[92:95], s36 offen lds
  s_add_u32 m0, s41, 31744
  s_add_u32 s36, s77, 1622016
  buffer_load_dwordx4 v65, s[92:95], s36 offen lds
  ds_read_b64_tr_b16 v[136:137], v68 offset:0
  ds_read_b64_tr_b16 v[138:139], v68 offset:1024
  ds_read_b64_tr_b16 v[140:141], v69 offset:0
  ds_read_b64_tr_b16 v[142:143], v69 offset:1024
  ds_read_b64_tr_b16 v[216:217], v70 offset:0
  ds_read_b64_tr_b16 v[218:219], v70 offset:1024
  ds_read_b64_tr_b16 v[220:221], v71 offset:0
  ds_read_b64_tr_b16 v[222:223], v71 offset:1024
  s_waitcnt lgkmcnt(0)
  s_waitcnt vmcnt(24)
  s_barrier
  s_add_u32 m0, s41, 0
  s_add_u32 s36, s77, 1572864
  buffer_load_dwordx4 v64, s[96:99], s36 offen lds
  s_add_u32 m0, s41, 1024
  s_add_u32 s36, s77, 1589248
  buffer_load_dwordx4 v64, s[96:99], s36 offen lds
  s_add_u32 m0, s41, 2048
  s_add_u32 s36, s77, 1605632
  buffer_load_dwordx4 v65, s[96:99], s36 offen lds
  s_add_u32 m0, s41, 3072
  s_add_u32 s36, s77, 1622016
  buffer_load_dwordx4 v65, s[96:99], s36 offen lds
  ds_read_b64_tr_b16 a[40:41], v68 offset:4096
  ds_read_b64_tr_b16 a[42:43], v68 offset:5120
  ds_read_b64_tr_b16 a[44:45], v69 offset:4096
  ds_read_b64_tr_b16 a[46:47], v69 offset:5120
  ds_read_b64_tr_b16 a[120:121], v70 offset:4096
  ds_read_b64_tr_b16 a[122:123], v70 offset:5120
  ds_read_b64_tr_b16 a[124:125], v71 offset:4096
  ds_read_b64_tr_b16 a[126:127], v71 offset:5120
  s_waitcnt lgkmcnt(0)
  s_waitcnt vmcnt(24)
  s_barrier
  s_add_u32 m0, s41, 4096
  s_add_u32 s36, s77, 2097152
  buffer_load_dwordx4 v64, s[88:91], s36 offen lds
  s_add_u32 m0, s41, 5120
  s_add_u32 s36, s77, 2113536
  buffer_load_dwordx4 v64, s[88:91], s36 offen lds
  s_add_u32 m0, s41, 6144
  s_add_u32 s36, s77, 2129920
  buffer_load_dwordx4 v65, s[88:91], s36 offen lds
  s_add_u32 m0, s41, 7168
  s_add_u32 s36, s77, 2146304
  buffer_load_dwordx4 v65, s[88:91], s36 offen lds
  ds_read_b64_tr_b16 a[160:161], v68 offset:8192
  ds_read_b64_tr_b16 a[162:163], v68 offset:9216
  ds_read_b64_tr_b16 a[164:165], v69 offset:8192
  ds_read_b64_tr_b16 a[166:167], v69 offset:9216
  ds_read_b64_tr_b16 a[208:209], v70 offset:8192
  ds_read_b64_tr_b16 a[210:211], v70 offset:9216
  ds_read_b64_tr_b16 a[212:213], v71 offset:8192
  ds_read_b64_tr_b16 a[214:215], v71 offset:9216
  s_waitcnt lgkmcnt(0)
  s_waitcnt vmcnt(24)
  s_barrier
  s_add_u32 m0, s41, 8192
  s_add_u32 s36, s77, 2097152
  buffer_load_dwordx4 v64, s[92:95], s36 offen lds
  s_add_u32 m0, s41, 9216
  s_add_u32 s36, s77, 2113536
  buffer_load_dwordx4 v64, s[92:95], s36 offen lds
  s_add_u32 m0, s41, 10240
  s_add_u32 s36, s77, 2129920
  buffer_load_dwordx4 v65, s[92:95], s36 offen lds
  s_add_u32 m0, s41, 11264
  s_add_u32 s36, s77, 2146304
  buffer_load_dwordx4 v65, s[92:95], s36 offen lds
  ds_read_b64_tr_b16 v[144:145], v68 offset:12288
  ds_read_b64_tr_b16 v[146:147], v68 offset:13312
  ds_read_b64_tr_b16 v[148:149], v69 offset:12288
  ds_read_b64_tr_b16 v[150:151], v69 offset:13312
  ds_read_b64_tr_b16 v[224:225], v70 offset:12288
  ds_read_b64_tr_b16 v[226:227], v70 offset:13312
  ds_read_b64_tr_b16 v[228:229], v71 offset:12288
  ds_read_b64_tr_b16 v[230:231], v71 offset:13312
  s_waitcnt lgkmcnt(0)
  s_waitcnt vmcnt(24)
  s_barrier
  s_add_u32 m0, s41, 12288
  s_add_u32 s36, s77, 2097152
  buffer_load_dwordx4 v64, s[96:99], s36 offen lds
  s_add_u32 m0, s41, 13312
  s_add_u32 s36, s77, 2113536
  buffer_load_dwordx4 v64, s[96:99], s36 offen lds
  s_add_u32 m0, s41, 14336
  s_add_u32 s36, s77, 2129920
  buffer_load_dwordx4 v65, s[96:99], s36 offen lds
  s_add_u32 m0, s41, 15360
  s_add_u32 s36, s77, 2146304
  buffer_load_dwordx4 v65, s[96:99], s36 offen lds
  ds_read_b64_tr_b16 a[48:49], v68 offset:16384
  ds_read_b64_tr_b16 a[50:51], v68 offset:17408
  ds_read_b64_tr_b16 a[52:53], v69 offset:16384
  ds_read_b64_tr_b16 a[54:55], v69 offset:17408
  ds_read_b64_tr_b16 a[128:129], v70 offset:16384
  ds_read_b64_tr_b16 a[130:131], v70 offset:17408
  ds_read_b64_tr_b16 a[132:133], v71 offset:16384
  ds_read_b64_tr_b16 a[134:135], v71 offset:17408
  s_waitcnt lgkmcnt(0)
  s_waitcnt vmcnt(24)
  s_barrier
  s_add_u32 m0, s41, 16384
  s_add_u32 s36, s67, 0
  buffer_load_dwordx4 v64, s[88:91], s36 offen lds
  s_add_u32 m0, s41, 17408
  s_add_u32 s36, s67, 16384
  buffer_load_dwordx4 v64, s[88:91], s36 offen lds
  s_add_u32 m0, s41, 18432
  s_add_u32 s36, s67, 32768
  buffer_load_dwordx4 v65, s[88:91], s36 offen lds
  s_add_u32 m0, s41, 19456
  s_add_u32 s36, s67, 49152
  buffer_load_dwordx4 v65, s[88:91], s36 offen lds
  ds_read_b64_tr_b16 a[168:169], v68 offset:20480
  ds_read_b64_tr_b16 a[170:171], v68 offset:21504
  ds_read_b64_tr_b16 a[172:173], v69 offset:20480
  ds_read_b64_tr_b16 a[174:175], v69 offset:21504
  ds_read_b64_tr_b16 a[216:217], v70 offset:20480
  ds_read_b64_tr_b16 a[218:219], v70 offset:21504
  ds_read_b64_tr_b16 a[220:221], v71 offset:20480
  ds_read_b64_tr_b16 a[222:223], v71 offset:21504
  s_waitcnt lgkmcnt(0)
  s_waitcnt vmcnt(24)
  s_barrier
  s_add_u32 m0, s41, 20480
  s_add_u32 s36, s67, 0
  buffer_load_dwordx4 v64, s[92:95], s36 offen lds
  s_add_u32 m0, s41, 21504
  s_add_u32 s36, s67, 16384
  buffer_load_dwordx4 v64, s[92:95], s36 offen lds
  s_add_u32 m0, s41, 22528
  s_add_u32 s36, s67, 32768
  buffer_load_dwordx4 v65, s[92:95], s36 offen lds
  s_add_u32 m0, s41, 23552
  s_add_u32 s36, s67, 49152
  buffer_load_dwordx4 v65, s[92:95], s36 offen lds
  ds_read_b64_tr_b16 v[152:153], v68 offset:24576
  ds_read_b64_tr_b16 v[154:155], v68 offset:25600
  ds_read_b64_tr_b16 v[156:157], v69 offset:24576
  ds_read_b64_tr_b16 v[158:159], v69 offset:25600
  ds_read_b64_tr_b16 v[232:233], v70 offset:24576
  ds_read_b64_tr_b16 v[234:235], v70 offset:25600
  ds_read_b64_tr_b16 v[236:237], v71 offset:24576
  ds_read_b64_tr_b16 v[238:239], v71 offset:25600
  s_waitcnt lgkmcnt(0)
  s_waitcnt vmcnt(24)
  s_barrier
  s_add_u32 m0, s41, 24576
  s_add_u32 s36, s67, 524288
  buffer_load_dwordx4 v64, s[88:91], s36 offen lds
  s_add_u32 m0, s41, 25600
  s_add_u32 s36, s67, 540672
  buffer_load_dwordx4 v64, s[88:91], s36 offen lds
  s_add_u32 m0, s41, 26624
  s_add_u32 s36, s67, 557056
  buffer_load_dwordx4 v65, s[88:91], s36 offen lds
  s_add_u32 m0, s41, 27648
  s_add_u32 s36, s67, 573440
  buffer_load_dwordx4 v65, s[88:91], s36 offen lds
  ds_read_b64_tr_b16 a[56:57], v68 offset:28672
  ds_read_b64_tr_b16 a[58:59], v68 offset:29696
  ds_read_b64_tr_b16 a[60:61], v69 offset:28672
  ds_read_b64_tr_b16 a[62:63], v69 offset:29696
  ds_read_b64_tr_b16 a[136:137], v70 offset:28672
  ds_read_b64_tr_b16 a[138:139], v70 offset:29696
  ds_read_b64_tr_b16 a[140:141], v71 offset:28672
  ds_read_b64_tr_b16 a[142:143], v71 offset:29696
  s_waitcnt lgkmcnt(0)
  s_waitcnt vmcnt(24)
  s_barrier
  s_add_u32 m0, s41, 28672
  s_add_u32 s36, s67, 524288
  buffer_load_dwordx4 v64, s[92:95], s36 offen lds
  s_add_u32 m0, s41, 29696
  s_add_u32 s36, s67, 540672
  buffer_load_dwordx4 v64, s[92:95], s36 offen lds
  s_add_u32 m0, s41, 30720
  s_add_u32 s36, s67, 557056
  buffer_load_dwordx4 v65, s[92:95], s36 offen lds
  s_add_u32 m0, s41, 31744
  s_add_u32 s36, s67, 573440
  buffer_load_dwordx4 v65, s[92:95], s36 offen lds
  ds_read_b64_tr_b16 a[176:177], v68 offset:0
  ds_read_b64_tr_b16 a[178:179], v68 offset:1024
  ds_read_b64_tr_b16 a[180:181], v69 offset:0
  ds_read_b64_tr_b16 a[182:183], v69 offset:1024
  ds_read_b64_tr_b16 a[224:225], v70 offset:0
  ds_read_b64_tr_b16 a[226:227], v70 offset:1024
  ds_read_b64_tr_b16 a[228:229], v71 offset:0
  ds_read_b64_tr_b16 a[230:231], v71 offset:1024
  s_waitcnt lgkmcnt(0)
  s_waitcnt vmcnt(24)
  s_barrier
  s_add_u32 m0, s41, 0
  s_add_u32 s36, s67, 1048576
  buffer_load_dwordx4 v64, s[88:91], s36 offen lds
  s_add_u32 m0, s41, 1024
  s_add_u32 s36, s67, 1064960
  buffer_load_dwordx4 v64, s[88:91], s36 offen lds
  s_add_u32 m0, s41, 2048
  s_add_u32 s36, s67, 1081344
  buffer_load_dwordx4 v65, s[88:91], s36 offen lds
  s_add_u32 m0, s41, 3072
  s_add_u32 s36, s67, 1097728
  buffer_load_dwordx4 v65, s[88:91], s36 offen lds
  ds_read_b64_tr_b16 v[160:161], v68 offset:4096
  ds_read_b64_tr_b16 v[162:163], v68 offset:5120
  ds_read_b64_tr_b16 v[164:165], v69 offset:4096
  ds_read_b64_tr_b16 v[166:167], v69 offset:5120
  ds_read_b64_tr_b16 v[240:241], v70 offset:4096
  ds_read_b64_tr_b16 v[242:243], v70 offset:5120
  ds_read_b64_tr_b16 v[244:245], v71 offset:4096
  ds_read_b64_tr_b16 v[246:247], v71 offset:5120
  s_waitcnt lgkmcnt(0)
  s_waitcnt vmcnt(24)
  s_barrier
  s_add_u32 m0, s41, 4096
  s_add_u32 s36, s67, 1048576
  buffer_load_dwordx4 v64, s[92:95], s36 offen lds
  s_add_u32 m0, s41, 5120
  s_add_u32 s36, s67, 1064960
  buffer_load_dwordx4 v64, s[92:95], s36 offen lds
  s_add_u32 m0, s41, 6144
  s_add_u32 s36, s67, 1081344
  buffer_load_dwordx4 v65, s[92:95], s36 offen lds
  s_add_u32 m0, s41, 7168
  s_add_u32 s36, s67, 1097728
  buffer_load_dwordx4 v65, s[92:95], s36 offen lds
  ds_read_b64_tr_b16 a[64:65], v68 offset:8192
  ds_read_b64_tr_b16 a[66:67], v68 offset:9216
  ds_read_b64_tr_b16 a[68:69], v69 offset:8192
  ds_read_b64_tr_b16 a[70:71], v69 offset:9216
  ds_read_b64_tr_b16 a[144:145], v70 offset:8192
  ds_read_b64_tr_b16 a[146:147], v70 offset:9216
  ds_read_b64_tr_b16 a[148:149], v71 offset:8192
  ds_read_b64_tr_b16 a[150:151], v71 offset:9216
  s_waitcnt lgkmcnt(0)
  s_waitcnt vmcnt(24)
  s_barrier
  s_add_u32 m0, s41, 8192
  s_add_u32 s36, s67, 1572864
  buffer_load_dwordx4 v64, s[88:91], s36 offen lds
  s_add_u32 m0, s41, 9216
  s_add_u32 s36, s67, 1589248
  buffer_load_dwordx4 v64, s[88:91], s36 offen lds
  s_add_u32 m0, s41, 10240
  s_add_u32 s36, s67, 1605632
  buffer_load_dwordx4 v65, s[88:91], s36 offen lds
  s_add_u32 m0, s41, 11264
  s_add_u32 s36, s67, 1622016
  buffer_load_dwordx4 v65, s[88:91], s36 offen lds
  ds_read_b64_tr_b16 a[184:185], v68 offset:12288
  ds_read_b64_tr_b16 a[186:187], v68 offset:13312
  ds_read_b64_tr_b16 a[188:189], v69 offset:12288
  ds_read_b64_tr_b16 a[190:191], v69 offset:13312
  ds_read_b64_tr_b16 a[232:233], v70 offset:12288
  ds_read_b64_tr_b16 a[234:235], v70 offset:13312
  ds_read_b64_tr_b16 a[236:237], v71 offset:12288
  ds_read_b64_tr_b16 a[238:239], v71 offset:13312
  s_waitcnt lgkmcnt(0)
  s_waitcnt vmcnt(24)
  s_barrier
  s_add_u32 m0, s41, 12288
  s_add_u32 s36, s67, 1572864
  buffer_load_dwordx4 v64, s[92:95], s36 offen lds
  s_add_u32 m0, s41, 13312
  s_add_u32 s36, s67, 1589248
  buffer_load_dwordx4 v64, s[92:95], s36 offen lds
  s_add_u32 m0, s41, 14336
  s_add_u32 s36, s67, 1605632
  buffer_load_dwordx4 v65, s[92:95], s36 offen lds
  s_add_u32 m0, s41, 15360
  s_add_u32 s36, s67, 1622016
  buffer_load_dwordx4 v65, s[92:95], s36 offen lds
  ds_read_b64_tr_b16 v[88:89], v68 offset:16384
  ds_read_b64_tr_b16 v[90:91], v68 offset:17408
  ds_read_b64_tr_b16 v[92:93], v69 offset:16384
  ds_read_b64_tr_b16 v[94:95], v69 offset:17408
  ds_read_b64_tr_b16 v[168:169], v70 offset:16384
  ds_read_b64_tr_b16 v[170:171], v70 offset:17408
  ds_read_b64_tr_b16 v[172:173], v71 offset:16384
  ds_read_b64_tr_b16 v[174:175], v71 offset:17408
  s_waitcnt lgkmcnt(0)
  s_waitcnt vmcnt(24)
  s_barrier
  s_add_u32 m0, s41, 16384
  s_add_u32 s36, s67, 2097152
  buffer_load_dwordx4 v64, s[88:91], s36 offen lds
  s_add_u32 m0, s41, 17408
  s_add_u32 s36, s67, 2113536
  buffer_load_dwordx4 v64, s[88:91], s36 offen lds
  s_add_u32 m0, s41, 18432
  s_add_u32 s36, s67, 2129920
  buffer_load_dwordx4 v65, s[88:91], s36 offen lds
  s_add_u32 m0, s41, 19456
  s_add_u32 s36, s67, 2146304
  buffer_load_dwordx4 v65, s[88:91], s36 offen lds
  ds_read_b64_tr_b16 v[248:249], v68 offset:20480
  ds_read_b64_tr_b16 v[250:251], v68 offset:21504
  ds_read_b64_tr_b16 v[252:253], v69 offset:20480
  ds_read_b64_tr_b16 v[254:255], v69 offset:21504
  ds_read_b64_tr_b16 a[72:73], v70 offset:20480
  ds_read_b64_tr_b16 a[74:75], v70 offset:21504
  ds_read_b64_tr_b16 a[76:77], v71 offset:20480
  ds_read_b64_tr_b16 a[78:79], v71 offset:21504
  s_waitcnt lgkmcnt(0)
  s_waitcnt vmcnt(24)
  s_barrier
  s_add_u32 m0, s41, 20480
  s_add_u32 s36, s67, 2097152
  buffer_load_dwordx4 v64, s[92:95], s36 offen lds
  s_add_u32 m0, s41, 21504
  s_add_u32 s36, s67, 2113536
  buffer_load_dwordx4 v64, s[92:95], s36 offen lds
  s_add_u32 m0, s41, 22528
  s_add_u32 s36, s67, 2129920
  buffer_load_dwordx4 v65, s[92:95], s36 offen lds
  s_add_u32 m0, s41, 23552
  s_add_u32 s36, s67, 2146304
  buffer_load_dwordx4 v65, s[92:95], s36 offen lds
  ds_read_b64_tr_b16 v[96:97], v68 offset:24576
  ds_read_b64_tr_b16 v[98:99], v68 offset:25600
  ds_read_b64_tr_b16 v[100:101], v69 offset:24576
  ds_read_b64_tr_b16 v[102:103], v69 offset:25600
  ds_read_b64_tr_b16 v[176:177], v70 offset:24576
  ds_read_b64_tr_b16 v[178:179], v70 offset:25600
  ds_read_b64_tr_b16 v[180:181], v71 offset:24576
  ds_read_b64_tr_b16 v[182:183], v71 offset:25600
  s_waitcnt lgkmcnt(0)
  s_waitcnt vmcnt(24)
  s_barrier
  s_add_u32 m0, s41, 24576
  s_add_u32 s36, s67, 2097152
  buffer_load_dwordx4 v64, s[96:99], s36 offen lds
  s_add_u32 m0, s41, 25600
  s_add_u32 s36, s67, 2113536
  buffer_load_dwordx4 v64, s[96:99], s36 offen lds
  s_add_u32 m0, s41, 26624
  s_add_u32 s36, s67, 2129920
  buffer_load_dwordx4 v65, s[96:99], s36 offen lds
  s_add_u32 m0, s41, 27648
  s_add_u32 s36, s67, 2146304
  buffer_load_dwordx4 v65, s[96:99], s36 offen lds
  v_lshrrev_b32 v15, 2, v0
  buffer_load_dword v62, v15, s[84:87], 0 offen sc1
  ds_read_b64_tr_b16 a[0:1], v68 offset:28672
  ds_read_b64_tr_b16 a[2:3], v68 offset:29696
  ds_read_b64_tr_b16 a[4:5], v69 offset:28672
  ds_read_b64_tr_b16 a[6:7], v69 offset:29696
  ds_read_b64_tr_b16 a[80:81], v70 offset:28672
  ds_read_b64_tr_b16 a[82:83], v70 offset:29696
  ds_read_b64_tr_b16 a[84:85], v71 offset:28672
  ds_read_b64_tr_b16 a[86:87], v71 offset:29696
  s_waitcnt lgkmcnt(0)
  s_waitcnt vmcnt(24)
  s_barrier
  s_add_u32 m0, s41, 28672
  s_add_u32 s36, s40, 256
  buffer_load_dwordx4 v66, s[80:83], s36 offen lds
  s_add_u32 m0, s41, 29696
  s_add_u32 s36, s40, 20736
  buffer_load_dwordx4 v67, s[80:83], s36 offen lds
  s_add_u32 m0, s41, 30720
  s_add_u32 s36, s40, 5376
  buffer_load_dwordx4 v66, s[80:83], s36 offen lds
  s_add_u32 m0, s41, 31744
  s_add_u32 s36, s40, 25856
  buffer_load_dwordx4 v67, s[80:83], s36 offen lds
  ds_read_b64_tr_b16 v[104:105], v68 offset:0
  ds_read_b64_tr_b16 v[106:107], v68 offset:1024
  ds_read_b64_tr_b16 v[108:109], v69 offset:0
  ds_read_b64_tr_b16 v[110:111], v69 offset:1024
  ds_read_b64_tr_b16 v[184:185], v70 offset:0
  ds_read_b64_tr_b16 v[186:187], v70 offset:1024
  ds_read_b64_tr_b16 v[188:189], v71 offset:0
  ds_read_b64_tr_b16 v[190:191], v71 offset:1024
  s_waitcnt lgkmcnt(0)
  s_waitcnt vmcnt(24)
  s_barrier
  s_add_u32 m0, s41, 0
  s_add_u32 s36, s67, 0
  buffer_load_dwordx4 v64, s[96:99], s36 offen lds
  s_add_u32 m0, s41, 1024
  s_add_u32 s36, s67, 16384
  buffer_load_dwordx4 v64, s[96:99], s36 offen lds
  s_add_u32 m0, s41, 2048
  s_add_u32 s36, s67, 32768
  buffer_load_dwordx4 v65, s[96:99], s36 offen lds
  s_add_u32 m0, s41, 3072
  s_add_u32 s36, s67, 49152
  buffer_load_dwordx4 v65, s[96:99], s36 offen lds
  s_load_dwordx2 s[88:89], s[0:1], 8
  s_waitcnt lgkmcnt(0)
  s_mov_b32 s90, 10240
  s_mov_b32 s91, 0x20000
  v_bfe_u32 v60, v0, 6, 2
  v_bfe_u32 v61, v0, 4, 1
  v_lshl_add_u32 v60, v60, 1, v61
  v_mul_u32_u24 v60, 1280, v60
  v_lshrrev_b32 v61, 8, v0
  v_lshl_add_u32 v60, v61, 5, v60
  v_bfe_u32 v61, v0, 5, 1
  v_lshl_add_u32 v60, v61, 4, v60
  s_add_u32 s36, s10, 0
  s_min_u32 s36, s36, 9
  s_lshl_b32 m0, s36, 10
  s_mul_i32 s37, s8, 5
  s_add_u32 s36, s36, s37
  s_sub_u32 s37, s36, 10
  s_cselect_b32 s36, s36, s37
  s_lshl_b32 s36, s36, 7
  buffer_load_dwordx4 v60, s[88:91], s36 offen lds
  s_add_u32 s36, s10, 4
  s_min_u32 s36, s36, 9
  s_lshl_b32 m0, s36, 10
  s_mul_i32 s37, s8, 5
  s_add_u32 s36, s36, s37
  s_sub_u32 s37, s36, 10
  s_cselect_b32 s36, s36, s37
  s_lshl_b32 s36, s36, 7
  buffer_load_dwordx4 v60, s[88:91], s36 offen lds
  s_add_u32 s36, s10, 8
  s_min_u32 s36, s36, 9
  s_lshl_b32 m0, s36, 10
  s_mul_i32 s37, s8, 5
  s_add_u32 s36, s36, s37
  s_sub_u32 s37, s36, 10
  s_cselect_b32 s36, s36, s37
  s_lshl_b32 s36, s36, 7
  buffer_load_dwordx4 v60, s[88:91], s36 offen lds
  ds_read_b64_tr_b16 a[8:9], v68 offset:4096
  ds_read_b64_tr_b16 a[10:11], v68 offset:5120
  ds_read_b64_tr_b16 a[12:13], v69 offset:4096
  ds_read_b64_tr_b16 a[14:15], v69 offset:5120
  ds_read_b64_tr_b16 a[88:89], v70 offset:4096
  ds_read_b64_tr_b16 a[90:91], v70 offset:5120
  ds_read_b64_tr_b16 a[92:93], v71 offset:4096
  ds_read_b64_tr_b16 a[94:95], v71 offset:5120
  s_waitcnt lgkmcnt(0)
  s_waitcnt vmcnt(24)
  s_barrier
  s_add_u32 m0, s41, 4096
  s_add_u32 s36, s67, 524288
  buffer_load_dwordx4 v64, s[96:99], s36 offen lds
  s_add_u32 m0, s41, 5120
  s_add_u32 s36, s67, 540672
  buffer_load_dwordx4 v64, s[96:99], s36 offen lds
  s_add_u32 m0, s41, 6144
  s_add_u32 s36, s67, 557056
  buffer_load_dwordx4 v65, s[96:99], s36 offen lds
  s_add_u32 m0, s41, 7168
  s_add_u32 s36, s67, 573440
  buffer_load_dwordx4 v65, s[96:99], s36 offen lds
  ds_read_b64_tr_b16 v[112:113], v68 offset:8192
  ds_read_b64_tr_b16 v[114:115], v68 offset:9216
  ds_read_b64_tr_b16 v[116:117], v69 offset:8192
  ds_read_b64_tr_b16 v[118:119], v69 offset:9216
  ds_read_b64_tr_b16 v[192:193], v70 offset:8192
  ds_read_b64_tr_b16 v[194:195], v70 offset:9216
  ds_read_b64_tr_b16 v[196:197], v71 offset:8192
  ds_read_b64_tr_b16 v[198:199], v71 offset:9216
  s_waitcnt lgkmcnt(0)
  s_waitcnt vmcnt(24)
  s_barrier
  s_add_u32 m0, s41, 8192
  s_add_u32 s36, s67, 1048576
  buffer_load_dwordx4 v64, s[96:99], s36 offen lds
  s_add_u32 m0, s41, 9216
  s_add_u32 s36, s67, 1064960
  buffer_load_dwordx4 v64, s[96:99], s36 offen lds
  s_add_u32 m0, s41, 10240
  s_add_u32 s36, s67, 1081344
  buffer_load_dwordx4 v65, s[96:99], s36 offen lds
  s_add_u32 m0, s41, 11264
  s_add_u32 s36, s67, 1097728
  buffer_load_dwordx4 v65, s[96:99], s36 offen lds
  ds_read_b64_tr_b16 a[16:17], v68 offset:12288
  ds_read_b64_tr_b16 a[18:19], v68 offset:13312
  ds_read_b64_tr_b16 a[20:21], v69 offset:12288
  ds_read_b64_tr_b16 a[22:23], v69 offset:13312
  ds_read_b64_tr_b16 a[96:97], v70 offset:12288
  ds_read_b64_tr_b16 a[98:99], v70 offset:13312
  ds_read_b64_tr_b16 a[100:101], v71 offset:12288
  ds_read_b64_tr_b16 a[102:103], v71 offset:13312
  s_waitcnt lgkmcnt(0)
  s_waitcnt vmcnt(24)
  s_barrier
  s_add_u32 m0, s41, 12288
  s_add_u32 s36, s67, 1572864
  buffer_load_dwordx4 v64, s[96:99], s36 offen lds
  s_add_u32 m0, s41, 13312
  s_add_u32 s36, s67, 1589248
  buffer_load_dwordx4 v64, s[96:99], s36 offen lds
  s_add_u32 m0, s41, 14336
  s_add_u32 s36, s67, 1605632
  buffer_load_dwordx4 v65, s[96:99], s36 offen lds
  s_add_u32 m0, s41, 15360
  s_add_u32 s36, s67, 1622016
  buffer_load_dwordx4 v65, s[96:99], s36 offen lds
  ds_read_b64_tr_b16 v[120:121], v68 offset:16384
  ds_read_b64_tr_b16 v[122:123], v68 offset:17408
  ds_read_b64_tr_b16 v[124:125], v69 offset:16384
  ds_read_b64_tr_b16 v[126:127], v69 offset:17408
  ds_read_b64_tr_b16 v[200:201], v70 offset:16384
  ds_read_b64_tr_b16 v[202:203], v70 offset:17408
  ds_read_b64_tr_b16 v[204:205], v71 offset:16384
  ds_read_b64_tr_b16 v[206:207], v71 offset:17408
  s_waitcnt lgkmcnt(0)
  s_waitcnt vmcnt(24)
  s_barrier
  s_add_u32 m0, s41, 16384
  s_add_u32 s36, s40, 0
  buffer_load_dwordx4 v66, s[80:83], s36 offen lds
  s_add_u32 m0, s41, 17408
  s_add_u32 s36, s40, 20480
  buffer_load_dwordx4 v67, s[80:83], s36 offen lds
  s_add_u32 m0, s41, 18432
  s_add_u32 s36, s40, 5120
  buffer_load_dwordx4 v66, s[80:83], s36 offen lds
  s_add_u32 m0, s41, 19456
  s_add_u32 s36, s40, 25600
  buffer_load_dwordx4 v67, s[80:83], s36 offen lds
  ds_read_b64_tr_b16 a[24:25], v68 offset:20480
  ds_read_b64_tr_b16 a[26:27], v68 offset:21504
  ds_read_b64_tr_b16 a[28:29], v69 offset:20480
  ds_read_b64_tr_b16 a[30:31], v69 offset:21504
  ds_read_b64_tr_b16 a[104:105], v70 offset:20480
  ds_read_b64_tr_b16 a[106:107], v70 offset:21504
  ds_read_b64_tr_b16 a[108:109], v71 offset:20480
  ds_read_b64_tr_b16 a[110:111], v71 offset:21504
  s_waitcnt lgkmcnt(0)
  s_waitcnt vmcnt(24)
  s_barrier
  s_add_u32 m0, s41, 20480
  s_add_u32 s36, s40, 128
  buffer_load_dwordx4 v66, s[80:83], s36 offen lds
  s_add_u32 m0, s41, 21504
  s_add_u32 s36, s40, 20608
  buffer_load_dwordx4 v67, s[80:83], s36 offen lds
  s_add_u32 m0, s41, 22528
  s_add_u32 s36, s40, 5248
  buffer_load_dwordx4 v66, s[80:83], s36 offen lds
  s_add_u32 m0, s41, 23552
  s_add_u32 s36, s40, 25728
  buffer_load_dwordx4 v67, s[80:83], s36 offen lds
  ds_read_b64_tr_b16 v[32:33], v68 offset:24576
  ds_read_b64_tr_b16 v[34:35], v68 offset:25600
  ds_read_b64_tr_b16 v[36:37], v69 offset:24576
  ds_read_b64_tr_b16 v[38:39], v69 offset:25600
  ds_read_b64_tr_b16 a[192:193], v70 offset:24576
  ds_read_b64_tr_b16 a[194:195], v70 offset:25600
  ds_read_b64_tr_b16 a[196:197], v71 offset:24576
  ds_read_b64_tr_b16 a[198:199], v71 offset:25600
  s_waitcnt lgkmcnt(0)
  s_waitcnt vmcnt(24)
  s_barrier
  ds_write_b128 v12, v[32:35] offset:32768
  ds_write_b128 v12, v[36:39] offset:33792
  s_add_u32 m0, s41, 24576
  s_add_u32 s36, s40, 384
  buffer_load_dwordx4 v66, s[80:83], s36 offen lds
  s_add_u32 m0, s41, 25600
  s_add_u32 s36, s40, 20864
  buffer_load_dwordx4 v67, s[80:83], s36 offen lds
  s_add_u32 m0, s41, 26624
  s_add_u32 s36, s40, 5504
  buffer_load_dwordx4 v66, s[80:83], s36 offen lds
  s_add_u32 m0, s41, 27648
  s_add_u32 s36, s40, 25984
  buffer_load_dwordx4 v67, s[80:83], s36 offen lds
  s_branch L_hs1_26
L_hs_25:
  s_sub_u32 s12, s12, 1
  s_cbranch_scc1 L_cabort
  buffer_load_dword v62, v15, s[84:87], 0 offen sc1
  s_waitcnt vmcnt(0)
L_hs1_26:
  v_readlane_b32 s77, v62, 10
  s_cmp_lt_u32 s77, 192
  s_cbranch_scc1 L_hs_25
  v_readlane_b32 s37, v62, 9
  v_readlane_b32 s36, v62, 0
  s_bcnt1_i32_b32 s36, s36
  s_add_u32 s37, s37, s36
  v_readlane_b32 s36, v62, 1
  s_bcnt1_i32_b32 s36, s36
  s_add_u32 s37, s37, s36
  v_readlane_b32 s36, v62, 2
  s_bcnt1_i32_b32 s36, s36
  s_add_u32 s37, s37, s36
  v_readlane_b32 s36, v62, 3
  s_bcnt1_i32_b32 s36, s36
  s_add_u32 s37, s37, s36
  v_readlane_b32 s36, v62, 4
  s_bcnt1_i32_b32 s36, s36
  s_add_u32 s37, s37, s36
  v_readlane_b32 s36, v62, 37
  s_bcnt1_i32_b32 s36, s36
  s_add_u32 s37, s37, s36
  v_readlane_b32 s36, v62, 6
  s_bcnt1_i32_b32 s36, s36
  s_add_u32 s37, s37, s36
  v_readlane_b32 s36, v62, 39
  s_bcnt1_i32_b32 s36, s36
  s_add_u32 s37, s37, s36
  s_cmp_lt_u32 s37, 256
  s_cbranch_scc1 L_hs_25
  v_readlane_b32 s90, v62, 48
  v_readlane_b32 s91, v62, 49
  s_cmp_lt_u32 s91, 134217728
  s_cbranch_scc1 L_hs_25
  s_bitcmp1_b64 s[90:91], 40
  s_cselect_b32 s36, 8192, 0
  s_add_u32 s76, s76, s36
  s_andn2_b32 s36, s36, s51
  s_add_u32 s22, s22, s36
  s_bitcmp1_b64 s[90:91], 0
  s_cselect_b32 s36, 8192, 0
  s_add_u32 s20, s21, s36
  s_add_u32 s16, s20, 1048576
  s_add_u32 s21, s21, 1048576
  s_lshr_b32 s38, s91, 16
  s_and_b32 s36, s38, 3
  s_lshl_b32 s36, s36, 13
  s_add_u32 s36, s36, 130023424
  s_and_b32 s37, s38, 12
  s_lshl_b32 s37, s37, 11
  s_add_u32 s37, s37, 132120576
  s_cmp_eq_u32 s8, 0
  s_cselect_b32 s19, s36, s37
  s_cselect_b32 s18, s37, s36
  v_lshlrev_b32 v60, 3, v0
  s_mov_b32 m0, 23424
  s_lshl_b32 s36, s10, 13
  s_add_u32 s36, s36, s42
  s_mov_b32 exec_hi, 0xff
  buffer_load_dword v60, s[4:7], s36 offen sc1 lds
  s_mov_b64 exec, 0xffff
  s_add_u32 s36, s15, 163840
  buffer_load_dword v60, s[4:7], s15 offen sc1 lds
  buffer_load_dword v60, s[4:7], s36 offen sc1 lds
  s_mov_b64 exec, -1
  v_readlane_b32 s36, v62, 37
  v_readlane_b32 s37, v62, 39
  s_cmp_eq_u32 s8, 0
  s_cselect_b32 s77, s36, s37
  ds_read_b64_tr_b16 a[240:241], v72 offset:28672
  ds_read_b64_tr_b16 a[242:243], v72 offset:29184
  ds_read_b64_tr_b16 a[244:245], v73 offset:28672
  ds_read_b64_tr_b16 a[246:247], v73 offset:29184
  ds_read_b64_tr_b16 a[248:249], v74 offset:28672
  ds_read_b64_tr_b16 a[250:251], v74 offset:29184
  ds_read_b64_tr_b16 a[252:253], v75 offset:28672
  ds_read_b64_tr_b16 a[254:255], v75 offset:29184
  s_waitcnt lgkmcnt(0)
  s_waitcnt vmcnt(24)
  s_barrier
  s_add_u32 m0, s41, 28672
  s_add_u32 s36, s40, 512
  buffer_load_dwordx4 v66, s[80:83], s36 offen lds
  s_add_u32 m0, s41, 29696
  s_add_u32 s36, s40, 20992
  buffer_load_dwordx4 v67, s[80:83], s36 offen lds
  s_add_u32 m0, s41, 30720
  s_add_u32 s36, s40, 5632
  buffer_load_dwordx4 v66, s[80:83], s36 offen lds
  s_add_u32 m0, s41, 31744
  s_add_u32 s36, s40, 26112
  buffer_load_dwordx4 v67, s[80:83], s36 offen lds
  v_lshrrev_b32 v60, 2, v0
  v_and_b32 v60, 12, v60
  buffer_load_dword v61, v60, s[4:7], s76 offen sc1
  v_lshrrev_b32 v60, 2, v60
  ds_read_b64_tr_b16 v[32:33], v68 offset:0
  ds_read_b64_tr_b16 v[34:35], v68 offset:1024
  ds_read_b64_tr_b16 v[36:37], v69 offset:0
  ds_read_b64_tr_b16 v[38:39], v69 offset:1024
  ds_read_b64_tr_b16 v[40:41], v70 offset:0
  ds_read_b64_tr_b16 v[42:43], v70 offset:1024
  ds_read_b64_tr_b16 v[44:45], v71 offset:0
  ds_read_b64_tr_b16 v[46:47], v71 offset:1024
  s_waitcnt lgkmcnt(0)
  s_waitcnt vmcnt(24)
  s_barrier
  ds_write_b128 v12, v[32:35] offset:0
  ds_write_b128 v12, v[36:39] offset:1024
  ds_write_b128 v12, v[40:43] offset:2048
  ds_write_b128 v12, v[44:47] offset:3072
  ds_read_b64_tr_b16 v[16:17], v68 offset:4096
  ds_read_b64_tr_b16 v[18:19], v68 offset:5120
  ds_read_b64_tr_b16 v[20:21], v69 offset:4096
  ds_read_b64_tr_b16 v[22:23], v69 offset:5120
  ds_read_b64_tr_b16 v[24:25], v70 offset:4096
  ds_read_b64_tr_b16 v[26:27], v70 offset:5120
  ds_read_b64_tr_b16 v[28:29], v71 offset:4096
  ds_read_b64_tr_b16 v[30:31], v71 offset:5120
  s_waitcnt lgkmcnt(0)
  s_waitcnt vmcnt(20)
  s_barrier
  ds_write_b128 v12, v[16:19] offset:4096
  ds_write_b128 v12, v[20:23] offset:5120
  ds_write_b128 v12, v[24:27] offset:6144
  ds_write_b128 v12, v[28:31] offset:7168
  ds_read_b64_tr_b16 v[32:33], v68 offset:8192
  ds_read_b64_tr_b16 v[34:35], v68 offset:9216
  ds_read_b64_tr_b16 v[36:37], v69 offset:8192
  ds_read_b64_tr_b16 v[38:39], v69 offset:9216
  ds_read_b64_tr_b16 v[40:41], v70 offset:8192
  ds_read_b64_tr_b16 v[42:43], v70 offset:9216
  ds_read_b64_tr_b16 v[44:45], v71 offset:8192
  ds_read_b64_tr_b16 v[46:47], v71 offset:9216
  s_waitcnt lgkmcnt(0)
  s_waitcnt vmcnt(16)
  s_barrier
  ds_write_b128 v12, v[32:35] offset:8192
  ds_write_b128 v12, v[36:39] offset:9216
  ds_write_b128 v12, v[40:43] offset:10240
  ds_write_b128 v12, v[44:47] offset:11264
  ds_read_b64_tr_b16 v[16:17], v68 offset:12288
  ds_read_b64_tr_b16 v[18:19], v68 offset:13312
  ds_read_b64_tr_b16 v[20:21], v69 offset:12288
  ds_read_b64_tr_b16 v[22:23], v69 offset:13312
  ds_read_b64_tr_b16 v[24:25], v70 offset:12288
  ds_read_b64_tr_b16 v[26:27], v70 offset:13312
  ds_read_b64_tr_b16 v[28:29], v71 offset:12288
  ds_read_b64_tr_b16 v[30:31], v71 offset:13312
  s_waitcnt lgkmcnt(0)
  s_waitcnt vmcnt(12)
  s_barrier
  ds_write_b128 v12, v[16:19] offset:12288
  ds_write_b128 v12, v[20:23] offset:13312
  ds_write_b128 v12, v[24:27] offset:14336
  ds_write_b128 v12, v[28:31] offset:15360
  ds_read_b64_tr_b16 v[32:33], v72 offset:16384
  ds_read_b64_tr_b16 v[34:35], v72 offset:16896
  ds_read_b64_tr_b16 v[36:37], v73 offset:16384
  ds_read_b64_tr_b16 v[38:39], v73 offset:16896
  ds_read_b64_tr_b16 v[40:41], v74 offset:16384
  ds_read_b64_tr_b16 v[42:43], v74 offset:16896
  ds_read_b64_tr_b16 v[44:45], v75 offset:16384
  ds_read_b64_tr_b16 v[46:47], v75 offset:16896
  s_waitcnt lgkmcnt(0)
  s_waitcnt vmcnt(8)
  s_barrier
  ds_write_b128 v12, v[32:35] offset:16384
  ds_write_b128 v12, v[36:39] offset:17408
  ds_write_b128 v12, v[40:43] offset:18432
  ds_write_b128 v12, v[44:47] offset:19456
  ds_read_b64_tr_b16 v[16:17], v72 offset:20480
  ds_read_b64_tr_b16 v[18:19], v72 offset:20992
  ds_read_b64_tr_b16 v[20:21], v73 offset:20480
  ds_read_b64_tr_b16 v[22:23], v73 offset:20992
  ds_read_b64_tr_b16 v[24:25], v74 offset:20480
  ds_read_b64_tr_b16 v[26:27], v74 offset:20992
  ds_read_b64_tr_b16 v[28:29], v75 offset:20480
  ds_read_b64_tr_b16 v[30:31], v75 offset:20992
  s_waitcnt lgkmcnt(0)
  s_waitcnt vmcnt(4)
  s_barrier
  ds_write_b128 v12, v[16:19] offset:20480
  ds_write_b128 v12, v[20:23] offset:21504
  ds_write_b128 v12, v[24:27] offset:22528
  ds_write_b128 v12, v[28:31] offset:23552
  ds_read_b64_tr_b16 v[32:33], v72 offset:24576
  ds_read_b64_tr_b16 v[34:35], v72 offset:25088
  ds_read_b64_tr_b16 v[36:37], v73 offset:24576
  ds_read_b64_tr_b16 v[38:39], v73 offset:25088
  ds_read_b64_tr_b16 v[40:41], v74 offset:24576
  ds_read_b64_tr_b16 v[42:43], v74 offset:25088
  ds_read_b64_tr_b16 v[44:45], v75 offset:24576
  ds_read_b64_tr_b16 v[46:47], v75 offset:25088
  s_waitcnt lgkmcnt(0)
  s_waitcnt vmcnt(0)
  s_barrier
  ds_write_b128 v12, v[32:35] offset:24576
  ds_write_b128 v12, v[36:39] offset:25600
  ds_write_b128 v12, v[40:43] offset:26624
  ds_write_b128 v12, v[44:47] offset:27648
  s_mov_b32 s39, 0
  s_branch L_rdya_28
L_rdy_27:
  s_sub_u32 s12, s12, 1
  s_cbranch_scc1 L_cabort
  v_lshrrev_b32 v60, 2, v0
  v_and_b32 v60, 12, v60
  buffer_load_dword v61, v60, s[4:7], s76 offen sc1
  v_lshrrev_b32 v60, 2, v60
L_rdya_28:
  s_waitcnt vmcnt(0)
  v_mad_u32_u24 v61, v61, 3, v60
  s_nop 0
  v_readlane_b32 s75, v61, 0
  v_readlane_b32 s36, v61, 1
  s_min_u32 s75, s75, s36
  v_readlane_b32 s36, v61, 2
  s_min_u32 s75, s75, s36
  s_cmp_ge_u32 s75, 64
  s_cselect_b32 s75, 128, s75
  s_cmp_ge_u32 s39, s75
  s_cbranch_scc1 L_rdy_27
  ds_read_b64_tr_b16 v[16:17], v72 offset:28672
  ds_read_b64_tr_b16 v[18:19], v72 offset:29184
  ds_read_b64_tr_b16 v[20:21], v73 offset:28672
  ds_read_b64_tr_b16 v[22:23], v73 offset:29184
  ds_read_b64_tr_b16 v[24:25], v74 offset:28672
  ds_read_b64_tr_b16 v[26:27], v74 offset:29184
  ds_read_b64_tr_b16 v[28:29], v75 offset:28672
  ds_read_b64_tr_b16 v[30:31], v75 offset:29184
  s_waitcnt lgkmcnt(0)
  s_barrier
  ds_write_b128 v12, v[16:19] offset:28672
  ds_write_b128 v12, v[20:23] offset:29696
  ds_write_b128 v12, v[24:27] offset:30720
  ds_write_b128 v12, v[28:31] offset:31744
  s_waitcnt lgkmcnt(0)
L_loaded:
  s_lshr_b32 s36, s10, 1
  s_lshl_b32 s36, s36, 7
  s_lshl_b32 s37, s10, 11
  s_add_u32 s36, s36, s37
  s_add_u32 s50, s36, 10240
  s_add_u32 s14, s20, s37
  s_lshl_b32 s57, s10, 10
  s_add_u32 s53, s57, 5120
  v_mov_b64 v[48:49], 0
  ds_write_b64 v48, v[48:49] offset:23040
  ds_write_b64 v48, v[48:49] offset:23048
  v_lshrrev_b32 v13, 3, v0
  v_and_b32 v13, 60, v13
  v_lshl_add_u32 v13, v0, 2, v13
  s_mov_b32 s82, 0x3f803f80
  s_mov_b32 s83, 0x3f803f80
  s_add_u32 s92, s13, 0
  s_add_u32 s93, s13, 32768
  s_add_u32 s94, s13, 65536
  s_add_u32 s95, s13, 98304
  s_add_u32 s96, s13, 131072
  ds_read_b128 v[52:55], v12 offset:0
  ds_read_b128 v[56:59], v12 offset:1024
  ds_read_b128 v[60:63], v12 offset:2048
  ds_read_b128 v[64:67], v12 offset:3072
  v_mov_b64 v[38:39], 0
  v_mov_b64 v[36:37], 0
  v_mov_b64 v[34:35], 0
  v_mov_b64 v[32:33], 0
  v_mfma_f32_32x32x8_bf16 v[16:31], v[38:39], v[38:39], 0
  s_waitcnt lgkmcnt(0)
  s_cmp_lg_u32 s77, -1
  s_cbranch_scc1 L_safe
  s_cmp_lg_u32 s10, 3
  s_add_u32 s38, s16, s56
  s_add_u32 s39, s11, 1
  v_lshlrev_b32 v14, 3, v0
  s_sub_u32 s36, s76, s38
  s_sub_u32 s36, s36, 128
  s_mov_b32 exec_lo, 0
  v_add_u32 v14, s36, v15
  s_mov_b32 exec_lo, -1
  s_cmp_eq_u32 s75, 128
  s_cbranch_scc1 L_known_29
  v_mov_b32 v48, 0
  ds_read_b128 v[48:51], v48 offset:23040
  s_waitcnt lgkmcnt(0)
  v_mad_u32_u24 v48, v48, 3, 0
  v_mad_u32_u24 v49, v49, 3, 1
  v_mad_u32_u24 v50, v50, 3, 2
  v_min3_u32 v48, v48, v49, v50
  s_nop 0
  v_readfirstlane_b32 s36, v48
  s_max_u32 s75, s75, s36
  s_cmp_ge_u32 s75, 64
  s_cselect_b32 s75, 128, s75
L_known_29:
  v_mov_b64 v[80:81], 0
  s_branch L_tk_f
.p2align 6
L_step_f:
  s_barrier
  s_cbranch_scc1 L_t012_f
  s_add_u32 s37, s18, s57
  s_nop 15
  s_nop 15
  s_nop 11
  s_mov_b32 m0, 0
  s_add_u32 s36, s17, 4096
  buffer_load_dwordx4 v0, s[4:7], s17 offen offset:0 sc1 lds
  buffer_load_dwordx4 v0, s[4:7], s17 offen offset:1024 sc1 lds
  buffer_load_dwordx4 v0, s[4:7], s17 offen offset:2048 sc1 lds
  buffer_load_dwordx4 v0, s[4:7], s17 offen offset:3072 sc1 lds
  s_mov_b32 m0, 4096
  s_nop 0
  buffer_load_dwordx4 v0, s[4:7], s36 offen sc1 lds
  s_nop 15
  s_nop 7
  s_mov_b32 m0, 0
  s_add_u32 s36, s17, 4096
  buffer_load_dwordx4 v0, s[4:7], s17 offen offset:0 sc1 lds
  buffer_load_dwordx4 v0, s[4:7], s17 offen offset:1024 sc1 lds
  buffer_load_dwordx4 v0, s[4:7], s17 offen offset:2048 sc1 lds
  buffer_load_dwordx4 v0, s[4:7], s17 offen offset:3072 sc1 lds
  s_mov_b32 m0, 4096
  s_nop 0
  buffer_load_dwordx4 v0, s[4:7], s36 offen sc1 lds
  s_mov_b32 m0, s50
  s_barrier
  buffer_load_dwordx4 v0, s[4:7], s14 offen offset:0 sc1 lds
  buffer_load_dwordx4 v0, s[4:7], s14 offen offset:1024 sc1 lds
  s_waitcnt vmcnt(7)
  ds_read2st64_b32 v[82:83], v84 offset0:0 offset1:4
  s_waitcnt lgkmcnt(0)
  v_cmp_u_f32 vcc, v82, v83
  s_cbranch_vccnz L_rl_f
L_bl3_f:
  s_barrier
  ds_read_b128 v[40:43], v0 offset:0
  s_mov_b32 m0, s53
  ds_read_b128 v[44:47], v0 offset:1024
  buffer_load_dwordx4 v0, s[4:7], s37 offen sc1 lds
  buffer_load_dwordx4 v0, s[4:7], s37 offen offset:1024 sc1 lds
L_go_f:
  s_cmp_eq_u32 s10, 3
  s_waitcnt lgkmcnt(1)
  v_smfmac_f32_16x16x64_bf16 v[32:35], v[40:43], v[52:59], v1
  ds_read_b128 v[52:55], v12 offset:4096
  v_smfmac_f32_16x16x64_bf16 v[16:19], v[40:43], v[88:95], v1
  ds_read_b128 v[56:59], v12 offset:5120
  v_smfmac_f32_16x16x64_bf16 v[20:23], v[40:43], v[168:175], v1
  ds_read_b128 v[48:51], v0 offset:2048
  s_waitcnt lgkmcnt(3)
  v_smfmac_f32_16x16x64_bf16 v[36:39], v[40:43], v[60:67], v1
  ds_read_b128 v[60:63], v12 offset:6144
  v_smfmac_f32_16x16x64_bf16 v[24:27], v[40:43], v[248:255], v1
  ds_read_b128 v[64:67], v12 offset:7168
  v_smfmac_f32_16x16x64_bf16 v[28:31], v[40:43], a[72:79], v1
  s_waitcnt lgkmcnt(3)
  v_smfmac_f32_16x16x64_bf16 v[32:35], v[44:47], v[52:59], v1
  ds_read_b128 v[52:55], v12 offset:8192
  v_smfmac_f32_16x16x64_bf16 v[16:19], v[44:47], v[96:103], v1
  ds_read_b128 v[56:59], v12 offset:9216
  v_smfmac_f32_16x16x64_bf16 v[20:23], v[44:47], v[176:183], v1
  ds_read_b128 v[40:43], v0 offset:3072
  s_waitcnt lgkmcnt(3)
  v_smfmac_f32_16x16x64_bf16 v[36:39], v[44:47], v[60:67], v1
  ds_read_b128 v[60:63], v12 offset:10240
  v_smfmac_f32_16x16x64_bf16 v[24:27], v[44:47], a[0:7], v1
  ds_read_b128 v[64:67], v12 offset:11264
  v_smfmac_f32_16x16x64_bf16 v[28:31], v[44:47], a[80:87], v1
  s_waitcnt lgkmcnt(3)
  buffer_load_dwordx4 v[68:71], v9, s[4:7], s20 offen offset:0 sc1
  v_smfmac_f32_16x16x64_bf16 v[32:35], v[48:51], v[52:59], v1
  ds_read_b128 v[52:55], v12 offset:12288
  v_smfmac_f32_16x16x64_bf16 v[16:19], v[48:51], v[104:111], v1
  ds_read_b128 v[56:59], v12 offset:13312
  v_smfmac_f32_16x16x64_bf16 v[20:23], v[48:51], v[184:191], v1
  ds_read_b128 v[44:47], v0 offset:4096
  s_waitcnt lgkmcnt(3)
  v_smfmac_f32_16x16x64_bf16 v[36:39], v[48:51], v[60:67], v1
  ds_read_b128 v[60:63], v12 offset:14336
  v_smfmac_f32_16x16x64_bf16 v[24:27], v[48:51], a[8:15], v1
  ds_read_b128 v[64:67], v12 offset:15360
  v_smfmac_f32_16x16x64_bf16 v[28:31], v[48:51], a[88:95], v1
  s_waitcnt lgkmcnt(3)
  buffer_load_dwordx4 v[72:75], v9, s[4:7], s20 offen offset:256 sc1
  v_smfmac_f32_16x16x64_bf16 v[32:35], v[40:43], v[52:59], v1
  ds_read_b128 v[52:55], v12 offset:32768
  v_smfmac_f32_16x16x64_bf16 v[16:19], v[40:43], v[112:119], v1
  ds_read_b128 v[56:59], v12 offset:33792
  v_smfmac_f32_16x16x64_bf16 v[20:23], v[40:43], v[192:199], v1
  s_waitcnt lgkmcnt(2)
  v_smfmac_f32_16x16x64_bf16 v[36:39], v[40:43], v[60:67], v1
  s_cmp_lg_u32 s10, 3
  v_smfmac_f32_16x16x64_bf16 v[24:27], v[40:43], a[16:23], v1
  s_waitcnt lgkmcnt(0)
  v_smfmac_f32_16x16x64_bf16 v[28:31], v[40:43], a[96:103], v1
  s_waitcnt vmcnt(2)
  s_barrier
  ds_read2st64_b32 v[80:81], v13 offset0:20 offset1:24
  v_smfmac_f32_16x16x64_bf16 v[32:35], v[44:47], v[52:59], v1
  ds_read_b128 v[48:51], v0 offset:5120
  v_smfmac_f32_16x16x64_bf16 v[16:19], v[44:47], v[120:127], v1
  ds_read_b128 v[40:43], v0 offset:6144
  s_cmp_ge_u32 s39, s75
  v_smfmac_f32_16x16x64_bf16 v[20:23], v[44:47], v[200:207], v1
  s_cbranch_scc1 L_rdy_f
L_brdy_f:
  v_smfmac_f32_16x16x64_bf16 v[36:39], v[44:47], a[192:199], v1
  s_mov_b32 m0, 22912
  s_waitcnt lgkmcnt(2)
  v_cmp_u_f32 vcc, v80, v81
  v_smfmac_f32_16x16x64_bf16 v[24:27], v[44:47], a[24:31], v1
  s_cbranch_vccnz L_rr_f
L_br_f:
  v_smfmac_f32_16x16x64_bf16 v[28:31], v[44:47], a[104:111], v1
  s_waitcnt lgkmcnt(1)
  s_cmp_eq_u32 s10, 3
  v_smfmac_f32_16x16x64_bf16 v[16:19], v[48:51], v[128:135], v1
  ds_read_b128 v[44:47], v0 offset:7168
  v_smfmac_f32_16x16x64_bf16 v[20:23], v[48:51], v[208:215], v1
  s_mov_b32 exec_hi, 15
  buffer_load_dword v14, s[4:7], s38 offen sc1 lds
  s_mov_b32 exec_hi, -1
  v_smfmac_f32_16x16x64_bf16 v[24:27], v[48:51], a[32:39], v1
  ds_read_b128 v[52:55], v8 offset:10240
  v_smfmac_f32_16x16x64_bf16 v[28:31], v[48:51], a[112:119], v1
  s_waitcnt lgkmcnt(2)
  v_smfmac_f32_16x16x64_bf16 v[16:19], v[40:43], v[136:143], v1
  ds_read_b128 v[48:51], v0 offset:8192
  v_smfmac_f32_16x16x64_bf16 v[20:23], v[40:43], v[216:223], v1
  v_smfmac_f32_16x16x64_bf16 v[24:27], v[40:43], a[40:47], v1
  ds_read_b128 v[56:59], v8 offset:12288
  v_smfmac_f32_16x16x64_bf16 v[28:31], v[40:43], a[120:127], v1
  s_waitcnt lgkmcnt(3)
  v_smfmac_f32_16x16x64_bf16 v[16:19], v[44:47], v[144:151], v1
  ds_read_b128 v[40:43], v0 offset:9216
  v_smfmac_f32_16x16x64_bf16 v[20:23], v[44:47], v[224:231], v1
  v_smfmac_f32_16x16x64_bf16 v[24:27], v[44:47], a[48:55], v1
  ds_read_b128 v[60:63], v8 offset:10368
  v_smfmac_f32_16x16x64_bf16 v[28:31], v[44:47], a[128:135], v1
  s_waitcnt lgkmcnt(3)
  v_smfmac_f32_16x16x64_bf16 v[16:19], v[48:51], v[152:159], v1
  ds_read_b128 v[44:47], v0 offset:5120
  s_waitcnt vmcnt(1)
  v_smfmac_f32_16x16x64_bf16 v[20:23], v[48:51], v[232:239], v1
  s_cbranch_scc1 L_svc_30
  s_mov_b64 exec, s[70:71]
  buffer_store_dwordx4 v[76:79], v0, s[4:7], s63 offen sc1
  s_mov_b64 exec, -1
L_svc_30:
  v_smfmac_f32_16x16x64_bf16 v[24:27], v[48:51], a[56:63], v1
  ds_read_b128 v[64:67], v8 offset:12416
  v_smfmac_f32_16x16x64_bf16 v[28:31], v[48:51], a[136:143], v1
  s_waitcnt lgkmcnt(3)
  v_smfmac_f32_16x16x64_bf16 v[16:19], v[40:43], v[160:167], v1
  s_nop 2
  v_smfmac_f32_16x16x64_bf16 v[20:23], v[40:43], v[240:247], v1
  s_cbranch_scc1 L_svc_31
  buffer_store_dwordx4 v[84:87], v0, s[4:7], s52 offen offset:0
L_svc_31:
  v_smfmac_f32_16x16x64_bf16 v[24:27], v[40:43], a[64:71], v1
  s_nop 1
  v_add_f32 v16, v16, v18
  v_smfmac_f32_16x16x64_bf16 v[28:31], v[40:43], a[144:151], v1
  s_nop 1
  v_add_f32 v17, v17, v19
  v_add_f32 v20, v20, v22
  v_add_f32 v21, v21, v23
  v_cvt_pk_bf16_f32 v82, v16, v20
  v_cvt_pk_bf16_f32 v83, v17, v21
  v_smfmac_f32_16x16x64_bf16 v[32:35], v[40:43], a[184:191], v1
  ds_write2_b32 v2, v82, v83 offset0:0 offset1:136
  v_cmp_u_f32 vcc, v16, v17
  v_smfmac_f32_16x16x64_bf16 v[36:39], v[40:43], a[232:239], v1
  ds_read_b128 v[40:43], v0 offset:6144
  v_add_f32 v24, v24, v26
  v_smfmac_f32_16x16x64_bf16 v[32:35], v[48:51], a[176:183], v1
  s_cbranch_vccnz L_bad_f
L_bbad_f:
  v_smfmac_f32_16x16x64_bf16 v[36:39], v[48:51], a[224:231], v1
  s_cbranch_scc1 L_svc_32
  buffer_store_dwordx4 v[84:87], v0, s[4:7], s52 offen offset:1024
L_svc_32:
  ds_read_b128 v[48:51], v0 offset:7168
  s_waitcnt lgkmcnt(2)
  v_smfmac_f32_16x16x64_bf16 v[32:35], v[44:47], a[152:159], v1
  s_barrier
  ds_read_b128 v[76:79], v3
  v_add_f32 v25, v25, v27
  v_smfmac_f32_16x16x64_bf16 v[36:39], v[44:47], a[200:207], v1
  ds_read_b128 v[80:83], v3 offset:64
  s_waitcnt lgkmcnt(2)
  v_smfmac_f32_16x16x64_bf16 v[32:35], v[40:43], a[160:167], v1
  ds_read_b128 v[16:19], v8 offset:10496
  v_add_f32 v28, v28, v30
  v_smfmac_f32_16x16x64_bf16 v[36:39], v[40:43], a[208:215], v1
  s_cbranch_scc1 L_svc_33
  buffer_store_dwordx2 v[84:85], v7, s[4:7], s54 offen
L_svc_33:
  v_add_f32 v29, v29, v31
  v_smfmac_f32_16x16x64_bf16 v[32:35], v[48:51], a[168:175], v1
  ds_read_b128 v[20:23], v8 offset:12544
  v_cvt_pk_bf16_f32 v14, v24, v28
  v_smfmac_f32_16x16x64_bf16 v[36:39], v[48:51], a[216:223], v1
  s_waitcnt lgkmcnt(2)
  v_cvt_pk_bf16_f32 v15, v25, v29
  v_mfma_f32_16x16x32_bf16 v[52:55], v[52:55], v[76:79], 0
  ds_write2_b32 v2, v14, v15 offset0:64 offset1:200
  v_mfma_f32_16x16x32_bf16 v[52:55], v[56:59], v[80:83], v[52:55]
  ds_read_b128 v[24:27], v8 offset:10624
  v_mov_b64 v[48:49], s[82:83]
  v_mfma_f32_16x16x32_bf16 v[60:63], v[60:63], v[76:79], 0
  ds_read_b128 v[28:31], v8 offset:12672
  v_mov_b64 v[50:51], s[82:83]
  v_mfma_f32_16x16x32_bf16 v[60:63], v[64:67], v[80:83], v[60:63]
  s_waitcnt lgkmcnt(3)
  v_add_f32 v64, v32, v34
  v_add_f32_dpp v84, v54, v52 row_ror:8 row_mask:0xf bank_mask:0x9
  v_mfma_f32_16x16x32_bf16 v[16:19], v[16:19], v[76:79], 0
  v_add_f32 v65, v33, v35
  v_add_f32_dpp v84, v53, v55 row_ror:8 row_mask:0xf bank_mask:0x6
  v_mfma_f32_16x16x32_bf16 v[16:19], v[20:23], v[80:83], v[16:19]
  v_exp_f32 v84, v84
  v_add_f32_dpp v85, v62, v60 row_ror:8 row_mask:0xf bank_mask:0x9
  s_waitcnt lgkmcnt(0)
  v_mfma_f32_16x16x32_bf16 v[24:27], v[24:27], v[76:79], 0
  s_barrier
  ds_read_b128 v[40:43], v4
  v_mfma_f32_16x16x32_bf16 v[24:27], v[28:31], v[80:83], v[24:27]
  ds_read_b128 v[44:47], v4 offset:64
  v_add_f32_dpp v85, v61, v63 row_ror:8 row_mask:0xf bank_mask:0x6
  v_add_f32_dpp v86, v18, v16 row_ror:8 row_mask:0xf bank_mask:0x9
  v_add_f32 v66, v36, v38
  v_exp_f32 v85, v85
  v_add_f32_dpp v86, v17, v19 row_ror:8 row_mask:0xf bank_mask:0x6
  v_add_f32 v67, v37, v39
  v_exp_f32 v86, v86
  v_add_f32_dpp v87, v26, v24 row_ror:8 row_mask:0xf bank_mask:0x9
  v_cvt_pk_bf16_f32 v60, v84, v85
  v_cvt_pk_bf16_f32 v14, v64, v65
  v_add_f32_dpp v87, v25, v27 row_ror:8 row_mask:0xf bank_mask:0x6
  v_cvt_pk_bf16_f32 v15, v66, v67
  s_waitcnt lgkmcnt(0)
  v_mfma_f32_16x16x32_bf16 v[40:43], v[40:43], v[76:79], 0
  v_exp_f32 v87, v87
  v_mfma_f32_16x16x32_bf16 v[40:43], v[44:47], v[80:83], v[40:43]
  v_cvt_pk_bf16_f32 v61, v86, v87
  v_mov_b32_dpp v62, v60 row_ror:8 row_mask:0xf bank_mask:0xf
  v_mov_b32 v81, 0
  v_mov_b32_dpp v63, v61 row_ror:8 row_mask:0xf bank_mask:0xf
  v_mov_b32 v82, 0
  v_mov_b64 v[64:65], 0
  v_mfma_f32_16x16x32_bf16 v[44:47], v[48:51], v[60:63], 0
  s_nop 0
  v_add_f32_dpp v66, v42, v40 row_ror:8 row_mask:0xf bank_mask:0xf
  v_add_f32_dpp v67, v43, v41 row_ror:8 row_mask:0xf bank_mask:0xf
  v_mfma_f32_16x16x32_bf16 v[32:35], v[68:71], v[60:63], 0
  v_mul_f32 v66, s24, v66
  v_mul_f32 v67, s24, v67
  v_exp_f32 v66, v66
  v_exp_f32 v67, v67
  v_mfma_f32_16x16x32_bf16 v[36:39], v[72:75], v[60:63], 0
  v_cvt_pk_bf16_f32 v80, v66, v67
  v_cvt_pk_bf16_f32 v83, v66, v67
  s_nop 0
  v_mfma_f32_16x16x16_bf16 v[44:47], v[48:49], v[80:81], v[44:47]
  ds_read_b128 v[52:55], v12 offset:16384
  ds_read_b128 v[56:59], v12 offset:17408
  v_mfma_f32_16x16x16_bf16 v[32:35], v[14:15], v[80:81], v[32:35]
  ds_read_b128 v[16:19], v12 offset:18432
  ds_read_b128 v[20:23], v12 offset:19456
  v_mfma_f32_16x16x16_bf16 v[36:39], v[14:15], v[82:83], v[36:39]
  ds_read_b128 v[24:27], v12 offset:20480
  ds_read_b128 v[28:31], v12 offset:21504
  v_rcp_f32 v46, v44
  v_subrev_u32 v44, s58, v44
  v_cmp_le_u32 vcc, s62, v44
  v_pk_mul_f32 v[32:33], v[32:33], v[46:47] op_sel_hi:[1,0]
  v_pk_mul_f32 v[34:35], v[34:35], v[46:47] op_sel_hi:[1,0]
  v_cvt_pk_bf16_f32 v84, v32, v33
  v_cvt_pk_bf16_f32 v85, v34, v35
  v_pk_mul_f32 v[36:37], v[36:37], v[46:47] op_sel_hi:[1,0]
  v_pk_mul_f32 v[38:39], v[38:39], v[46:47] op_sel_hi:[1,0]
  v_mov_b32_dpp v86, v84 row_ror:8 row_mask:0xf bank_mask:0xf
  v_mov_b32_dpp v87, v85 row_ror:8 row_mask:0xf bank_mask:0xf
  s_mov_b64 exec, s[26:27]
  v_cvt_pk_bf16_f32 v86, v36, v37
  v_cvt_pk_bf16_f32 v87, v38, v39
  s_mov_b64 exec, -1
  ds_write_b64 v5, v[86:87]
  s_cbranch_vccnz L_max_f
L_bmax2_f:
  v_mfma_f32_32x32x8_bf16 v[32:47], v[64:65], v[64:65], 0
  ds_read_b128 v[68:71], v12 offset:24576
  ds_read_b128 v[72:75], v12 offset:25600
  s_cmp_eq_u32 s11, 63
  s_waitcnt lgkmcnt(2)
  s_barrier
  ds_read_b128 v[76:79], v0 offset:0
  ds_read_b128 v[80:83], v0 offset:1024
  s_cbranch_scc1 L_done_f
  v_mfma_f32_16x16x16_bf16 v[48:51], v[64:65], v[64:65], 0
  ds_read_b128 v[60:63], v12 offset:22528
  ds_read_b128 v[64:67], v12 offset:23552
  s_cmp_eq_u32 s23, 0
  s_waitcnt lgkmcnt(3)
  v_smfmac_f32_16x16x64_bf16 v[32:35], v[76:79], v[52:59], v1
  ds_read_b128 v[52:55], v12 offset:26624
  s_waitcnt lgkmcnt(3)
  v_smfmac_f32_16x16x64_bf16 v[32:35], v[80:83], v[16:23], v1
  ds_read_b128 v[56:59], v12 offset:27648
  s_nop 0
  v_smfmac_f32_16x16x64_bf16 v[40:43], v[76:79], v[24:31], v1
  ds_read_b128 v[16:19], v12 offset:28672
  s_waitcnt lgkmcnt(3)
  v_smfmac_f32_16x16x64_bf16 v[40:43], v[80:83], v[60:67], v1
  ds_read_b128 v[20:23], v12 offset:29696
  s_nop 0
  v_add_f32 v32, v32, v34
  v_smfmac_f32_16x16x64_bf16 v[36:39], v[76:79], a[240:247], v1
  ds_read_b128 v[24:27], v12 offset:30720
  v_add_f32 v33, v33, v35
  v_cvt_pk_bf16_f32 v32, v32, v33
  v_smfmac_f32_16x16x64_bf16 v[36:39], v[80:83], a[248:255], v1
  buffer_store_dword v32, v6, s[4:7], s92 offen
  ds_read_b128 v[28:31], v12 offset:31744
  v_add_f32 v40, v40, v42
  v_smfmac_f32_16x16x64_bf16 v[44:47], v[76:79], v[68:75], v1
  s_waitcnt lgkmcnt(2)
  v_add_f32 v41, v41, v43
  v_cvt_pk_bf16_f32 v40, v40, v41
  v_smfmac_f32_16x16x64_bf16 v[44:47], v[80:83], v[52:59], v1
  buffer_store_dword v40, v6, s[4:7], s93 offen
  v_add_f32 v36, v36, v38
  v_smfmac_f32_16x16x64_bf16 v[48:51], v[76:79], v[16:23], v1
  s_waitcnt lgkmcnt(0)
  s_nop 0
  v_add_f32 v37, v37, v39
  v_cvt_pk_bf16_f32 v36, v36, v37
  v_smfmac_f32_16x16x64_bf16 v[48:51], v[80:83], v[24:31], v1
  buffer_store_dword v36, v6, s[4:7], s94 offen
  v_add_f32 v44, v44, v46
  v_add_f32 v45, v45, v47
  v_cvt_pk_bf16_f32 v44, v44, v45
  s_nop 1
  buffer_store_dword v44, v6, s[4:7], s95 offen
  s_nop 0
  v_add_f32 v48, v48, v50
  v_add_f32 v49, v49, v51
  v_cvt_pk_bf16_f32 v48, v48, v49
  buffer_store_dword v48, v6, s[4:7], s96 offen
  s_cbranch_scc1 L_nr_f
  ds_write2_b32 v11, v14, v15 offset0:0 offset1:64
  s_add_u32 s22, s22, s74
  s_lshr_b32 s37, s11, 3
  s_bitcmp1_b32 s91, s37
  s_cselect_b32 s37, s51, 0
  s_add_u32 s63, s22, s37
  s_add_u32 s11, s11, 1
  s_or_b32 s54, s17, s60
  s_or_b32 s52, s15, s60
  s_and_b32 s37, s11, 3
  s_lshl_b32 s37, s37, 13
  s_add_u32 s17, s42, s37
  s_add_u32 s19, s19, 32768
  s_add_u32 s18, s18, 32768
  s_and_b32 s37, s11, 15
  s_cselect_b32 s37, 0, 0x4000
  s_xor_b32 s19, s19, s37
  s_xor_b32 s18, s18, s37
  s_add_u32 s92, s92, s43
  s_add_u32 s93, s93, s43
  s_add_u32 s94, s94, s43
  s_add_u32 s95, s95, s43
  s_add_u32 s96, s96, s43
  v_lshrrev_b32 v15, 2, v0
  s_nop 6
  buffer_load_dwordx4 v[40:43], v0, s[4:7], s15 offen sc1
  buffer_load_dwordx4 v[44:47], v0, s[4:7], s15 offen offset:1024 sc1
  v_and_b32 v14, 64, v0
  v_lshrrev_b32 v14, 2, v14
  v_lshlrev_b32 v14, v14, s59
  v_cndmask_b32 v48, 0, v14, s[28:29]
  v_cndmask_b32 v49, 0, v14, s[30:31]
  v_cndmask_b32 v50, 0, v14, s[32:33]
  v_cndmask_b32 v51, 0, v14, s[34:35]
  s_mov_b32 s20, s16
  s_add_u32 s14, s20, s55
  s_add_u32 s21, s21, 1048576
  s_add_u32 s37, s11, 1
  s_lshr_b32 s37, s37, 1
  s_bitcmp1_b64 s[90:91], s37
  s_cselect_b32 s37, 8192, 0
  s_add_u32 s16, s21, s37
  s_nop 7
  buffer_load_dwordx4 v[68:71], v0, s[4:7], s15 offen sc1
  buffer_load_dwordx4 v[72:75], v0, s[4:7], s15 offen offset:1024 sc1
  v_mov_b64 v[38:39], 0
  v_mov_b64 v[36:37], 0
  v_mov_b64 v[34:35], 0
  v_mov_b64 v[32:33], 0
  v_mfma_f32_32x32x8_bf16 v[16:31], v[38:39], v[38:39], 0
  ds_read_b128 v[52:55], v12 offset:0
  ds_read_b128 v[56:59], v12 offset:1024
  ds_read_b128 v[60:63], v12 offset:2048
  ds_read_b128 v[64:67], v12 offset:3072
  s_waitcnt vmcnt(3)
  v_mfma_f32_16x16x32_bf16 v[80:83], v[48:51], v[40:43], 0
  v_fma_f32 v14, v40, v41, v42
  s_waitcnt vmcnt(2)
  v_mfma_f32_16x16x32_bf16 v[80:83], v[48:51], v[44:47], v[80:83]
  v_fma_f32 v14, v43, v44, v14
  v_fma_f32 v14, v45, v46, v14
  v_cmp_u_f32 vcc, v14, v47
  s_nop 3
  s_cbranch_vccnz L_rred0_f
  v_add_f32_dpp v80, v80, v80 row_ror:4 row_mask:0xf bank_mask:0xf
  v_add_f32_dpp v81, v81, v81 row_ror:4 row_mask:0xf bank_mask:0xf
  v_add_f32_dpp v82, v82, v82 row_ror:4 row_mask:0xf bank_mask:0xf
  v_add_f32_dpp v83, v83, v83 row_ror:4 row_mask:0xf bank_mask:0xf
  v_add_f32_dpp v80, v80, v80 row_ror:8 row_mask:0xf bank_mask:0xf
  v_add_f32_dpp v81, v81, v81 row_ror:8 row_mask:0xf bank_mask:0xf
  v_add_f32_dpp v82, v82, v82 row_ror:8 row_mask:0xf bank_mask:0xf
  v_add_f32_dpp v83, v83, v83 row_ror:8 row_mask:0xf bank_mask:0xf
  v_cvt_pk_bf16_f32 v80, v80, v81
  v_cvt_pk_bf16_f32 v81, v82, v83
  buffer_store_dwordx2 v[80:81], v7, s[4:7], s17 offen
  buffer_store_dwordx2 v[80:81], v7, s[4:7], s19 offen sc1
L_nored_34:
  s_add_u32 s15, s15, s43
  s_sub_u32 s43, 0, s43
  s_waitcnt lgkmcnt(0)
  s_cmp_lg_u32 s10, 3
  s_branch L_step_f
L_nr_f:
  ds_write2_b32 v11, v14, v15 offset0:0 offset1:64
  s_add_u32 s22, s22, s74
  s_lshr_b32 s37, s11, 3
  s_bitcmp1_b32 s91, s37
  s_cselect_b32 s37, s51, 0
  s_add_u32 s63, s22, s37
  s_add_u32 s11, s11, 1
  s_or_b32 s54, s17, s60
  s_or_b32 s52, s15, s60
  s_and_b32 s37, s11, 3
  s_lshl_b32 s37, s37, 13
  s_add_u32 s17, s42, s37
  s_add_u32 s19, s19, 32768
  s_add_u32 s18, s18, 32768
  s_and_b32 s37, s11, 15
  s_cselect_b32 s37, 0, 0x4000
  s_xor_b32 s19, s19, s37
  s_xor_b32 s18, s18, s37
  s_add_u32 s92, s92, s43
  s_add_u32 s93, s93, s43
  s_add_u32 s94, s94, s43
  s_add_u32 s95, s95, s43
  s_add_u32 s96, s96, s43
  v_lshrrev_b32 v15, 2, v0
  s_mov_b32 s20, s16
  s_add_u32 s14, s20, s55
  s_add_u32 s21, s21, 1048576
  s_add_u32 s37, s11, 1
  s_lshr_b32 s37, s37, 1
  s_bitcmp1_b64 s[90:91], s37
  s_cselect_b32 s37, 8192, 0
  s_add_u32 s16, s21, s37
  ds_read_b128 v[52:55], v12 offset:0
  ds_read_b128 v[56:59], v12 offset:1024
  ds_read_b128 v[60:63], v12 offset:2048
  ds_read_b128 v[64:67], v12 offset:3072
  v_mov_b64 v[38:39], 0
  v_mov_b64 v[36:37], 0
  v_mov_b64 v[34:35], 0
  v_mov_b64 v[32:33], 0
  v_mfma_f32_32x32x8_bf16 v[16:31], v[38:39], v[38:39], 0
  s_add_u32 s38, s16, s56
  s_add_u32 s39, s11, 1
  v_lshlrev_b32 v14, 3, v0
  s_sub_u32 s36, s76, s38
  s_sub_u32 s36, s36, 128
  s_mov_b32 exec_lo, 0
  v_add_u32 v14, s36, v15
  s_mov_b32 exec_lo, -1
  s_cmp_eq_u32 s75, 128
  s_cbranch_scc1 L_known_35
  v_mov_b32 v48, 0
  ds_read_b128 v[48:51], v48 offset:23040
  s_waitcnt lgkmcnt(0)
  v_mad_u32_u24 v48, v48, 3, 0
  v_mad_u32_u24 v49, v49, 3, 1
  v_mad_u32_u24 v50, v50, 3, 2
  v_min3_u32 v48, v48, v49, v50
  s_nop 0
  v_readfirstlane_b32 s36, v48
  s_max_u32 s75, s75, s36
  s_cmp_ge_u32 s75, 64
  s_cselect_b32 s75, 128, s75
L_known_35:
  v_lshrrev_b32 v84, 3, v0
  v_and_b32 v84, 60, v84
  v_lshl_add_u32 v84, v0, 2, v84
  s_branch L_nored_34
L_t012_f:
  s_add_u32 s38, s16, s56
  s_add_u32 s39, s11, 1
  v_lshlrev_b32 v14, 3, v0
  s_sub_u32 s36, s76, s38
  s_sub_u32 s36, s36, 128
  s_mov_b32 exec_lo, 0
  v_add_u32 v14, s36, v15
  s_mov_b32 exec_lo, -1
  s_cmp_eq_u32 s75, 128
  s_cbranch_scc1 L_known_36
  v_mov_b32 v48, 0
  ds_read_b128 v[48:51], v48 offset:23040
  s_waitcnt lgkmcnt(0)
  v_mad_u32_u24 v48, v48, 3, 0
  v_mad_u32_u24 v49, v49, 3, 1
  v_mad_u32_u24 v50, v50, 3, 2
  v_min3_u32 v48, v48, v49, v50
  s_nop 0
  v_readfirstlane_b32 s36, v48
  s_max_u32 s75, s75, s36
  s_cmp_ge_u32 s75, 64
  s_cselect_b32 s75, 128, s75
L_known_36:
  s_waitcnt vmcnt(2)
  ds_read_b128 v[76:79], v10
  v_mov_b64 v[84:85], s[68:69]
  v_mov_b64 v[86:87], s[68:69]
  s_sub_u32 s36, s11, 1
  v_mov_b32 v48, s36
  s_waitcnt lgkmcnt(0)
  v_cndmask_b32 v76, v76, v48, s[72:73]
  s_barrier
  s_mov_b32 m0, s50
  s_nop 0
  buffer_load_dwordx4 v0, s[4:7], s14 offen offset:0 sc1 lds
  buffer_load_dwordx4 v0, s[4:7], s14 offen offset:1024 sc1 lds
  s_mov_b32 m0, s53
  s_add_u32 s37, s18, s57
  s_barrier
  ds_read_b128 v[40:43], v0 offset:0
  ds_read_b128 v[44:47], v0 offset:1024
  buffer_load_dwordx4 v0, s[4:7], s37 offen sc1 lds
  s_branch L_go_f
L_tk_f:
  s_mov_b32 m0, s50
  s_nop 0
  buffer_load_dwordx4 v0, s[4:7], s14 offen offset:0 sc1 lds
  buffer_load_dwordx4 v0, s[4:7], s14 offen offset:1024 sc1 lds
  s_barrier
  ds_read_b128 v[40:43], v0 offset:0
  ds_read_b128 v[44:47], v0 offset:1024
  s_branch L_go_f
L_rred0_f:
  s_add_u32 s64, s64, 1
  buffer_load_dwordx4 v[40:43], v0, s[4:7], s15 offen sc1
  buffer_load_dwordx4 v[44:47], v0, s[4:7], s15 offen offset:1024 sc1
  s_waitcnt vmcnt(3)
  v_mfma_f32_16x16x32_bf16 v[80:83], v[48:51], v[68:71], 0
  v_fma_f32 v14, v68, v69, v70
  s_waitcnt vmcnt(2)
  v_mfma_f32_16x16x32_bf16 v[80:83], v[48:51], v[72:75], v[80:83]
  v_fma_f32 v14, v71, v72, v14
  v_fma_f32 v14, v73, v74, v14
  v_cmp_u_f32 vcc, v14, v75
  s_nop 3
  s_cbranch_vccnz L_rred1_f
L_bred_f:
  v_add_f32_dpp v80, v80, v80 row_ror:4 row_mask:0xf bank_mask:0xf
  v_add_f32_dpp v81, v81, v81 row_ror:4 row_mask:0xf bank_mask:0xf
  v_add_f32_dpp v82, v82, v82 row_ror:4 row_mask:0xf bank_mask:0xf
  v_add_f32_dpp v83, v83, v83 row_ror:4 row_mask:0xf bank_mask:0xf
  v_add_f32_dpp v80, v80, v80 row_ror:8 row_mask:0xf bank_mask:0xf
  v_add_f32_dpp v81, v81, v81 row_ror:8 row_mask:0xf bank_mask:0xf
  v_add_f32_dpp v82, v82, v82 row_ror:8 row_mask:0xf bank_mask:0xf
  v_add_f32_dpp v83, v83, v83 row_ror:8 row_mask:0xf bank_mask:0xf
  v_cvt_pk_bf16_f32 v80, v80, v81
  v_cvt_pk_bf16_f32 v81, v82, v83
  buffer_store_dwordx2 v[80:81], v7, s[4:7], s17 offen
  buffer_store_dwordx2 v[80:81], v7, s[4:7], s19 offen sc1
  s_branch L_nored_34
L_rred1_f:
  s_add_u32 s64, s64, 1
  s_sub_u32 s12, s12, 1
  s_cbranch_scc1 L_cabort
  s_and_b32 s36, s12, 7
  s_cbranch_scc1 L_go_37
  s_mov_b64 s[40:41], 0
  v_cmp_eq_u32 vcc, s25, v68
  s_or_b64 s[40:41], s[40:41], vcc
  v_cmp_eq_u32 vcc, s25, v69
  s_or_b64 s[40:41], s[40:41], vcc
  v_cmp_eq_u32 vcc, s25, v70
  s_or_b64 s[40:41], s[40:41], vcc
  v_cmp_eq_u32 vcc, s25, v71
  s_or_b64 s[40:41], s[40:41], vcc
  v_cmp_eq_u32 vcc, s25, v72
  s_or_b64 s[40:41], s[40:41], vcc
  v_cmp_eq_u32 vcc, s25, v73
  s_or_b64 s[40:41], s[40:41], vcc
  v_cmp_eq_u32 vcc, s25, v74
  s_or_b64 s[40:41], s[40:41], vcc
  v_cmp_eq_u32 vcc, s25, v75
  s_or_b64 s[40:41], s[40:41], vcc
  s_cbranch_scc0 L_bred_f
L_go_37:
  buffer_load_dwordx4 v[68:71], v0, s[4:7], s15 offen sc1
  buffer_load_dwordx4 v[72:75], v0, s[4:7], s15 offen offset:1024 sc1
  s_waitcnt vmcnt(3)
  v_mfma_f32_16x16x32_bf16 v[80:83], v[48:51], v[40:43], 0
  v_fma_f32 v14, v40, v41, v42
  s_waitcnt vmcnt(2)
  v_mfma_f32_16x16x32_bf16 v[80:83], v[48:51], v[44:47], v[80:83]
  v_fma_f32 v14, v43, v44, v14
  v_fma_f32 v14, v45, v46, v14
  v_cmp_u_f32 vcc, v14, v47
  s_nop 3
  s_cbranch_vccnz L_rred0_f
  v_add_f32_dpp v80, v80, v80 row_ror:4 row_mask:0xf bank_mask:0xf
  v_add_f32_dpp v81, v81, v81 row_ror:4 row_mask:0xf bank_mask:0xf
  v_add_f32_dpp v82, v82, v82 row_ror:4 row_mask:0xf bank_mask:0xf
  v_add_f32_dpp v83, v83, v83 row_ror:4 row_mask:0xf bank_mask:0xf
  v_add_f32_dpp v80, v80, v80 row_ror:8 row_mask:0xf bank_mask:0xf
  v_add_f32_dpp v81, v81, v81 row_ror:8 row_mask:0xf bank_mask:0xf
  v_add_f32_dpp v82, v82, v82 row_ror:8 row_mask:0xf bank_mask:0xf
  v_add_f32_dpp v83, v83, v83 row_ror:8 row_mask:0xf bank_mask:0xf
  v_cvt_pk_bf16_f32 v80, v80, v81
  v_cvt_pk_bf16_f32 v81, v82, v83
  buffer_store_dwordx2 v[80:81], v7, s[4:7], s17 offen
  buffer_store_dwordx2 v[80:81], v7, s[4:7], s19 offen sc1
  s_branch L_nored_34
L_rl_f:
  s_add_u32 s65, s65, 0x10000
  s_waitcnt vmcnt(2)
  ds_read2st64_b32 v[82:83], v84 offset0:0 offset1:4
  s_mov_b32 m0, 0
  s_add_u32 s36, s17, 4096
  buffer_load_dwordx4 v0, s[4:7], s17 offen offset:0 sc1 lds
  buffer_load_dwordx4 v0, s[4:7], s17 offen offset:1024 sc1 lds
  buffer_load_dwordx4 v0, s[4:7], s17 offen offset:2048 sc1 lds
  buffer_load_dwordx4 v0, s[4:7], s17 offen offset:3072 sc1 lds
  s_mov_b32 m0, 4096
  s_nop 0
  buffer_load_dwordx4 v0, s[4:7], s36 offen sc1 lds
  s_waitcnt lgkmcnt(0)
  v_cmp_u_f32 vcc, v82, v83
  s_cbranch_vccz L_bl3_f
  s_branch L_rl4_f
L_rl3_f:
  s_mov_b32 m0, 0
  s_add_u32 s36, s17, 4096
  buffer_load_dwordx4 v0, s[4:7], s17 offen offset:0 sc1 lds
  buffer_load_dwordx4 v0, s[4:7], s17 offen offset:1024 sc1 lds
  buffer_load_dwordx4 v0, s[4:7], s17 offen offset:2048 sc1 lds
  buffer_load_dwordx4 v0, s[4:7], s17 offen offset:3072 sc1 lds
  s_mov_b32 m0, 4096
  s_nop 0
  buffer_load_dwordx4 v0, s[4:7], s36 offen sc1 lds
L_rl4_f:
  s_add_u32 s65, s65, 1
  s_mov_b64 s[40:41], 0
  v_cmp_eq_u32 vcc, s25, v82
  s_or_b64 s[40:41], s[40:41], vcc
  v_cmp_eq_u32 vcc, s25, v83
  s_or_b64 s[40:41], s[40:41], vcc
  s_cbranch_scc0 L_bl3_f
  s_sub_u32 s12, s12, 1
  s_cbranch_scc1 L_cabort
  s_waitcnt vmcnt(0)
  ds_read2st64_b32 v[82:83], v84 offset0:0 offset1:4
  s_waitcnt lgkmcnt(0)
  v_cmp_u_f32 vcc, v82, v83
  s_cbranch_vccz L_bl3_f
  s_branch L_rl3_f
L_rlx_f:
  s_add_u32 s65, s65, 1
  s_mov_b32 m0, 0
  s_add_u32 s36, s17, 4096
  buffer_load_dwordx4 v0, s[4:7], s17 offen offset:0 sc1 lds
  buffer_load_dwordx4 v0, s[4:7], s17 offen offset:1024 sc1 lds
  buffer_load_dwordx4 v0, s[4:7], s17 offen offset:2048 sc1 lds
  buffer_load_dwordx4 v0, s[4:7], s17 offen offset:3072 sc1 lds
  s_mov_b32 m0, 4096
  s_nop 0
  buffer_load_dwordx4 v0, s[4:7], s36 offen sc1 lds
  s_waitcnt vmcnt(5)
  v_cmp_u_f32 vcc, v82, v83
  s_cbranch_vccz L_bl2_f
  s_mov_b64 s[40:41], 0
  v_cmp_eq_u32 vcc, s25, v82
  s_or_b64 s[40:41], s[40:41], vcc
  v_cmp_eq_u32 vcc, s25, v83
  s_or_b64 s[40:41], s[40:41], vcc
  s_cbranch_scc0 L_bl2_f
  s_sub_u32 s12, s12, 1
  s_cbranch_scc1 L_cabort
  s_branch L_rl_f
L_bl2_f:
  s_waitcnt vmcnt(0)
  s_branch L_bl3_f
L_rr_f:
  s_cmp_eq_u32 s11, 0
  s_cbranch_scc1 L_br_f
  s_mov_b64 s[40:41], 0
  v_cmp_eq_u32 vcc, s25, v80
  s_or_b64 s[40:41], s[40:41], vcc
  v_cmp_eq_u32 vcc, s25, v81
  s_or_b64 s[40:41], s[40:41], vcc
  s_cbranch_scc0 L_br_f
  s_waitcnt lgkmcnt(0)
  s_barrier
  s_sub_u32 s12, s12, 1
  s_cbranch_scc1 L_cabort
  s_cmp_lg_u32 s10, 3
  s_cbranch_scc1 L_w3_38
  s_add_u32 s66, s66, 1
  s_mov_b32 m0, 5120
  s_add_u32 s36, s18, 4096
  buffer_load_dwordx4 v0, s[4:7], s18 offen offset:0 sc1 lds
  buffer_load_dwordx4 v0, s[4:7], s18 offen offset:1024 sc1 lds
  buffer_load_dwordx4 v0, s[4:7], s18 offen offset:2048 sc1 lds
  buffer_load_dwordx4 v0, s[4:7], s18 offen offset:3072 sc1 lds
  s_mov_b32 m0, 9216
  s_nop 0
  buffer_load_dwordx4 v0, s[4:7], s36 offen sc1 lds
  s_mov_b32 m0, 22912
  s_waitcnt vmcnt(0)
L_w3_38:
  s_barrier
  ds_read2st64_b32 v[80:81], v13 offset0:20 offset1:24
  ds_read_b128 v[48:51], v0 offset:5120
  ds_read_b128 v[40:43], v0 offset:6144
  s_waitcnt lgkmcnt(0)
  v_cmp_u_f32 vcc, v80, v81
  s_cbranch_vccz L_br_f
  s_branch L_rr_f
L_bad_f:
  s_cmp_eq_u32 s11, 0
  s_cbranch_scc1 L_clean_39
  s_mov_b64 s[40:41], 0
  ds_read_b128 v[76:79], v0 offset:0
  s_waitcnt lgkmcnt(0)
  v_cmp_eq_u32 vcc, s25, v76
  s_or_b64 s[40:41], s[40:41], vcc
  v_cmp_eq_u32 vcc, s25, v77
  s_or_b64 s[40:41], s[40:41], vcc
  v_cmp_eq_u32 vcc, s25, v78
  s_or_b64 s[40:41], s[40:41], vcc
  v_cmp_eq_u32 vcc, s25, v79
  s_or_b64 s[40:41], s[40:41], vcc
  ds_read_b128 v[76:79], v0 offset:1024
  s_waitcnt lgkmcnt(0)
  v_cmp_eq_u32 vcc, s25, v76
  s_or_b64 s[40:41], s[40:41], vcc
  v_cmp_eq_u32 vcc, s25, v77
  s_or_b64 s[40:41], s[40:41], vcc
  v_cmp_eq_u32 vcc, s25, v78
  s_or_b64 s[40:41], s[40:41], vcc
  v_cmp_eq_u32 vcc, s25, v79
  s_or_b64 s[40:41], s[40:41], vcc
  ds_read_b128 v[76:79], v0 offset:2048
  s_waitcnt lgkmcnt(0)
  v_cmp_eq_u32 vcc, s25, v76
  s_or_b64 s[40:41], s[40:41], vcc
  v_cmp_eq_u32 vcc, s25, v77
  s_or_b64 s[40:41], s[40:41], vcc
  v_cmp_eq_u32 vcc, s25, v78
  s_or_b64 s[40:41], s[40:41], vcc
  v_cmp_eq_u32 vcc, s25, v79
  s_or_b64 s[40:41], s[40:41], vcc
  ds_read_b128 v[76:79], v0 offset:3072
  s_waitcnt lgkmcnt(0)
  v_cmp_eq_u32 vcc, s25, v76
  s_or_b64 s[40:41], s[40:41], vcc
  v_cmp_eq_u32 vcc, s25, v77
  s_or_b64 s[40:41], s[40:41], vcc
  v_cmp_eq_u32 vcc, s25, v78
  s_or_b64 s[40:41], s[40:41], vcc
  v_cmp_eq_u32 vcc, s25, v79
  s_or_b64 s[40:41], s[40:41], vcc
  ds_read_b128 v[76:79], v0 offset:4096
  s_waitcnt lgkmcnt(0)
  v_cmp_eq_u32 vcc, s25, v76
  s_or_b64 s[40:41], s[40:41], vcc
  v_cmp_eq_u32 vcc, s25, v77
  s_or_b64 s[40:41], s[40:41], vcc
  v_cmp_eq_u32 vcc, s25, v78
  s_or_b64 s[40:41], s[40:41], vcc
  v_cmp_eq_u32 vcc, s25, v79
  s_or_b64 s[40:41], s[40:41], vcc
  ds_read_b128 v[76:79], v0 offset:5120
  s_waitcnt lgkmcnt(0)
  v_cmp_eq_u32 vcc, s25, v76
  s_or_b64 s[40:41], s[40:41], vcc
  v_cmp_eq_u32 vcc, s25, v77
  s_or_b64 s[40:41], s[40:41], vcc
  v_cmp_eq_u32 vcc, s25, v78
  s_or_b64 s[40:41], s[40:41], vcc
  v_cmp_eq_u32 vcc, s25, v79
  s_or_b64 s[40:41], s[40:41], vcc
  ds_read_b128 v[76:79], v0 offset:6144
  s_waitcnt lgkmcnt(0)
  v_cmp_eq_u32 vcc, s25, v76
  s_or_b64 s[40:41], s[40:41], vcc
  v_cmp_eq_u32 vcc, s25, v77
  s_or_b64 s[40:41], s[40:41], vcc
  v_cmp_eq_u32 vcc, s25, v78
  s_or_b64 s[40:41], s[40:41], vcc
  v_cmp_eq_u32 vcc, s25, v79
  s_or_b64 s[40:41], s[40:41], vcc
  ds_read_b128 v[76:79], v0 offset:7168
  s_waitcnt lgkmcnt(0)
  v_cmp_eq_u32 vcc, s25, v76
  s_or_b64 s[40:41], s[40:41], vcc
  v_cmp_eq_u32 vcc, s25, v77
  s_or_b64 s[40:41], s[40:41], vcc
  v_cmp_eq_u32 vcc, s25, v78
  s_or_b64 s[40:41], s[40:41], vcc
  v_cmp_eq_u32 vcc, s25, v79
  s_or_b64 s[40:41], s[40:41], vcc
  ds_read_b128 v[76:79], v0 offset:8192
  s_waitcnt lgkmcnt(0)
  v_cmp_eq_u32 vcc, s25, v76
  s_or_b64 s[40:41], s[40:41], vcc
  v_cmp_eq_u32 vcc, s25, v77
  s_or_b64 s[40:41], s[40:41], vcc
  v_cmp_eq_u32 vcc, s25, v78
  s_or_b64 s[40:41], s[40:41], vcc
  v_cmp_eq_u32 vcc, s25, v79
  s_or_b64 s[40:41], s[40:41], vcc
  ds_read_b128 v[76:79], v0 offset:9216
  s_waitcnt lgkmcnt(0)
  v_cmp_eq_u32 vcc, s25, v76
  s_or_b64 s[40:41], s[40:41], vcc
  v_cmp_eq_u32 vcc, s25, v77
  s_or_b64 s[40:41], s[40:41], vcc
  v_cmp_eq_u32 vcc, s25, v78
  s_or_b64 s[40:41], s[40:41], vcc
  v_cmp_eq_u32 vcc, s25, v79
  s_or_b64 s[40:41], s[40:41], vcc
  s_cbranch_scc0 L_clean_39
  s_sub_u32 s12, s12, 1
  s_cbranch_scc1 L_cabort
  s_barrier
  s_mov_b32 m0, 0
  s_add_u32 s36, s17, 4096
  buffer_load_dwordx4 v0, s[4:7], s17 offen offset:0 sc1 lds
  buffer_load_dwordx4 v0, s[4:7], s17 offen offset:1024 sc1 lds
  buffer_load_dwordx4 v0, s[4:7], s17 offen offset:2048 sc1 lds
  buffer_load_dwordx4 v0, s[4:7], s17 offen offset:3072 sc1 lds
  s_mov_b32 m0, 4096
  s_nop 0
  buffer_load_dwordx4 v0, s[4:7], s36 offen sc1 lds
  s_mov_b32 m0, 5120
  s_add_u32 s36, s18, 4096
  buffer_load_dwordx4 v0, s[4:7], s18 offen offset:0 sc1 lds
  buffer_load_dwordx4 v0, s[4:7], s18 offen offset:1024 sc1 lds
  buffer_load_dwordx4 v0, s[4:7], s18 offen offset:2048 sc1 lds
  buffer_load_dwordx4 v0, s[4:7], s18 offen offset:3072 sc1 lds
  s_mov_b32 m0, 9216
  s_nop 0
  buffer_load_dwordx4 v0, s[4:7], s36 offen sc1 lds
  s_waitcnt vmcnt(0)
  s_barrier
  s_branch L_bad_f
L_clean_39:
  v_mov_b64 v[16:17], 0
  v_mov_b64 v[18:19], 0
  v_mov_b64 v[20:21], 0
  v_mov_b64 v[22:23], 0
  v_mov_b64 v[24:25], 0
  v_mov_b64 v[26:27], 0
  v_mov_b64 v[28:29], 0
  v_mov_b64 v[30:31], 0
  v_mov_b64 v[32:33], 0
  v_mov_b64 v[34:35], 0
  v_mov_b64 v[36:37], 0
  v_mov_b64 v[38:39], 0
  ds_read_b128 v[76:79], v0 offset:0
  ds_read_b128 v[52:55], v12 offset:0
  ds_read_b128 v[56:59], v12 offset:1024
  ds_read_b128 v[60:63], v12 offset:2048
  ds_read_b128 v[64:67], v12 offset:3072
  s_waitcnt lgkmcnt(0)
  v_smfmac_f32_16x16x64_bf16 v[16:19], v[76:79], v[88:95], v1
  v_smfmac_f32_16x16x64_bf16 v[20:23], v[76:79], v[168:175], v1
  v_smfmac_f32_16x16x64_bf16 v[24:27], v[76:79], v[248:255], v1
  v_smfmac_f32_16x16x64_bf16 v[28:31], v[76:79], a[72:79], v1
  v_smfmac_f32_16x16x64_bf16 v[32:35], v[76:79], v[52:59], v1
  v_smfmac_f32_16x16x64_bf16 v[36:39], v[76:79], v[60:67], v1
  ds_read_b128 v[76:79], v0 offset:1024
  ds_read_b128 v[52:55], v12 offset:4096
  ds_read_b128 v[56:59], v12 offset:5120
  ds_read_b128 v[60:63], v12 offset:6144
  ds_read_b128 v[64:67], v12 offset:7168
  s_waitcnt lgkmcnt(0)
  v_smfmac_f32_16x16x64_bf16 v[16:19], v[76:79], v[96:103], v1
  v_smfmac_f32_16x16x64_bf16 v[20:23], v[76:79], v[176:183], v1
  v_smfmac_f32_16x16x64_bf16 v[24:27], v[76:79], a[0:7], v1
  v_smfmac_f32_16x16x64_bf16 v[28:31], v[76:79], a[80:87], v1
  v_smfmac_f32_16x16x64_bf16 v[32:35], v[76:79], v[52:59], v1
  v_smfmac_f32_16x16x64_bf16 v[36:39], v[76:79], v[60:67], v1
  ds_read_b128 v[76:79], v0 offset:2048
  ds_read_b128 v[52:55], v12 offset:8192
  ds_read_b128 v[56:59], v12 offset:9216
  ds_read_b128 v[60:63], v12 offset:10240
  ds_read_b128 v[64:67], v12 offset:11264
  s_waitcnt lgkmcnt(0)
  v_smfmac_f32_16x16x64_bf16 v[16:19], v[76:79], v[104:111], v1
  v_smfmac_f32_16x16x64_bf16 v[20:23], v[76:79], v[184:191], v1
  v_smfmac_f32_16x16x64_bf16 v[24:27], v[76:79], a[8:15], v1
  v_smfmac_f32_16x16x64_bf16 v[28:31], v[76:79], a[88:95], v1
  v_smfmac_f32_16x16x64_bf16 v[32:35], v[76:79], v[52:59], v1
  v_smfmac_f32_16x16x64_bf16 v[36:39], v[76:79], v[60:67], v1
  ds_read_b128 v[76:79], v0 offset:3072
  ds_read_b128 v[52:55], v12 offset:12288
  ds_read_b128 v[56:59], v12 offset:13312
  ds_read_b128 v[60:63], v12 offset:14336
  ds_read_b128 v[64:67], v12 offset:15360
  s_waitcnt lgkmcnt(0)
  v_smfmac_f32_16x16x64_bf16 v[16:19], v[76:79], v[112:119], v1
  v_smfmac_f32_16x16x64_bf16 v[20:23], v[76:79], v[192:199], v1
  v_smfmac_f32_16x16x64_bf16 v[24:27], v[76:79], a[16:23], v1
  v_smfmac_f32_16x16x64_bf16 v[28:31], v[76:79], a[96:103], v1
  v_smfmac_f32_16x16x64_bf16 v[32:35], v[76:79], v[52:59], v1
  v_smfmac_f32_16x16x64_bf16 v[36:39], v[76:79], v[60:67], v1
  ds_read_b128 v[76:79], v0 offset:4096
  ds_read_b128 v[52:55], v12 offset:32768
  ds_read_b128 v[56:59], v12 offset:33792
  s_waitcnt lgkmcnt(0)
  v_smfmac_f32_16x16x64_bf16 v[16:19], v[76:79], v[120:127], v1
  v_smfmac_f32_16x16x64_bf16 v[20:23], v[76:79], v[200:207], v1
  v_smfmac_f32_16x16x64_bf16 v[24:27], v[76:79], a[24:31], v1
  v_smfmac_f32_16x16x64_bf16 v[28:31], v[76:79], a[104:111], v1
  v_smfmac_f32_16x16x64_bf16 v[32:35], v[76:79], v[52:59], v1
  v_smfmac_f32_16x16x64_bf16 v[36:39], v[76:79], a[192:199], v1
  ds_read_b128 v[76:79], v0 offset:5120
  s_waitcnt lgkmcnt(0)
  v_smfmac_f32_16x16x64_bf16 v[16:19], v[76:79], v[128:135], v1
  v_smfmac_f32_16x16x64_bf16 v[20:23], v[76:79], v[208:215], v1
  v_smfmac_f32_16x16x64_bf16 v[24:27], v[76:79], a[32:39], v1
  v_smfmac_f32_16x16x64_bf16 v[28:31], v[76:79], a[112:119], v1
  ds_read_b128 v[76:79], v0 offset:6144
  s_waitcnt lgkmcnt(0)
  v_smfmac_f32_16x16x64_bf16 v[16:19], v[76:79], v[136:143], v1
  v_smfmac_f32_16x16x64_bf16 v[20:23], v[76:79], v[216:223], v1
  v_smfmac_f32_16x16x64_bf16 v[24:27], v[76:79], a[40:47], v1
  v_smfmac_f32_16x16x64_bf16 v[28:31], v[76:79], a[120:127], v1
  ds_read_b128 v[76:79], v0 offset:7168
  s_waitcnt lgkmcnt(0)
  v_smfmac_f32_16x16x64_bf16 v[16:19], v[76:79], v[144:151], v1
  v_smfmac_f32_16x16x64_bf16 v[20:23], v[76:79], v[224:231], v1
  v_smfmac_f32_16x16x64_bf16 v[24:27], v[76:79], a[48:55], v1
  v_smfmac_f32_16x16x64_bf16 v[28:31], v[76:79], a[128:135], v1
  ds_read_b128 v[76:79], v0 offset:8192
  s_waitcnt lgkmcnt(0)
  v_smfmac_f32_16x16x64_bf16 v[16:19], v[76:79], v[152:159], v1
  v_smfmac_f32_16x16x64_bf16 v[20:23], v[76:79], v[232:239], v1
  v_smfmac_f32_16x16x64_bf16 v[24:27], v[76:79], a[56:63], v1
  v_smfmac_f32_16x16x64_bf16 v[28:31], v[76:79], a[136:143], v1
  v_smfmac_f32_16x16x64_bf16 v[32:35], v[76:79], a[176:183], v1
  ds_read_b128 v[76:79], v0 offset:9216
  s_waitcnt lgkmcnt(0)
  v_smfmac_f32_16x16x64_bf16 v[16:19], v[76:79], v[160:167], v1
  v_smfmac_f32_16x16x64_bf16 v[20:23], v[76:79], v[240:247], v1
  v_smfmac_f32_16x16x64_bf16 v[24:27], v[76:79], a[64:71], v1
  v_smfmac_f32_16x16x64_bf16 v[28:31], v[76:79], a[144:151], v1
  v_smfmac_f32_16x16x64_bf16 v[32:35], v[76:79], a[184:191], v1
  v_smfmac_f32_16x16x64_bf16 v[36:39], v[76:79], a[232:239], v1
  ds_read_b128 v[52:55], v8 offset:10240
  ds_read_b128 v[56:59], v8 offset:12288
  ds_read_b128 v[60:63], v8 offset:10368
  ds_read_b128 v[64:67], v8 offset:12416
  ds_read_b128 v[48:51], v0 offset:8192
  ds_read_b128 v[44:47], v0 offset:5120
  ds_read_b128 v[40:43], v0 offset:6144
  v_add_f32 v16, v16, v18
  v_add_f32 v17, v17, v19
  v_add_f32 v20, v20, v22
  v_add_f32 v21, v21, v23
  v_add_f32 v24, v24, v26
  v_cvt_pk_bf16_f32 v82, v16, v20
  v_cvt_pk_bf16_f32 v83, v17, v21
  ds_write2_b32 v2, v82, v83 offset0:0 offset1:136
  s_waitcnt lgkmcnt(0)
  s_cmp_eq_u32 s10, 3
  s_branch L_bbad_f
L_max_f:
  s_waitcnt lgkmcnt(0)
  ds_read_b128 v[76:79], v3
  ds_read_b128 v[80:83], v3 offset:64
  ds_read_b128 v[40:43], v4
  ds_read_b128 v[44:47], v4 offset:64
  ds_read_b128 v[52:55], v8 offset:10240
  ds_read_b128 v[56:59], v8 offset:12288
  ds_read_b128 v[60:63], v8 offset:10368
  ds_read_b128 v[64:67], v8 offset:12416
  ds_read_b128 v[16:19], v8 offset:10496
  ds_read_b128 v[20:23], v8 offset:12544
  ds_read_b128 v[24:27], v8 offset:10624
  ds_read_b128 v[28:31], v8 offset:12672
  s_waitcnt lgkmcnt(0)
  v_mfma_f32_16x16x32_bf16 v[52:55], v[52:55], v[76:79], 0
  v_mfma_f32_16x16x32_bf16 v[52:55], v[56:59], v[80:83], v[52:55]
  v_mfma_f32_16x16x32_bf16 v[60:63], v[60:63], v[76:79], 0
  v_mfma_f32_16x16x32_bf16 v[60:63], v[64:67], v[80:83], v[60:63]
  v_mfma_f32_16x16x32_bf16 v[16:19], v[16:19], v[76:79], 0
  v_mfma_f32_16x16x32_bf16 v[16:19], v[20:23], v[80:83], v[16:19]
  v_mfma_f32_16x16x32_bf16 v[24:27], v[24:27], v[76:79], 0
  v_mfma_f32_16x16x32_bf16 v[24:27], v[28:31], v[80:83], v[24:27]
  v_mfma_f32_16x16x32_bf16 v[40:43], v[40:43], v[76:79], 0
  v_mfma_f32_16x16x32_bf16 v[40:43], v[44:47], v[80:83], v[40:43]
  v_add_f32_dpp v84, v54, v52 row_ror:8 row_mask:0xf bank_mask:0x9
  s_nop 1
  v_add_f32_dpp v84, v53, v55 row_ror:8 row_mask:0xf bank_mask:0x6
  v_add_f32_dpp v85, v62, v60 row_ror:8 row_mask:0xf bank_mask:0x9
  s_nop 1
  v_add_f32_dpp v85, v61, v63 row_ror:8 row_mask:0xf bank_mask:0x6
  v_add_f32_dpp v86, v18, v16 row_ror:8 row_mask:0xf bank_mask:0x9
  s_nop 1
  v_add_f32_dpp v86, v17, v19 row_ror:8 row_mask:0xf bank_mask:0x6
  v_add_f32_dpp v87, v26, v24 row_ror:8 row_mask:0xf bank_mask:0x9
  s_nop 1
  v_add_f32_dpp v87, v25, v27 row_ror:8 row_mask:0xf bank_mask:0x6
  v_add_f32_dpp v64, v42, v40 row_ror:8 row_mask:0xf bank_mask:0xf
  v_add_f32_dpp v65, v43, v41 row_ror:8 row_mask:0xf bank_mask:0xf
  v_mul_f32 v64, s24, v64
  v_mul_f32 v65, s24, v65
  ds_read_b128 v[52:55], v12 offset:16384
  ds_read_b128 v[56:59], v12 offset:17408
  ds_read_b128 v[16:19], v12 offset:18432
  ds_read_b128 v[20:23], v12 offset:19456
  ds_read_b128 v[24:27], v12 offset:20480
  ds_read_b128 v[28:31], v12 offset:21504
  v_max3_f32 v82, v84, v85, v86
  v_max_f32 v82, v82, v87
  s_mov_b64 exec, s[26:27]
  v_max3_f32 v82, v82, v64, v65
  s_mov_b64 exec, -1
  s_nop 0
  v_max_f32_dpp v82, v82, v82 row_ror:8 row_mask:0xf bank_mask:0xf
  v_mov_b32 v83, v82
  s_nop 1
  v_permlane16_swap_b32 v82, v83
  v_max_f32 v82, v82, v83
  v_mov_b32 v83, v82
  s_nop 1
  v_permlane32_swap_b32 v82, v83
  v_max_f32 v82, v82, v83
  v_sub_f32 v84, v84, v82
  v_exp_f32 v84, v84
  v_sub_f32 v85, v85, v82
  v_exp_f32 v85, v85
  v_sub_f32 v86, v86, v82
  v_exp_f32 v86, v86
  v_sub_f32 v87, v87, v82
  v_exp_f32 v87, v87
  v_sub_f32 v64, v64, v82
  v_exp_f32 v64, v64
  v_sub_f32 v65, v65, v82
  v_exp_f32 v65, v65
  v_cvt_pk_bf16_f32 v60, v84, v85
  v_cvt_pk_bf16_f32 v61, v86, v87
  v_cvt_pk_bf16_f32 v80, v64, v65
  v_cvt_pk_bf16_f32 v83, v64, v65
  v_mov_b32 v81, 0
  v_mov_b32 v82, 0
  v_mov_b32_dpp v62, v60 row_ror:8 row_mask:0xf bank_mask:0xf
  v_mov_b32_dpp v63, v61 row_ror:8 row_mask:0xf bank_mask:0xf
  v_mov_b64 v[64:65], 0
  s_nop 0
  v_mfma_f32_16x16x32_bf16 v[44:47], v[48:51], v[60:63], 0
  v_mfma_f32_16x16x32_bf16 v[32:35], v[68:71], v[60:63], 0
  v_mfma_f32_16x16x32_bf16 v[36:39], v[72:75], v[60:63], 0
  v_mfma_f32_16x16x16_bf16 v[44:47], v[48:49], v[80:81], v[44:47]
  v_mfma_f32_16x16x16_bf16 v[32:35], v[14:15], v[80:81], v[32:35]
  v_mfma_f32_16x16x16_bf16 v[36:39], v[14:15], v[82:83], v[36:39]
  s_nop 5
  v_rcp_f32 v46, v44
  s_nop 0
  v_pk_mul_f32 v[32:33], v[32:33], v[46:47] op_sel_hi:[1,0]
  v_pk_mul_f32 v[34:35], v[34:35], v[46:47] op_sel_hi:[1,0]
  v_cvt_pk_bf16_f32 v84, v32, v33
  v_cvt_pk_bf16_f32 v85, v34, v35
  v_pk_mul_f32 v[36:37], v[36:37], v[46:47] op_sel_hi:[1,0]
  v_pk_mul_f32 v[38:39], v[38:39], v[46:47] op_sel_hi:[1,0]
  v_mov_b32_dpp v86, v84 row_ror:8 row_mask:0xf bank_mask:0xf
  v_mov_b32_dpp v87, v85 row_ror:8 row_mask:0xf bank_mask:0xf
  s_mov_b64 exec, s[26:27]
  v_cvt_pk_bf16_f32 v86, v36, v37
  v_cvt_pk_bf16_f32 v87, v38, v39
  s_mov_b64 exec, -1
  ds_write_b64 v5, v[86:87]
  s_branch L_bmax2_f
L_rdy_f:
L_rdy_40:
  s_sub_u32 s12, s12, 1
  s_cbranch_scc1 L_cabort
  v_lshrrev_b32 v82, 2, v0
  v_and_b32 v82, 12, v82
  buffer_load_dword v83, v82, s[4:7], s76 offen sc1
  v_lshrrev_b32 v82, 2, v82
L_rdya_41:
  s_waitcnt vmcnt(0)
  v_mad_u32_u24 v83, v83, 3, v82
  s_nop 0
  v_readlane_b32 s75, v83, 0
  v_readlane_b32 s36, v83, 1
  s_min_u32 s75, s75, s36
  v_readlane_b32 s36, v83, 2
  s_min_u32 s75, s75, s36
  s_cmp_ge_u32 s75, 64
  s_cselect_b32 s75, 128, s75
  s_cmp_ge_u32 s39, s75
  s_cbranch_scc1 L_rdy_40
  s_branch L_brdy_f
L_done_f:
  ds_write2_b32 v11, v14, v15 offset0:0 offset1:64
  s_add_u32 s22, s22, s74
  s_lshr_b32 s37, s11, 3
  s_bitcmp1_b32 s91, s37
  s_cselect_b32 s37, s51, 0
  s_add_u32 s63, s22, s37
  s_waitcnt vmcnt(0) lgkmcnt(0)
  s_barrier
  ds_read_b128 v[76:79], v10
  v_mov_b32 v48, 63
  s_waitcnt lgkmcnt(0)
  v_cndmask_b32 v76, v76, v48, s[72:73]
  s_mov_b64 exec, s[70:71]
  buffer_store_dwordx4 v[76:79], v0, s[4:7], s63 offen sc1
  s_mov_b64 exec, -1
  v_mov_b32 v48, 64
  s_cmp_eq_u32 s10, 2
  s_cselect_b32 s36, s22, 0x80000000
  s_waitcnt vmcnt(0)
  s_barrier
  s_mov_b64 exec, 1
  buffer_store_dword v48, v0, s[4:7], s36 offen sc1
  s_mov_b64 exec, -1
  s_branch L_cend
L_safe:
  s_cmp_lg_u32 s10, 3
  s_add_u32 s38, s16, s56
  s_add_u32 s39, s11, 1
  v_lshlrev_b32 v14, 3, v0
  s_sub_u32 s36, s76, s38
  s_sub_u32 s36, s36, 128
  s_mov_b32 exec_lo, 0
  v_add_u32 v14, s36, v15
  s_mov_b32 exec_lo, -1
  s_cmp_eq_u32 s75, 128
  s_cbranch_scc1 L_known_42
  v_mov_b32 v48, 0
  ds_read_b128 v[48:51], v48 offset:23040
  s_waitcnt lgkmcnt(0)
  v_mad_u32_u24 v48, v48, 3, 0
  v_mad_u32_u24 v49, v49, 3, 1
  v_mad_u32_u24 v50, v50, 3, 2
  v_min3_u32 v48, v48, v49, v50
  s_nop 0
  v_readfirstlane_b32 s36, v48
  s_max_u32 s75, s75, s36
  s_cmp_ge_u32 s75, 64
  s_cselect_b32 s75, 128, s75
L_known_42:
  v_mov_b64 v[80:81], 0
  s_branch L_tk_s
.p2align 6
L_step_s:
  s_barrier
  s_cbranch_scc1 L_t012_s
  s_add_u32 s37, s18, s57
  s_nop 15
  s_nop 15
  s_nop 11
  s_mov_b32 m0, 0
  s_add_u32 s36, s17, 4096
  buffer_load_dwordx4 v0, s[4:7], s17 offen offset:0 sc1 lds
  buffer_load_dwordx4 v0, s[4:7], s17 offen offset:1024 sc1 lds
  buffer_load_dwordx4 v0, s[4:7], s17 offen offset:2048 sc1 lds
  buffer_load_dwordx4 v0, s[4:7], s17 offen offset:3072 sc1 lds
  s_mov_b32 m0, 4096
  s_nop 0
  buffer_load_dwordx4 v0, s[4:7], s36 offen sc1 lds
  s_nop 15
  s_nop 7
  s_mov_b32 m0, 0
  s_add_u32 s36, s17, 4096
  buffer_load_dwordx4 v0, s[4:7], s17 offen offset:0 sc1 lds
  buffer_load_dwordx4 v0, s[4:7], s17 offen offset:1024 sc1 lds
  buffer_load_dwordx4 v0, s[4:7], s17 offen offset:2048 sc1 lds
  buffer_load_dwordx4 v0, s[4:7], s17 offen offset:3072 sc1 lds
  s_mov_b32 m0, 4096
  s_nop 0
  buffer_load_dwordx4 v0, s[4:7], s36 offen sc1 lds
  s_mov_b32 m0, s50
  s_barrier
  buffer_load_dwordx4 v0, s[4:7], s14 offen offset:0 sc1 lds
  buffer_load_dwordx4 v0, s[4:7], s14 offen offset:1024 sc1 lds
  s_waitcnt vmcnt(7)
  ds_read2st64_b32 v[82:83], v84 offset0:0 offset1:4
  s_waitcnt lgkmcnt(0)
  v_cmp_u_f32 vcc, v82, v83
  s_cbranch_vccnz L_rl_s
L_bl3_s:
  s_barrier
  ds_read_b128 v[40:43], v0 offset:0
  s_mov_b32 m0, s53
  ds_read_b128 v[44:47], v0 offset:1024
  buffer_load_dwordx4 v0, s[4:7], s37 offen sc1 lds
  buffer_load_dwordx4 v0, s[4:7], s37 offen offset:1024 sc1 lds
L_go_s:
  s_cmp_eq_u32 s10, 3
  s_waitcnt lgkmcnt(1)
  v_smfmac_f32_16x16x64_bf16 v[32:35], v[40:43], v[52:59], v1
  ds_read_b128 v[52:55], v12 offset:4096
  v_smfmac_f32_16x16x64_bf16 v[16:19], v[40:43], v[88:95], v1
  ds_read_b128 v[56:59], v12 offset:5120
  v_smfmac_f32_16x16x64_bf16 v[20:23], v[40:43], v[168:175], v1
  ds_read_b128 v[48:51], v0 offset:2048
  s_waitcnt lgkmcnt(3)
  v_smfmac_f32_16x16x64_bf16 v[36:39], v[40:43], v[60:67], v1
  ds_read_b128 v[60:63], v12 offset:6144
  v_smfmac_f32_16x16x64_bf16 v[24:27], v[40:43], v[248:255], v1
  ds_read_b128 v[64:67], v12 offset:7168
  v_smfmac_f32_16x16x64_bf16 v[28:31], v[40:43], a[72:79], v1
  s_waitcnt lgkmcnt(3)
  v_smfmac_f32_16x16x64_bf16 v[32:35], v[44:47], v[52:59], v1
  ds_read_b128 v[52:55], v12 offset:8192
  v_smfmac_f32_16x16x64_bf16 v[16:19], v[44:47], v[96:103], v1
  ds_read_b128 v[56:59], v12 offset:9216
  v_smfmac_f32_16x16x64_bf16 v[20:23], v[44:47], v[176:183], v1
  ds_read_b128 v[40:43], v0 offset:3072
  s_waitcnt lgkmcnt(3)
  v_smfmac_f32_16x16x64_bf16 v[36:39], v[44:47], v[60:67], v1
  ds_read_b128 v[60:63], v12 offset:10240
  v_smfmac_f32_16x16x64_bf16 v[24:27], v[44:47], a[0:7], v1
  ds_read_b128 v[64:67], v12 offset:11264
  v_smfmac_f32_16x16x64_bf16 v[28:31], v[44:47], a[80:87], v1
  s_waitcnt lgkmcnt(3)
  buffer_load_dwordx4 v[68:71], v9, s[4:7], s20 offen offset:0 sc1
  v_smfmac_f32_16x16x64_bf16 v[32:35], v[48:51], v[52:59], v1
  ds_read_b128 v[52:55], v12 offset:12288
  v_smfmac_f32_16x16x64_bf16 v[16:19], v[48:51], v[104:111], v1
  ds_read_b128 v[56:59], v12 offset:13312
  v_smfmac_f32_16x16x64_bf16 v[20:23], v[48:51], v[184:191], v1
  ds_read_b128 v[44:47], v0 offset:4096
  s_waitcnt lgkmcnt(3)
  v_smfmac_f32_16x16x64_bf16 v[36:39], v[48:51], v[60:67], v1
  ds_read_b128 v[60:63], v12 offset:14336
  v_smfmac_f32_16x16x64_bf16 v[24:27], v[48:51], a[8:15], v1
  ds_read_b128 v[64:67], v12 offset:15360
  v_smfmac_f32_16x16x64_bf16 v[28:31], v[48:51], a[88:95], v1
  s_waitcnt lgkmcnt(3)
  buffer_load_dwordx4 v[72:75], v9, s[4:7], s20 offen offset:256 sc1
  v_smfmac_f32_16x16x64_bf16 v[32:35], v[40:43], v[52:59], v1
  ds_read_b128 v[52:55], v12 offset:32768
  v_smfmac_f32_16x16x64_bf16 v[16:19], v[40:43], v[112:119], v1
  ds_read_b128 v[56:59], v12 offset:33792
  v_smfmac_f32_16x16x64_bf16 v[20:23], v[40:43], v[192:199], v1
  s_waitcnt lgkmcnt(2)
  v_smfmac_f32_16x16x64_bf16 v[36:39], v[40:43], v[60:67], v1
  s_cmp_lg_u32 s10, 3
  v_smfmac_f32_16x16x64_bf16 v[24:27], v[40:43], a[16:23], v1
  s_waitcnt lgkmcnt(0)
  v_smfmac_f32_16x16x64_bf16 v[28:31], v[40:43], a[96:103], v1
  s_waitcnt vmcnt(2)
  s_barrier
  ds_read2st64_b32 v[80:81], v13 offset0:20 offset1:24
  v_smfmac_f32_16x16x64_bf16 v[32:35], v[44:47], v[52:59], v1
  ds_read_b128 v[48:51], v0 offset:5120
  v_smfmac_f32_16x16x64_bf16 v[16:19], v[44:47], v[120:127], v1
  ds_read_b128 v[40:43], v0 offset:6144
  s_cmp_ge_u32 s39, s75
  v_smfmac_f32_16x16x64_bf16 v[20:23], v[44:47], v[200:207], v1
  s_cbranch_scc1 L_rdy_s
L_brdy_s:
  v_smfmac_f32_16x16x64_bf16 v[36:39], v[44:47], a[192:199], v1
  s_mov_b32 m0, 22912
  s_waitcnt lgkmcnt(2)
  v_cmp_u_f32 vcc, v80, v81
  v_smfmac_f32_16x16x64_bf16 v[24:27], v[44:47], a[24:31], v1
  s_cbranch_vccnz L_rr_s
L_br_s:
  v_smfmac_f32_16x16x64_bf16 v[28:31], v[44:47], a[104:111], v1
  s_waitcnt lgkmcnt(1)
  s_cmp_eq_u32 s10, 3
  v_smfmac_f32_16x16x64_bf16 v[16:19], v[48:51], v[128:135], v1
  ds_read_b128 v[44:47], v0 offset:7168
  v_smfmac_f32_16x16x64_bf16 v[20:23], v[48:51], v[208:215], v1
  s_mov_b32 exec_hi, 15
  buffer_load_dword v14, s[4:7], s38 offen sc1 lds
  s_mov_b32 exec_hi, -1
  v_smfmac_f32_16x16x64_bf16 v[24:27], v[48:51], a[32:39], v1
  ds_read_b128 v[52:55], v8 offset:10240
  v_smfmac_f32_16x16x64_bf16 v[28:31], v[48:51], a[112:119], v1
  s_waitcnt lgkmcnt(2)
  v_smfmac_f32_16x16x64_bf16 v[16:19], v[40:43], v[136:143], v1
  ds_read_b128 v[48:51], v0 offset:8192
  v_smfmac_f32_16x16x64_bf16 v[20:23], v[40:43], v[216:223], v1
  v_smfmac_f32_16x16x64_bf16 v[24:27], v[40:43], a[40:47], v1
  ds_read_b128 v[56:59], v8 offset:12288
  v_smfmac_f32_16x16x64_bf16 v[28:31], v[40:43], a[120:127], v1
  s_waitcnt lgkmcnt(3)
  v_smfmac_f32_16x16x64_bf16 v[16:19], v[44:47], v[144:151], v1
  ds_read_b128 v[40:43], v0 offset:9216
  v_smfmac_f32_16x16x64_bf16 v[20:23], v[44:47], v[224:231], v1
  v_smfmac_f32_16x16x64_bf16 v[24:27], v[44:47], a[48:55], v1
  ds_read_b128 v[60:63], v8 offset:10368
  v_smfmac_f32_16x16x64_bf16 v[28:31], v[44:47], a[128:135], v1
  s_waitcnt lgkmcnt(3)
  v_smfmac_f32_16x16x64_bf16 v[16:19], v[48:51], v[152:159], v1
  ds_read_b128 v[44:47], v0 offset:5120
  s_waitcnt vmcnt(1)
  v_smfmac_f32_16x16x64_bf16 v[20:23], v[48:51], v[232:239], v1
  s_cbranch_scc1 L_svc_43
  s_mov_b64 exec, s[70:71]
  buffer_store_dwordx4 v[76:79], v0, s[4:7], s63 offen sc1
  s_mov_b64 exec, -1
L_svc_43:
  v_smfmac_f32_16x16x64_bf16 v[24:27], v[48:51], a[56:63], v1
  ds_read_b128 v[64:67], v8 offset:12416
  v_smfmac_f32_16x16x64_bf16 v[28:31], v[48:51], a[136:143], v1
  s_waitcnt lgkmcnt(3)
  v_smfmac_f32_16x16x64_bf16 v[16:19], v[40:43], v[160:167], v1
  s_nop 2
  v_smfmac_f32_16x16x64_bf16 v[20:23], v[40:43], v[240:247], v1
  s_cbranch_scc1 L_svc_44
  buffer_store_dwordx4 v[84:87], v0, s[4:7], s52 offen offset:0 sc1
L_svc_44:
  v_smfmac_f32_16x16x64_bf16 v[24:27], v[40:43], a[64:71], v1
  s_nop 1
  v_add_f32 v16, v16, v18
  v_smfmac_f32_16x16x64_bf16 v[28:31], v[40:43], a[144:151], v1
  s_nop 1
  v_add_f32 v17, v17, v19
  v_add_f32 v20, v20, v22
  v_add_f32 v21, v21, v23
  v_cvt_pk_bf16_f32 v82, v16, v20
  v_cvt_pk_bf16_f32 v83, v17, v21
  v_smfmac_f32_16x16x64_bf16 v[32:35], v[40:43], a[184:191], v1
  ds_write2_b32 v2, v82, v83 offset0:0 offset1:136
  v_cmp_u_f32 vcc, v16, v17
  v_smfmac_f32_16x16x64_bf16 v[36:39], v[40:43], a[232:239], v1
  ds_read_b128 v[40:43], v0 offset:6144
  v_add_f32 v24, v24, v26
  v_smfmac_f32_16x16x64_bf16 v[32:35], v[48:51], a[176:183], v1
  s_cbranch_vccnz L_bad_s
L_bbad_s:
  v_smfmac_f32_16x16x64_bf16 v[36:39], v[48:51], a[224:231], v1
  s_cbranch_scc1 L_svc_45
  buffer_store_dwordx4 v[84:87], v0, s[4:7], s52 offen offset:1024 sc1
L_svc_45:
  ds_read_b128 v[48:51], v0 offset:7168
  s_waitcnt lgkmcnt(2)
  v_smfmac_f32_16x16x64_bf16 v[32:35], v[44:47], a[152:159], v1
  s_barrier
  ds_read_b128 v[76:79], v3
  v_add_f32 v25, v25, v27
  v_smfmac_f32_16x16x64_bf16 v[36:39], v[44:47], a[200:207], v1
  ds_read_b128 v[80:83], v3 offset:64
  s_waitcnt lgkmcnt(2)
  v_smfmac_f32_16x16x64_bf16 v[32:35], v[40:43], a[160:167], v1
  ds_read_b128 v[16:19], v8 offset:10496
  v_add_f32 v28, v28, v30
  v_smfmac_f32_16x16x64_bf16 v[36:39], v[40:43], a[208:215], v1
  s_cbranch_scc1 L_svc_46
  buffer_store_dwordx2 v[84:85], v7, s[4:7], s54 offen sc1
L_svc_46:
  v_add_f32 v29, v29, v31
  v_smfmac_f32_16x16x64_bf16 v[32:35], v[48:51], a[168:175], v1
  ds_read_b128 v[20:23], v8 offset:12544
  v_cvt_pk_bf16_f32 v14, v24, v28
  v_smfmac_f32_16x16x64_bf16 v[36:39], v[48:51], a[216:223], v1
  s_waitcnt lgkmcnt(2)
  v_cvt_pk_bf16_f32 v15, v25, v29
  v_mfma_f32_16x16x32_bf16 v[52:55], v[52:55], v[76:79], 0
  ds_write2_b32 v2, v14, v15 offset0:64 offset1:200
  v_mfma_f32_16x16x32_bf16 v[52:55], v[56:59], v[80:83], v[52:55]
  ds_read_b128 v[24:27], v8 offset:10624
  v_mov_b64 v[48:49], s[82:83]
  v_mfma_f32_16x16x32_bf16 v[60:63], v[60:63], v[76:79], 0
  ds_read_b128 v[28:31], v8 offset:12672
  v_mov_b64 v[50:51], s[82:83]
  v_mfma_f32_16x16x32_bf16 v[60:63], v[64:67], v[80:83], v[60:63]
  s_waitcnt lgkmcnt(3)
  v_add_f32 v64, v32, v34
  v_add_f32_dpp v84, v54, v52 row_ror:8 row_mask:0xf bank_mask:0x9
  v_mfma_f32_16x16x32_bf16 v[16:19], v[16:19], v[76:79], 0
  v_add_f32 v65, v33, v35
  v_add_f32_dpp v84, v53, v55 row_ror:8 row_mask:0xf bank_mask:0x6
  v_mfma_f32_16x16x32_bf16 v[16:19], v[20:23], v[80:83], v[16:19]
  v_exp_f32 v84, v84
  v_add_f32_dpp v85, v62, v60 row_ror:8 row_mask:0xf bank_mask:0x9
  s_waitcnt lgkmcnt(0)
  v_mfma_f32_16x16x32_bf16 v[24:27], v[24:27], v[76:79], 0
  s_barrier
  ds_read_b128 v[40:43], v4
  v_mfma_f32_16x16x32_bf16 v[24:27], v[28:31], v[80:83], v[24:27]
  ds_read_b128 v[44:47], v4 offset:64
  v_add_f32_dpp v85, v61, v63 row_ror:8 row_mask:0xf bank_mask:0x6
  v_add_f32_dpp v86, v18, v16 row_ror:8 row_mask:0xf bank_mask:0x9
  v_add_f32 v66, v36, v38
  v_exp_f32 v85, v85
  v_add_f32_dpp v86, v17, v19 row_ror:8 row_mask:0xf bank_mask:0x6
  v_add_f32 v67, v37, v39
  v_exp_f32 v86, v86
  v_add_f32_dpp v87, v26, v24 row_ror:8 row_mask:0xf bank_mask:0x9
  v_cvt_pk_bf16_f32 v60, v84, v85
  v_cvt_pk_bf16_f32 v14, v64, v65
  v_add_f32_dpp v87, v25, v27 row_ror:8 row_mask:0xf bank_mask:0x6
  v_cvt_pk_bf16_f32 v15, v66, v67
  s_waitcnt lgkmcnt(0)
  v_mfma_f32_16x16x32_bf16 v[40:43], v[40:43], v[76:79], 0
  v_exp_f32 v87, v87
  v_mfma_f32_16x16x32_bf16 v[40:43], v[44:47], v[80:83], v[40:43]
  v_cvt_pk_bf16_f32 v61, v86, v87
  v_mov_b32_dpp v62, v60 row_ror:8 row_mask:0xf bank_mask:0xf
  v_mov_b32 v81, 0
  v_mov_b32_dpp v63, v61 row_ror:8 row_mask:0xf bank_mask:0xf
  v_mov_b32 v82, 0
  v_mov_b64 v[64:65], 0
  v_mfma_f32_16x16x32_bf16 v[44:47], v[48:51], v[60:63], 0
  s_nop 0
  v_add_f32_dpp v66, v42, v40 row_ror:8 row_mask:0xf bank_mask:0xf
  v_add_f32_dpp v67, v43, v41 row_ror:8 row_mask:0xf bank_mask:0xf
  v_mfma_f32_16x16x32_bf16 v[32:35], v[68:71], v[60:63], 0
  v_mul_f32 v66, s24, v66
  v_mul_f32 v67, s24, v67
  v_exp_f32 v66, v66
  v_exp_f32 v67, v67
  v_mfma_f32_16x16x32_bf16 v[36:39], v[72:75], v[60:63], 0
  v_cvt_pk_bf16_f32 v80, v66, v67
  v_cvt_pk_bf16_f32 v83, v66, v67
  s_nop 0
  v_mfma_f32_16x16x16_bf16 v[44:47], v[48:49], v[80:81], v[44:47]
  ds_read_b128 v[52:55], v12 offset:16384
  ds_read_b128 v[56:59], v12 offset:17408
  v_mfma_f32_16x16x16_bf16 v[32:35], v[14:15], v[80:81], v[32:35]
  ds_read_b128 v[16:19], v12 offset:18432
  ds_read_b128 v[20:23], v12 offset:19456
  v_mfma_f32_16x16x16_bf16 v[36:39], v[14:15], v[82:83], v[36:39]
  ds_read_b128 v[24:27], v12 offset:20480
  ds_read_b128 v[28:31], v12 offset:21504
  v_rcp_f32 v46, v44
  v_subrev_u32 v44, s58, v44
  v_cmp_le_u32 vcc, s62, v44
  v_pk_mul_f32 v[32:33], v[32:33], v[46:47] op_sel_hi:[1,0]
  v_pk_mul_f32 v[34:35], v[34:35], v[46:47] op_sel_hi:[1,0]
  v_cvt_pk_bf16_f32 v84, v32, v33
  v_cvt_pk_bf16_f32 v85, v34, v35
  v_pk_mul_f32 v[36:37], v[36:37], v[46:47] op_sel_hi:[1,0]
  v_pk_mul_f32 v[38:39], v[38:39], v[46:47] op_sel_hi:[1,0]
  v_mov_b32_dpp v86, v84 row_ror:8 row_mask:0xf bank_mask:0xf
  v_mov_b32_dpp v87, v85 row_ror:8 row_mask:0xf bank_mask:0xf
  s_mov_b64 exec, s[26:27]
  v_cvt_pk_bf16_f32 v86, v36, v37
  v_cvt_pk_bf16_f32 v87, v38, v39
  s_mov_b64 exec, -1
  ds_write_b64 v5, v[86:87]
  s_cbranch_vccnz L_max_s
L_bmax2_s:
  v_mfma_f32_32x32x8_bf16 v[32:47], v[64:65], v[64:65], 0
  ds_read_b128 v[68:71], v12 offset:24576
  ds_read_b128 v[72:75], v12 offset:25600
  s_cmp_eq_u32 s11, 63
  s_waitcnt lgkmcnt(2)
  s_barrier
  ds_read_b128 v[76:79], v0 offset:0
  ds_read_b128 v[80:83], v0 offset:1024
  s_cbranch_scc1 L_done_s
  v_mfma_f32_16x16x16_bf16 v[48:51], v[64:65], v[64:65], 0
  ds_read_b128 v[60:63], v12 offset:22528
  ds_read_b128 v[64:67], v12 offset:23552
  s_cmp_eq_u32 s23, 0
  s_waitcnt lgkmcnt(3)
  v_smfmac_f32_16x16x64_bf16 v[32:35], v[76:79], v[52:59], v1
  ds_read_b128 v[52:55], v12 offset:26624
  s_waitcnt lgkmcnt(3)
  v_smfmac_f32_16x16x64_bf16 v[32:35], v[80:83], v[16:23], v1
  ds_read_b128 v[56:59], v12 offset:27648
  s_nop 0
  v_smfmac_f32_16x16x64_bf16 v[40:43], v[76:79], v[24:31], v1
  ds_read_b128 v[16:19], v12 offset:28672
  s_waitcnt lgkmcnt(3)
  v_smfmac_f32_16x16x64_bf16 v[40:43], v[80:83], v[60:67], v1
  ds_read_b128 v[20:23], v12 offset:29696
  s_nop 0
  v_add_f32 v32, v32, v34
  v_smfmac_f32_16x16x64_bf16 v[36:39], v[76:79], a[240:247], v1
  ds_read_b128 v[24:27], v12 offset:30720
  v_add_f32 v33, v33, v35
  v_cvt_pk_bf16_f32 v32, v32, v33
  v_smfmac_f32_16x16x64_bf16 v[36:39], v[80:83], a[248:255], v1
  buffer_store_dword v32, v6, s[4:7], s92 offen sc1
  ds_read_b128 v[28:31], v12 offset:31744
  v_add_f32 v40, v40, v42
  v_smfmac_f32_16x16x64_bf16 v[44:47], v[76:79], v[68:75], v1
  s_waitcnt lgkmcnt(2)
  v_add_f32 v41, v41, v43
  v_cvt_pk_bf16_f32 v40, v40, v41
  v_smfmac_f32_16x16x64_bf16 v[44:47], v[80:83], v[52:59], v1
  buffer_store_dword v40, v6, s[4:7], s93 offen sc1
  v_add_f32 v36, v36, v38
  v_smfmac_f32_16x16x64_bf16 v[48:51], v[76:79], v[16:23], v1
  s_waitcnt lgkmcnt(0)
  s_nop 0
  v_add_f32 v37, v37, v39
  v_cvt_pk_bf16_f32 v36, v36, v37
  v_smfmac_f32_16x16x64_bf16 v[48:51], v[80:83], v[24:31], v1
  buffer_store_dword v36, v6, s[4:7], s94 offen sc1
  v_add_f32 v44, v44, v46
  v_add_f32 v45, v45, v47
  v_cvt_pk_bf16_f32 v44, v44, v45
  s_nop 1
  buffer_store_dword v44, v6, s[4:7], s95 offen sc1
  s_nop 0
  v_add_f32 v48, v48, v50
  v_add_f32 v49, v49, v51
  v_cvt_pk_bf16_f32 v48, v48, v49
  buffer_store_dword v48, v6, s[4:7], s96 offen sc1
  s_cbranch_scc1 L_nr_s
  ds_write2_b32 v11, v14, v15 offset0:0 offset1:64
  s_add_u32 s22, s22, s74
  s_lshr_b32 s37, s11, 3
  s_bitcmp1_b32 s91, s37
  s_cselect_b32 s37, s51, 0
  s_add_u32 s63, s22, s37
  s_add_u32 s11, s11, 1
  s_or_b32 s54, s17, s60
  s_or_b32 s52, s15, s60
  s_and_b32 s37, s11, 3
  s_lshl_b32 s37, s37, 13
  s_add_u32 s17, s42, s37
  s_add_u32 s19, s19, 32768
  s_add_u32 s18, s18, 32768
  s_and_b32 s37, s11, 15
  s_cselect_b32 s37, 0, 0x4000
  s_xor_b32 s19, s19, s37
  s_xor_b32 s18, s18, s37
  s_add_u32 s92, s92, s43
  s_add_u32 s93, s93, s43
  s_add_u32 s94, s94, s43
  s_add_u32 s95, s95, s43
  s_add_u32 s96, s96, s43
  v_lshrrev_b32 v15, 2, v0
  s_nop 6
  buffer_load_dwordx4 v[40:43], v0, s[4:7], s15 offen sc1
  buffer_load_dwordx4 v[44:47], v0, s[4:7], s15 offen offset:1024 sc1
  v_and_b32 v14, 64, v0
  v_lshrrev_b32 v14, 2, v14
  v_lshlrev_b32 v14, v14, s59
  v_cndmask_b32 v48, 0, v14, s[28:29]
  v_cndmask_b32 v49, 0, v14, s[30:31]
  v_cndmask_b32 v50, 0, v14, s[32:33]
  v_cndmask_b32 v51, 0, v14, s[34:35]
  s_mov_b32 s20, s16
  s_add_u32 s14, s20, s55
  s_add_u32 s21, s21, 1048576
  s_add_u32 s37, s11, 1
  s_lshr_b32 s37, s37, 1
  s_bitcmp1_b64 s[90:91], s37
  s_cselect_b32 s37, 8192, 0
  s_add_u32 s16, s21, s37
  s_nop 7
  buffer_load_dwordx4 v[68:71], v0, s[4:7], s15 offen sc1
  buffer_load_dwordx4 v[72:75], v0, s[4:7], s15 offen offset:1024 sc1
  v_mov_b64 v[38:39], 0
  v_mov_b64 v[36:37], 0
  v_mov_b64 v[34:35], 0
  v_mov_b64 v[32:33], 0
  v_mfma_f32_32x32x8_bf16 v[16:31], v[38:39], v[38:39], 0
  ds_read_b128 v[52:55], v12 offset:0
  ds_read_b128 v[56:59], v12 offset:1024
  ds_read_b128 v[60:63], v12 offset:2048
  ds_read_b128 v[64:67], v12 offset:3072
  s_waitcnt vmcnt(3)
  v_mfma_f32_16x16x32_bf16 v[80:83], v[48:51], v[40:43], 0
  v_fma_f32 v14, v40, v41, v42
  s_waitcnt vmcnt(2)
  v_mfma_f32_16x16x32_bf16 v[80:83], v[48:51], v[44:47], v[80:83]
  v_fma_f32 v14, v43, v44, v14
  v_fma_f32 v14, v45, v46, v14
  v_cmp_u_f32 vcc, v14, v47
  s_nop 3
  s_cbranch_vccnz L_rred0_s
  v_add_f32_dpp v80, v80, v80 row_ror:4 row_mask:0xf bank_mask:0xf
  v_add_f32_dpp v81, v81, v81 row_ror:4 row_mask:0xf bank_mask:0xf
  v_add_f32_dpp v82, v82, v82 row_ror:4 row_mask:0xf bank_mask:0xf
  v_add_f32_dpp v83, v83, v83 row_ror:4 row_mask:0xf bank_mask:0xf
  v_add_f32_dpp v80, v80, v80 row_ror:8 row_mask:0xf bank_mask:0xf
  v_add_f32_dpp v81, v81, v81 row_ror:8 row_mask:0xf bank_mask:0xf
  v_add_f32_dpp v82, v82, v82 row_ror:8 row_mask:0xf bank_mask:0xf
  v_add_f32_dpp v83, v83, v83 row_ror:8 row_mask:0xf bank_mask:0xf
  v_cvt_pk_bf16_f32 v80, v80, v81
  v_cvt_pk_bf16_f32 v81, v82, v83
  buffer_store_dwordx2 v[80:81], v7, s[4:7], s17 offen sc1
  buffer_store_dwordx2 v[80:81], v7, s[4:7], s19 offen sc1
L_nored_47:
  s_add_u32 s15, s15, s43
  s_sub_u32 s43, 0, s43
  s_waitcnt lgkmcnt(0)
  s_cmp_lg_u32 s10, 3
  s_branch L_step_s
L_nr_s:
  ds_write2_b32 v11, v14, v15 offset0:0 offset1:64
  s_add_u32 s22, s22, s74
  s_lshr_b32 s37, s11, 3
  s_bitcmp1_b32 s91, s37
  s_cselect_b32 s37, s51, 0
  s_add_u32 s63, s22, s37
  s_add_u32 s11, s11, 1
  s_or_b32 s54, s17, s60
  s_or_b32 s52, s15, s60
  s_and_b32 s37, s11, 3
  s_lshl_b32 s37, s37, 13
  s_add_u32 s17, s42, s37
  s_add_u32 s19, s19, 32768
  s_add_u32 s18, s18, 32768
  s_and_b32 s37, s11, 15
  s_cselect_b32 s37, 0, 0x4000
  s_xor_b32 s19, s19, s37
  s_xor_b32 s18, s18, s37
  s_add_u32 s92, s92, s43
  s_add_u32 s93, s93, s43
  s_add_u32 s94, s94, s43
  s_add_u32 s95, s95, s43
  s_add_u32 s96, s96, s43
  v_lshrrev_b32 v15, 2, v0
  s_mov_b32 s20, s16
  s_add_u32 s14, s20, s55
  s_add_u32 s21, s21, 1048576
  s_add_u32 s37, s11, 1
  s_lshr_b32 s37, s37, 1
  s_bitcmp1_b64 s[90:91], s37
  s_cselect_b32 s37, 8192, 0
  s_add_u32 s16, s21, s37
  ds_read_b128 v[52:55], v12 offset:0
  ds_read_b128 v[56:59], v12 offset:1024
  ds_read_b128 v[60:63], v12 offset:2048
  ds_read_b128 v[64:67], v12 offset:3072
  v_mov_b64 v[38:39], 0
  v_mov_b64 v[36:37], 0
  v_mov_b64 v[34:35], 0
  v_mov_b64 v[32:33], 0
  v_mfma_f32_32x32x8_bf16 v[16:31], v[38:39], v[38:39], 0
  s_add_u32 s38, s16, s56
  s_add_u32 s39, s11, 1
  v_lshlrev_b32 v14, 3, v0
  s_sub_u32 s36, s76, s38
  s_sub_u32 s36, s36, 128
  s_mov_b32 exec_lo, 0
  v_add_u32 v14, s36, v15
  s_mov_b32 exec_lo, -1
  s_cmp_eq_u32 s75, 128
  s_cbranch_scc1 L_known_48
  v_mov_b32 v48, 0
  ds_read_b128 v[48:51], v48 offset:23040
  s_waitcnt lgkmcnt(0)
  v_mad_u32_u24 v48, v48, 3, 0
  v_mad_u32_u24 v49, v49, 3, 1
  v_mad_u32_u24 v50, v50, 3, 2
  v_min3_u32 v48, v48, v49, v50
  s_nop 0
  v_readfirstlane_b32 s36, v48
  s_max_u32 s75, s75, s36
  s_cmp_ge_u32 s75, 64
  s_cselect_b32 s75, 128, s75
L_known_48:
  v_lshrrev_b32 v84, 3, v0
  v_and_b32 v84, 60, v84
  v_lshl_add_u32 v84, v0, 2, v84
  s_branch L_nored_47
L_t012_s:
  s_add_u32 s38, s16, s56
  s_add_u32 s39, s11, 1
  v_lshlrev_b32 v14, 3, v0
  s_sub_u32 s36, s76, s38
  s_sub_u32 s36, s36, 128
  s_mov_b32 exec_lo, 0
  v_add_u32 v14, s36, v15
  s_mov_b32 exec_lo, -1
  s_cmp_eq_u32 s75, 128
  s_cbranch_scc1 L_known_49
  v_mov_b32 v48, 0
  ds_read_b128 v[48:51], v48 offset:23040
  s_waitcnt lgkmcnt(0)
  v_mad_u32_u24 v48, v48, 3, 0
  v_mad_u32_u24 v49, v49, 3, 1
  v_mad_u32_u24 v50, v50, 3, 2
  v_min3_u32 v48, v48, v49, v50
  s_nop 0
  v_readfirstlane_b32 s36, v48
  s_max_u32 s75, s75, s36
  s_cmp_ge_u32 s75, 64
  s_cselect_b32 s75, 128, s75
L_known_49:
  s_waitcnt vmcnt(2)
  ds_read_b128 v[76:79], v10
  v_mov_b64 v[84:85], s[68:69]
  v_mov_b64 v[86:87], s[68:69]
  s_sub_u32 s36, s11, 1
  v_mov_b32 v48, s36
  s_waitcnt lgkmcnt(0)
  v_cndmask_b32 v76, v76, v48, s[72:73]
  s_barrier
  s_mov_b32 m0, s50
  s_nop 0
  buffer_load_dwordx4 v0, s[4:7], s14 offen offset:0 sc1 lds
  buffer_load_dwordx4 v0, s[4:7], s14 offen offset:1024 sc1 lds
  s_mov_b32 m0, s53
  s_add_u32 s37, s18, s57
  s_barrier
  ds_read_b128 v[40:43], v0 offset:0
  ds_read_b128 v[44:47], v0 offset:1024
  buffer_load_dwordx4 v0, s[4:7], s37 offen sc1 lds
  s_branch L_go_s
L_tk_s:
  s_mov_b32 m0, s50
  s_nop 0
  buffer_load_dwordx4 v0, s[4:7], s14 offen offset:0 sc1 lds
  buffer_load_dwordx4 v0, s[4:7], s14 offen offset:1024 sc1 lds
  s_barrier
  ds_read_b128 v[40:43], v0 offset:0
  ds_read_b128 v[44:47], v0 offset:1024
  s_branch L_go_s
L_rred0_s:
  s_add_u32 s64, s64, 1
  buffer_load_dwordx4 v[40:43], v0, s[4:7], s15 offen sc1
  buffer_load_dwordx4 v[44:47], v0, s[4:7], s15 offen offset:1024 sc1
  s_waitcnt vmcnt(3)
  v_mfma_f32_16x16x32_bf16 v[80:83], v[48:51], v[68:71], 0
  v_fma_f32 v14, v68, v69, v70
  s_waitcnt vmcnt(2)
  v_mfma_f32_16x16x32_bf16 v[80:83], v[48:51], v[72:75], v[80:83]
  v_fma_f32 v14, v71, v72, v14
  v_fma_f32 v14, v73, v74, v14
  v_cmp_u_f32 vcc, v14, v75
  s_nop 3
  s_cbranch_vccnz L_rred1_s
L_bred_s:
  v_add_f32_dpp v80, v80, v80 row_ror:4 row_mask:0xf bank_mask:0xf
  v_add_f32_dpp v81, v81, v81 row_ror:4 row_mask:0xf bank_mask:0xf
  v_add_f32_dpp v82, v82, v82 row_ror:4 row_mask:0xf bank_mask:0xf
  v_add_f32_dpp v83, v83, v83 row_ror:4 row_mask:0xf bank_mask:0xf
  v_add_f32_dpp v80, v80, v80 row_ror:8 row_mask:0xf bank_mask:0xf
  v_add_f32_dpp v81, v81, v81 row_ror:8 row_mask:0xf bank_mask:0xf
  v_add_f32_dpp v82, v82, v82 row_ror:8 row_mask:0xf bank_mask:0xf
  v_add_f32_dpp v83, v83, v83 row_ror:8 row_mask:0xf bank_mask:0xf
  v_cvt_pk_bf16_f32 v80, v80, v81
  v_cvt_pk_bf16_f32 v81, v82, v83
  buffer_store_dwordx2 v[80:81], v7, s[4:7], s17 offen sc1
  buffer_store_dwordx2 v[80:81], v7, s[4:7], s19 offen sc1
  s_branch L_nored_47
L_rred1_s:
  s_add_u32 s64, s64, 1
  s_sub_u32 s12, s12, 1
  s_cbranch_scc1 L_cabort
  s_and_b32 s36, s12, 7
  s_cbranch_scc1 L_go_50
  s_mov_b64 s[40:41], 0
  v_cmp_eq_u32 vcc, s25, v68
  s_or_b64 s[40:41], s[40:41], vcc
  v_cmp_eq_u32 vcc, s25, v69
  s_or_b64 s[40:41], s[40:41], vcc
  v_cmp_eq_u32 vcc, s25, v70
  s_or_b64 s[40:41], s[40:41], vcc
  v_cmp_eq_u32 vcc, s25, v71
  s_or_b64 s[40:41], s[40:41], vcc
  v_cmp_eq_u32 vcc, s25, v72
  s_or_b64 s[40:41], s[40:41], vcc
  v_cmp_eq_u32 vcc, s25, v73
  s_or_b64 s[40:41], s[40:41], vcc
  v_cmp_eq_u32 vcc, s25, v74
  s_or_b64 s[40:41], s[40:41], vcc
  v_cmp_eq_u32 vcc, s25, v75
  s_or_b64 s[40:41], s[40:41], vcc
  s_cbranch_scc0 L_bred_s
L_go_50:
  buffer_load_dwordx4 v[68:71], v0, s[4:7], s15 offen sc1
  buffer_load_dwordx4 v[72:75], v0, s[4:7], s15 offen offset:1024 sc1
  s_waitcnt vmcnt(3)
  v_mfma_f32_16x16x32_bf16 v[80:83], v[48:51], v[40:43], 0
  v_fma_f32 v14, v40, v41, v42
  s_waitcnt vmcnt(2)
  v_mfma_f32_16x16x32_bf16 v[80:83], v[48:51], v[44:47], v[80:83]
  v_fma_f32 v14, v43, v44, v14
  v_fma_f32 v14, v45, v46, v14
  v_cmp_u_f32 vcc, v14, v47
  s_nop 3
  s_cbranch_vccnz L_rred0_s
  v_add_f32_dpp v80, v80, v80 row_ror:4 row_mask:0xf bank_mask:0xf
  v_add_f32_dpp v81, v81, v81 row_ror:4 row_mask:0xf bank_mask:0xf
  v_add_f32_dpp v82, v82, v82 row_ror:4 row_mask:0xf bank_mask:0xf
  v_add_f32_dpp v83, v83, v83 row_ror:4 row_mask:0xf bank_mask:0xf
  v_add_f32_dpp v80, v80, v80 row_ror:8 row_mask:0xf bank_mask:0xf
  v_add_f32_dpp v81, v81, v81 row_ror:8 row_mask:0xf bank_mask:0xf
  v_add_f32_dpp v82, v82, v82 row_ror:8 row_mask:0xf bank_mask:0xf
  v_add_f32_dpp v83, v83, v83 row_ror:8 row_mask:0xf bank_mask:0xf
  v_cvt_pk_bf16_f32 v80, v80, v81
  v_cvt_pk_bf16_f32 v81, v82, v83
  buffer_store_dwordx2 v[80:81], v7, s[4:7], s17 offen sc1
  buffer_store_dwordx2 v[80:81], v7, s[4:7], s19 offen sc1
  s_branch L_nored_47
L_rl_s:
  s_add_u32 s65, s65, 0x10000
  s_waitcnt vmcnt(2)
  ds_read2st64_b32 v[82:83], v84 offset0:0 offset1:4
  s_mov_b32 m0, 0
  s_add_u32 s36, s17, 4096
  buffer_load_dwordx4 v0, s[4:7], s17 offen offset:0 sc1 lds
  buffer_load_dwordx4 v0, s[4:7], s17 offen offset:1024 sc1 lds
  buffer_load_dwordx4 v0, s[4:7], s17 offen offset:2048 sc1 lds
  buffer_load_dwordx4 v0, s[4:7], s17 offen offset:3072 sc1 lds
  s_mov_b32 m0, 4096
  s_nop 0
  buffer_load_dwordx4 v0, s[4:7], s36 offen sc1 lds
  s_waitcnt lgkmcnt(0)
  v_cmp_u_f32 vcc, v82, v83
  s_cbranch_vccz L_bl3_s
  s_branch L_rl4_s
L_rl3_s:
  s_mov_b32 m0, 0
  s_add_u32 s36, s17, 4096
  buffer_load_dwordx4 v0, s[4:7], s17 offen offset:0 sc1 lds
  buffer_load_dwordx4 v0, s[4:7], s17 offen offset:1024 sc1 lds
  buffer_load_dwordx4 v0, s[4:7], s17 offen offset:2048 sc1 lds
  buffer_load_dwordx4 v0, s[4:7], s17 offen offset:3072 sc1 lds
  s_mov_b32 m0, 4096
  s_nop 0
  buffer_load_dwordx4 v0, s[4:7], s36 offen sc1 lds
L_rl4_s:
  s_add_u32 s65, s65, 1
  s_mov_b64 s[40:41], 0
  v_cmp_eq_u32 vcc, s25, v82
  s_or_b64 s[40:41], s[40:41], vcc
  v_cmp_eq_u32 vcc, s25, v83
  s_or_b64 s[40:41], s[40:41], vcc
  s_cbranch_scc0 L_bl3_s
  s_sub_u32 s12, s12, 1
  s_cbranch_scc1 L_cabort
  s_waitcnt vmcnt(0)
  ds_read2st64_b32 v[82:83], v84 offset0:0 offset1:4
  s_waitcnt lgkmcnt(0)
  v_cmp_u_f32 vcc, v82, v83
  s_cbranch_vccz L_bl3_s
  s_branch L_rl3_s
L_rlx_s:
  s_add_u32 s65, s65, 1
  s_mov_b32 m0, 0
  s_add_u32 s36, s17, 4096
  buffer_load_dwordx4 v0, s[4:7], s17 offen offset:0 sc1 lds
  buffer_load_dwordx4 v0, s[4:7], s17 offen offset:1024 sc1 lds
  buffer_load_dwordx4 v0, s[4:7], s17 offen offset:2048 sc1 lds
  buffer_load_dwordx4 v0, s[4:7], s17 offen offset:3072 sc1 lds
  s_mov_b32 m0, 4096
  s_nop 0
  buffer_load_dwordx4 v0, s[4:7], s36 offen sc1 lds
  s_waitcnt vmcnt(5)
  v_cmp_u_f32 vcc, v82, v83
  s_cbranch_vccz L_bl2_s
  s_mov_b64 s[40:41], 0
  v_cmp_eq_u32 vcc, s25, v82
  s_or_b64 s[40:41], s[40:41], vcc
  v_cmp_eq_u32 vcc, s25, v83
  s_or_b64 s[40:41], s[40:41], vcc
  s_cbranch_scc0 L_bl2_s
  s_sub_u32 s12, s12, 1
  s_cbranch_scc1 L_cabort
  s_branch L_rl_s
L_bl2_s:
  s_waitcnt vmcnt(0)
  s_branch L_bl3_s
L_rr_s:
  s_cmp_eq_u32 s11, 0
  s_cbranch_scc1 L_br_s
  s_mov_b64 s[40:41], 0
  v_cmp_eq_u32 vcc, s25, v80
  s_or_b64 s[40:41], s[40:41], vcc
  v_cmp_eq_u32 vcc, s25, v81
  s_or_b64 s[40:41], s[40:41], vcc
  s_cbranch_scc0 L_br_s
  s_waitcnt lgkmcnt(0)
  s_barrier
  s_sub_u32 s12, s12, 1
  s_cbranch_scc1 L_cabort
  s_cmp_lg_u32 s10, 3
  s_cbranch_scc1 L_w3_51
  s_add_u32 s66, s66, 1
  s_mov_b32 m0, 5120
  s_add_u32 s36, s18, 4096
  buffer_load_dwordx4 v0, s[4:7], s18 offen offset:0 sc1 lds
  buffer_load_dwordx4 v0, s[4:7], s18 offen offset:1024 sc1 lds
  buffer_load_dwordx4 v0, s[4:7], s18 offen offset:2048 sc1 lds
  buffer_load_dwordx4 v0, s[4:7], s18 offen offset:3072 sc1 lds
  s_mov_b32 m0, 9216
  s_nop 0
  buffer_load_dwordx4 v0, s[4:7], s36 offen sc1 lds
  s_mov_b32 m0, 22912
  s_waitcnt vmcnt(0)
L_w3_51:
  s_barrier
  ds_read2st64_b32 v[80:81], v13 offset0:20 offset1:24
  ds_read_b128 v[48:51], v0 offset:5120
  ds_read_b128 v[40:43], v0 offset:6144
  s_waitcnt lgkmcnt(0)
  v_cmp_u_f32 vcc, v80, v81
  s_cbranch_vccz L_br_s
  s_branch L_rr_s
L_bad_s:
  s_cmp_eq_u32 s11, 0
  s_cbranch_scc1 L_clean_52
  s_mov_b64 s[40:41], 0
  ds_read_b128 v[76:79], v0 offset:0
  s_waitcnt lgkmcnt(0)
  v_cmp_eq_u32 vcc, s25, v76
  s_or_b64 s[40:41], s[40:41], vcc
  v_cmp_eq_u32 vcc, s25, v77
  s_or_b64 s[40:41], s[40:41], vcc
  v_cmp_eq_u32 vcc, s25, v78
  s_or_b64 s[40:41], s[40:41], vcc
  v_cmp_eq_u32 vcc, s25, v79
  s_or_b64 s[40:41], s[40:41], vcc
  ds_read_b128 v[76:79], v0 offset:1024
  s_waitcnt lgkmcnt(0)
  v_cmp_eq_u32 vcc, s25, v76
  s_or_b64 s[40:41], s[40:41], vcc
  v_cmp_eq_u32 vcc, s25, v77
  s_or_b64 s[40:41], s[40:41], vcc
  v_cmp_eq_u32 vcc, s25, v78
  s_or_b64 s[40:41], s[40:41], vcc
  v_cmp_eq_u32 vcc, s25, v79
  s_or_b64 s[40:41], s[40:41], vcc
  ds_read_b128 v[76:79], v0 offset:2048
  s_waitcnt lgkmcnt(0)
  v_cmp_eq_u32 vcc, s25, v76
  s_or_b64 s[40:41], s[40:41], vcc
  v_cmp_eq_u32 vcc, s25, v77
  s_or_b64 s[40:41], s[40:41], vcc
  v_cmp_eq_u32 vcc, s25, v78
  s_or_b64 s[40:41], s[40:41], vcc
  v_cmp_eq_u32 vcc, s25, v79
  s_or_b64 s[40:41], s[40:41], vcc
  ds_read_b128 v[76:79], v0 offset:3072
  s_waitcnt lgkmcnt(0)
  v_cmp_eq_u32 vcc, s25, v76
  s_or_b64 s[40:41], s[40:41], vcc
  v_cmp_eq_u32 vcc, s25, v77
  s_or_b64 s[40:41], s[40:41], vcc
  v_cmp_eq_u32 vcc, s25, v78
  s_or_b64 s[40:41], s[40:41], vcc
  v_cmp_eq_u32 vcc, s25, v79
  s_or_b64 s[40:41], s[40:41], vcc
  ds_read_b128 v[76:79], v0 offset:4096
  s_waitcnt lgkmcnt(0)
  v_cmp_eq_u32 vcc, s25, v76
  s_or_b64 s[40:41], s[40:41], vcc
  v_cmp_eq_u32 vcc, s25, v77
  s_or_b64 s[40:41], s[40:41], vcc
  v_cmp_eq_u32 vcc, s25, v78
  s_or_b64 s[40:41], s[40:41], vcc
  v_cmp_eq_u32 vcc, s25, v79
  s_or_b64 s[40:41], s[40:41], vcc
  ds_read_b128 v[76:79], v0 offset:5120
  s_waitcnt lgkmcnt(0)
  v_cmp_eq_u32 vcc, s25, v76
  s_or_b64 s[40:41], s[40:41], vcc
  v_cmp_eq_u32 vcc, s25, v77
  s_or_b64 s[40:41], s[40:41], vcc
  v_cmp_eq_u32 vcc, s25, v78
  s_or_b64 s[40:41], s[40:41], vcc
  v_cmp_eq_u32 vcc, s25, v79
  s_or_b64 s[40:41], s[40:41], vcc
  ds_read_b128 v[76:79], v0 offset:6144
  s_waitcnt lgkmcnt(0)
  v_cmp_eq_u32 vcc, s25, v76
  s_or_b64 s[40:41], s[40:41], vcc
  v_cmp_eq_u32 vcc, s25, v77
  s_or_b64 s[40:41], s[40:41], vcc
  v_cmp_eq_u32 vcc, s25, v78
  s_or_b64 s[40:41], s[40:41], vcc
  v_cmp_eq_u32 vcc, s25, v79
  s_or_b64 s[40:41], s[40:41], vcc
  ds_read_b128 v[76:79], v0 offset:7168
  s_waitcnt lgkmcnt(0)
  v_cmp_eq_u32 vcc, s25, v76
  s_or_b64 s[40:41], s[40:41], vcc
  v_cmp_eq_u32 vcc, s25, v77
  s_or_b64 s[40:41], s[40:41], vcc
  v_cmp_eq_u32 vcc, s25, v78
  s_or_b64 s[40:41], s[40:41], vcc
  v_cmp_eq_u32 vcc, s25, v79
  s_or_b64 s[40:41], s[40:41], vcc
  ds_read_b128 v[76:79], v0 offset:8192
  s_waitcnt lgkmcnt(0)
  v_cmp_eq_u32 vcc, s25, v76
  s_or_b64 s[40:41], s[40:41], vcc
  v_cmp_eq_u32 vcc, s25, v77
  s_or_b64 s[40:41], s[40:41], vcc
  v_cmp_eq_u32 vcc, s25, v78
  s_or_b64 s[40:41], s[40:41], vcc
  v_cmp_eq_u32 vcc, s25, v79
  s_or_b64 s[40:41], s[40:41], vcc
  ds_read_b128 v[76:79], v0 offset:9216
  s_waitcnt lgkmcnt(0)
  v_cmp_eq_u32 vcc, s25, v76
  s_or_b64 s[40:41], s[40:41], vcc
  v_cmp_eq_u32 vcc, s25, v77
  s_or_b64 s[40:41], s[40:41], vcc
  v_cmp_eq_u32 vcc, s25, v78
  s_or_b64 s[40:41], s[40:41], vcc
  v_cmp_eq_u32 vcc, s25, v79
  s_or_b64 s[40:41], s[40:41], vcc
  s_cbranch_scc0 L_clean_52
  s_sub_u32 s12, s12, 1
  s_cbranch_scc1 L_cabort
  s_barrier
  s_mov_b32 m0, 0
  s_add_u32 s36, s17, 4096
  buffer_load_dwordx4 v0, s[4:7], s17 offen offset:0 sc1 lds
  buffer_load_dwordx4 v0, s[4:7], s17 offen offset:1024 sc1 lds
  buffer_load_dwordx4 v0, s[4:7], s17 offen offset:2048 sc1 lds
  buffer_load_dwordx4 v0, s[4:7], s17 offen offset:3072 sc1 lds
  s_mov_b32 m0, 4096
  s_nop 0
  buffer_load_dwordx4 v0, s[4:7], s36 offen sc1 lds
  s_mov_b32 m0, 5120
  s_add_u32 s36, s18, 4096
  buffer_load_dwordx4 v0, s[4:7], s18 offen offset:0 sc1 lds
  buffer_load_dwordx4 v0, s[4:7], s18 offen offset:1024 sc1 lds
  buffer_load_dwordx4 v0, s[4:7], s18 offen offset:2048 sc1 lds
  buffer_load_dwordx4 v0, s[4:7], s18 offen offset:3072 sc1 lds
  s_mov_b32 m0, 9216
  s_nop 0
  buffer_load_dwordx4 v0, s[4:7], s36 offen sc1 lds
  s_waitcnt vmcnt(0)
  s_barrier
  s_branch L_bad_s
L_clean_52:
  v_mov_b64 v[16:17], 0
  v_mov_b64 v[18:19], 0
  v_mov_b64 v[20:21], 0
  v_mov_b64 v[22:23], 0
  v_mov_b64 v[24:25], 0
  v_mov_b64 v[26:27], 0
  v_mov_b64 v[28:29], 0
  v_mov_b64 v[30:31], 0
  v_mov_b64 v[32:33], 0
  v_mov_b64 v[34:35], 0
  v_mov_b64 v[36:37], 0
  v_mov_b64 v[38:39], 0
  ds_read_b128 v[76:79], v0 offset:0
  ds_read_b128 v[52:55], v12 offset:0
  ds_read_b128 v[56:59], v12 offset:1024
  ds_read_b128 v[60:63], v12 offset:2048
  ds_read_b128 v[64:67], v12 offset:3072
  s_waitcnt lgkmcnt(0)
  v_smfmac_f32_16x16x64_bf16 v[16:19], v[76:79], v[88:95], v1
  v_smfmac_f32_16x16x64_bf16 v[20:23], v[76:79], v[168:175], v1
  v_smfmac_f32_16x16x64_bf16 v[24:27], v[76:79], v[248:255], v1
  v_smfmac_f32_16x16x64_bf16 v[28:31], v[76:79], a[72:79], v1
  v_smfmac_f32_16x16x64_bf16 v[32:35], v[76:79], v[52:59], v1
  v_smfmac_f32_16x16x64_bf16 v[36:39], v[76:79], v[60:67], v1
  ds_read_b128 v[76:79], v0 offset:1024
  ds_read_b128 v[52:55], v12 offset:4096
  ds_read_b128 v[56:59], v12 offset:5120
  ds_read_b128 v[60:63], v12 offset:6144
  ds_read_b128 v[64:67], v12 offset:7168
  s_waitcnt lgkmcnt(0)
  v_smfmac_f32_16x16x64_bf16 v[16:19], v[76:79], v[96:103], v1
  v_smfmac_f32_16x16x64_bf16 v[20:23], v[76:79], v[176:183], v1
  v_smfmac_f32_16x16x64_bf16 v[24:27], v[76:79], a[0:7], v1
  v_smfmac_f32_16x16x64_bf16 v[28:31], v[76:79], a[80:87], v1
  v_smfmac_f32_16x16x64_bf16 v[32:35], v[76:79], v[52:59], v1
  v_smfmac_f32_16x16x64_bf16 v[36:39], v[76:79], v[60:67], v1
  ds_read_b128 v[76:79], v0 offset:2048
  ds_read_b128 v[52:55], v12 offset:8192
  ds_read_b128 v[56:59], v12 offset:9216
  ds_read_b128 v[60:63], v12 offset:10240
  ds_read_b128 v[64:67], v12 offset:11264
  s_waitcnt lgkmcnt(0)
  v_smfmac_f32_16x16x64_bf16 v[16:19], v[76:79], v[104:111], v1
  v_smfmac_f32_16x16x64_bf16 v[20:23], v[76:79], v[184:191], v1
  v_smfmac_f32_16x16x64_bf16 v[24:27], v[76:79], a[8:15], v1
  v_smfmac_f32_16x16x64_bf16 v[28:31], v[76:79], a[88:95], v1
  v_smfmac_f32_16x16x64_bf16 v[32:35], v[76:79], v[52:59], v1
  v_smfmac_f32_16x16x64_bf16 v[36:39], v[76:79], v[60:67], v1
  ds_read_b128 v[76:79], v0 offset:3072
  ds_read_b128 v[52:55], v12 offset:12288
  ds_read_b128 v[56:59], v12 offset:13312
  ds_read_b128 v[60:63], v12 offset:14336
  ds_read_b128 v[64:67], v12 offset:15360
  s_waitcnt lgkmcnt(0)
  v_smfmac_f32_16x16x64_bf16 v[16:19], v[76:79], v[112:119], v1
  v_smfmac_f32_16x16x64_bf16 v[20:23], v[76:79], v[192:199], v1
  v_smfmac_f32_16x16x64_bf16 v[24:27], v[76:79], a[16:23], v1
  v_smfmac_f32_16x16x64_bf16 v[28:31], v[76:79], a[96:103], v1
  v_smfmac_f32_16x16x64_bf16 v[32:35], v[76:79], v[52:59], v1
  v_smfmac_f32_16x16x64_bf16 v[36:39], v[76:79], v[60:67], v1
  ds_read_b128 v[76:79], v0 offset:4096
  ds_read_b128 v[52:55], v12 offset:32768
  ds_read_b128 v[56:59], v12 offset:33792
  s_waitcnt lgkmcnt(0)
  v_smfmac_f32_16x16x64_bf16 v[16:19], v[76:79], v[120:127], v1
  v_smfmac_f32_16x16x64_bf16 v[20:23], v[76:79], v[200:207], v1
  v_smfmac_f32_16x16x64_bf16 v[24:27], v[76:79], a[24:31], v1
  v_smfmac_f32_16x16x64_bf16 v[28:31], v[76:79], a[104:111], v1
  v_smfmac_f32_16x16x64_bf16 v[32:35], v[76:79], v[52:59], v1
  v_smfmac_f32_16x16x64_bf16 v[36:39], v[76:79], a[192:199], v1
  ds_read_b128 v[76:79], v0 offset:5120
  s_waitcnt lgkmcnt(0)
  v_smfmac_f32_16x16x64_bf16 v[16:19], v[76:79], v[128:135], v1
  v_smfmac_f32_16x16x64_bf16 v[20:23], v[76:79], v[208:215], v1
  v_smfmac_f32_16x16x64_bf16 v[24:27], v[76:79], a[32:39], v1
  v_smfmac_f32_16x16x64_bf16 v[28:31], v[76:79], a[112:119], v1
  ds_read_b128 v[76:79], v0 offset:6144
  s_waitcnt lgkmcnt(0)
  v_smfmac_f32_16x16x64_bf16 v[16:19], v[76:79], v[136:143], v1
  v_smfmac_f32_16x16x64_bf16 v[20:23], v[76:79], v[216:223], v1
  v_smfmac_f32_16x16x64_bf16 v[24:27], v[76:79], a[40:47], v1
  v_smfmac_f32_16x16x64_bf16 v[28:31], v[76:79], a[120:127], v1
  ds_read_b128 v[76:79], v0 offset:7168
  s_waitcnt lgkmcnt(0)
  v_smfmac_f32_16x16x64_bf16 v[16:19], v[76:79], v[144:151], v1
  v_smfmac_f32_16x16x64_bf16 v[20:23], v[76:79], v[224:231], v1
  v_smfmac_f32_16x16x64_bf16 v[24:27], v[76:79], a[48:55], v1
  v_smfmac_f32_16x16x64_bf16 v[28:31], v[76:79], a[128:135], v1
  ds_read_b128 v[76:79], v0 offset:8192
  s_waitcnt lgkmcnt(0)
  v_smfmac_f32_16x16x64_bf16 v[16:19], v[76:79], v[152:159], v1
  v_smfmac_f32_16x16x64_bf16 v[20:23], v[76:79], v[232:239], v1
  v_smfmac_f32_16x16x64_bf16 v[24:27], v[76:79], a[56:63], v1
  v_smfmac_f32_16x16x64_bf16 v[28:31], v[76:79], a[136:143], v1
  v_smfmac_f32_16x16x64_bf16 v[32:35], v[76:79], a[176:183], v1
  ds_read_b128 v[76:79], v0 offset:9216
  s_waitcnt lgkmcnt(0)
  v_smfmac_f32_16x16x64_bf16 v[16:19], v[76:79], v[160:167], v1
  v_smfmac_f32_16x16x64_bf16 v[20:23], v[76:79], v[240:247], v1
  v_smfmac_f32_16x16x64_bf16 v[24:27], v[76:79], a[64:71], v1
  v_smfmac_f32_16x16x64_bf16 v[28:31], v[76:79], a[144:151], v1
  v_smfmac_f32_16x16x64_bf16 v[32:35], v[76:79], a[184:191], v1
  v_smfmac_f32_16x16x64_bf16 v[36:39], v[76:79], a[232:239], v1
  ds_read_b128 v[52:55], v8 offset:10240
  ds_read_b128 v[56:59], v8 offset:12288
  ds_read_b128 v[60:63], v8 offset:10368
  ds_read_b128 v[64:67], v8 offset:12416
  ds_read_b128 v[48:51], v0 offset:8192
  ds_read_b128 v[44:47], v0 offset:5120
  ds_read_b128 v[40:43], v0 offset:6144
  v_add_f32 v16, v16, v18
  v_add_f32 v17, v17, v19
  v_add_f32 v20, v20, v22
  v_add_f32 v21, v21, v23
  v_add_f32 v24, v24, v26
  v_cvt_pk_bf16_f32 v82, v16, v20
  v_cvt_pk_bf16_f32 v83, v17, v21
  ds_write2_b32 v2, v82, v83 offset0:0 offset1:136
  s_waitcnt lgkmcnt(0)
  s_cmp_eq_u32 s10, 3
  s_branch L_bbad_s
L_max_s:
  s_waitcnt lgkmcnt(0)
  ds_read_b128 v[76:79], v3
  ds_read_b128 v[80:83], v3 offset:64
  ds_read_b128 v[40:43], v4
  ds_read_b128 v[44:47], v4 offset:64
  ds_read_b128 v[52:55], v8 offset:10240
  ds_read_b128 v[56:59], v8 offset:12288
  ds_read_b128 v[60:63], v8 offset:10368
  ds_read_b128 v[64:67], v8 offset:12416
  ds_read_b128 v[16:19], v8 offset:10496
  ds_read_b128 v[20:23], v8 offset:12544
  ds_read_b128 v[24:27], v8 offset:10624
  ds_read_b128 v[28:31], v8 offset:12672
  s_waitcnt lgkmcnt(0)
  v_mfma_f32_16x16x32_bf16 v[52:55], v[52:55], v[76:79], 0
  v_mfma_f32_16x16x32_bf16 v[52:55], v[56:59], v[80:83], v[52:55]
  v_mfma_f32_16x16x32_bf16 v[60:63], v[60:63], v[76:79], 0
  v_mfma_f32_16x16x32_bf16 v[60:63], v[64:67], v[80:83], v[60:63]
  v_mfma_f32_16x16x32_bf16 v[16:19], v[16:19], v[76:79], 0
  v_mfma_f32_16x16x32_bf16 v[16:19], v[20:23], v[80:83], v[16:19]
  v_mfma_f32_16x16x32_bf16 v[24:27], v[24:27], v[76:79], 0
  v_mfma_f32_16x16x32_bf16 v[24:27], v[28:31], v[80:83], v[24:27]
  v_mfma_f32_16x16x32_bf16 v[40:43], v[40:43], v[76:79], 0
  v_mfma_f32_16x16x32_bf16 v[40:43], v[44:47], v[80:83], v[40:43]
  v_add_f32_dpp v84, v54, v52 row_ror:8 row_mask:0xf bank_mask:0x9
  s_nop 1
  v_add_f32_dpp v84, v53, v55 row_ror:8 row_mask:0xf bank_mask:0x6
  v_add_f32_dpp v85, v62, v60 row_ror:8 row_mask:0xf bank_mask:0x9
  s_nop 1
  v_add_f32_dpp v85, v61, v63 row_ror:8 row_mask:0xf bank_mask:0x6
  v_add_f32_dpp v86, v18, v16 row_ror:8 row_mask:0xf bank_mask:0x9
  s_nop 1
  v_add_f32_dpp v86, v17, v19 row_ror:8 row_mask:0xf bank_mask:0x6
  v_add_f32_dpp v87, v26, v24 row_ror:8 row_mask:0xf bank_mask:0x9
  s_nop 1
  v_add_f32_dpp v87, v25, v27 row_ror:8 row_mask:0xf bank_mask:0x6
  v_add_f32_dpp v64, v42, v40 row_ror:8 row_mask:0xf bank_mask:0xf
  v_add_f32_dpp v65, v43, v41 row_ror:8 row_mask:0xf bank_mask:0xf
  v_mul_f32 v64, s24, v64
  v_mul_f32 v65, s24, v65
  ds_read_b128 v[52:55], v12 offset:16384
  ds_read_b128 v[56:59], v12 offset:17408
  ds_read_b128 v[16:19], v12 offset:18432
  ds_read_b128 v[20:23], v12 offset:19456
  ds_read_b128 v[24:27], v12 offset:20480
  ds_read_b128 v[28:31], v12 offset:21504
  v_max3_f32 v82, v84, v85, v86
  v_max_f32 v82, v82, v87
  s_mov_b64 exec, s[26:27]
  v_max3_f32 v82, v82, v64, v65
  s_mov_b64 exec, -1
  s_nop 0
  v_max_f32_dpp v82, v82, v82 row_ror:8 row_mask:0xf bank_mask:0xf
  v_mov_b32 v83, v82
  s_nop 1
  v_permlane16_swap_b32 v82, v83
  v_max_f32 v82, v82, v83
  v_mov_b32 v83, v82
  s_nop 1
  v_permlane32_swap_b32 v82, v83
  v_max_f32 v82, v82, v83
  v_sub_f32 v84, v84, v82
  v_exp_f32 v84, v84
  v_sub_f32 v85, v85, v82
  v_exp_f32 v85, v85
  v_sub_f32 v86, v86, v82
  v_exp_f32 v86, v86
  v_sub_f32 v87, v87, v82
  v_exp_f32 v87, v87
  v_sub_f32 v64, v64, v82
  v_exp_f32 v64, v64
  v_sub_f32 v65, v65, v82
  v_exp_f32 v65, v65
  v_cvt_pk_bf16_f32 v60, v84, v85
  v_cvt_pk_bf16_f32 v61, v86, v87
  v_cvt_pk_bf16_f32 v80, v64, v65
  v_cvt_pk_bf16_f32 v83, v64, v65
  v_mov_b32 v81, 0
  v_mov_b32 v82, 0
  v_mov_b32_dpp v62, v60 row_ror:8 row_mask:0xf bank_mask:0xf
  v_mov_b32_dpp v63, v61 row_ror:8 row_mask:0xf bank_mask:0xf
  v_mov_b64 v[64:65], 0
  s_nop 0
  v_mfma_f32_16x16x32_bf16 v[44:47], v[48:51], v[60:63], 0
  v_mfma_f32_16x16x32_bf16 v[32:35], v[68:71], v[60:63], 0
  v_mfma_f32_16x16x32_bf16 v[36:39], v[72:75], v[60:63], 0
  v_mfma_f32_16x16x16_bf16 v[44:47], v[48:49], v[80:81], v[44:47]
  v_mfma_f32_16x16x16_bf16 v[32:35], v[14:15], v[80:81], v[32:35]
  v_mfma_f32_16x16x16_bf16 v[36:39], v[14:15], v[82:83], v[36:39]
  s_nop 5
  v_rcp_f32 v46, v44
  s_nop 0
  v_pk_mul_f32 v[32:33], v[32:33], v[46:47] op_sel_hi:[1,0]
  v_pk_mul_f32 v[34:35], v[34:35], v[46:47] op_sel_hi:[1,0]
  v_cvt_pk_bf16_f32 v84, v32, v33
  v_cvt_pk_bf16_f32 v85, v34, v35
  v_pk_mul_f32 v[36:37], v[36:37], v[46:47] op_sel_hi:[1,0]
  v_pk_mul_f32 v[38:39], v[38:39], v[46:47] op_sel_hi:[1,0]
  v_mov_b32_dpp v86, v84 row_ror:8 row_mask:0xf bank_mask:0xf
  v_mov_b32_dpp v87, v85 row_ror:8 row_mask:0xf bank_mask:0xf
  s_mov_b64 exec, s[26:27]
  v_cvt_pk_bf16_f32 v86, v36, v37
  v_cvt_pk_bf16_f32 v87, v38, v39
  s_mov_b64 exec, -1
  ds_write_b64 v5, v[86:87]
  s_branch L_bmax2_s
L_rdy_s:
L_rdy_53:
  s_sub_u32 s12, s12, 1
  s_cbranch_scc1 L_cabort
  v_lshrrev_b32 v82, 2, v0
  v_and_b32 v82, 12, v82
  buffer_load_dword v83, v82, s[4:7], s76 offen sc1
  v_lshrrev_b32 v82, 2, v82
L_rdya_54:
  s_waitcnt vmcnt(0)
  v_mad_u32_u24 v83, v83, 3, v82
  s_nop 0
  v_readlane_b32 s75, v83, 0
  v_readlane_b32 s36, v83, 1
  s_min_u32 s75, s75, s36
  v_readlane_b32 s36, v83, 2
  s_min_u32 s75, s75, s36
  s_cmp_ge_u32 s75, 64
  s_cselect_b32 s75, 128, s75
  s_cmp_ge_u32 s39, s75
  s_cbranch_scc1 L_rdy_53
  s_branch L_brdy_s
L_done_s:
  ds_write2_b32 v11, v14, v15 offset0:0 offset1:64
  s_add_u32 s22, s22, s74
  s_lshr_b32 s37, s11, 3
  s_bitcmp1_b32 s91, s37
  s_cselect_b32 s37, s51, 0
  s_add_u32 s63, s22, s37
  s_waitcnt vmcnt(0) lgkmcnt(0)
  s_barrier
  ds_read_b128 v[76:79], v10
  v_mov_b32 v48, 63
  s_waitcnt lgkmcnt(0)
  v_cndmask_b32 v76, v76, v48, s[72:73]
  s_mov_b64 exec, s[70:71]
  buffer_store_dwordx4 v[76:79], v0, s[4:7], s63 offen sc1
  s_mov_b64 exec, -1
  v_mov_b32 v48, 64
  s_cmp_eq_u32 s10, 2
  s_cselect_b32 s36, s22, 0x80000000
  s_waitcnt vmcnt(0)
  s_barrier
  s_mov_b64 exec, 1
  buffer_store_dword v48, v0, s[4:7], s36 offen sc1
  s_mov_b64 exec, -1
L_cend:
L_abort:
  s_endpgm
L_cabort:
  s_endpgm
L_worker:
  s_cmp_eq_u32 s36, 6
  s_cselect_b32 s37, 32, 0
  s_sub_u32 s8, s3, s37
  v_lshlrev_b32 v1, 4, v0
  s_lshl_b32 s24, s10, 15
  s_lshr_b32 s36, s8, 5
  s_and_b32 s37, s8, 31
  s_cmp_ge_u32 s36, 4
  s_cbranch_scc1 L_second
  s_mul_i32 s9, s36, 24
  s_add_u32 s9, s9, s37
  s_mul_i32 s64, s9, 171
  s_lshr_b32 s64, s64, 9
  s_mul_i32 s38, s64, 3
  s_sub_u32 s65, s9, s38
  s_lshl_b32 s36, s36, 3
  s_add_u32 s36, s36, s37
  s_add_u32 s36, s36, 72
  s_lshr_b32 s38, s36, 1
  s_sub_u32 s38, s38, 16
  s_and_b32 s39, s36, 1
  s_cmp_ge_u32 s37, 24
  s_cselect_b32 s9, s36, s9
  s_cselect_b32 s64, s38, s64
  s_cselect_b32 s65, s39, s65
  s_cselect_b32 s53, 2, 3
L_ct1:
  s_load_dwordx2 s[32:33], s[0:1], 16
  s_load_dwordx2 s[34:35], s[0:1], 24
  s_load_dwordx2 s[40:41], s[0:1], 32
  s_load_dwordx2 s[96:97], s[0:1], 0
  s_waitcnt lgkmcnt(0)
  s_mov_b32 s98, 2621440
  s_mov_b32 s99, 0x20000
  s_mov_b32 s36, s64
  s_cmp_lt_u32 s10, 2
  s_cselect_b32 s92, s34, s40
  s_cselect_b32 s93, s35, s41
  s_cselect_b32 s28, 0, 1
  s_cmp_lt_u32 s36, 32
  s_cselect_b32 s92, s92, s32
  s_cselect_b32 s93, s93, s33
  s_cselect_b32 s28, s28, 0
  s_cselect_b32 s26, 0x3e0293ee, 1.0
  s_mov_b32 s27, s26
  s_mov_b32 s94, 5242880
  s_mov_b32 s95, 0x20000
  s_and_b32 s37, s10, 1
  s_lshl_b32 s37, s37, 7
  s_lshl_b32 s38, s36, 8
  s_add_u32 s37, s37, s38
  s_sub_u32 s38, s36, 32
  s_lshl_b32 s38, s38, 2
  s_add_u32 s38, s38, s10
  s_lshl_b32 s39, s38, 7
  s_cmp_lt_u32 s36, 32
  s_cselect_b32 s13, s37, s39
  s_cselect_b32 s31, 0, 8192
  s_and_b32 s37, s36, 31
  s_lshl_b32 s37, s37, 1
  s_lshr_b32 s38, s10, 1
  s_add_u32 s37, s37, s38
  s_lshl_b32 s37, s37, 14
  s_and_b32 s38, s10, 1
  s_lshl_b32 s38, s38, 12
  s_add_u32 s37, s37, s38
  s_lshl_b32 s38, s65, 20
  s_add_u32 s37, s37, s38
  s_add_u32 s16, s37, 134217728
  s_lshl_b32 s17, s53, 20
  s_mov_b32 s75, s65
  s_mul_i32 s14, s65, 40960
  s_mul_i32 s15, s53, 40960
  s_cmp_eq_u32 s65, 0
  s_cselect_b32 s18, 22, 21
  s_cmp_lt_u32 s64, 32
  s_cselect_b32 s18, s18, 32
  v_lshrrev_b32 v16, 3, v0
  v_mul_u32_u24 v16, 8192, v16
  v_lshrrev_b32 v17, 2, v0
  v_and_b32 v17, 4, v17
  v_xor_b32 v17, v17, v0
  v_and_b32 v17, 7, v17
  v_lshl_add_u32 v3, v17, 4, v16
  s_add_u32 m0, s24, 0
  s_add_u32 s36, s13, 0
  buffer_load_dwordx4 v3, s[92:95], s36 offen lds
  s_add_u32 m0, s24, 1024
  s_add_u32 s36, s13, 65536
  buffer_load_dwordx4 v3, s[92:95], s36 offen lds
  s_add_u32 m0, s24, 2048
  s_add_u32 s36, s13, 131072
  buffer_load_dwordx4 v3, s[92:95], s36 offen lds
  s_add_u32 m0, s24, 3072
  s_add_u32 s36, s13, 196608
  buffer_load_dwordx4 v3, s[92:95], s36 offen lds
  v_mov_b32 v19, 0
  s_bitcmp1_b32 s2, 31
  s_cbranch_scc1 L_cask_55
  s_cmp_lg_u32 s10, 0
  s_cbranch_scc1 L_cask_55
  s_lshr_b32 s38, s3, 5
  s_lshr_b32 s36, 160, s38
  s_and_b32 s36, s36, 1
  s_lshl_b32 s36, s36, 5
  s_add_u32 s38, s38, s36
  s_lshl_b32 s38, s38, 2
  s_and_b32 s37, s3, 31
  s_lshl_b32 s36, 1, s37
  v_mov_b32 v18, s36
  s_mov_b64 exec, 1
  buffer_atomic_or v18, v19, s[84:87], s38 offen sc0
  s_mov_b64 exec, -1
L_cask_55:
  s_add_u32 m0, s24, 4096
  s_add_u32 s36, s13, 262144
  buffer_load_dwordx4 v3, s[92:95], s36 offen lds
  s_add_u32 m0, s24, 5120
  s_add_u32 s36, s13, 327680
  buffer_load_dwordx4 v3, s[92:95], s36 offen lds
  s_add_u32 m0, s24, 6144
  s_add_u32 s36, s13, 393216
  buffer_load_dwordx4 v3, s[92:95], s36 offen lds
  s_add_u32 m0, s24, 7168
  s_add_u32 s36, s13, 458752
  buffer_load_dwordx4 v3, s[92:95], s36 offen lds
  s_add_u32 m0, s24, 8192
  s_add_u32 s36, s13, 524288
  buffer_load_dwordx4 v3, s[92:95], s36 offen lds
  s_add_u32 m0, s24, 9216
  s_add_u32 s36, s13, 589824
  buffer_load_dwordx4 v3, s[92:95], s36 offen lds
  s_add_u32 m0, s24, 10240
  s_add_u32 s36, s13, 655360
  buffer_load_dwordx4 v3, s[92:95], s36 offen lds
  s_add_u32 m0, s24, 11264
  s_add_u32 s36, s13, 720896
  buffer_load_dwordx4 v3, s[92:95], s36 offen lds
  s_add_u32 m0, s24, 12288
  s_add_u32 s36, s13, 786432
  buffer_load_dwordx4 v3, s[92:95], s36 offen lds
  s_add_u32 m0, s24, 13312
  s_add_u32 s36, s13, 851968
  buffer_load_dwordx4 v3, s[92:95], s36 offen lds
  s_add_u32 m0, s24, 14336
  s_add_u32 s36, s13, 917504
  buffer_load_dwordx4 v3, s[92:95], s36 offen lds
  s_add_u32 m0, s24, 15360
  s_add_u32 s36, s13, 983040
  buffer_load_dwordx4 v3, s[92:95], s36 offen lds
  s_add_u32 m0, s24, 16384
  s_add_u32 s36, s13, 1048576
  buffer_load_dwordx4 v3, s[92:95], s36 offen lds
  s_add_u32 m0, s24, 17408
  s_add_u32 s36, s13, 1114112
  buffer_load_dwordx4 v3, s[92:95], s36 offen lds
  s_add_u32 m0, s24, 18432
  s_add_u32 s36, s13, 1179648
  buffer_load_dwordx4 v3, s[92:95], s36 offen lds
  s_add_u32 m0, s24, 19456
  s_add_u32 s36, s13, 1245184
  buffer_load_dwordx4 v3, s[92:95], s36 offen lds
  s_add_u32 m0, s24, 20480
  s_add_u32 s36, s13, 1310720
  buffer_load_dwordx4 v3, s[92:95], s36 offen lds
  s_add_u32 m0, s24, 21504
  s_add_u32 s36, s13, 1376256
  buffer_load_dwordx4 v3, s[92:95], s36 offen lds
  s_add_u32 m0, s24, 22528
  s_add_u32 s36, s13, 1441792
  buffer_load_dwordx4 v3, s[92:95], s36 offen lds
  s_add_u32 m0, s24, 23552
  s_add_u32 s36, s13, 1507328
  buffer_load_dwordx4 v3, s[92:95], s36 offen lds
  s_add_u32 m0, s24, 24576
  s_add_u32 s36, s13, 1572864
  buffer_load_dwordx4 v3, s[92:95], s36 offen lds
  s_add_u32 m0, s24, 25600
  s_add_u32 s36, s13, 1638400
  buffer_load_dwordx4 v3, s[92:95], s36 offen lds
  s_add_u32 m0, s24, 26624
  s_add_u32 s36, s13, 1703936
  buffer_load_dwordx4 v3, s[92:95], s36 offen lds
  s_add_u32 m0, s24, 27648
  s_add_u32 s36, s13, 1769472
  buffer_load_dwordx4 v3, s[92:95], s36 offen lds
  s_add_u32 m0, s24, 28672
  s_add_u32 s36, s13, 1835008
  buffer_load_dwordx4 v3, s[92:95], s36 offen lds
  s_add_u32 m0, s24, 29696
  s_add_u32 s36, s13, 1900544
  buffer_load_dwordx4 v3, s[92:95], s36 offen lds
  s_add_u32 m0, s24, 30720
  s_add_u32 s36, s13, 1966080
  buffer_load_dwordx4 v3, s[92:95], s36 offen lds
  s_add_u32 m0, s24, 31744
  s_add_u32 s36, s13, 2031616
  buffer_load_dwordx4 v3, s[92:95], s36 offen lds
  s_bitcmp1_b32 s2, 31
  s_cbranch_scc1 L_cdone_56
  s_cmp_lg_u32 s10, 0
  s_cbranch_scc1 L_cwait_57
  s_lshr_b32 s38, s3, 5
  s_lshr_b32 s36, 160, s38
  s_and_b32 s36, s36, 1
  s_lshl_b32 s36, s36, 5
  s_add_u32 s38, s38, s36
  s_lshl_b32 s38, s38, 2
  s_and_b32 s37, s3, 31
  s_lshl_b32 s36, 1, s37
  s_mov_b64 exec, 1
  s_waitcnt vmcnt(28)
  s_branch L_cans_64
L_ctry_58:
  s_lshl_b32 s36, 1, s37
  v_mov_b32 v18, s36
  s_mov_b64 exec, 1
  buffer_atomic_or v18, v19, s[84:87], s38 offen sc0
  s_waitcnt vmcnt(0)
L_cans_64:
  v_readfirstlane_b32 s39, v18
  s_mov_b64 exec, -1
  s_and_b32 s36, s36, s39
  s_cbranch_scc0 L_cgot_59
  s_cmp_eq_u32 s39, -1
  s_cbranch_scc1 L_covf_60
  s_mul_i32 s37, s2, 37
  s_lshr_b32 s37, s37, 3
  s_and_b32 s37, s37, 31
  s_mov_b32 vcc_lo, s39
  s_mov_b32 vcc_hi, s39
  s_lshr_b64 vcc, vcc, s37
  s_ff0_i32_b32 s36, vcc_lo
  s_add_u32 s37, s37, s36
  s_and_b32 s37, s37, 31
  s_branch L_ctry_58
L_cgot_59:
  s_and_b32 s36, s3, 0xe0
  s_add_u32 s37, s37, s36
  s_branch L_chave_63
L_covf_60:
  v_mov_b32 v18, 1
  s_mov_b64 exec, 1
  buffer_atomic_add v18, v19, s[84:87], 36 offen sc0
  s_waitcnt vmcnt(0)
  v_readfirstlane_b32 s38, v18
  s_mov_b64 exec, -1
  v_lshlrev_b32 v19, 2, v0
L_clp_61:
  s_sub_u32 s12, s12, 1
  s_cbranch_scc1 L_abort
  buffer_load_dword v18, v19, s[84:87], 0 offen sc1
  s_waitcnt vmcnt(0)
  v_readlane_b32 s37, v18, 9
  v_readlane_b32 s36, v18, 0
  s_bcnt1_i32_b32 s36, s36
  s_add_u32 s37, s37, s36
  v_readlane_b32 s36, v18, 1
  s_bcnt1_i32_b32 s36, s36
  s_add_u32 s37, s37, s36
  v_readlane_b32 s36, v18, 2
  s_bcnt1_i32_b32 s36, s36
  s_add_u32 s37, s37, s36
  v_readlane_b32 s36, v18, 3
  s_bcnt1_i32_b32 s36, s36
  s_add_u32 s37, s37, s36
  v_readlane_b32 s36, v18, 4
  s_bcnt1_i32_b32 s36, s36
  s_add_u32 s37, s37, s36
  v_readlane_b32 s36, v18, 37
  s_bcnt1_i32_b32 s36, s36
  s_add_u32 s37, s37, s36
  v_readlane_b32 s36, v18, 6
  s_bcnt1_i32_b32 s36, s36
  s_add_u32 s37, s37, s36
  v_readlane_b32 s36, v18, 39
  s_bcnt1_i32_b32 s36, s36
  s_add_u32 s37, s37, s36
  s_cmp_lt_u32 s37, 256
  s_cbranch_scc1 L_clp_61
  v_readlane_b32 s39, v18, 0
  s_mov_b32 s37, 0
  s_bcnt0_i32_b32 s36, s39
  s_cmp_lt_u32 s38, s36
  s_cbranch_scc1 L_csel_62
  s_sub_u32 s38, s38, s36
  v_readlane_b32 s39, v18, 1
  s_mov_b32 s37, 32
  s_bcnt0_i32_b32 s36, s39
  s_cmp_lt_u32 s38, s36
  s_cbranch_scc1 L_csel_62
  s_sub_u32 s38, s38, s36
  v_readlane_b32 s39, v18, 2
  s_mov_b32 s37, 64
  s_bcnt0_i32_b32 s36, s39
  s_cmp_lt_u32 s38, s36
  s_cbranch_scc1 L_csel_62
  s_sub_u32 s38, s38, s36
  v_readlane_b32 s39, v18, 3
  s_mov_b32 s37, 96
  s_bcnt0_i32_b32 s36, s39
  s_cmp_lt_u32 s38, s36
  s_cbranch_scc1 L_csel_62
  s_sub_u32 s38, s38, s36
  v_readlane_b32 s39, v18, 4
  s_mov_b32 s37, 128
  s_bcnt0_i32_b32 s36, s39
  s_cmp_lt_u32 s38, s36
  s_cbranch_scc1 L_csel_62
  s_sub_u32 s38, s38, s36
  v_readlane_b32 s39, v18, 37
  s_mov_b32 s37, 160
  s_bcnt0_i32_b32 s36, s39
  s_cmp_lt_u32 s38, s36
  s_cbranch_scc1 L_csel_62
  s_sub_u32 s38, s38, s36
  v_readlane_b32 s39, v18, 6
  s_mov_b32 s37, 192
  s_bcnt0_i32_b32 s36, s39
  s_cmp_lt_u32 s38, s36
  s_cbranch_scc1 L_csel_62
  s_sub_u32 s38, s38, s36
  v_readlane_b32 s39, v18, 39
  s_mov_b32 s37, 224
  s_bcnt0_i32_b32 s36, s39
  s_cmp_lt_u32 s38, s36
  s_cbranch_scc1 L_csel_62
  s_sub_u32 s38, s38, s36
  s_branch L_abort
L_csel_62:
  s_ff0_i32_b32 s36, s39
  s_bitset1_b32 s39, s36
  s_sub_u32 s38, s38, 1
  s_cbranch_scc0 L_csel_62
  s_add_u32 s37, s37, s36
L_chave_63:
  v_mov_b32 v18, s37
  v_mov_b32 v19, 163836
  ds_write_b32 v19, v18
  s_waitcnt lgkmcnt(0)
L_cwait_57:
  s_barrier
  v_mov_b32 v19, 163836
  ds_read_b32 v18, v19
  s_waitcnt lgkmcnt(0)
  v_readfirstlane_b32 s36, v18
  s_bitset1_b32 s2, 31
  s_and_b32 s36, s36, 255
  s_cmp_eq_u32 s36, s3
  s_cbranch_scc1 L_cdone_56
  s_mov_b32 s3, s36
  s_waitcnt vmcnt(0)
  s_barrier
  s_branch L_dispatch
L_cdone_56:
  v_lshrrev_b32 v16, 5, v0
  v_lshlrev_b32 v16, 10, v16
  v_bfe_u32 v17, v0, 2, 2
  v_lshl_add_u32 v16, v17, 7, v16
  v_bfe_u32 v17, v0, 3, 1
  v_lshl_add_u32 v16, v17, 6, v16
  v_bfe_u32 v17, v0, 4, 1
  v_lshl_add_u32 v18, v17, 5, v16
  v_bfe_u32 v17, v0, 1, 1
  v_lshl_add_u32 v18, v17, 4, v18
  v_bfe_u32 v17, v0, 0, 1
  v_lshl_add_u32 v18, v17, 3, v18
  v_add_u32 v2, s24, v18
  v_xor_b32 v4, 64, v2
  s_lshl_b32 s36, s10, 3
  v_lshrrev_b32 v16, 3, v0
  v_add_u32 v16, s36, v16
  v_lshrrev_b32 v17, 1, v16
  v_xor_b32 v17, v17, v0
  v_and_b32 v17, 7, v17
  v_mul_u32_u24 v16, 1280, v16
  v_lshl_add_u32 v5, v17, 4, v16
  v_and_b32 v16, 31, v0
  v_bfe_u32 v17, v0, 1, 3
  v_lshrrev_b32 v18, 5, v0
  v_xor_b32 v17, v17, v18
  v_lshlrev_b32 v16, 7, v16
  v_xor_b32 v18, 0, v17
  v_lshl_add_u32 v6, v18, 4, v16
  v_xor_b32 v18, 2, v17
  v_lshl_add_u32 v7, v18, 4, v16
  v_xor_b32 v18, 4, v17
  v_lshl_add_u32 v8, v18, 4, v16
  v_xor_b32 v18, 6, v17
  v_lshl_add_u32 v9, v18, 4, v16
  s_lshl_b32 s37, s64, 7
  s_lshl_b32 s38, s65, 2
  s_add_u32 s37, s37, s38
  s_add_u32 s37, s37, 218103808
  s_cmp_eq_u32 s10, 0
  s_cselect_b32 s19, s37, 0x80000000
  v_mov_b32 v16, 0
  s_mov_b64 exec, 1
  s_add_u32 s37, s19, 8192
  buffer_store_dword v16, v1, s[4:7], s19 offen sc1
  buffer_store_dword v16, v1, s[4:7], s37 offen sc1
  s_mov_b64 exec, -1
  s_lshl_b32 s36, s8, 2
  s_add_u32 s32, s36, s10
  s_lshl_b32 s37, s32, 13
  s_add_u32 s37, s37, 130023424
  s_sub_u32 s38, s32, 512
  s_mul_i32 s39, s38, 5120
  s_add_u32 s39, s39, 60817408
  s_cmp_lt_u32 s32, 512
  s_cselect_b32 s37, s37, s39
  s_sub_u32 s38, s32, 640
  s_lshl_b32 s39, s38, 13
  s_add_u32 s39, s39, 61865984
  s_cmp_lt_u32 s32, 640
  s_cselect_b32 s37, s37, s39
  s_cmp_lt_u32 s32, 648
  s_cselect_b32 s37, s37, 0x80000000
  v_mov_b32 v20, 0x7f817f81
  v_mov_b32 v21, 0x7f817f81
  v_mov_b32 v22, 0x7f817f81
  v_mov_b32 v23, 0x7f817f81
  buffer_store_dwordx4 v[20:23], v1, s[4:7], s37 offen offset:0 sc1
  buffer_store_dwordx4 v[20:23], v1, s[4:7], s37 offen offset:1024 sc1
  buffer_store_dwordx4 v[20:23], v1, s[4:7], s37 offen offset:2048 sc1
  buffer_store_dwordx4 v[20:23], v1, s[4:7], s37 offen offset:3072 sc1
  s_add_u32 s37, s37, 4096
  buffer_store_dwordx4 v[20:23], v1, s[4:7], s37 offen sc1
  v_lshlrev_b32 v17, 7, v0
  s_sub_u32 s38, s32, 648
  s_lshl_b32 s39, s38, 13
  s_add_u32 s39, s39, 218120192
  s_cmp_lt_u32 s38, 2
  s_cselect_b32 s37, s39, 0x80000000
  buffer_store_dword v16, v17, s[4:7], s37 offen sc1
  s_mov_b32 s39, 63979520
  s_cmp_eq_u32 s38, 2
  s_cselect_b32 s37, s39, 0x80000000
  buffer_store_dword v16, v17, s[4:7], s37 offen sc1
  s_mul_i32 s36, s10, 10240
  s_add_u32 s36, s36, s14
  buffer_load_dword v25, v17, s[96:99], s36 offen
  buffer_load_dword v26, v17, s[96:99], s36 offen offset:2048
  s_waitcnt vmcnt(24)
  ds_read_b64_tr_b16 v[192:193], v2 offset:0
  ds_read_b64_tr_b16 v[194:195], v2 offset:512
  ds_read_b64_tr_b16 a[96:97], v4 offset:0
  ds_read_b64_tr_b16 a[98:99], v4 offset:512
  ds_read_b64_tr_b16 v[196:197], v2 offset:2048
  ds_read_b64_tr_b16 v[198:199], v2 offset:2560
  ds_read_b64_tr_b16 a[100:101], v4 offset:2048
  ds_read_b64_tr_b16 a[102:103], v4 offset:2560
  s_waitcnt lgkmcnt(0)
  ds_read_b64_tr_b16 v[200:201], v2 offset:4096
  ds_read_b64_tr_b16 v[202:203], v2 offset:4608
  ds_read_b64_tr_b16 a[104:105], v4 offset:4096
  ds_read_b64_tr_b16 a[106:107], v4 offset:4608
  ds_read_b64_tr_b16 v[204:205], v2 offset:6144
  ds_read_b64_tr_b16 v[206:207], v2 offset:6656
  ds_read_b64_tr_b16 a[108:109], v4 offset:6144
  ds_read_b64_tr_b16 a[110:111], v4 offset:6656
  s_waitcnt lgkmcnt(0)
  s_add_u32 m0, s24, 0
  s_add_u32 s36, s13, 2097152
  buffer_load_dwordx4 v3, s[92:95], s36 offen lds
  s_add_u32 m0, s24, 1024
  s_add_u32 s36, s13, 2162688
  buffer_load_dwordx4 v3, s[92:95], s36 offen lds
  s_add_u32 m0, s24, 2048
  s_add_u32 s36, s13, 2228224
  buffer_load_dwordx4 v3, s[92:95], s36 offen lds
  s_add_u32 m0, s24, 3072
  s_add_u32 s36, s13, 2293760
  buffer_load_dwordx4 v3, s[92:95], s36 offen lds
  s_add_u32 m0, s24, 4096
  s_add_u32 s36, s13, 2359296
  buffer_load_dwordx4 v3, s[92:95], s36 offen lds
  s_add_u32 m0, s24, 5120
  s_add_u32 s36, s13, 2424832
  buffer_load_dwordx4 v3, s[92:95], s36 offen lds
  s_add_u32 m0, s24, 6144
  s_add_u32 s36, s13, 2490368
  buffer_load_dwordx4 v3, s[92:95], s36 offen lds
  s_add_u32 m0, s24, 7168
  s_add_u32 s36, s13, 2555904
  buffer_load_dwordx4 v3, s[92:95], s36 offen lds
  s_waitcnt vmcnt(24)
  ds_read_b64_tr_b16 v[208:209], v2 offset:8192
  ds_read_b64_tr_b16 v[210:211], v2 offset:8704
  ds_read_b64_tr_b16 a[112:113], v4 offset:8192
  ds_read_b64_tr_b16 a[114:115], v4 offset:8704
  ds_read_b64_tr_b16 v[212:213], v2 offset:10240
  ds_read_b64_tr_b16 v[214:215], v2 offset:10752
  ds_read_b64_tr_b16 a[116:117], v4 offset:10240
  ds_read_b64_tr_b16 a[118:119], v4 offset:10752
  s_waitcnt lgkmcnt(0)
  ds_read_b64_tr_b16 v[216:217], v2 offset:12288
  ds_read_b64_tr_b16 v[218:219], v2 offset:12800
  ds_read_b64_tr_b16 a[120:121], v4 offset:12288
  ds_read_b64_tr_b16 a[122:123], v4 offset:12800
  ds_read_b64_tr_b16 v[220:221], v2 offset:14336
  ds_read_b64_tr_b16 v[222:223], v2 offset:14848
  ds_read_b64_tr_b16 a[124:125], v4 offset:14336
  ds_read_b64_tr_b16 a[126:127], v4 offset:14848
  s_waitcnt lgkmcnt(0)
  s_add_u32 m0, s24, 8192
  s_add_u32 s36, s13, 2621440
  buffer_load_dwordx4 v3, s[92:95], s36 offen lds
  s_add_u32 m0, s24, 9216
  s_add_u32 s36, s13, 2686976
  buffer_load_dwordx4 v3, s[92:95], s36 offen lds
  s_add_u32 m0, s24, 10240
  s_add_u32 s36, s13, 2752512
  buffer_load_dwordx4 v3, s[92:95], s36 offen lds
  s_add_u32 m0, s24, 11264
  s_add_u32 s36, s13, 2818048
  buffer_load_dwordx4 v3, s[92:95], s36 offen lds
  s_add_u32 m0, s24, 12288
  s_add_u32 s36, s13, 2883584
  buffer_load_dwordx4 v3, s[92:95], s36 offen lds
  s_add_u32 m0, s24, 13312
  s_add_u32 s36, s13, 2949120
  buffer_load_dwordx4 v3, s[92:95], s36 offen lds
  s_add_u32 m0, s24, 14336
  s_add_u32 s36, s13, 3014656
  buffer_load_dwordx4 v3, s[92:95], s36 offen lds
  s_add_u32 m0, s24, 15360
  s_add_u32 s36, s13, 3080192
  buffer_load_dwordx4 v3, s[92:95], s36 offen lds
  s_waitcnt vmcnt(24)
  ds_read_b64_tr_b16 v[224:225], v2 offset:16384
  ds_read_b64_tr_b16 v[226:227], v2 offset:16896
  ds_read_b64_tr_b16 a[128:129], v4 offset:16384
  ds_read_b64_tr_b16 a[130:131], v4 offset:16896
  ds_read_b64_tr_b16 v[228:229], v2 offset:18432
  ds_read_b64_tr_b16 v[230:231], v2 offset:18944
  ds_read_b64_tr_b16 a[132:133], v4 offset:18432
  ds_read_b64_tr_b16 a[134:135], v4 offset:18944
  s_waitcnt lgkmcnt(0)
  ds_read_b64_tr_b16 v[232:233], v2 offset:20480
  ds_read_b64_tr_b16 v[234:235], v2 offset:20992
  ds_read_b64_tr_b16 a[136:137], v4 offset:20480
  ds_read_b64_tr_b16 a[138:139], v4 offset:20992
  ds_read_b64_tr_b16 v[236:237], v2 offset:22528
  ds_read_b64_tr_b16 v[238:239], v2 offset:23040
  ds_read_b64_tr_b16 a[140:141], v4 offset:22528
  ds_read_b64_tr_b16 a[142:143], v4 offset:23040
  s_waitcnt lgkmcnt(0)
  s_add_u32 m0, s24, 16384
  s_add_u32 s36, s13, 3145728
  buffer_load_dwordx4 v3, s[92:95], s36 offen lds
  s_add_u32 m0, s24, 17408
  s_add_u32 s36, s13, 3211264
  buffer_load_dwordx4 v3, s[92:95], s36 offen lds
  s_add_u32 m0, s24, 18432
  s_add_u32 s36, s13, 3276800
  buffer_load_dwordx4 v3, s[92:95], s36 offen lds
  s_add_u32 m0, s24, 19456
  s_add_u32 s36, s13, 3342336
  buffer_load_dwordx4 v3, s[92:95], s36 offen lds
  s_add_u32 m0, s24, 20480
  s_add_u32 s36, s13, 3407872
  buffer_load_dwordx4 v3, s[92:95], s36 offen lds
  s_add_u32 m0, s24, 21504
  s_add_u32 s36, s13, 3473408
  buffer_load_dwordx4 v3, s[92:95], s36 offen lds
  s_add_u32 m0, s24, 22528
  s_add_u32 s36, s13, 3538944
  buffer_load_dwordx4 v3, s[92:95], s36 offen lds
  s_add_u32 m0, s24, 23552
  s_add_u32 s36, s13, 3604480
  buffer_load_dwordx4 v3, s[92:95], s36 offen lds
  s_waitcnt vmcnt(24)
  ds_read_b64_tr_b16 v[240:241], v2 offset:24576
  ds_read_b64_tr_b16 v[242:243], v2 offset:25088
  ds_read_b64_tr_b16 a[144:145], v4 offset:24576
  ds_read_b64_tr_b16 a[146:147], v4 offset:25088
  ds_read_b64_tr_b16 v[244:245], v2 offset:26624
  ds_read_b64_tr_b16 v[246:247], v2 offset:27136
  ds_read_b64_tr_b16 a[148:149], v4 offset:26624
  ds_read_b64_tr_b16 a[150:151], v4 offset:27136
  s_waitcnt lgkmcnt(0)
  ds_read_b64_tr_b16 v[248:249], v2 offset:28672
  ds_read_b64_tr_b16 v[250:251], v2 offset:29184
  ds_read_b64_tr_b16 a[152:153], v4 offset:28672
  ds_read_b64_tr_b16 a[154:155], v4 offset:29184
  ds_read_b64_tr_b16 v[252:253], v2 offset:30720
  ds_read_b64_tr_b16 v[254:255], v2 offset:31232
  ds_read_b64_tr_b16 a[156:157], v4 offset:30720
  ds_read_b64_tr_b16 a[158:159], v4 offset:31232
  s_waitcnt lgkmcnt(0)
  s_add_u32 m0, s24, 24576
  s_add_u32 s36, s13, 3670016
  buffer_load_dwordx4 v3, s[92:95], s36 offen lds
  s_add_u32 m0, s24, 25600
  s_add_u32 s36, s13, 3735552
  buffer_load_dwordx4 v3, s[92:95], s36 offen lds
  s_add_u32 m0, s24, 26624
  s_add_u32 s36, s13, 3801088
  buffer_load_dwordx4 v3, s[92:95], s36 offen lds
  s_add_u32 m0, s24, 27648
  s_add_u32 s36, s13, 3866624
  buffer_load_dwordx4 v3, s[92:95], s36 offen lds
  s_add_u32 m0, s24, 28672
  s_add_u32 s36, s13, 3932160
  buffer_load_dwordx4 v3, s[92:95], s36 offen lds
  s_add_u32 m0, s24, 29696
  s_add_u32 s36, s13, 3997696
  buffer_load_dwordx4 v3, s[92:95], s36 offen lds
  s_add_u32 m0, s24, 30720
  s_add_u32 s36, s13, 4063232
  buffer_load_dwordx4 v3, s[92:95], s36 offen lds
  s_add_u32 m0, s24, 31744
  s_add_u32 s36, s13, 4128768
  buffer_load_dwordx4 v3, s[92:95], s36 offen lds
  s_waitcnt vmcnt(24)
  ds_read_b64_tr_b16 a[0:1], v2 offset:0
  ds_read_b64_tr_b16 a[2:3], v2 offset:512
  ds_read_b64_tr_b16 a[160:161], v4 offset:0
  ds_read_b64_tr_b16 a[162:163], v4 offset:512
  ds_read_b64_tr_b16 a[4:5], v2 offset:2048
  ds_read_b64_tr_b16 a[6:7], v2 offset:2560
  ds_read_b64_tr_b16 a[164:165], v4 offset:2048
  ds_read_b64_tr_b16 a[166:167], v4 offset:2560
  s_waitcnt lgkmcnt(0)
  ds_read_b64_tr_b16 a[8:9], v2 offset:4096
  ds_read_b64_tr_b16 a[10:11], v2 offset:4608
  ds_read_b64_tr_b16 a[168:169], v4 offset:4096
  ds_read_b64_tr_b16 a[170:171], v4 offset:4608
  ds_read_b64_tr_b16 a[12:13], v2 offset:6144
  ds_read_b64_tr_b16 a[14:15], v2 offset:6656
  ds_read_b64_tr_b16 a[172:173], v4 offset:6144
  ds_read_b64_tr_b16 a[174:175], v4 offset:6656
  s_waitcnt lgkmcnt(0)
  s_add_u32 m0, s24, 0
  s_add_u32 s36, s13, 4194304
  buffer_load_dwordx4 v3, s[92:95], s36 offen lds
  s_add_u32 m0, s24, 1024
  s_add_u32 s36, s13, 4259840
  buffer_load_dwordx4 v3, s[92:95], s36 offen lds
  s_add_u32 m0, s24, 2048
  s_add_u32 s36, s13, 4325376
  buffer_load_dwordx4 v3, s[92:95], s36 offen lds
  s_add_u32 m0, s24, 3072
  s_add_u32 s36, s13, 4390912
  buffer_load_dwordx4 v3, s[92:95], s36 offen lds
  s_add_u32 m0, s24, 4096
  s_add_u32 s36, s13, 4456448
  buffer_load_dwordx4 v3, s[92:95], s36 offen lds
  s_add_u32 m0, s24, 5120
  s_add_u32 s36, s13, 4521984
  buffer_load_dwordx4 v3, s[92:95], s36 offen lds
  s_add_u32 m0, s24, 6144
  s_add_u32 s36, s13, 4587520
  buffer_load_dwordx4 v3, s[92:95], s36 offen lds
  s_add_u32 m0, s24, 7168
  s_add_u32 s36, s13, 4653056
  buffer_load_dwordx4 v3, s[92:95], s36 offen lds
  s_load_dwordx2 s[88:89], s[0:1], 40
  s_waitcnt lgkmcnt(0)
  s_mov_b32 s90, 5242880
  s_mov_b32 s91, 0x20000
  v_lshlrev_b32 v17, 7, v0
  s_lshl_b32 s36, s32, 13
  buffer_load_dword v24, v17, s[88:91], s36 offen
  s_load_dwordx2 s[88:89], s[0:1], 80
  s_waitcnt lgkmcnt(0)
  s_mov_b32 s90, 5242880
  s_mov_b32 s91, 0x20000
  s_barrier
  s_cmp_lg_u32 s10, 0
  s_cbranch_scc1 L_noinit_65
  v_mov_b32 v16, 1
  s_mov_b64 exec, 1
  buffer_atomic_add v16, v1, s[84:87], 40 offen
  s_mov_b64 exec, -1
L_noinit_65:
  v_mov_b32 v34, 0
  buffer_load_dwordx2 v[32:33], v34, s[84:87], 0 offen offset:192 sc1
  s_waitcnt vmcnt(24)
  ds_read_b64_tr_b16 a[16:17], v2 offset:8192
  ds_read_b64_tr_b16 a[18:19], v2 offset:8704
  ds_read_b64_tr_b16 a[176:177], v4 offset:8192
  ds_read_b64_tr_b16 a[178:179], v4 offset:8704
  ds_read_b64_tr_b16 a[20:21], v2 offset:10240
  ds_read_b64_tr_b16 a[22:23], v2 offset:10752
  ds_read_b64_tr_b16 a[180:181], v4 offset:10240
  ds_read_b64_tr_b16 a[182:183], v4 offset:10752
  s_waitcnt lgkmcnt(0)
  ds_read_b64_tr_b16 a[24:25], v2 offset:12288
  ds_read_b64_tr_b16 a[26:27], v2 offset:12800
  ds_read_b64_tr_b16 a[184:185], v4 offset:12288
  ds_read_b64_tr_b16 a[186:187], v4 offset:12800
  ds_read_b64_tr_b16 a[28:29], v2 offset:14336
  ds_read_b64_tr_b16 a[30:31], v2 offset:14848
  ds_read_b64_tr_b16 a[188:189], v4 offset:14336
  ds_read_b64_tr_b16 a[190:191], v4 offset:14848
  s_waitcnt lgkmcnt(0)
  s_add_u32 m0, s24, 8192
  s_add_u32 s36, s13, 4718592
  buffer_load_dwordx4 v3, s[92:95], s36 offen lds
  s_add_u32 m0, s24, 9216
  s_add_u32 s36, s13, 4784128
  buffer_load_dwordx4 v3, s[92:95], s36 offen lds
  s_add_u32 m0, s24, 10240
  s_add_u32 s36, s13, 4849664
  buffer_load_dwordx4 v3, s[92:95], s36 offen lds
  s_add_u32 m0, s24, 11264
  s_add_u32 s36, s13, 4915200
  buffer_load_dwordx4 v3, s[92:95], s36 offen lds
  s_add_u32 m0, s24, 12288
  s_add_u32 s36, s13, 4980736
  buffer_load_dwordx4 v3, s[92:95], s36 offen lds
  s_add_u32 m0, s24, 13312
  s_add_u32 s36, s13, 5046272
  buffer_load_dwordx4 v3, s[92:95], s36 offen lds
  s_add_u32 m0, s24, 14336
  s_add_u32 s36, s13, 5111808
  buffer_load_dwordx4 v3, s[92:95], s36 offen lds
  s_add_u32 m0, s24, 15360
  s_add_u32 s36, s13, 5177344
  buffer_load_dwordx4 v3, s[92:95], s36 offen lds
  s_waitcnt vmcnt(24)
  ds_read_b64_tr_b16 a[32:33], v2 offset:16384
  ds_read_b64_tr_b16 a[34:35], v2 offset:16896
  ds_read_b64_tr_b16 a[192:193], v4 offset:16384
  ds_read_b64_tr_b16 a[194:195], v4 offset:16896
  ds_read_b64_tr_b16 a[36:37], v2 offset:18432
  ds_read_b64_tr_b16 a[38:39], v2 offset:18944
  ds_read_b64_tr_b16 a[196:197], v4 offset:18432
  ds_read_b64_tr_b16 a[198:199], v4 offset:18944
  s_waitcnt lgkmcnt(0)
  ds_read_b64_tr_b16 a[40:41], v2 offset:20480
  ds_read_b64_tr_b16 a[42:43], v2 offset:20992
  ds_read_b64_tr_b16 a[200:201], v4 offset:20480
  ds_read_b64_tr_b16 a[202:203], v4 offset:20992
  ds_read_b64_tr_b16 a[44:45], v2 offset:22528
  ds_read_b64_tr_b16 a[46:47], v2 offset:23040
  ds_read_b64_tr_b16 a[204:205], v4 offset:22528
  ds_read_b64_tr_b16 a[206:207], v4 offset:23040
  s_waitcnt lgkmcnt(0)
  s_waitcnt vmcnt(16)
  ds_read_b64_tr_b16 a[48:49], v2 offset:24576
  ds_read_b64_tr_b16 a[50:51], v2 offset:25088
  ds_read_b64_tr_b16 a[208:209], v4 offset:24576
  ds_read_b64_tr_b16 a[210:211], v4 offset:25088
  ds_read_b64_tr_b16 a[52:53], v2 offset:26624
  ds_read_b64_tr_b16 a[54:55], v2 offset:27136
  ds_read_b64_tr_b16 a[212:213], v4 offset:26624
  ds_read_b64_tr_b16 a[214:215], v4 offset:27136
  s_waitcnt lgkmcnt(0)
  ds_read_b64_tr_b16 a[56:57], v2 offset:28672
  ds_read_b64_tr_b16 a[58:59], v2 offset:29184
  ds_read_b64_tr_b16 a[216:217], v4 offset:28672
  ds_read_b64_tr_b16 a[218:219], v4 offset:29184
  ds_read_b64_tr_b16 a[60:61], v2 offset:30720
  ds_read_b64_tr_b16 a[62:63], v2 offset:31232
  ds_read_b64_tr_b16 a[220:221], v4 offset:30720
  ds_read_b64_tr_b16 a[222:223], v4 offset:31232
  s_waitcnt lgkmcnt(0)
  s_waitcnt vmcnt(8)
  ds_read_b64_tr_b16 a[64:65], v2 offset:0
  ds_read_b64_tr_b16 a[66:67], v2 offset:512
  ds_read_b64_tr_b16 a[224:225], v4 offset:0
  ds_read_b64_tr_b16 a[226:227], v4 offset:512
  ds_read_b64_tr_b16 a[68:69], v2 offset:2048
  ds_read_b64_tr_b16 a[70:71], v2 offset:2560
  ds_read_b64_tr_b16 a[228:229], v4 offset:2048
  ds_read_b64_tr_b16 a[230:231], v4 offset:2560
  s_waitcnt lgkmcnt(0)
  ds_read_b64_tr_b16 a[72:73], v2 offset:4096
  ds_read_b64_tr_b16 a[74:75], v2 offset:4608
  ds_read_b64_tr_b16 a[232:233], v4 offset:4096
  ds_read_b64_tr_b16 a[234:235], v4 offset:4608
  ds_read_b64_tr_b16 a[76:77], v2 offset:6144
  ds_read_b64_tr_b16 a[78:79], v2 offset:6656
  ds_read_b64_tr_b16 a[236:237], v4 offset:6144
  ds_read_b64_tr_b16 a[238:239], v4 offset:6656
  s_waitcnt lgkmcnt(0)
  s_waitcnt vmcnt(0)
  ds_read_b64_tr_b16 a[80:81], v2 offset:8192
  ds_read_b64_tr_b16 a[82:83], v2 offset:8704
  ds_read_b64_tr_b16 a[240:241], v4 offset:8192
  ds_read_b64_tr_b16 a[242:243], v4 offset:8704
  ds_read_b64_tr_b16 a[84:85], v2 offset:10240
  ds_read_b64_tr_b16 a[86:87], v2 offset:10752
  ds_read_b64_tr_b16 a[244:245], v4 offset:10240
  ds_read_b64_tr_b16 a[246:247], v4 offset:10752
  s_waitcnt lgkmcnt(0)
  ds_read_b64_tr_b16 a[88:89], v2 offset:12288
  ds_read_b64_tr_b16 a[90:91], v2 offset:12800
  ds_read_b64_tr_b16 a[248:249], v4 offset:12288
  ds_read_b64_tr_b16 a[250:251], v4 offset:12800
  ds_read_b64_tr_b16 a[92:93], v2 offset:14336
  ds_read_b64_tr_b16 a[94:95], v2 offset:14848
  ds_read_b64_tr_b16 a[252:253], v4 offset:14336
  ds_read_b64_tr_b16 a[254:255], v4 offset:14848
  s_waitcnt lgkmcnt(0)
  s_barrier
  s_branch L_mka_67
L_mk_66:
  s_sub_u32 s12, s12, 1
  s_cbranch_scc1 L_abort
  s_sleep 8
  v_mov_b32 v34, 0
  buffer_load_dwordx2 v[32:33], v34, s[84:87], 0 offen offset:192 sc1
L_mka_67:
  s_waitcnt vmcnt(0)
  v_readfirstlane_b32 s76, v32
  v_readfirstlane_b32 s77, v33
  s_cmp_lt_u32 s77, 134217728
  s_cbranch_scc1 L_mk_66
  s_bitcmp1_b32 s77, 8
  s_cselect_b32 s36, 8192, 0
  s_add_u32 s19, s19, s36
  s_mov_b32 s23, s18
  s_lshl_b32 s32, s10, 10
  s_mov_b32 s22, s32
  s_mov_b32 s21, 0
  s_mov_b32 s20, 0
  s_mov_b32 s66, 0x80000000
  v_mov_b32 v16, 0
  s_cmp_gt_i32 s23, 0
  s_cselect_b32 s37, s14, 0x80000000
  s_sub_u32 s23, s23, 1
  s_add_u32 s14, s14, s15
  s_add_u32 m0, s22, 0
  s_add_u32 s36, s37, 0
  buffer_load_dwordx4 v5, s[96:99], s36 offen lds
  s_add_u32 m0, s22, 4096
  s_add_u32 s36, s37, 128
  buffer_load_dwordx4 v5, s[96:99], s36 offen lds
  s_add_u32 m0, s22, 8192
  s_add_u32 s36, s37, 256
  buffer_load_dwordx4 v5, s[96:99], s36 offen lds
  s_add_u32 m0, s22, 12288
  s_add_u32 s36, s37, 384
  buffer_load_dwordx4 v5, s[96:99], s36 offen lds
  s_add_u32 m0, s22, 16384
  s_add_u32 s36, s37, 512
  buffer_load_dwordx4 v5, s[96:99], s36 offen lds
  s_add_u32 m0, s22, 20480
  s_add_u32 s36, s37, 640
  buffer_load_dwordx4 v5, s[96:99], s36 offen lds
  s_add_u32 m0, s22, 24576
  s_add_u32 s36, s37, 768
  buffer_load_dwordx4 v5, s[96:99], s36 offen lds
  s_add_u32 m0, s22, 28672
  s_add_u32 s36, s37, 896
  buffer_load_dwordx4 v5, s[96:99], s36 offen lds
  s_add_u32 m0, s22, 32768
  s_add_u32 s36, s37, 1024
  buffer_load_dwordx4 v5, s[96:99], s36 offen lds
  s_add_u32 m0, s22, 36864
  s_add_u32 s36, s37, 1152
  buffer_load_dwordx4 v5, s[96:99], s36 offen lds
  s_add_u32 s22, s22, 40960
  s_cmp_ge_u32 s22, 122880
  s_cselect_b32 s22, s32, s22
  s_cmp_gt_i32 s23, 0
  s_cselect_b32 s37, s14, 0x80000000
  s_sub_u32 s23, s23, 1
  s_add_u32 s14, s14, s15
  s_add_u32 m0, s22, 0
  s_add_u32 s36, s37, 0
  buffer_load_dwordx4 v5, s[96:99], s36 offen lds
  s_add_u32 m0, s22, 4096
  s_add_u32 s36, s37, 128
  buffer_load_dwordx4 v5, s[96:99], s36 offen lds
  s_add_u32 m0, s22, 8192
  s_add_u32 s36, s37, 256
  buffer_load_dwordx4 v5, s[96:99], s36 offen lds
  s_add_u32 m0, s22, 12288
  s_add_u32 s36, s37, 384
  buffer_load_dwordx4 v5, s[96:99], s36 offen lds
  s_add_u32 m0, s22, 16384
  s_add_u32 s36, s37, 512
  buffer_load_dwordx4 v5, s[96:99], s36 offen lds
  s_add_u32 m0, s22, 20480
  s_add_u32 s36, s37, 640
  buffer_load_dwordx4 v5, s[96:99], s36 offen lds
  s_add_u32 m0, s22, 24576
  s_add_u32 s36, s37, 768
  buffer_load_dwordx4 v5, s[96:99], s36 offen lds
  s_add_u32 m0, s22, 28672
  s_add_u32 s36, s37, 896
  buffer_load_dwordx4 v5, s[96:99], s36 offen lds
  s_add_u32 m0, s22, 32768
  s_add_u32 s36, s37, 1024
  buffer_load_dwordx4 v5, s[96:99], s36 offen lds
  s_add_u32 m0, s22, 36864
  s_add_u32 s36, s37, 1152
  buffer_load_dwordx4 v5, s[96:99], s36 offen lds
  s_add_u32 s22, s22, 40960
  s_cmp_ge_u32 s22, 122880
  s_cselect_b32 s22, s32, s22
  v_add_u32 v10, s21, v6
  v_add_u32 v11, s21, v7
  v_add_u32 v12, s21, v8
  v_add_u32 v13, s21, v9
  s_waitcnt vmcnt(10)
  s_barrier
  ds_read_b128 v[160:163], v10 offset:0
  ds_read_b128 v[164:167], v11 offset:0
  ds_read_b128 v[168:171], v12 offset:0
  s_cmp_eq_u32 s28, 1
  s_cbranch_scc1 L_aq_v_68
L_gemm_70:
  s_cmp_gt_i32 s23, 0
  s_cselect_b32 s37, s14, 0x80000000
  s_sub_u32 s23, s23, 1
  s_add_u32 s14, s14, s15
  s_waitcnt lgkmcnt(2)
  v_mfma_f32_32x32x16_bf16 v[128:143], v[192:195], v[160:163], 0
  ds_read_b128 v[172:175], v13 offset:0
  v_mfma_f32_32x32x16_bf16 v[144:159], a[96:99], v[160:163], 0
  s_mov_b64 exec, 1
  buffer_store_dword v16, v1, s[4:7], s19 offen sc1
  s_mov_b64 exec, -1
  s_waitcnt lgkmcnt(2)
  v_mfma_f32_32x32x16_bf16 v[128:143], v[196:199], v[164:167], v[128:143]
  ds_read_b128 v[160:163], v10 offset:4096
  v_mfma_f32_32x32x16_bf16 v[144:159], a[100:103], v[164:167], v[144:159]
  s_waitcnt lgkmcnt(2)
  v_mfma_f32_32x32x16_bf16 v[128:143], v[200:203], v[168:171], v[128:143]
  ds_read_b128 v[164:167], v11 offset:4096
  v_mfma_f32_32x32x16_bf16 v[144:159], a[104:107], v[168:171], v[144:159]
  buffer_store_dwordx4 v[176:179], v1, s[4:7], s66 offen offset:0 sc1
  s_waitcnt lgkmcnt(2)
  v_mfma_f32_32x32x16_bf16 v[128:143], v[204:207], v[172:175], v[128:143]
  ds_read_b128 v[168:171], v12 offset:4096
  v_mfma_f32_32x32x16_bf16 v[144:159], a[108:111], v[172:175], v[144:159]
  s_waitcnt lgkmcnt(2)
  v_mfma_f32_32x32x16_bf16 v[128:143], v[208:211], v[160:163], v[128:143]
  ds_read_b128 v[172:175], v13 offset:4096
  v_mfma_f32_32x32x16_bf16 v[144:159], a[112:115], v[160:163], v[144:159]
  buffer_store_dwordx4 v[180:183], v1, s[4:7], s66 offen offset:1024 sc1
  s_waitcnt lgkmcnt(2)
  v_mfma_f32_32x32x16_bf16 v[128:143], v[212:215], v[164:167], v[128:143]
  ds_read_b128 v[160:163], v10 offset:8192
  v_mfma_f32_32x32x16_bf16 v[144:159], a[116:119], v[164:167], v[144:159]
  s_waitcnt lgkmcnt(2)
  v_mfma_f32_32x32x16_bf16 v[128:143], v[216:219], v[168:171], v[128:143]
  ds_read_b128 v[164:167], v11 offset:8192
  v_mfma_f32_32x32x16_bf16 v[144:159], a[120:123], v[168:171], v[144:159]
  buffer_store_dwordx4 v[184:187], v1, s[4:7], s66 offen offset:2048 sc1
  s_waitcnt lgkmcnt(2)
  v_mfma_f32_32x32x16_bf16 v[128:143], v[220:223], v[172:175], v[128:143]
  ds_read_b128 v[168:171], v12 offset:8192
  v_mfma_f32_32x32x16_bf16 v[144:159], a[124:127], v[172:175], v[144:159]
  s_waitcnt lgkmcnt(2)
  v_mfma_f32_32x32x16_bf16 v[128:143], v[224:227], v[160:163], v[128:143]
  ds_read_b128 v[172:175], v13 offset:8192
  v_mfma_f32_32x32x16_bf16 v[144:159], a[128:131], v[160:163], v[144:159]
  buffer_store_dwordx4 v[188:191], v1, s[4:7], s66 offen offset:3072 sc1
  s_waitcnt lgkmcnt(2)
  v_mfma_f32_32x32x16_bf16 v[128:143], v[228:231], v[164:167], v[128:143]
  ds_read_b128 v[160:163], v10 offset:12288
  v_mfma_f32_32x32x16_bf16 v[144:159], a[132:135], v[164:167], v[144:159]
  s_waitcnt lgkmcnt(2)
  v_mfma_f32_32x32x16_bf16 v[128:143], v[232:235], v[168:171], v[128:143]
  ds_read_b128 v[164:167], v11 offset:12288
  v_mfma_f32_32x32x16_bf16 v[144:159], a[136:139], v[168:171], v[144:159]
  s_add_u32 m0, s22, 0
  s_add_u32 s36, s37, 0
  buffer_load_dwordx4 v5, s[96:99], s36 offen lds
  s_waitcnt lgkmcnt(2)
  v_mfma_f32_32x32x16_bf16 v[128:143], v[236:239], v[172:175], v[128:143]
  ds_read_b128 v[168:171], v12 offset:12288
  v_mfma_f32_32x32x16_bf16 v[144:159], a[140:143], v[172:175], v[144:159]
  s_waitcnt lgkmcnt(2)
  v_mfma_f32_32x32x16_bf16 v[128:143], v[240:243], v[160:163], v[128:143]
  ds_read_b128 v[172:175], v13 offset:12288
  v_mfma_f32_32x32x16_bf16 v[144:159], a[144:147], v[160:163], v[144:159]
  s_add_u32 m0, s22, 4096
  s_add_u32 s36, s37, 128
  buffer_load_dwordx4 v5, s[96:99], s36 offen lds
  s_waitcnt lgkmcnt(2)
  v_mfma_f32_32x32x16_bf16 v[128:143], v[244:247], v[164:167], v[128:143]
  ds_read_b128 v[160:163], v10 offset:16384
  v_mfma_f32_32x32x16_bf16 v[144:159], a[148:151], v[164:167], v[144:159]
  s_waitcnt lgkmcnt(2)
  v_mfma_f32_32x32x16_bf16 v[128:143], v[248:251], v[168:171], v[128:143]
  ds_read_b128 v[164:167], v11 offset:16384
  v_mfma_f32_32x32x16_bf16 v[144:159], a[152:155], v[168:171], v[144:159]
  s_add_u32 m0, s22, 8192
  s_add_u32 s36, s37, 256
  buffer_load_dwordx4 v5, s[96:99], s36 offen lds
  s_waitcnt lgkmcnt(2)
  v_mfma_f32_32x32x16_bf16 v[128:143], v[252:255], v[172:175], v[128:143]
  ds_read_b128 v[168:171], v12 offset:16384
  v_mfma_f32_32x32x16_bf16 v[144:159], a[156:159], v[172:175], v[144:159]
  s_waitcnt lgkmcnt(2)
  v_mfma_f32_32x32x16_bf16 v[128:143], a[0:3], v[160:163], v[128:143]
  ds_read_b128 v[172:175], v13 offset:16384
  v_mfma_f32_32x32x16_bf16 v[144:159], a[160:163], v[160:163], v[144:159]
  s_add_u32 m0, s22, 12288
  s_add_u32 s36, s37, 384
  buffer_load_dwordx4 v5, s[96:99], s36 offen lds
  s_waitcnt lgkmcnt(2)
  v_mfma_f32_32x32x16_bf16 v[128:143], a[4:7], v[164:167], v[128:143]
  ds_read_b128 v[160:163], v10 offset:20480
  v_mfma_f32_32x32x16_bf16 v[144:159], a[164:167], v[164:167], v[144:159]
  s_waitcnt lgkmcnt(2)
  v_mfma_f32_32x32x16_bf16 v[128:143], a[8:11], v[168:171], v[128:143]
  ds_read_b128 v[164:167], v11 offset:20480
  v_mfma_f32_32x32x16_bf16 v[144:159], a[168:171], v[168:171], v[144:159]
  s_add_u32 m0, s22, 16384
  s_add_u32 s36, s37, 512
  buffer_load_dwordx4 v5, s[96:99], s36 offen lds
  s_waitcnt lgkmcnt(2)
  v_mfma_f32_32x32x16_bf16 v[128:143], a[12:15], v[172:175], v[128:143]
  ds_read_b128 v[168:171], v12 offset:20480
  v_mfma_f32_32x32x16_bf16 v[144:159], a[172:175], v[172:175], v[144:159]
  s_waitcnt lgkmcnt(2)
  v_mfma_f32_32x32x16_bf16 v[128:143], a[16:19], v[160:163], v[128:143]
  ds_read_b128 v[172:175], v13 offset:20480
  v_mfma_f32_32x32x16_bf16 v[144:159], a[176:179], v[160:163], v[144:159]
  s_add_u32 m0, s22, 20480
  s_add_u32 s36, s37, 640
  buffer_load_dwordx4 v5, s[96:99], s36 offen lds
  s_waitcnt lgkmcnt(2)
  v_mfma_f32_32x32x16_bf16 v[128:143], a[20:23], v[164:167], v[128:143]
  ds_read_b128 v[160:163], v10 offset:24576
  v_mfma_f32_32x32x16_bf16 v[144:159], a[180:183], v[164:167], v[144:159]
  s_waitcnt lgkmcnt(2)
  v_mfma_f32_32x32x16_bf16 v[128:143], a[24:27], v[168:171], v[128:143]
  ds_read_b128 v[164:167], v11 offset:24576
  v_mfma_f32_32x32x16_bf16 v[144:159], a[184:187], v[168:171], v[144:159]
  s_add_u32 m0, s22, 24576
  s_add_u32 s36, s37, 768
  buffer_load_dwordx4 v5, s[96:99], s36 offen lds
  s_waitcnt lgkmcnt(2)
  v_mfma_f32_32x32x16_bf16 v[128:143], a[28:31], v[172:175], v[128:143]
  ds_read_b128 v[168:171], v12 offset:24576
  v_mfma_f32_32x32x16_bf16 v[144:159], a[188:191], v[172:175], v[144:159]
  s_waitcnt lgkmcnt(2)
  v_mfma_f32_32x32x16_bf16 v[128:143], a[32:35], v[160:163], v[128:143]
  ds_read_b128 v[172:175], v13 offset:24576
  v_mfma_f32_32x32x16_bf16 v[144:159], a[192:195], v[160:163], v[144:159]
  s_add_u32 m0, s22, 28672
  s_add_u32 s36, s37, 896
  buffer_load_dwordx4 v5, s[96:99], s36 offen lds
  s_waitcnt lgkmcnt(2)
  v_mfma_f32_32x32x16_bf16 v[128:143], a[36:39], v[164:167], v[128:143]
  ds_read_b128 v[160:163], v10 offset:28672
  v_mfma_f32_32x32x16_bf16 v[144:159], a[196:199], v[164:167], v[144:159]
  s_waitcnt lgkmcnt(2)
  v_mfma_f32_32x32x16_bf16 v[128:143], a[40:43], v[168:171], v[128:143]
  ds_read_b128 v[164:167], v11 offset:28672
  v_mfma_f32_32x32x16_bf16 v[144:159], a[200:203], v[168:171], v[144:159]
  s_add_u32 m0, s22, 32768
  s_add_u32 s36, s37, 1024
  buffer_load_dwordx4 v5, s[96:99], s36 offen lds
  s_waitcnt lgkmcnt(2)
  v_mfma_f32_32x32x16_bf16 v[128:143], a[44:47], v[172:175], v[128:143]
  ds_read_b128 v[168:171], v12 offset:28672
  v_mfma_f32_32x32x16_bf16 v[144:159], a[204:207], v[172:175], v[144:159]
  s_waitcnt lgkmcnt(2)
  v_mfma_f32_32x32x16_bf16 v[128:143], a[48:51], v[160:163], v[128:143]
  ds_read_b128 v[172:175], v13 offset:28672
  v_mfma_f32_32x32x16_bf16 v[144:159], a[208:211], v[160:163], v[144:159]
  s_add_u32 m0, s22, 36864
  s_add_u32 s36, s37, 1152
  buffer_load_dwordx4 v5, s[96:99], s36 offen lds
  s_waitcnt lgkmcnt(2)
  v_mfma_f32_32x32x16_bf16 v[128:143], a[52:55], v[164:167], v[128:143]
  ds_read_b128 v[160:163], v10 offset:32768
  v_mfma_f32_32x32x16_bf16 v[144:159], a[212:215], v[164:167], v[144:159]
  s_waitcnt lgkmcnt(2)
  v_mfma_f32_32x32x16_bf16 v[128:143], a[56:59], v[168:171], v[128:143]
  ds_read_b128 v[164:167], v11 offset:32768
  v_mfma_f32_32x32x16_bf16 v[144:159], a[216:219], v[168:171], v[144:159]
  s_waitcnt lgkmcnt(2)
  v_mfma_f32_32x32x16_bf16 v[128:143], a[60:63], v[172:175], v[128:143]
  ds_read_b128 v[168:171], v12 offset:32768
  v_mfma_f32_32x32x16_bf16 v[144:159], a[220:223], v[172:175], v[144:159]
  s_waitcnt lgkmcnt(2)
  v_mfma_f32_32x32x16_bf16 v[128:143], a[64:67], v[160:163], v[128:143]
  ds_read_b128 v[172:175], v13 offset:32768
  v_mfma_f32_32x32x16_bf16 v[144:159], a[224:227], v[160:163], v[144:159]
  s_waitcnt lgkmcnt(2)
  v_mfma_f32_32x32x16_bf16 v[128:143], a[68:71], v[164:167], v[128:143]
  ds_read_b128 v[160:163], v10 offset:36864
  v_mfma_f32_32x32x16_bf16 v[144:159], a[228:231], v[164:167], v[144:159]
  s_waitcnt lgkmcnt(2)
  v_mfma_f32_32x32x16_bf16 v[128:143], a[72:75], v[168:171], v[128:143]
  ds_read_b128 v[164:167], v11 offset:36864
  v_mfma_f32_32x32x16_bf16 v[144:159], a[232:235], v[168:171], v[144:159]
  s_waitcnt lgkmcnt(2)
  v_mfma_f32_32x32x16_bf16 v[128:143], a[76:79], v[172:175], v[128:143]
  ds_read_b128 v[168:171], v12 offset:36864
  v_mfma_f32_32x32x16_bf16 v[144:159], a[236:239], v[172:175], v[144:159]
  s_waitcnt lgkmcnt(2)
  v_mfma_f32_32x32x16_bf16 v[128:143], a[80:83], v[160:163], v[128:143]
  ds_read_b128 v[172:175], v13 offset:36864
  v_mfma_f32_32x32x16_bf16 v[144:159], a[240:243], v[160:163], v[144:159]
  s_waitcnt lgkmcnt(2)
  v_mfma_f32_32x32x16_bf16 v[128:143], a[84:87], v[164:167], v[128:143]
  v_mfma_f32_32x32x16_bf16 v[144:159], a[244:247], v[164:167], v[144:159]
  s_waitcnt lgkmcnt(1)
  v_mfma_f32_32x32x16_bf16 v[128:143], a[88:91], v[168:171], v[128:143]
  s_add_u32 s22, s22, 40960
  s_cmp_ge_u32 s22, 122880
  s_cselect_b32 s22, s32, s22
  v_mov_b32 v16, s20
  v_mfma_f32_32x32x16_bf16 v[144:159], a[248:251], v[168:171], v[144:159]
  s_add_u32 s21, s21, 40960
  s_cmp_ge_u32 s21, 122880
  s_cselect_b32 s21, 0, s21
  s_add_u32 s20, s20, 1
  s_waitcnt lgkmcnt(0)
  v_mfma_f32_32x32x16_bf16 v[128:143], a[92:95], v[172:175], v[128:143]
  v_mfma_f32_32x32x16_bf16 v[144:159], a[252:255], v[172:175], v[144:159]
  v_add_u32 v10, s21, v6
  v_add_u32 v11, s21, v7
  v_add_u32 v12, s21, v8
  v_add_u32 v13, s21, v9
  s_waitcnt vmcnt(10)
  s_barrier
  ds_read_b128 v[160:163], v10 offset:0
  ds_read_b128 v[164:167], v11 offset:0
  ds_read_b128 v[168:171], v12 offset:0
  s_lshr_b32 s38, s75, 1
  s_bitcmp1_b32 s76, s38
  s_cselect_b32 s38, 8192, 0
  s_xor_b32 s38, s38, s31
  s_add_u32 s66, s16, s38
  s_add_u32 s75, s75, s53
  s_add_u32 s16, s16, s17
  s_cmp_lt_u32 s20, s18
  v_pk_mul_f32 v[128:129], v[128:129], s[26:27]
  v_pk_mul_f32 v[130:131], v[130:131], s[26:27]
  v_pk_mul_f32 v[132:133], v[132:133], s[26:27]
  v_pk_mul_f32 v[134:135], v[134:135], s[26:27]
  v_pk_mul_f32 v[136:137], v[136:137], s[26:27]
  v_pk_mul_f32 v[138:139], v[138:139], s[26:27]
  v_pk_mul_f32 v[140:141], v[140:141], s[26:27]
  v_pk_mul_f32 v[142:143], v[142:143], s[26:27]
  v_cvt_pk_bf16_f32 v176, v128, v136
  v_cvt_pk_bf16_f32 v177, v129, v137
  v_cvt_pk_bf16_f32 v178, v130, v138
  v_cvt_pk_bf16_f32 v179, v131, v139
  v_cvt_pk_bf16_f32 v180, v132, v140
  v_cvt_pk_bf16_f32 v181, v133, v141
  v_cvt_pk_bf16_f32 v182, v134, v142
  v_cvt_pk_bf16_f32 v183, v135, v143
  v_pk_mul_f32 v[144:145], v[144:145], s[26:27]
  v_pk_mul_f32 v[146:147], v[146:147], s[26:27]
  v_pk_mul_f32 v[148:149], v[148:149], s[26:27]
  v_pk_mul_f32 v[150:151], v[150:151], s[26:27]
  v_pk_mul_f32 v[152:153], v[152:153], s[26:27]
  v_pk_mul_f32 v[154:155], v[154:155], s[26:27]
  v_pk_mul_f32 v[156:157], v[156:157], s[26:27]
  v_pk_mul_f32 v[158:159], v[158:159], s[26:27]
  v_cvt_pk_bf16_f32 v184, v144, v152
  v_cvt_pk_bf16_f32 v185, v145, v153
  v_cvt_pk_bf16_f32 v186, v146, v154
  v_cvt_pk_bf16_f32 v187, v147, v155
  v_cvt_pk_bf16_f32 v188, v148, v156
  v_cvt_pk_bf16_f32 v189, v149, v157
  v_cvt_pk_bf16_f32 v190, v150, v158
  v_cvt_pk_bf16_f32 v191, v151, v159
  s_cmp_lg_u32 s20, 1
  s_cbranch_scc1 L_rest_71
  buffer_store_dwordx4 v[176:179], v1, s[4:7], s66 offen offset:0 sc1
  buffer_store_dwordx4 v[180:183], v1, s[4:7], s66 offen offset:1024 sc1
  buffer_store_dwordx4 v[184:187], v1, s[4:7], s66 offen offset:2048 sc1
  buffer_store_dwordx4 v[188:191], v1, s[4:7], s66 offen offset:3072 sc1
  s_mov_b32 s66, 0x80000000
  v_mov_b32 v16, 1
  s_waitcnt vmcnt(0)
  s_barrier
L_rest_71:
  s_cmp_lt_u32 s20, s18
  s_cbranch_scc1 L_gemm_70
  buffer_store_dwordx4 v[176:179], v1, s[4:7], s66 offen offset:0 sc1
  buffer_store_dwordx4 v[180:183], v1, s[4:7], s66 offen offset:1024 sc1
  buffer_store_dwordx4 v[184:187], v1, s[4:7], s66 offen offset:2048 sc1
  buffer_store_dwordx4 v[188:191], v1, s[4:7], s66 offen offset:3072 sc1
  s_waitcnt lgkmcnt(0)
  s_branch L_aq_e_69
L_aq_v_68:
L_gemm_72:
  s_cmp_gt_i32 s23, 0
  s_cselect_b32 s37, s14, 0x80000000
  s_sub_u32 s23, s23, 1
  s_add_u32 s14, s14, s15
  s_waitcnt lgkmcnt(2)
  v_mfma_f32_32x32x16_bf16 v[128:143], v[160:163], v[192:195], 0
  ds_read_b128 v[172:175], v13 offset:0
  v_mfma_f32_32x32x16_bf16 v[144:159], v[160:163], a[96:99], 0
  s_mov_b64 exec, 1
  buffer_store_dword v16, v1, s[4:7], s19 offen sc1
  s_mov_b64 exec, -1
  s_waitcnt lgkmcnt(2)
  v_mfma_f32_32x32x16_bf16 v[128:143], v[164:167], v[196:199], v[128:143]
  ds_read_b128 v[160:163], v10 offset:4096
  v_mfma_f32_32x32x16_bf16 v[144:159], v[164:167], a[100:103], v[144:159]
  s_waitcnt lgkmcnt(2)
  v_mfma_f32_32x32x16_bf16 v[128:143], v[168:171], v[200:203], v[128:143]
  ds_read_b128 v[164:167], v11 offset:4096
  v_mfma_f32_32x32x16_bf16 v[144:159], v[168:171], a[104:107], v[144:159]
  buffer_store_dwordx4 v[176:179], v1, s[4:7], s66 offen offset:0 sc1
  s_waitcnt lgkmcnt(2)
  v_mfma_f32_32x32x16_bf16 v[128:143], v[172:175], v[204:207], v[128:143]
  ds_read_b128 v[168:171], v12 offset:4096
  v_mfma_f32_32x32x16_bf16 v[144:159], v[172:175], a[108:111], v[144:159]
  s_waitcnt lgkmcnt(2)
  v_mfma_f32_32x32x16_bf16 v[128:143], v[160:163], v[208:211], v[128:143]
  ds_read_b128 v[172:175], v13 offset:4096
  v_mfma_f32_32x32x16_bf16 v[144:159], v[160:163], a[112:115], v[144:159]
  buffer_store_dwordx4 v[180:183], v1, s[4:7], s66 offen offset:1024 sc1
  s_waitcnt lgkmcnt(2)
  v_mfma_f32_32x32x16_bf16 v[128:143], v[164:167], v[212:215], v[128:143]
  ds_read_b128 v[160:163], v10 offset:8192
  v_mfma_f32_32x32x16_bf16 v[144:159], v[164:167], a[116:119], v[144:159]
  s_waitcnt lgkmcnt(2)
  v_mfma_f32_32x32x16_bf16 v[128:143], v[168:171], v[216:219], v[128:143]
  ds_read_b128 v[164:167], v11 offset:8192
  v_mfma_f32_32x32x16_bf16 v[144:159], v[168:171], a[120:123], v[144:159]
  buffer_store_dwordx4 v[184:187], v1, s[4:7], s66 offen offset:2048 sc1
  s_waitcnt lgkmcnt(2)
  v_mfma_f32_32x32x16_bf16 v[128:143], v[172:175], v[220:223], v[128:143]
  ds_read_b128 v[168:171], v12 offset:8192
  v_mfma_f32_32x32x16_bf16 v[144:159], v[172:175], a[124:127], v[144:159]
  s_waitcnt lgkmcnt(2)
  v_mfma_f32_32x32x16_bf16 v[128:143], v[160:163], v[224:227], v[128:143]
  ds_read_b128 v[172:175], v13 offset:8192
  v_mfma_f32_32x32x16_bf16 v[144:159], v[160:163], a[128:131], v[144:159]
  buffer_store_dwordx4 v[188:191], v1, s[4:7], s66 offen offset:3072 sc1
  s_waitcnt lgkmcnt(2)
  v_mfma_f32_32x32x16_bf16 v[128:143], v[164:167], v[228:231], v[128:143]
  ds_read_b128 v[160:163], v10 offset:12288
  v_mfma_f32_32x32x16_bf16 v[144:159], v[164:167], a[132:135], v[144:159]
  s_waitcnt lgkmcnt(2)
  v_mfma_f32_32x32x16_bf16 v[128:143], v[168:171], v[232:235], v[128:143]
  ds_read_b128 v[164:167], v11 offset:12288
  v_mfma_f32_32x32x16_bf16 v[144:159], v[168:171], a[136:139], v[144:159]
  s_add_u32 m0, s22, 0
  s_add_u32 s36, s37, 0
  buffer_load_dwordx4 v5, s[96:99], s36 offen lds
  s_waitcnt lgkmcnt(2)
  v_mfma_f32_32x32x16_bf16 v[128:143], v[172:175], v[236:239], v[128:143]
  ds_read_b128 v[168:171], v12 offset:12288
  v_mfma_f32_32x32x16_bf16 v[144:159], v[172:175], a[140:143], v[144:159]
  s_waitcnt lgkmcnt(2)
  v_mfma_f32_32x32x16_bf16 v[128:143], v[160:163], v[240:243], v[128:143]
  ds_read_b128 v[172:175], v13 offset:12288
  v_mfma_f32_32x32x16_bf16 v[144:159], v[160:163], a[144:147], v[144:159]
  s_add_u32 m0, s22, 4096
  s_add_u32 s36, s37, 128
  buffer_load_dwordx4 v5, s[96:99], s36 offen lds
  s_waitcnt lgkmcnt(2)
  v_mfma_f32_32x32x16_bf16 v[128:143], v[164:167], v[244:247], v[128:143]
  ds_read_b128 v[160:163], v10 offset:16384
  v_mfma_f32_32x32x16_bf16 v[144:159], v[164:167], a[148:151], v[144:159]
  s_waitcnt lgkmcnt(2)
  v_mfma_f32_32x32x16_bf16 v[128:143], v[168:171], v[248:251], v[128:143]
  ds_read_b128 v[164:167], v11 offset:16384
  v_mfma_f32_32x32x16_bf16 v[144:159], v[168:171], a[152:155], v[144:159]
  s_add_u32 m0, s22, 8192
  s_add_u32 s36, s37, 256
  buffer_load_dwordx4 v5, s[96:99], s36 offen lds
  s_waitcnt lgkmcnt(2)
  v_mfma_f32_32x32x16_bf16 v[128:143], v[172:175], v[252:255], v[128:143]
  ds_read_b128 v[168:171], v12 offset:16384
  v_mfma_f32_32x32x16_bf16 v[144:159], v[172:175], a[156:159], v[144:159]
  s_waitcnt lgkmcnt(2)
  v_mfma_f32_32x32x16_bf16 v[128:143], v[160:163], a[0:3], v[128:143]
  ds_read_b128 v[172:175], v13 offset:16384
  v_mfma_f32_32x32x16_bf16 v[144:159], v[160:163], a[160:163], v[144:159]
  s_add_u32 m0, s22, 12288
  s_add_u32 s36, s37, 384
  buffer_load_dwordx4 v5, s[96:99], s36 offen lds
  s_waitcnt lgkmcnt(2)
  v_mfma_f32_32x32x16_bf16 v[128:143], v[164:167], a[4:7], v[128:143]
  ds_read_b128 v[160:163], v10 offset:20480
  v_mfma_f32_32x32x16_bf16 v[144:159], v[164:167], a[164:167], v[144:159]
  s_waitcnt lgkmcnt(2)
  v_mfma_f32_32x32x16_bf16 v[128:143], v[168:171], a[8:11], v[128:143]
  ds_read_b128 v[164:167], v11 offset:20480
  v_mfma_f32_32x32x16_bf16 v[144:159], v[168:171], a[168:171], v[144:159]
  s_add_u32 m0, s22, 16384
  s_add_u32 s36, s37, 512
  buffer_load_dwordx4 v5, s[96:99], s36 offen lds
  s_waitcnt lgkmcnt(2)
  v_mfma_f32_32x32x16_bf16 v[128:143], v[172:175], a[12:15], v[128:143]
  ds_read_b128 v[168:171], v12 offset:20480
  v_mfma_f32_32x32x16_bf16 v[144:159], v[172:175], a[172:175], v[144:159]
  s_waitcnt lgkmcnt(2)
  v_mfma_f32_32x32x16_bf16 v[128:143], v[160:163], a[16:19], v[128:143]
  ds_read_b128 v[172:175], v13 offset:20480
  v_mfma_f32_32x32x16_bf16 v[144:159], v[160:163], a[176:179], v[144:159]
  s_add_u32 m0, s22, 20480
  s_add_u32 s36, s37, 640
  buffer_load_dwordx4 v5, s[96:99], s36 offen lds
  s_waitcnt lgkmcnt(2)
  v_mfma_f32_32x32x16_bf16 v[128:143], v[164:167], a[20:23], v[128:143]
  ds_read_b128 v[160:163], v10 offset:24576
  v_mfma_f32_32x32x16_bf16 v[144:159], v[164:167], a[180:183], v[144:159]
  s_waitcnt lgkmcnt(2)
  v_mfma_f32_32x32x16_bf16 v[128:143], v[168:171], a[24:27], v[128:143]
  ds_read_b128 v[164:167], v11 offset:24576
  v_mfma_f32_32x32x16_bf16 v[144:159], v[168:171], a[184:187], v[144:159]
  s_add_u32 m0, s22, 24576
  s_add_u32 s36, s37, 768
  buffer_load_dwordx4 v5, s[96:99], s36 offen lds
  s_waitcnt lgkmcnt(2)
  v_mfma_f32_32x32x16_bf16 v[128:143], v[172:175], a[28:31], v[128:143]
  ds_read_b128 v[168:171], v12 offset:24576
  v_mfma_f32_32x32x16_bf16 v[144:159], v[172:175], a[188:191], v[144:159]
  s_waitcnt lgkmcnt(2)
  v_mfma_f32_32x32x16_bf16 v[128:143], v[160:163], a[32:35], v[128:143]
  ds_read_b128 v[172:175], v13 offset:24576
  v_mfma_f32_32x32x16_bf16 v[144:159], v[160:163], a[192:195], v[144:159]
  s_add_u32 m0, s22, 28672
  s_add_u32 s36, s37, 896
  buffer_load_dwordx4 v5, s[96:99], s36 offen lds
  s_waitcnt lgkmcnt(2)
  v_mfma_f32_32x32x16_bf16 v[128:143], v[164:167], a[36:39], v[128:143]
  ds_read_b128 v[160:163], v10 offset:28672
  v_mfma_f32_32x32x16_bf16 v[144:159], v[164:167], a[196:199], v[144:159]
  s_waitcnt lgkmcnt(2)
  v_mfma_f32_32x32x16_bf16 v[128:143], v[168:171], a[40:43], v[128:143]
  ds_read_b128 v[164:167], v11 offset:28672
  v_mfma_f32_32x32x16_bf16 v[144:159], v[168:171], a[200:203], v[144:159]
  s_add_u32 m0, s22, 32768
  s_add_u32 s36, s37, 1024
  buffer_load_dwordx4 v5, s[96:99], s36 offen lds
  s_waitcnt lgkmcnt(2)
  v_mfma_f32_32x32x16_bf16 v[128:143], v[172:175], a[44:47], v[128:143]
  ds_read_b128 v[168:171], v12 offset:28672
  v_mfma_f32_32x32x16_bf16 v[144:159], v[172:175], a[204:207], v[144:159]
  s_waitcnt lgkmcnt(2)
  v_mfma_f32_32x32x16_bf16 v[128:143], v[160:163], a[48:51], v[128:143]
  ds_read_b128 v[172:175], v13 offset:28672
  v_mfma_f32_32x32x16_bf16 v[144:159], v[160:163], a[208:211], v[144:159]
  s_add_u32 m0, s22, 36864
  s_add_u32 s36, s37, 1152
  buffer_load_dwordx4 v5, s[96:99], s36 offen lds
  s_waitcnt lgkmcnt(2)
  v_mfma_f32_32x32x16_bf16 v[128:143], v[164:167], a[52:55], v[128:143]
  ds_read_b128 v[160:163], v10 offset:32768
  v_mfma_f32_32x32x16_bf16 v[144:159], v[164:167], a[212:215], v[144:159]
  s_waitcnt lgkmcnt(2)
  v_mfma_f32_32x32x16_bf16 v[128:143], v[168:171], a[56:59], v[128:143]
  ds_read_b128 v[164:167], v11 offset:32768
  v_mfma_f32_32x32x16_bf16 v[144:159], v[168:171], a[216:219], v[144:159]
  s_waitcnt lgkmcnt(2)
  v_mfma_f32_32x32x16_bf16 v[128:143], v[172:175], a[60:63], v[128:143]
  ds_read_b128 v[168:171], v12 offset:32768
  v_mfma_f32_32x32x16_bf16 v[144:159], v[172:175], a[220:223], v[144:159]
  s_waitcnt lgkmcnt(2)
  v_mfma_f32_32x32x16_bf16 v[128:143], v[160:163], a[64:67], v[128:143]
  ds_read_b128 v[172:175], v13 offset:32768
  v_mfma_f32_32x32x16_bf16 v[144:159], v[160:163], a[224:227], v[144:159]
  s_waitcnt lgkmcnt(2)
  v_mfma_f32_32x32x16_bf16 v[128:143], v[164:167], a[68:71], v[128:143]
  ds_read_b128 v[160:163], v10 offset:36864
  v_mfma_f32_32x32x16_bf16 v[144:159], v[164:167], a[228:231], v[144:159]
  s_waitcnt lgkmcnt(2)
  v_mfma_f32_32x32x16_bf16 v[128:143], v[168:171], a[72:75], v[128:143]
  ds_read_b128 v[164:167], v11 offset:36864
  v_mfma_f32_32x32x16_bf16 v[144:159], v[168:171], a[232:235], v[144:159]
  s_waitcnt lgkmcnt(2)
  v_mfma_f32_32x32x16_bf16 v[128:143], v[172:175], a[76:79], v[128:143]
  ds_read_b128 v[168:171], v12 offset:36864
  v_mfma_f32_32x32x16_bf16 v[144:159], v[172:175], a[236:239], v[144:159]
  s_waitcnt lgkmcnt(2)
  v_mfma_f32_32x32x16_bf16 v[128:143], v[160:163], a[80:83], v[128:143]
  ds_read_b128 v[172:175], v13 offset:36864
  v_mfma_f32_32x32x16_bf16 v[144:159], v[160:163], a[240:243], v[144:159]
  s_waitcnt lgkmcnt(2)
  v_mfma_f32_32x32x16_bf16 v[128:143], v[164:167], a[84:87], v[128:143]
  v_mfma_f32_32x32x16_bf16 v[144:159], v[164:167], a[244:247], v[144:159]
  s_waitcnt lgkmcnt(1)
  v_mfma_f32_32x32x16_bf16 v[128:143], v[168:171], a[88:91], v[128:143]
  s_add_u32 s22, s22, 40960
  s_cmp_ge_u32 s22, 122880
  s_cselect_b32 s22, s32, s22
  v_mov_b32 v16, s20
  v_mfma_f32_32x32x16_bf16 v[144:159], v[168:171], a[248:251], v[144:159]
  s_add_u32 s21, s21, 40960
  s_cmp_ge_u32 s21, 122880
  s_cselect_b32 s21, 0, s21
  s_add_u32 s20, s20, 1
  s_waitcnt lgkmcnt(0)
  v_mfma_f32_32x32x16_bf16 v[128:143], v[172:175], a[92:95], v[128:143]
  v_mfma_f32_32x32x16_bf16 v[144:159], v[172:175], a[252:255], v[144:159]
  v_add_u32 v10, s21, v6
  v_add_u32 v11, s21, v7
  v_add_u32 v12, s21, v8
  v_add_u32 v13, s21, v9
  s_waitcnt vmcnt(10)
  s_barrier
  ds_read_b128 v[160:163], v10 offset:0
  ds_read_b128 v[164:167], v11 offset:0
  ds_read_b128 v[168:171], v12 offset:0
  s_lshr_b32 s38, s75, 1
  s_bitcmp1_b32 s76, s38
  s_cselect_b32 s38, 8192, 0
  s_xor_b32 s38, s38, s31
  s_add_u32 s66, s16, s38
  s_add_u32 s75, s75, s53
  s_add_u32 s16, s16, s17
  s_cmp_lt_u32 s20, s18
  v_cvt_pk_bf16_f32 v176, v128, v132
  v_cvt_pk_bf16_f32 v177, v136, v140
  v_cvt_pk_bf16_f32 v178, v129, v133
  v_cvt_pk_bf16_f32 v179, v137, v141
  v_cvt_pk_bf16_f32 v180, v130, v134
  v_cvt_pk_bf16_f32 v181, v138, v142
  v_cvt_pk_bf16_f32 v182, v131, v135
  v_cvt_pk_bf16_f32 v183, v139, v143
  v_cvt_pk_bf16_f32 v184, v144, v148
  v_cvt_pk_bf16_f32 v185, v152, v156
  v_cvt_pk_bf16_f32 v186, v145, v149
  v_cvt_pk_bf16_f32 v187, v153, v157
  v_cvt_pk_bf16_f32 v188, v146, v150
  v_cvt_pk_bf16_f32 v189, v154, v158
  v_cvt_pk_bf16_f32 v190, v147, v151
  v_cvt_pk_bf16_f32 v191, v155, v159
  s_cmp_lg_u32 s20, 1
  s_cbranch_scc1 L_rest_73
  buffer_store_dwordx4 v[176:179], v1, s[4:7], s66 offen offset:0 sc1
  buffer_store_dwordx4 v[180:183], v1, s[4:7], s66 offen offset:1024 sc1
  buffer_store_dwordx4 v[184:187], v1, s[4:7], s66 offen offset:2048 sc1
  buffer_store_dwordx4 v[188:191], v1, s[4:7], s66 offen offset:3072 sc1
  s_mov_b32 s66, 0x80000000
  v_mov_b32 v16, 1
  s_waitcnt vmcnt(0)
  s_barrier
L_rest_73:
  s_cmp_lt_u32 s20, s18
  s_cbranch_scc1 L_gemm_72
  buffer_store_dwordx4 v[176:179], v1, s[4:7], s66 offen offset:0 sc1
  buffer_store_dwordx4 v[180:183], v1, s[4:7], s66 offen offset:1024 sc1
  buffer_store_dwordx4 v[184:187], v1, s[4:7], s66 offen offset:2048 sc1
  buffer_store_dwordx4 v[188:191], v1, s[4:7], s66 offen offset:3072 sc1
  s_waitcnt lgkmcnt(0)
L_aq_e_69:
  s_waitcnt vmcnt(0)
  s_barrier
  v_mov_b32 v16, s18
  s_mov_b64 exec, 1
  buffer_store_dword v16, v1, s[4:7], s19 offen sc1
  s_mov_b64 exec, -1
  s_mov_b32 s19, 0x80000000
L_ct2:
  s_mov_b32 s38, 52
  s_cmp_ge_u32 s9, 96
  s_cselect_b32 s38, 256, s38
  s_waitcnt vmcnt(0)
  s_barrier
  s_cmp_lg_u32 s10, 0
  s_cbranch_scc1 L_arr_74
  v_mov_b32 v16, 1
  s_mov_b64 exec, 1
  buffer_atomic_add v16, v1, s[84:87], s38 offen
  s_mov_b64 exec, -1
L_arr_74:
  s_cmp_lg_u32 s10, 0
  s_cbranch_scc1 L_polled_76
  v_and_b32 v17, 0, v0
  v_lshlrev_b32 v17, 2, v17
L_poll_75:
  buffer_load_dword v16, v17, s[84:87], 44 offen sc1
  s_waitcnt vmcnt(0)
  v_cmp_gt_u32 vcc, 64, v16
  s_cbranch_vccz L_polled_76
  s_sub_u32 s12, s12, 1
  s_cbranch_scc1 L_abort
  s_sleep 2
  s_branch L_poll_75
L_polled_76:
  s_barrier
  v_and_b32 v17, 32, v0
  v_lshl_add_u32 v3, v17, 25, v1
  v_and_b32 v16, 31, v0
  v_subrev_u32 v18, 4, v16
  v_cmp_gt_u32 vcc, 20, v16
  s_nop 1
  v_cndmask_b32 v16, v18, v16, vcc
  v_mul_u32_u24 v17, 320, v17
  v_lshl_add_u32 v4, v16, 4, v17
  v_add_u32 v5, 20480, v4
  v_and_b32 v16, 31, v0
  v_lshrrev_b32 v17, 5, v0
  v_lshlrev_b32 v17, 2, v17
  v_sub_u32 v16, v16, v17
  v_mov_b32 v17, 0xf149f2ca
  v_cmp_le_i32 vcc, 0, v16
  s_nop 1
  v_cndmask_b32 v164, v17, 0, vcc
  v_cmp_le_i32 vcc, 1, v16
  s_nop 1
  v_cndmask_b32 v165, v17, 0, vcc
  v_cmp_le_i32 vcc, 2, v16
  s_nop 1
  v_cndmask_b32 v166, v17, 0, vcc
  v_cmp_le_i32 vcc, 3, v16
  s_nop 1
  v_cndmask_b32 v167, v17, 0, vcc
  v_cmp_le_i32 vcc, 8, v16
  s_nop 1
  v_cndmask_b32 v168, v17, 0, vcc
  v_cmp_le_i32 vcc, 9, v16
  s_nop 1
  v_cndmask_b32 v169, v17, 0, vcc
  v_cmp_le_i32 vcc, 10, v16
  s_nop 1
  v_cndmask_b32 v170, v17, 0, vcc
  v_cmp_le_i32 vcc, 11, v16
  s_nop 1
  v_cndmask_b32 v171, v17, 0, vcc
  v_cmp_le_i32 vcc, 16, v16
  s_nop 1
  v_cndmask_b32 v172, v17, 0, vcc
  v_cmp_le_i32 vcc, 17, v16
  s_nop 1
  v_cndmask_b32 v173, v17, 0, vcc
  v_cmp_le_i32 vcc, 18, v16
  s_nop 1
  v_cndmask_b32 v174, v17, 0, vcc
  v_cmp_le_i32 vcc, 19, v16
  s_nop 1
  v_cndmask_b32 v175, v17, 0, vcc
  v_cmp_le_i32 vcc, 24, v16
  s_nop 1
  v_cndmask_b32 v176, v17, 0, vcc
  v_cmp_le_i32 vcc, 25, v16
  s_nop 1
  v_cndmask_b32 v177, v17, 0, vcc
  v_cmp_le_i32 vcc, 26, v16
  s_nop 1
  v_cndmask_b32 v178, v17, 0, vcc
  v_cmp_le_i32 vcc, 27, v16
  s_nop 1
  v_cndmask_b32 v179, v17, 0, vcc
  v_and_b32 v16, 31, v0
  v_lshrrev_b32 v17, 5, v0
  v_lshlrev_b32 v17, 2, v17
  v_sub_u32 v16, v16, v17
  v_mov_b32 v17, 0xf149f2ca
  v_cmp_gt_i32 vcc, 0, v16
  s_nop 1
  v_cndmask_b32 v180, v17, 0, vcc
  v_cmp_gt_i32 vcc, 1, v16
  s_nop 1
  v_cndmask_b32 v181, v17, 0, vcc
  v_cmp_gt_i32 vcc, 2, v16
  s_nop 1
  v_cndmask_b32 v182, v17, 0, vcc
  v_cmp_gt_i32 vcc, 3, v16
  s_nop 1
  v_cndmask_b32 v183, v17, 0, vcc
  v_cmp_gt_i32 vcc, 8, v16
  s_nop 1
  v_cndmask_b32 v184, v17, 0, vcc
  v_cmp_gt_i32 vcc, 9, v16
  s_nop 1
  v_cndmask_b32 v185, v17, 0, vcc
  v_cmp_gt_i32 vcc, 10, v16
  s_nop 1
  v_cndmask_b32 v186, v17, 0, vcc
  v_cmp_gt_i32 vcc, 11, v16
  s_nop 1
  v_cndmask_b32 v187, v17, 0, vcc
  v_cmp_gt_i32 vcc, 16, v16
  s_nop 1
  v_cndmask_b32 v188, v17, 0, vcc
  v_cmp_gt_i32 vcc, 17, v16
  s_nop 1
  v_cndmask_b32 v189, v17, 0, vcc
  v_cmp_gt_i32 vcc, 18, v16
  s_nop 1
  v_cndmask_b32 v190, v17, 0, vcc
  v_cmp_gt_i32 vcc, 19, v16
  s_nop 1
  v_cndmask_b32 v191, v17, 0, vcc
  v_cmp_gt_i32 vcc, 24, v16
  s_nop 1
  v_cndmask_b32 v192, v17, 0, vcc
  v_cmp_gt_i32 vcc, 25, v16
  s_nop 1
  v_cndmask_b32 v193, v17, 0, vcc
  v_cmp_gt_i32 vcc, 26, v16
  s_nop 1
  v_cndmask_b32 v194, v17, 0, vcc
  v_cmp_gt_i32 vcc, 27, v16
  s_nop 1
  v_cndmask_b32 v195, v17, 0, vcc
  s_mov_b32 s26, 0
  s_mov_b32 s27, -1
  s_mov_b32 s34, 0x00ffffff
  s_mov_b32 s35, 0x00ffffff
  v_mov_b32 v16, 0x3f803f80
  v_accvgpr_write_b32 a6, v16
  v_accvgpr_write_b32 a7, v16
  v_accvgpr_write_b32 a8, v16
  v_accvgpr_write_b32 a9, v16
  v_accvgpr_write_b32 a10, v16
  v_accvgpr_write_b32 a11, v16
  v_accvgpr_write_b32 a12, v16
  v_accvgpr_write_b32 a13, v16
  v_accvgpr_write_b32 a20, v16
  v_accvgpr_write_b32 a21, v16
  v_accvgpr_write_b32 a22, v16
  v_accvgpr_write_b32 a23, v16
  v_accvgpr_write_b32 a24, v16
  v_accvgpr_write_b32 a25, v16
  v_accvgpr_write_b32 a26, v16
  v_accvgpr_write_b32 a27, v16
  v_accvgpr_write_b32 a34, v16
  v_accvgpr_write_b32 a35, v16
  v_accvgpr_write_b32 a36, v16
  v_accvgpr_write_b32 a37, v16
  v_accvgpr_write_b32 a38, v16
  v_accvgpr_write_b32 a39, v16
  v_accvgpr_write_b32 a40, v16
  v_accvgpr_write_b32 a41, v16
  v_accvgpr_write_b32 a48, v16
  v_accvgpr_write_b32 a49, v16
  v_accvgpr_write_b32 a50, v16
  v_accvgpr_write_b32 a51, v16
  v_accvgpr_write_b32 a52, v16
  v_accvgpr_write_b32 a53, v16
  v_accvgpr_write_b32 a54, v16
  v_accvgpr_write_b32 a55, v16
  v_accvgpr_write_b32 a62, v16
  v_accvgpr_write_b32 a63, v16
  v_accvgpr_write_b32 a64, v16
  v_accvgpr_write_b32 a65, v16
  v_accvgpr_write_b32 a66, v16
  v_accvgpr_write_b32 a67, v16
  v_accvgpr_write_b32 a68, v16
  v_accvgpr_write_b32 a69, v16
  v_accvgpr_write_b32 a76, v16
  v_accvgpr_write_b32 a77, v16
  v_accvgpr_write_b32 a78, v16
  v_accvgpr_write_b32 a79, v16
  v_accvgpr_write_b32 a80, v16
  v_accvgpr_write_b32 a81, v16
  v_accvgpr_write_b32 a82, v16
  v_accvgpr_write_b32 a83, v16
  v_accvgpr_write_b32 a90, v16
  v_accvgpr_write_b32 a91, v16
  v_accvgpr_write_b32 a92, v16
  v_accvgpr_write_b32 a93, v16
  v_accvgpr_write_b32 a94, v16
  v_accvgpr_write_b32 a95, v16
  v_accvgpr_write_b32 a96, v16
  v_accvgpr_write_b32 a97, v16
  v_accvgpr_write_b32 a104, v16
  v_accvgpr_write_b32 a105, v16
  v_accvgpr_write_b32 a106, v16
  v_accvgpr_write_b32 a107, v16
  v_accvgpr_write_b32 a108, v16
  v_accvgpr_write_b32 a109, v16
  v_accvgpr_write_b32 a110, v16
  v_accvgpr_write_b32 a111, v16
  v_accvgpr_write_b32 a118, v16
  v_accvgpr_write_b32 a119, v16
  v_accvgpr_write_b32 a120, v16
  v_accvgpr_write_b32 a121, v16
  v_accvgpr_write_b32 a122, v16
  v_accvgpr_write_b32 a123, v16
  v_accvgpr_write_b32 a124, v16
  v_accvgpr_write_b32 a125, v16
  v_accvgpr_write_b32 a132, v16
  v_accvgpr_write_b32 a133, v16
  v_accvgpr_write_b32 a134, v16
  v_accvgpr_write_b32 a135, v16
  v_accvgpr_write_b32 a136, v16
  v_accvgpr_write_b32 a137, v16
  v_accvgpr_write_b32 a138, v16
  v_accvgpr_write_b32 a139, v16
  v_accvgpr_write_b32 a146, v16
  v_accvgpr_write_b32 a147, v16
  v_accvgpr_write_b32 a148, v16
  v_accvgpr_write_b32 a149, v16
  v_accvgpr_write_b32 a150, v16
  v_accvgpr_write_b32 a151, v16
  v_accvgpr_write_b32 a152, v16
  v_accvgpr_write_b32 a153, v16
  v_accvgpr_write_b32 a160, v16
  v_accvgpr_write_b32 a161, v16
  v_accvgpr_write_b32 a162, v16
  v_accvgpr_write_b32 a163, v16
  v_accvgpr_write_b32 a164, v16
  v_accvgpr_write_b32 a165, v16
  v_accvgpr_write_b32 a166, v16
  v_accvgpr_write_b32 a167, v16
  v_accvgpr_write_b32 a174, v16
  v_accvgpr_write_b32 a175, v16
  v_accvgpr_write_b32 a176, v16
  v_accvgpr_write_b32 a177, v16
  v_accvgpr_write_b32 a178, v16
  v_accvgpr_write_b32 a179, v16
  v_accvgpr_write_b32 a180, v16
  v_accvgpr_write_b32 a181, v16
  v_accvgpr_write_b32 a188, v16
  v_accvgpr_write_b32 a189, v16
  v_accvgpr_write_b32 a190, v16
  v_accvgpr_write_b32 a191, v16
  v_accvgpr_write_b32 a192, v16
  v_accvgpr_write_b32 a193, v16
  v_accvgpr_write_b32 a194, v16
  v_accvgpr_write_b32 a195, v16
  v_accvgpr_write_b32 a202, v16
  v_accvgpr_write_b32 a203, v16
  v_accvgpr_write_b32 a204, v16
  v_accvgpr_write_b32 a205, v16
  v_accvgpr_write_b32 a206, v16
  v_accvgpr_write_b32 a207, v16
  v_accvgpr_write_b32 a208, v16
  v_accvgpr_write_b32 a209, v16
  v_accvgpr_write_b32 a216, v16
  v_accvgpr_write_b32 a217, v16
  v_accvgpr_write_b32 a218, v16
  v_accvgpr_write_b32 a219, v16
  v_accvgpr_write_b32 a220, v16
  v_accvgpr_write_b32 a221, v16
  v_accvgpr_write_b32 a222, v16
  v_accvgpr_write_b32 a223, v16
  v_accvgpr_write_b32 a230, v16
  v_accvgpr_write_b32 a231, v16
  v_accvgpr_write_b32 a232, v16
  v_accvgpr_write_b32 a233, v16
  v_accvgpr_write_b32 a234, v16
  v_accvgpr_write_b32 a235, v16
  v_accvgpr_write_b32 a236, v16
  v_accvgpr_write_b32 a237, v16
  v_accvgpr_write_b32 a244, v16
  v_accvgpr_write_b32 a245, v16
  v_accvgpr_write_b32 a246, v16
  v_accvgpr_write_b32 a247, v16
  v_accvgpr_write_b32 a248, v16
  v_accvgpr_write_b32 a249, v16
  v_accvgpr_write_b32 a250, v16
  v_accvgpr_write_b32 a251, v16
  s_lshr_b32 s28, s9, 3
  s_lshl_b32 s28, s28, 2
  s_add_u32 s28, s28, s10
  s_and_b32 s36, s9, 7
  s_mul_i32 s32, s36, 5120
  s_mul_i32 s33, s36, 1280
  s_add_u32 s33, s33, 73400320
  s_add_i32 s36, s28, -8
  s_mul_i32 s37, s36, 40960
  s_cmp_ge_i32 s36, 0
  s_cselect_b32 s44, s37, 0x40000000
  s_add_i32 s36, s28, -7
  s_mul_i32 s37, s36, 40960
  s_cmp_ge_i32 s36, 0
  s_cselect_b32 s45, s37, 0x40000000
  s_add_i32 s36, s28, -6
  s_mul_i32 s37, s36, 40960
  s_cmp_ge_i32 s36, 0
  s_cselect_b32 s46, s37, 0x40000000
  s_add_i32 s36, s28, -5
  s_mul_i32 s37, s36, 40960
  s_cmp_ge_i32 s36, 0
  s_cselect_b32 s47, s37, 0x40000000
  s_add_i32 s36, s28, -4
  s_mul_i32 s37, s36, 40960
  s_cmp_ge_i32 s36, 0
  s_cselect_b32 s48, s37, 0x40000000
  s_add_i32 s36, s28, -3
  s_mul_i32 s37, s36, 40960
  s_cmp_ge_i32 s36, 0
  s_cselect_b32 s49, s37, 0x40000000
  s_add_i32 s36, s28, -2
  s_mul_i32 s37, s36, 40960
  s_cmp_ge_i32 s36, 0
  s_cselect_b32 s50, s37, 0x40000000
  s_add_i32 s36, s28, -1
  s_mul_i32 s37, s36, 40960
  s_cmp_ge_i32 s36, 0
  s_cselect_b32 s51, s37, 0x40000000
  s_add_i32 s36, s28, 0
  s_mul_i32 s37, s36, 40960
  s_cmp_ge_i32 s36, 0
  s_cselect_b32 s52, s37, 0x40000000
  s_add_u32 s36, s52, s32
  s_add_u32 s36, s36, 67108864
  buffer_load_dwordx4 v[212:215], v1, s[4:7], s36 offen offset:0 sc1
  buffer_load_dwordx2 v[216:217], v3, s[4:7], s36 offen offset:1024 sc1
  s_add_u32 s36, s44, s32
  s_add_u32 s36, s36, 70254592
  buffer_load_dwordx4 a[0:3], v1, s[4:7], s36 offen offset:0 sc1
  buffer_load_dwordx2 a[4:5], v3, s[4:7], s36 offen offset:1024 sc1
  s_add_u32 s36, s45, s32
  s_add_u32 s36, s36, 70254592
  buffer_load_dwordx4 a[14:17], v1, s[4:7], s36 offen offset:0 sc1
  buffer_load_dwordx2 a[18:19], v3, s[4:7], s36 offen offset:1024 sc1
  s_add_u32 s36, s46, s32
  s_add_u32 s36, s36, 70254592
  buffer_load_dwordx4 a[28:31], v1, s[4:7], s36 offen offset:0 sc1
  buffer_load_dwordx2 a[32:33], v3, s[4:7], s36 offen offset:1024 sc1
  s_add_u32 s36, s47, s32
  s_add_u32 s36, s36, 70254592
  buffer_load_dwordx4 a[42:45], v1, s[4:7], s36 offen offset:0 sc1
  buffer_load_dwordx2 a[46:47], v3, s[4:7], s36 offen offset:1024 sc1
  s_add_u32 s36, s48, s32
  s_add_u32 s36, s36, 70254592
  buffer_load_dwordx4 a[56:59], v1, s[4:7], s36 offen offset:0 sc1
  buffer_load_dwordx2 a[60:61], v3, s[4:7], s36 offen offset:1024 sc1
  s_add_u32 s36, s49, s32
  s_add_u32 s36, s36, 70254592
  buffer_load_dwordx4 a[70:73], v1, s[4:7], s36 offen offset:0 sc1
  buffer_load_dwordx2 a[74:75], v3, s[4:7], s36 offen offset:1024 sc1
  s_add_u32 s36, s50, s32
  s_add_u32 s36, s36, 70254592
  buffer_load_dwordx4 a[84:87], v1, s[4:7], s36 offen offset:0 sc1
  buffer_load_dwordx2 a[88:89], v3, s[4:7], s36 offen offset:1024 sc1
  s_add_u32 s36, s51, s32
  s_add_u32 s36, s36, 70254592
  buffer_load_dwordx4 a[98:101], v1, s[4:7], s36 offen offset:0 sc1
  buffer_load_dwordx2 a[102:103], v3, s[4:7], s36 offen offset:1024 sc1
  s_add_u32 s36, s52, s32
  s_add_u32 s36, s36, 70254592
  buffer_load_dwordx4 a[112:115], v1, s[4:7], s36 offen offset:0 sc1
  buffer_load_dwordx2 a[116:117], v3, s[4:7], s36 offen offset:1024 sc1
  s_add_u32 s36, s44, s33
  s_mov_b64 exec, s[34:35]
  buffer_load_dwordx4 a[6:9], v4, s[4:7], s36 offen offset:0 sc1
  s_mov_b64 exec, -1
  s_mov_b64 exec, s[34:35]
  buffer_load_dwordx4 a[10:13], v5, s[4:7], s36 offen offset:0 sc1
  s_mov_b64 exec, -1
  s_add_u32 s36, s45, s33
  s_mov_b64 exec, s[34:35]
  buffer_load_dwordx4 a[20:23], v4, s[4:7], s36 offen offset:0 sc1
  s_mov_b64 exec, -1
  s_mov_b64 exec, s[34:35]
  buffer_load_dwordx4 a[24:27], v5, s[4:7], s36 offen offset:0 sc1
  s_mov_b64 exec, -1
  s_add_u32 s36, s46, s33
  s_mov_b64 exec, s[34:35]
  buffer_load_dwordx4 a[34:37], v4, s[4:7], s36 offen offset:0 sc1
  s_mov_b64 exec, -1
  s_mov_b64 exec, s[34:35]
  buffer_load_dwordx4 a[38:41], v5, s[4:7], s36 offen offset:0 sc1
  s_mov_b64 exec, -1
  s_add_u32 s36, s47, s33
  s_mov_b64 exec, s[34:35]
  buffer_load_dwordx4 a[48:51], v4, s[4:7], s36 offen offset:0 sc1
  s_mov_b64 exec, -1
  s_mov_b64 exec, s[34:35]
  buffer_load_dwordx4 a[52:55], v5, s[4:7], s36 offen offset:0 sc1
  s_mov_b64 exec, -1
  s_add_u32 s36, s48, s33
  s_mov_b64 exec, s[34:35]
  buffer_load_dwordx4 a[62:65], v4, s[4:7], s36 offen offset:0 sc1
  s_mov_b64 exec, -1
  s_mov_b64 exec, s[34:35]
  buffer_load_dwordx4 a[66:69], v5, s[4:7], s36 offen offset:0 sc1
  s_mov_b64 exec, -1
  s_add_u32 s36, s49, s33
  s_mov_b64 exec, s[34:35]
  buffer_load_dwordx4 a[76:79], v4, s[4:7], s36 offen offset:0 sc1
  s_mov_b64 exec, -1
  s_mov_b64 exec, s[34:35]
  buffer_load_dwordx4 a[80:83], v5, s[4:7], s36 offen offset:0 sc1
  s_mov_b64 exec, -1
  s_add_u32 s36, s50, s33
  s_mov_b64 exec, s[34:35]
  buffer_load_dwordx4 a[90:93], v4, s[4:7], s36 offen offset:0 sc1
  s_mov_b64 exec, -1
  s_mov_b64 exec, s[34:35]
  buffer_load_dwordx4 a[94:97], v5, s[4:7], s36 offen offset:0 sc1
  s_mov_b64 exec, -1
  s_add_u32 s36, s51, s33
  s_mov_b64 exec, s[34:35]
  buffer_load_dwordx4 a[104:107], v4, s[4:7], s36 offen offset:0 sc1
  s_mov_b64 exec, -1
  s_mov_b64 exec, s[34:35]
  buffer_load_dwordx4 a[108:111], v5, s[4:7], s36 offen offset:0 sc1
  s_mov_b64 exec, -1
  s_add_u32 s36, s52, s33
  s_mov_b64 exec, s[34:35]
  buffer_load_dwordx4 a[118:121], v4, s[4:7], s36 offen offset:0 sc1
  s_mov_b64 exec, -1
  s_mov_b64 exec, s[34:35]
  buffer_load_dwordx4 a[122:125], v5, s[4:7], s36 offen offset:0 sc1
  s_mov_b64 exec, -1
  s_waitcnt vmcnt(0)
L_battn_77:
  s_mul_i32 s16, s28, 40960
  s_add_u32 s16, s16, s32
  s_add_u32 s16, s16, 77594624
  s_waitcnt vmcnt(2)
  v_mfma_f32_32x32x16_bf16 v[20:35], a[0:3], v[212:215], v[180:195]
  v_mfma_f32_32x32x8_bf16 v[20:35], a[4:5], v[216:217], v[20:35]
  s_add_u32 s36, s52, s32
  s_add_u32 s36, s36, 67109888
  buffer_load_dwordx4 v[218:221], v1, s[4:7], s36 offen offset:512 sc1
  v_mfma_f32_32x32x16_bf16 v[36:51], a[14:17], v[212:215], 0
  v_mfma_f32_32x32x8_bf16 v[36:51], a[18:19], v[216:217], v[36:51]
  buffer_load_dwordx2 v[222:223], v3, s[4:7], s36 offen offset:8 sc1
  v_mfma_f32_32x32x16_bf16 v[52:67], a[28:31], v[212:215], 0
  v_mfma_f32_32x32x8_bf16 v[52:67], a[32:33], v[216:217], v[52:67]
  s_add_u32 s36, s44, s32
  s_add_u32 s36, s36, 70255616
  buffer_load_dwordx4 a[126:129], v1, s[4:7], s36 offen offset:512 sc1
  v_mfma_f32_32x32x16_bf16 v[68:83], a[42:45], v[212:215], 0
  v_mfma_f32_32x32x8_bf16 v[68:83], a[46:47], v[216:217], v[68:83]
  buffer_load_dwordx2 a[130:131], v3, s[4:7], s36 offen offset:8 sc1
  v_mfma_f32_32x32x16_bf16 v[84:99], a[56:59], v[212:215], 0
  v_mfma_f32_32x32x8_bf16 v[84:99], a[60:61], v[216:217], v[84:99]
  s_add_u32 s36, s45, s32
  s_add_u32 s36, s36, 70255616
  buffer_load_dwordx4 a[140:143], v1, s[4:7], s36 offen offset:512 sc1
  v_mfma_f32_32x32x16_bf16 v[100:115], a[70:73], v[212:215], 0
  v_mfma_f32_32x32x8_bf16 v[100:115], a[74:75], v[216:217], v[100:115]
  buffer_load_dwordx2 a[144:145], v3, s[4:7], s36 offen offset:8 sc1
  v_mfma_f32_32x32x16_bf16 v[116:131], a[84:87], v[212:215], 0
  v_mfma_f32_32x32x8_bf16 v[116:131], a[88:89], v[216:217], v[116:131]
  s_add_u32 s36, s46, s32
  s_add_u32 s36, s36, 70255616
  buffer_load_dwordx4 a[154:157], v1, s[4:7], s36 offen offset:512 sc1
  v_mfma_f32_32x32x16_bf16 v[132:147], a[98:101], v[212:215], 0
  v_mfma_f32_32x32x8_bf16 v[132:147], a[102:103], v[216:217], v[132:147]
  buffer_load_dwordx2 a[158:159], v3, s[4:7], s36 offen offset:8 sc1
  v_mfma_f32_32x32x16_bf16 v[148:163], a[112:115], v[212:215], v[164:179]
  v_mfma_f32_32x32x8_bf16 v[148:163], a[116:117], v[216:217], v[148:163]
  s_add_u32 s36, s47, s32
  s_add_u32 s36, s36, 70255616
  buffer_load_dwordx4 a[168:171], v1, s[4:7], s36 offen offset:512 sc1
  s_cmp_ge_u32 s28, 8
  s_cbranch_scc1 L_full_78
  v_mov_b32 v20, 0xf149f2ca
  v_mov_b32 v21, 0xf149f2ca
  v_mov_b32 v22, 0xf149f2ca
  v_mov_b32 v23, 0xf149f2ca
  v_mov_b32 v24, 0xf149f2ca
  v_mov_b32 v25, 0xf149f2ca
  v_mov_b32 v26, 0xf149f2ca
  v_mov_b32 v27, 0xf149f2ca
  v_mov_b32 v28, 0xf149f2ca
  v_mov_b32 v29, 0xf149f2ca
  v_mov_b32 v30, 0xf149f2ca
  v_mov_b32 v31, 0xf149f2ca
  v_mov_b32 v32, 0xf149f2ca
  v_mov_b32 v33, 0xf149f2ca
  v_mov_b32 v34, 0xf149f2ca
  v_mov_b32 v35, 0xf149f2ca
  s_cmp_ge_u32 s28, 7
  s_cbranch_scc1 L_full_78
  v_mov_b32 v36, 0xf149f2ca
  v_mov_b32 v37, 0xf149f2ca
  v_mov_b32 v38, 0xf149f2ca
  v_mov_b32 v39, 0xf149f2ca
  v_mov_b32 v40, 0xf149f2ca
  v_mov_b32 v41, 0xf149f2ca
  v_mov_b32 v42, 0xf149f2ca
  v_mov_b32 v43, 0xf149f2ca
  v_mov_b32 v44, 0xf149f2ca
  v_mov_b32 v45, 0xf149f2ca
  v_mov_b32 v46, 0xf149f2ca
  v_mov_b32 v47, 0xf149f2ca
  v_mov_b32 v48, 0xf149f2ca
  v_mov_b32 v49, 0xf149f2ca
  v_mov_b32 v50, 0xf149f2ca
  v_mov_b32 v51, 0xf149f2ca
  s_cmp_ge_u32 s28, 6
  s_cbranch_scc1 L_full_78
  v_mov_b32 v52, 0xf149f2ca
  v_mov_b32 v53, 0xf149f2ca
  v_mov_b32 v54, 0xf149f2ca
  v_mov_b32 v55, 0xf149f2ca
  v_mov_b32 v56, 0xf149f2ca
  v_mov_b32 v57, 0xf149f2ca
  v_mov_b32 v58, 0xf149f2ca
  v_mov_b32 v59, 0xf149f2ca
  v_mov_b32 v60, 0xf149f2ca
  v_mov_b32 v61, 0xf149f2ca
  v_mov_b32 v62, 0xf149f2ca
  v_mov_b32 v63, 0xf149f2ca
  v_mov_b32 v64, 0xf149f2ca
  v_mov_b32 v65, 0xf149f2ca
  v_mov_b32 v66, 0xf149f2ca
  v_mov_b32 v67, 0xf149f2ca
  s_cmp_ge_u32 s28, 5
  s_cbranch_scc1 L_full_78
  v_mov_b32 v68, 0xf149f2ca
  v_mov_b32 v69, 0xf149f2ca
  v_mov_b32 v70, 0xf149f2ca
  v_mov_b32 v71, 0xf149f2ca
  v_mov_b32 v72, 0xf149f2ca
  v_mov_b32 v73, 0xf149f2ca
  v_mov_b32 v74, 0xf149f2ca
  v_mov_b32 v75, 0xf149f2ca
  v_mov_b32 v76, 0xf149f2ca
  v_mov_b32 v77, 0xf149f2ca
  v_mov_b32 v78, 0xf149f2ca
  v_mov_b32 v79, 0xf149f2ca
  v_mov_b32 v80, 0xf149f2ca
  v_mov_b32 v81, 0xf149f2ca
  v_mov_b32 v82, 0xf149f2ca
  v_mov_b32 v83, 0xf149f2ca
  s_cmp_ge_u32 s28, 4
  s_cbranch_scc1 L_full_78
  v_mov_b32 v84, 0xf149f2ca
  v_mov_b32 v85, 0xf149f2ca
  v_mov_b32 v86, 0xf149f2ca
  v_mov_b32 v87, 0xf149f2ca
  v_mov_b32 v88, 0xf149f2ca
  v_mov_b32 v89, 0xf149f2ca
  v_mov_b32 v90, 0xf149f2ca
  v_mov_b32 v91, 0xf149f2ca
  v_mov_b32 v92, 0xf149f2ca
  v_mov_b32 v93, 0xf149f2ca
  v_mov_b32 v94, 0xf149f2ca
  v_mov_b32 v95, 0xf149f2ca
  v_mov_b32 v96, 0xf149f2ca
  v_mov_b32 v97, 0xf149f2ca
  v_mov_b32 v98, 0xf149f2ca
  v_mov_b32 v99, 0xf149f2ca
  s_cmp_ge_u32 s28, 3
  s_cbranch_scc1 L_full_78
  v_mov_b32 v100, 0xf149f2ca
  v_mov_b32 v101, 0xf149f2ca
  v_mov_b32 v102, 0xf149f2ca
  v_mov_b32 v103, 0xf149f2ca
  v_mov_b32 v104, 0xf149f2ca
  v_mov_b32 v105, 0xf149f2ca
  v_mov_b32 v106, 0xf149f2ca
  v_mov_b32 v107, 0xf149f2ca
  v_mov_b32 v108, 0xf149f2ca
  v_mov_b32 v109, 0xf149f2ca
  v_mov_b32 v110, 0xf149f2ca
  v_mov_b32 v111, 0xf149f2ca
  v_mov_b32 v112, 0xf149f2ca
  v_mov_b32 v113, 0xf149f2ca
  v_mov_b32 v114, 0xf149f2ca
  v_mov_b32 v115, 0xf149f2ca
  s_cmp_ge_u32 s28, 2
  s_cbranch_scc1 L_full_78
  v_mov_b32 v116, 0xf149f2ca
  v_mov_b32 v117, 0xf149f2ca
  v_mov_b32 v118, 0xf149f2ca
  v_mov_b32 v119, 0xf149f2ca
  v_mov_b32 v120, 0xf149f2ca
  v_mov_b32 v121, 0xf149f2ca
  v_mov_b32 v122, 0xf149f2ca
  v_mov_b32 v123, 0xf149f2ca
  v_mov_b32 v124, 0xf149f2ca
  v_mov_b32 v125, 0xf149f2ca
  v_mov_b32 v126, 0xf149f2ca
  v_mov_b32 v127, 0xf149f2ca
  v_mov_b32 v128, 0xf149f2ca
  v_mov_b32 v129, 0xf149f2ca
  v_mov_b32 v130, 0xf149f2ca
  v_mov_b32 v131, 0xf149f2ca
  s_cmp_ge_u32 s28, 1
  s_cbranch_scc1 L_full_78
  v_mov_b32 v132, 0xf149f2ca
  v_mov_b32 v133, 0xf149f2ca
  v_mov_b32 v134, 0xf149f2ca
  v_mov_b32 v135, 0xf149f2ca
  v_mov_b32 v136, 0xf149f2ca
  v_mov_b32 v137, 0xf149f2ca
  v_mov_b32 v138, 0xf149f2ca
  v_mov_b32 v139, 0xf149f2ca
  v_mov_b32 v140, 0xf149f2ca
  v_mov_b32 v141, 0xf149f2ca
  v_mov_b32 v142, 0xf149f2ca
  v_mov_b32 v143, 0xf149f2ca
  v_mov_b32 v144, 0xf149f2ca
  v_mov_b32 v145, 0xf149f2ca
  v_mov_b32 v146, 0xf149f2ca
  v_mov_b32 v147, 0xf149f2ca
L_full_78:
  v_max_f32 v16, v20, v21
  v_max3_f32 v16, v16, v22, v23
  v_max3_f32 v16, v16, v24, v25
  v_max3_f32 v16, v16, v26, v27
  v_max3_f32 v16, v16, v28, v29
  v_max3_f32 v16, v16, v30, v31
  v_max3_f32 v16, v16, v32, v33
  v_max3_f32 v16, v16, v34, v35
  v_max3_f32 v16, v16, v36, v37
  v_max3_f32 v16, v16, v38, v39
  v_max3_f32 v16, v16, v40, v41
  v_max3_f32 v16, v16, v42, v43
  v_max3_f32 v16, v16, v44, v45
  v_max3_f32 v16, v16, v46, v47
  v_max3_f32 v16, v16, v48, v49
  v_max3_f32 v16, v16, v50, v51
  v_max3_f32 v16, v16, v52, v53
  buffer_load_dwordx2 a[172:173], v3, s[4:7], s36 offen offset:8 sc1
  v_max3_f32 v16, v16, v54, v55
  v_max3_f32 v16, v16, v56, v57
  v_max3_f32 v16, v16, v58, v59
  v_max3_f32 v16, v16, v60, v61
  v_max3_f32 v16, v16, v62, v63
  v_max3_f32 v16, v16, v64, v65
  v_max3_f32 v16, v16, v66, v67
  v_max3_f32 v16, v16, v68, v69
  v_max3_f32 v16, v16, v70, v71
  v_max3_f32 v16, v16, v72, v73
  v_max3_f32 v16, v16, v74, v75
  v_max3_f32 v16, v16, v76, v77
  v_max3_f32 v16, v16, v78, v79
  v_max3_f32 v16, v16, v80, v81
  v_max3_f32 v16, v16, v82, v83
  v_max3_f32 v16, v16, v84, v85
  s_add_u32 s36, s48, s32
  s_add_u32 s36, s36, 70255616
  buffer_load_dwordx4 a[182:185], v1, s[4:7], s36 offen offset:512 sc1
  v_max3_f32 v16, v16, v86, v87
  v_max3_f32 v16, v16, v88, v89
  v_max3_f32 v16, v16, v90, v91
  v_max3_f32 v16, v16, v92, v93
  v_max3_f32 v16, v16, v94, v95
  v_max3_f32 v16, v16, v96, v97
  v_max3_f32 v16, v16, v98, v99
  v_max3_f32 v16, v16, v100, v101
  v_max3_f32 v16, v16, v102, v103
  v_max3_f32 v16, v16, v104, v105
  v_max3_f32 v16, v16, v106, v107
  v_max3_f32 v16, v16, v108, v109
  v_max3_f32 v16, v16, v110, v111
  v_max3_f32 v16, v16, v112, v113
  v_max3_f32 v16, v16, v114, v115
  v_max3_f32 v16, v16, v116, v117
  buffer_load_dwordx2 a[186:187], v3, s[4:7], s36 offen offset:8 sc1
  v_max3_f32 v16, v16, v118, v119
  v_max3_f32 v16, v16, v120, v121
  v_max3_f32 v16, v16, v122, v123
  v_max3_f32 v16, v16, v124, v125
  v_max3_f32 v16, v16, v126, v127
  v_max3_f32 v16, v16, v128, v129
  v_max3_f32 v16, v16, v130, v131
  v_max3_f32 v16, v16, v132, v133
  v_max3_f32 v16, v16, v134, v135
  v_max3_f32 v16, v16, v136, v137
  v_max3_f32 v16, v16, v138, v139
  v_max3_f32 v16, v16, v140, v141
  v_max3_f32 v16, v16, v142, v143
  v_max3_f32 v16, v16, v144, v145
  v_max3_f32 v16, v16, v146, v147
  v_max3_f32 v16, v16, v148, v149
  s_add_u32 s36, s49, s32
  s_add_u32 s36, s36, 70255616
  buffer_load_dwordx4 a[196:199], v1, s[4:7], s36 offen offset:512 sc1
  v_max3_f32 v16, v16, v150, v151
  v_max3_f32 v16, v16, v152, v153
  v_max3_f32 v16, v16, v154, v155
  v_max3_f32 v16, v16, v156, v157
  v_max3_f32 v16, v16, v158, v159
  v_max3_f32 v16, v16, v160, v161
  v_max3_f32 v16, v16, v162, v163
  v_mov_b32 v17, v16
  s_nop 1
  v_permlane32_swap_b32 v16, v17
  v_max_f32 v16, v16, v17
  v_sub_f32 v20, v20, v16
  v_sub_f32 v21, v21, v16
  v_sub_f32 v22, v22, v16
  v_sub_f32 v23, v23, v16
  v_sub_f32 v24, v24, v16
  v_sub_f32 v25, v25, v16
  v_sub_f32 v26, v26, v16
  v_sub_f32 v27, v27, v16
  v_sub_f32 v28, v28, v16
  v_sub_f32 v29, v29, v16
  v_sub_f32 v30, v30, v16
  v_sub_f32 v31, v31, v16
  v_sub_f32 v32, v32, v16
  v_sub_f32 v33, v33, v16
  v_sub_f32 v34, v34, v16
  v_sub_f32 v35, v35, v16
  buffer_load_dwordx2 a[200:201], v3, s[4:7], s36 offen offset:8 sc1
  v_exp_f32 v20, v20
  v_exp_f32 v21, v21
  v_exp_f32 v22, v22
  v_exp_f32 v23, v23
  v_exp_f32 v24, v24
  v_exp_f32 v25, v25
  v_exp_f32 v26, v26
  v_exp_f32 v27, v27
  s_add_u32 s36, s50, s32
  s_add_u32 s36, s36, 70255616
  buffer_load_dwordx4 a[210:213], v1, s[4:7], s36 offen offset:512 sc1
  v_exp_f32 v28, v28
  v_exp_f32 v29, v29
  v_exp_f32 v30, v30
  v_exp_f32 v31, v31
  v_exp_f32 v32, v32
  v_exp_f32 v33, v33
  v_exp_f32 v34, v34
  v_exp_f32 v35, v35
  buffer_load_dwordx2 a[214:215], v3, s[4:7], s36 offen offset:8 sc1
  v_cvt_pk_bf16_f32 v224, v20, v24
  v_cvt_pk_bf16_f32 v225, v28, v32
  v_cvt_pk_bf16_f32 v226, v21, v25
  v_cvt_pk_bf16_f32 v227, v29, v33
  v_cvt_pk_bf16_f32 v228, v22, v26
  v_cvt_pk_bf16_f32 v229, v30, v34
  v_cvt_pk_bf16_f32 v230, v23, v27
  v_cvt_pk_bf16_f32 v231, v31, v35
  v_mfma_f32_32x32x16_bf16 v[196:211], a[6:9], v[224:227], 0
  s_nop 0
  v_mfma_f32_32x32x16_bf16 v[196:211], a[10:13], v[228:231], v[196:211]
  s_add_u32 s36, s51, s32
  s_add_u32 s36, s36, 70255616
  buffer_load_dwordx4 a[224:227], v1, s[4:7], s36 offen offset:512 sc1
  v_sub_f32 v36, v36, v16
  v_sub_f32 v37, v37, v16
  v_sub_f32 v38, v38, v16
  v_sub_f32 v39, v39, v16
  v_sub_f32 v40, v40, v16
  v_sub_f32 v41, v41, v16
  v_sub_f32 v42, v42, v16
  v_sub_f32 v43, v43, v16
  v_sub_f32 v44, v44, v16
  v_sub_f32 v45, v45, v16
  v_sub_f32 v46, v46, v16
  v_sub_f32 v47, v47, v16
  v_sub_f32 v48, v48, v16
  v_sub_f32 v49, v49, v16
  v_sub_f32 v50, v50, v16
  v_sub_f32 v51, v51, v16
  buffer_load_dwordx2 a[228:229], v3, s[4:7], s36 offen offset:8 sc1
  v_exp_f32 v36, v36
  v_exp_f32 v37, v37
  v_exp_f32 v38, v38
  v_exp_f32 v39, v39
  v_exp_f32 v40, v40
  v_exp_f32 v41, v41
  v_exp_f32 v42, v42
  v_exp_f32 v43, v43
  s_add_u32 s36, s52, s32
  s_add_u32 s36, s36, 70255616
  buffer_load_dwordx4 a[238:241], v1, s[4:7], s36 offen offset:512 sc1
  v_exp_f32 v44, v44
  v_exp_f32 v45, v45
  v_exp_f32 v46, v46
  v_exp_f32 v47, v47
  v_exp_f32 v48, v48
  v_exp_f32 v49, v49
  v_exp_f32 v50, v50
  v_exp_f32 v51, v51
  buffer_load_dwordx2 a[242:243], v3, s[4:7], s36 offen offset:8 sc1
  v_cvt_pk_bf16_f32 v232, v36, v40
  v_cvt_pk_bf16_f32 v233, v44, v48
  v_cvt_pk_bf16_f32 v234, v37, v41
  v_cvt_pk_bf16_f32 v235, v45, v49
  v_cvt_pk_bf16_f32 v236, v38, v42
  v_cvt_pk_bf16_f32 v237, v46, v50
  v_cvt_pk_bf16_f32 v238, v39, v43
  v_cvt_pk_bf16_f32 v239, v47, v51
  v_mfma_f32_32x32x16_bf16 v[196:211], a[20:23], v[232:235], v[196:211]
  s_nop 0
  v_mfma_f32_32x32x16_bf16 v[196:211], a[24:27], v[236:239], v[196:211]
  s_add_u32 s36, s44, s33
  s_mov_b64 exec, s[34:35]
  buffer_load_dwordx4 a[132:135], v4, s[4:7], s36 offen offset:320 sc1
  s_mov_b64 exec, -1
  v_sub_f32 v52, v52, v16
  v_sub_f32 v53, v53, v16
  v_sub_f32 v54, v54, v16
  v_sub_f32 v55, v55, v16
  v_sub_f32 v56, v56, v16
  v_sub_f32 v57, v57, v16
  v_sub_f32 v58, v58, v16
  v_sub_f32 v59, v59, v16
  v_sub_f32 v60, v60, v16
  v_sub_f32 v61, v61, v16
  v_sub_f32 v62, v62, v16
  v_sub_f32 v63, v63, v16
  v_sub_f32 v64, v64, v16
  v_sub_f32 v65, v65, v16
  v_sub_f32 v66, v66, v16
  v_sub_f32 v67, v67, v16
  s_mov_b64 exec, s[34:35]
  buffer_load_dwordx4 a[136:139], v5, s[4:7], s36 offen offset:320 sc1
  s_mov_b64 exec, -1
  v_exp_f32 v52, v52
  v_exp_f32 v53, v53
  v_exp_f32 v54, v54
  v_exp_f32 v55, v55
  v_exp_f32 v56, v56
  v_exp_f32 v57, v57
  v_exp_f32 v58, v58
  v_exp_f32 v59, v59
  s_add_u32 s36, s45, s33
  s_mov_b64 exec, s[34:35]
  buffer_load_dwordx4 a[146:149], v4, s[4:7], s36 offen offset:320 sc1
  s_mov_b64 exec, -1
  v_exp_f32 v60, v60
  v_exp_f32 v61, v61
  v_exp_f32 v62, v62
  v_exp_f32 v63, v63
  v_exp_f32 v64, v64
  v_exp_f32 v65, v65
  v_exp_f32 v66, v66
  v_exp_f32 v67, v67
  s_mov_b64 exec, s[34:35]
  buffer_load_dwordx4 a[150:153], v5, s[4:7], s36 offen offset:320 sc1
  s_mov_b64 exec, -1
  v_cvt_pk_bf16_f32 v224, v52, v56
  v_cvt_pk_bf16_f32 v225, v60, v64
  v_cvt_pk_bf16_f32 v226, v53, v57
  v_cvt_pk_bf16_f32 v227, v61, v65
  v_cvt_pk_bf16_f32 v228, v54, v58
  v_cvt_pk_bf16_f32 v229, v62, v66
  v_cvt_pk_bf16_f32 v230, v55, v59
  v_cvt_pk_bf16_f32 v231, v63, v67
  v_mfma_f32_32x32x16_bf16 v[196:211], a[34:37], v[224:227], v[196:211]
  s_nop 0
  v_mfma_f32_32x32x16_bf16 v[196:211], a[38:41], v[228:231], v[196:211]
  s_add_u32 s36, s46, s33
  s_mov_b64 exec, s[34:35]
  buffer_load_dwordx4 a[160:163], v4, s[4:7], s36 offen offset:320 sc1
  s_mov_b64 exec, -1
  v_sub_f32 v68, v68, v16
  v_sub_f32 v69, v69, v16
  v_sub_f32 v70, v70, v16
  v_sub_f32 v71, v71, v16
  v_sub_f32 v72, v72, v16
  v_sub_f32 v73, v73, v16
  v_sub_f32 v74, v74, v16
  v_sub_f32 v75, v75, v16
  v_sub_f32 v76, v76, v16
  v_sub_f32 v77, v77, v16
  v_sub_f32 v78, v78, v16
  v_sub_f32 v79, v79, v16
  v_sub_f32 v80, v80, v16
  v_sub_f32 v81, v81, v16
  v_sub_f32 v82, v82, v16
  v_sub_f32 v83, v83, v16
  s_mov_b64 exec, s[34:35]
  buffer_load_dwordx4 a[164:167], v5, s[4:7], s36 offen offset:320 sc1
  s_mov_b64 exec, -1
  v_exp_f32 v68, v68
  v_exp_f32 v69, v69
  v_exp_f32 v70, v70
  v_exp_f32 v71, v71
  v_exp_f32 v72, v72
  v_exp_f32 v73, v73
  v_exp_f32 v74, v74
  v_exp_f32 v75, v75
  s_add_u32 s36, s47, s33
  s_mov_b64 exec, s[34:35]
  buffer_load_dwordx4 a[174:177], v4, s[4:7], s36 offen offset:320 sc1
  s_mov_b64 exec, -1
  v_exp_f32 v76, v76
  v_exp_f32 v77, v77
  v_exp_f32 v78, v78
  v_exp_f32 v79, v79
  v_exp_f32 v80, v80
  v_exp_f32 v81, v81
  v_exp_f32 v82, v82
  v_exp_f32 v83, v83
  s_mov_b64 exec, s[34:35]
  buffer_load_dwordx4 a[178:181], v5, s[4:7], s36 offen offset:320 sc1
  s_mov_b64 exec, -1
  v_cvt_pk_bf16_f32 v232, v68, v72
  v_cvt_pk_bf16_f32 v233, v76, v80
  v_cvt_pk_bf16_f32 v234, v69, v73
  v_cvt_pk_bf16_f32 v235, v77, v81
  v_cvt_pk_bf16_f32 v236, v70, v74
  v_cvt_pk_bf16_f32 v237, v78, v82
  v_cvt_pk_bf16_f32 v238, v71, v75
  v_cvt_pk_bf16_f32 v239, v79, v83
  v_mfma_f32_32x32x16_bf16 v[196:211], a[48:51], v[232:235], v[196:211]
  s_nop 0
  v_mfma_f32_32x32x16_bf16 v[196:211], a[52:55], v[236:239], v[196:211]
  s_add_u32 s36, s48, s33
  s_mov_b64 exec, s[34:35]
  buffer_load_dwordx4 a[188:191], v4, s[4:7], s36 offen offset:320 sc1
  s_mov_b64 exec, -1
  v_sub_f32 v84, v84, v16
  v_sub_f32 v85, v85, v16
  v_sub_f32 v86, v86, v16
  v_sub_f32 v87, v87, v16
  v_sub_f32 v88, v88, v16
  v_sub_f32 v89, v89, v16
  v_sub_f32 v90, v90, v16
  v_sub_f32 v91, v91, v16
  v_sub_f32 v92, v92, v16
  v_sub_f32 v93, v93, v16
  v_sub_f32 v94, v94, v16
  v_sub_f32 v95, v95, v16
  v_sub_f32 v96, v96, v16
  v_sub_f32 v97, v97, v16
  v_sub_f32 v98, v98, v16
  v_sub_f32 v99, v99, v16
  s_mov_b64 exec, s[34:35]
  buffer_load_dwordx4 a[192:195], v5, s[4:7], s36 offen offset:320 sc1
  s_mov_b64 exec, -1
  v_exp_f32 v84, v84
  v_exp_f32 v85, v85
  v_exp_f32 v86, v86
  v_exp_f32 v87, v87
  v_exp_f32 v88, v88
  v_exp_f32 v89, v89
  v_exp_f32 v90, v90
  v_exp_f32 v91, v91
  s_add_u32 s36, s49, s33
  s_mov_b64 exec, s[34:35]
  buffer_load_dwordx4 a[202:205], v4, s[4:7], s36 offen offset:320 sc1
  s_mov_b64 exec, -1
  v_exp_f32 v92, v92
  v_exp_f32 v93, v93
  v_exp_f32 v94, v94
  v_exp_f32 v95, v95
  v_exp_f32 v96, v96
  v_exp_f32 v97, v97
  v_exp_f32 v98, v98
  v_exp_f32 v99, v99
  s_mov_b64 exec, s[34:35]
  buffer_load_dwordx4 a[206:209], v5, s[4:7], s36 offen offset:320 sc1
  s_mov_b64 exec, -1
  v_cvt_pk_bf16_f32 v224, v84, v88
  v_cvt_pk_bf16_f32 v225, v92, v96
  v_cvt_pk_bf16_f32 v226, v85, v89
  v_cvt_pk_bf16_f32 v227, v93, v97
  v_cvt_pk_bf16_f32 v228, v86, v90
  v_cvt_pk_bf16_f32 v229, v94, v98
  v_cvt_pk_bf16_f32 v230, v87, v91
  v_cvt_pk_bf16_f32 v231, v95, v99
  v_mfma_f32_32x32x16_bf16 v[196:211], a[62:65], v[224:227], v[196:211]
  s_nop 0
  v_mfma_f32_32x32x16_bf16 v[196:211], a[66:69], v[228:231], v[196:211]
  s_add_u32 s36, s50, s33
  s_mov_b64 exec, s[34:35]
  buffer_load_dwordx4 a[216:219], v4, s[4:7], s36 offen offset:320 sc1
  s_mov_b64 exec, -1
  v_sub_f32 v100, v100, v16
  v_sub_f32 v101, v101, v16
  v_sub_f32 v102, v102, v16
  v_sub_f32 v103, v103, v16
  v_sub_f32 v104, v104, v16
  v_sub_f32 v105, v105, v16
  v_sub_f32 v106, v106, v16
  v_sub_f32 v107, v107, v16
  v_sub_f32 v108, v108, v16
  v_sub_f32 v109, v109, v16
  v_sub_f32 v110, v110, v16
  v_sub_f32 v111, v111, v16
  v_sub_f32 v112, v112, v16
  v_sub_f32 v113, v113, v16
  v_sub_f32 v114, v114, v16
  v_sub_f32 v115, v115, v16
  s_mov_b64 exec, s[34:35]
  buffer_load_dwordx4 a[220:223], v5, s[4:7], s36 offen offset:320 sc1
  s_mov_b64 exec, -1
  v_exp_f32 v100, v100
  v_exp_f32 v101, v101
  v_exp_f32 v102, v102
  v_exp_f32 v103, v103
  v_exp_f32 v104, v104
  v_exp_f32 v105, v105
  v_exp_f32 v106, v106
  v_exp_f32 v107, v107
  s_add_u32 s36, s51, s33
  s_mov_b64 exec, s[34:35]
  buffer_load_dwordx4 a[230:233], v4, s[4:7], s36 offen offset:320 sc1
  s_mov_b64 exec, -1
  v_exp_f32 v108, v108
  v_exp_f32 v109, v109
  v_exp_f32 v110, v110
  v_exp_f32 v111, v111
  v_exp_f32 v112, v112
  v_exp_f32 v113, v113
  v_exp_f32 v114, v114
  v_exp_f32 v115, v115
  s_mov_b64 exec, s[34:35]
  buffer_load_dwordx4 a[234:237], v5, s[4:7], s36 offen offset:320 sc1
  s_mov_b64 exec, -1
  v_cvt_pk_bf16_f32 v232, v100, v104
  v_cvt_pk_bf16_f32 v233, v108, v112
  v_cvt_pk_bf16_f32 v234, v101, v105
  v_cvt_pk_bf16_f32 v235, v109, v113
  v_cvt_pk_bf16_f32 v236, v102, v106
  v_cvt_pk_bf16_f32 v237, v110, v114
  v_cvt_pk_bf16_f32 v238, v103, v107
  v_cvt_pk_bf16_f32 v239, v111, v115
  v_mfma_f32_32x32x16_bf16 v[196:211], a[76:79], v[232:235], v[196:211]
  s_nop 0
  v_mfma_f32_32x32x16_bf16 v[196:211], a[80:83], v[236:239], v[196:211]
  s_add_u32 s36, s52, s33
  s_mov_b64 exec, s[34:35]
  buffer_load_dwordx4 a[244:247], v4, s[4:7], s36 offen offset:320 sc1
  s_mov_b64 exec, -1
  v_sub_f32 v116, v116, v16
  v_sub_f32 v117, v117, v16
  v_sub_f32 v118, v118, v16
  v_sub_f32 v119, v119, v16
  v_sub_f32 v120, v120, v16
  v_sub_f32 v121, v121, v16
  v_sub_f32 v122, v122, v16
  v_sub_f32 v123, v123, v16
  v_sub_f32 v124, v124, v16
  v_sub_f32 v125, v125, v16
  v_sub_f32 v126, v126, v16
  v_sub_f32 v127, v127, v16
  v_sub_f32 v128, v128, v16
  v_sub_f32 v129, v129, v16
  v_sub_f32 v130, v130, v16
  v_sub_f32 v131, v131, v16
  s_mov_b64 exec, s[34:35]
  buffer_load_dwordx4 a[248:251], v5, s[4:7], s36 offen offset:320 sc1
  s_mov_b64 exec, -1
  v_exp_f32 v116, v116
  v_exp_f32 v117, v117
  v_exp_f32 v118, v118
  v_exp_f32 v119, v119
  v_exp_f32 v120, v120
  v_exp_f32 v121, v121
  v_exp_f32 v122, v122
  v_exp_f32 v123, v123
  v_exp_f32 v124, v124
  v_exp_f32 v125, v125
  v_exp_f32 v126, v126
  v_exp_f32 v127, v127
  v_exp_f32 v128, v128
  v_exp_f32 v129, v129
  v_exp_f32 v130, v130
  v_exp_f32 v131, v131
  v_cvt_pk_bf16_f32 v224, v116, v120
  v_cvt_pk_bf16_f32 v225, v124, v128
  v_cvt_pk_bf16_f32 v226, v117, v121
  v_cvt_pk_bf16_f32 v227, v125, v129
  v_cvt_pk_bf16_f32 v228, v118, v122
  v_cvt_pk_bf16_f32 v229, v126, v130
  v_cvt_pk_bf16_f32 v230, v119, v123
  v_cvt_pk_bf16_f32 v231, v127, v131
  v_mfma_f32_32x32x16_bf16 v[196:211], a[90:93], v[224:227], v[196:211]
  s_nop 0
  v_mfma_f32_32x32x16_bf16 v[196:211], a[94:97], v[228:231], v[196:211]
  v_sub_f32 v132, v132, v16
  v_sub_f32 v133, v133, v16
  v_sub_f32 v134, v134, v16
  v_sub_f32 v135, v135, v16
  v_sub_f32 v136, v136, v16
  v_sub_f32 v137, v137, v16
  v_sub_f32 v138, v138, v16
  v_sub_f32 v139, v139, v16
  v_sub_f32 v140, v140, v16
  v_sub_f32 v141, v141, v16
  v_sub_f32 v142, v142, v16
  v_sub_f32 v143, v143, v16
  v_sub_f32 v144, v144, v16
  v_sub_f32 v145, v145, v16
  v_sub_f32 v146, v146, v16
  v_sub_f32 v147, v147, v16
  v_exp_f32 v132, v132
  v_exp_f32 v133, v133
  v_exp_f32 v134, v134
  v_exp_f32 v135, v135
  v_exp_f32 v136, v136
  v_exp_f32 v137, v137
  v_exp_f32 v138, v138
  v_exp_f32 v139, v139
  v_exp_f32 v140, v140
  v_exp_f32 v141, v141
  v_exp_f32 v142, v142
  v_exp_f32 v143, v143
  v_exp_f32 v144, v144
  v_exp_f32 v145, v145
  v_exp_f32 v146, v146
  v_exp_f32 v147, v147
  v_cvt_pk_bf16_f32 v232, v132, v136
  v_cvt_pk_bf16_f32 v233, v140, v144
  v_cvt_pk_bf16_f32 v234, v133, v137
  v_cvt_pk_bf16_f32 v235, v141, v145
  v_cvt_pk_bf16_f32 v236, v134, v138
  v_cvt_pk_bf16_f32 v237, v142, v146
  v_cvt_pk_bf16_f32 v238, v135, v139
  v_cvt_pk_bf16_f32 v239, v143, v147
  v_mfma_f32_32x32x16_bf16 v[196:211], a[104:107], v[232:235], v[196:211]
  s_nop 0
  v_mfma_f32_32x32x16_bf16 v[196:211], a[108:111], v[236:239], v[196:211]
  v_sub_f32 v148, v148, v16
  v_sub_f32 v149, v149, v16
  v_sub_f32 v150, v150, v16
  v_sub_f32 v151, v151, v16
  v_sub_f32 v152, v152, v16
  v_sub_f32 v153, v153, v16
  v_sub_f32 v154, v154, v16
  v_sub_f32 v155, v155, v16
  v_sub_f32 v156, v156, v16
  v_sub_f32 v157, v157, v16
  v_sub_f32 v158, v158, v16
  v_sub_f32 v159, v159, v16
  v_sub_f32 v160, v160, v16
  v_sub_f32 v161, v161, v16
  v_sub_f32 v162, v162, v16
  v_sub_f32 v163, v163, v16
  v_exp_f32 v148, v148
  v_exp_f32 v149, v149
  v_exp_f32 v150, v150
  v_exp_f32 v151, v151
  v_exp_f32 v152, v152
  v_exp_f32 v153, v153
  v_exp_f32 v154, v154
  v_exp_f32 v155, v155
  v_exp_f32 v156, v156
  v_exp_f32 v157, v157
  v_exp_f32 v158, v158
  v_exp_f32 v159, v159
  v_exp_f32 v160, v160
  v_exp_f32 v161, v161
  v_exp_f32 v162, v162
  v_exp_f32 v163, v163
  v_cvt_pk_bf16_f32 v224, v148, v152
  v_cvt_pk_bf16_f32 v225, v156, v160
  v_cvt_pk_bf16_f32 v226, v149, v153
  v_cvt_pk_bf16_f32 v227, v157, v161
  v_cvt_pk_bf16_f32 v228, v150, v154
  v_cvt_pk_bf16_f32 v229, v158, v162
  v_cvt_pk_bf16_f32 v230, v151, v155
  v_cvt_pk_bf16_f32 v231, v159, v163
  v_mfma_f32_32x32x16_bf16 v[196:211], a[118:121], v[224:227], v[196:211]
  s_nop 0
  v_mfma_f32_32x32x16_bf16 v[196:211], a[122:125], v[228:231], v[196:211]
  s_nop 11
  v_rcp_f32 v16, v208
  s_nop 0
  v_mul_f32 v196, v196, v16
  v_mul_f32 v197, v197, v16
  v_mul_f32 v198, v198, v16
  v_mul_f32 v199, v199, v16
  v_mul_f32 v200, v200, v16
  v_mul_f32 v201, v201, v16
  v_mul_f32 v202, v202, v16
  v_mul_f32 v203, v203, v16
  v_mul_f32 v204, v204, v16
  v_mul_f32 v205, v205, v16
  v_mul_f32 v206, v206, v16
  v_mul_f32 v207, v207, v16
  v_cvt_pk_bf16_f32 v240, v196, v197
  v_cvt_pk_bf16_f32 v241, v198, v199
  v_cvt_pk_bf16_f32 v242, v200, v201
  v_cvt_pk_bf16_f32 v243, v202, v203
  v_cvt_pk_bf16_f32 v244, v204, v205
  v_cvt_pk_bf16_f32 v245, v206, v207
  buffer_store_dwordx4 v[240:243], v1, s[4:7], s16 offen offset:0 sc1
  s_waitcnt vmcnt(1)
  v_mfma_f32_32x32x16_bf16 v[20:35], a[126:129], v[218:221], v[180:195]
  v_mfma_f32_32x32x8_bf16 v[20:35], a[130:131], v[222:223], v[20:35]
  s_add_u32 s36, s52, s32
  s_add_u32 s36, s36, 67111424
  buffer_load_dwordx4 v[212:215], v1, s[4:7], s36 offen offset:0 sc1
  v_mfma_f32_32x32x16_bf16 v[36:51], a[140:143], v[218:221], 0
  v_mfma_f32_32x32x8_bf16 v[36:51], a[144:145], v[222:223], v[36:51]
  buffer_load_dwordx2 v[216:217], v3, s[4:7], s36 offen offset:1024 sc1
  v_mfma_f32_32x32x16_bf16 v[52:67], a[154:157], v[218:221], 0
  v_mfma_f32_32x32x8_bf16 v[52:67], a[158:159], v[222:223], v[52:67]
  s_add_u32 s36, s44, s32
  s_add_u32 s36, s36, 70257152
  buffer_load_dwordx4 a[0:3], v1, s[4:7], s36 offen offset:0 sc1
  v_mfma_f32_32x32x16_bf16 v[68:83], a[168:171], v[218:221], 0
  v_mfma_f32_32x32x8_bf16 v[68:83], a[172:173], v[222:223], v[68:83]
  buffer_load_dwordx2 a[4:5], v3, s[4:7], s36 offen offset:1024 sc1
  v_mfma_f32_32x32x16_bf16 v[84:99], a[182:185], v[218:221], 0
  v_mfma_f32_32x32x8_bf16 v[84:99], a[186:187], v[222:223], v[84:99]
  s_add_u32 s36, s45, s32
  s_add_u32 s36, s36, 70257152
  buffer_load_dwordx4 a[14:17], v1, s[4:7], s36 offen offset:0 sc1
  v_mfma_f32_32x32x16_bf16 v[100:115], a[196:199], v[218:221], 0
  v_mfma_f32_32x32x8_bf16 v[100:115], a[200:201], v[222:223], v[100:115]
  buffer_load_dwordx2 a[18:19], v3, s[4:7], s36 offen offset:1024 sc1
  v_mfma_f32_32x32x16_bf16 v[116:131], a[210:213], v[218:221], 0
  v_mfma_f32_32x32x8_bf16 v[116:131], a[214:215], v[222:223], v[116:131]
  s_add_u32 s36, s46, s32
  s_add_u32 s36, s36, 70257152
  buffer_load_dwordx4 a[28:31], v1, s[4:7], s36 offen offset:0 sc1
  v_mfma_f32_32x32x16_bf16 v[132:147], a[224:227], v[218:221], 0
  v_mfma_f32_32x32x8_bf16 v[132:147], a[228:229], v[222:223], v[132:147]
  buffer_load_dwordx2 a[32:33], v3, s[4:7], s36 offen offset:1024 sc1
  v_mfma_f32_32x32x16_bf16 v[148:163], a[238:241], v[218:221], v[164:179]
  v_mfma_f32_32x32x8_bf16 v[148:163], a[242:243], v[222:223], v[148:163]
  s_add_u32 s36, s47, s32
  s_add_u32 s36, s36, 70257152
  buffer_load_dwordx4 a[42:45], v1, s[4:7], s36 offen offset:0 sc1
  s_cmp_ge_u32 s28, 8
  s_cbranch_scc1 L_full_79
  v_mov_b32 v20, 0xf149f2ca
  v_mov_b32 v21, 0xf149f2ca
  v_mov_b32 v22, 0xf149f2ca
  v_mov_b32 v23, 0xf149f2ca
  v_mov_b32 v24, 0xf149f2ca
  v_mov_b32 v25, 0xf149f2ca
  v_mov_b32 v26, 0xf149f2ca
  v_mov_b32 v27, 0xf149f2ca
  v_mov_b32 v28, 0xf149f2ca
  v_mov_b32 v29, 0xf149f2ca
  v_mov_b32 v30, 0xf149f2ca
  v_mov_b32 v31, 0xf149f2ca
  v_mov_b32 v32, 0xf149f2ca
  v_mov_b32 v33, 0xf149f2ca
  v_mov_b32 v34, 0xf149f2ca
  v_mov_b32 v35, 0xf149f2ca
  s_cmp_ge_u32 s28, 7
  s_cbranch_scc1 L_full_79
  v_mov_b32 v36, 0xf149f2ca
  v_mov_b32 v37, 0xf149f2ca
  v_mov_b32 v38, 0xf149f2ca
  v_mov_b32 v39, 0xf149f2ca
  v_mov_b32 v40, 0xf149f2ca
  v_mov_b32 v41, 0xf149f2ca
  v_mov_b32 v42, 0xf149f2ca
  v_mov_b32 v43, 0xf149f2ca
  v_mov_b32 v44, 0xf149f2ca
  v_mov_b32 v45, 0xf149f2ca
  v_mov_b32 v46, 0xf149f2ca
  v_mov_b32 v47, 0xf149f2ca
  v_mov_b32 v48, 0xf149f2ca
  v_mov_b32 v49, 0xf149f2ca
  v_mov_b32 v50, 0xf149f2ca
  v_mov_b32 v51, 0xf149f2ca
  s_cmp_ge_u32 s28, 6
  s_cbranch_scc1 L_full_79
  v_mov_b32 v52, 0xf149f2ca
  v_mov_b32 v53, 0xf149f2ca
  v_mov_b32 v54, 0xf149f2ca
  v_mov_b32 v55, 0xf149f2ca
  v_mov_b32 v56, 0xf149f2ca
  v_mov_b32 v57, 0xf149f2ca
  v_mov_b32 v58, 0xf149f2ca
  v_mov_b32 v59, 0xf149f2ca
  v_mov_b32 v60, 0xf149f2ca
  v_mov_b32 v61, 0xf149f2ca
  v_mov_b32 v62, 0xf149f2ca
  v_mov_b32 v63, 0xf149f2ca
  v_mov_b32 v64, 0xf149f2ca
  v_mov_b32 v65, 0xf149f2ca
  v_mov_b32 v66, 0xf149f2ca
  v_mov_b32 v67, 0xf149f2ca
  s_cmp_ge_u32 s28, 5
  s_cbranch_scc1 L_full_79
  v_mov_b32 v68, 0xf149f2ca
  v_mov_b32 v69, 0xf149f2ca
  v_mov_b32 v70, 0xf149f2ca
  v_mov_b32 v71, 0xf149f2ca
  v_mov_b32 v72, 0xf149f2ca
  v_mov_b32 v73, 0xf149f2ca
  v_mov_b32 v74, 0xf149f2ca
  v_mov_b32 v75, 0xf149f2ca
  v_mov_b32 v76, 0xf149f2ca
  v_mov_b32 v77, 0xf149f2ca
  v_mov_b32 v78, 0xf149f2ca
  v_mov_b32 v79, 0xf149f2ca
  v_mov_b32 v80, 0xf149f2ca
  v_mov_b32 v81, 0xf149f2ca
  v_mov_b32 v82, 0xf149f2ca
  v_mov_b32 v83, 0xf149f2ca
  s_cmp_ge_u32 s28, 4
  s_cbranch_scc1 L_full_79
  v_mov_b32 v84, 0xf149f2ca
  v_mov_b32 v85, 0xf149f2ca
  v_mov_b32 v86, 0xf149f2ca
  v_mov_b32 v87, 0xf149f2ca
  v_mov_b32 v88, 0xf149f2ca
  v_mov_b32 v89, 0xf149f2ca
  v_mov_b32 v90, 0xf149f2ca
  v_mov_b32 v91, 0xf149f2ca
  v_mov_b32 v92, 0xf149f2ca
  v_mov_b32 v93, 0xf149f2ca
  v_mov_b32 v94, 0xf149f2ca
  v_mov_b32 v95, 0xf149f2ca
  v_mov_b32 v96, 0xf149f2ca
  v_mov_b32 v97, 0xf149f2ca
  v_mov_b32 v98, 0xf149f2ca
  v_mov_b32 v99, 0xf149f2ca
  s_cmp_ge_u32 s28, 3
  s_cbranch_scc1 L_full_79
  v_mov_b32 v100, 0xf149f2ca
  v_mov_b32 v101, 0xf149f2ca
  v_mov_b32 v102, 0xf149f2ca
  v_mov_b32 v103, 0xf149f2ca
  v_mov_b32 v104, 0xf149f2ca
  v_mov_b32 v105, 0xf149f2ca
  v_mov_b32 v106, 0xf149f2ca
  v_mov_b32 v107, 0xf149f2ca
  v_mov_b32 v108, 0xf149f2ca
  v_mov_b32 v109, 0xf149f2ca
  v_mov_b32 v110, 0xf149f2ca
  v_mov_b32 v111, 0xf149f2ca
  v_mov_b32 v112, 0xf149f2ca
  v_mov_b32 v113, 0xf149f2ca
  v_mov_b32 v114, 0xf149f2ca
  v_mov_b32 v115, 0xf149f2ca
  s_cmp_ge_u32 s28, 2
  s_cbranch_scc1 L_full_79
  v_mov_b32 v116, 0xf149f2ca
  v_mov_b32 v117, 0xf149f2ca
  v_mov_b32 v118, 0xf149f2ca
  v_mov_b32 v119, 0xf149f2ca
  v_mov_b32 v120, 0xf149f2ca
  v_mov_b32 v121, 0xf149f2ca
  v_mov_b32 v122, 0xf149f2ca
  v_mov_b32 v123, 0xf149f2ca
  v_mov_b32 v124, 0xf149f2ca
  v_mov_b32 v125, 0xf149f2ca
  v_mov_b32 v126, 0xf149f2ca
  v_mov_b32 v127, 0xf149f2ca
  v_mov_b32 v128, 0xf149f2ca
  v_mov_b32 v129, 0xf149f2ca
  v_mov_b32 v130, 0xf149f2ca
  v_mov_b32 v131, 0xf149f2ca
  s_cmp_ge_u32 s28, 1
  s_cbranch_scc1 L_full_79
  v_mov_b32 v132, 0xf149f2ca
  v_mov_b32 v133, 0xf149f2ca
  v_mov_b32 v134, 0xf149f2ca
  v_mov_b32 v135, 0xf149f2ca
  v_mov_b32 v136, 0xf149f2ca
  v_mov_b32 v137, 0xf149f2ca
  v_mov_b32 v138, 0xf149f2ca
  v_mov_b32 v139, 0xf149f2ca
  v_mov_b32 v140, 0xf149f2ca
  v_mov_b32 v141, 0xf149f2ca
  v_mov_b32 v142, 0xf149f2ca
  v_mov_b32 v143, 0xf149f2ca
  v_mov_b32 v144, 0xf149f2ca
  v_mov_b32 v145, 0xf149f2ca
  v_mov_b32 v146, 0xf149f2ca
  v_mov_b32 v147, 0xf149f2ca
L_full_79:
  v_max_f32 v16, v20, v21
  v_max3_f32 v16, v16, v22, v23
  v_max3_f32 v16, v16, v24, v25
  v_max3_f32 v16, v16, v26, v27
  v_max3_f32 v16, v16, v28, v29
  v_max3_f32 v16, v16, v30, v31
  v_max3_f32 v16, v16, v32, v33
  v_max3_f32 v16, v16, v34, v35
  v_max3_f32 v16, v16, v36, v37
  v_max3_f32 v16, v16, v38, v39
  v_max3_f32 v16, v16, v40, v41
  v_max3_f32 v16, v16, v42, v43
  v_max3_f32 v16, v16, v44, v45
  v_max3_f32 v16, v16, v46, v47
  v_max3_f32 v16, v16, v48, v49
  v_max3_f32 v16, v16, v50, v51
  v_max3_f32 v16, v16, v52, v53
  buffer_load_dwordx2 a[46:47], v3, s[4:7], s36 offen offset:1024 sc1
  v_max3_f32 v16, v16, v54, v55
  v_max3_f32 v16, v16, v56, v57
  v_max3_f32 v16, v16, v58, v59
  v_max3_f32 v16, v16, v60, v61
  v_max3_f32 v16, v16, v62, v63
  v_max3_f32 v16, v16, v64, v65
  v_max3_f32 v16, v16, v66, v67
  v_max3_f32 v16, v16, v68, v69
  v_max3_f32 v16, v16, v70, v71
  v_max3_f32 v16, v16, v72, v73
  v_max3_f32 v16, v16, v74, v75
  v_max3_f32 v16, v16, v76, v77
  v_max3_f32 v16, v16, v78, v79
  v_max3_f32 v16, v16, v80, v81
  v_max3_f32 v16, v16, v82, v83
  v_max3_f32 v16, v16, v84, v85
  s_add_u32 s36, s48, s32
  s_add_u32 s36, s36, 70257152
  buffer_load_dwordx4 a[56:59], v1, s[4:7], s36 offen offset:0 sc1
  v_max3_f32 v16, v16, v86, v87
  v_max3_f32 v16, v16, v88, v89
  v_max3_f32 v16, v16, v90, v91
  v_max3_f32 v16, v16, v92, v93
  v_max3_f32 v16, v16, v94, v95
  v_max3_f32 v16, v16, v96, v97
  v_max3_f32 v16, v16, v98, v99
  v_max3_f32 v16, v16, v100, v101
  v_max3_f32 v16, v16, v102, v103
  v_max3_f32 v16, v16, v104, v105
  v_max3_f32 v16, v16, v106, v107
  v_max3_f32 v16, v16, v108, v109
  v_max3_f32 v16, v16, v110, v111
  v_max3_f32 v16, v16, v112, v113
  v_max3_f32 v16, v16, v114, v115
  v_max3_f32 v16, v16, v116, v117
  buffer_load_dwordx2 a[60:61], v3, s[4:7], s36 offen offset:1024 sc1
  v_max3_f32 v16, v16, v118, v119
  v_max3_f32 v16, v16, v120, v121
  v_max3_f32 v16, v16, v122, v123
  v_max3_f32 v16, v16, v124, v125
  v_max3_f32 v16, v16, v126, v127
  v_max3_f32 v16, v16, v128, v129
  v_max3_f32 v16, v16, v130, v131
  v_max3_f32 v16, v16, v132, v133
  v_max3_f32 v16, v16, v134, v135
  v_max3_f32 v16, v16, v136, v137
  v_max3_f32 v16, v16, v138, v139
  v_max3_f32 v16, v16, v140, v141
  v_max3_f32 v16, v16, v142, v143
  v_max3_f32 v16, v16, v144, v145
  v_max3_f32 v16, v16, v146, v147
  v_max3_f32 v16, v16, v148, v149
  s_add_u32 s36, s49, s32
  s_add_u32 s36, s36, 70257152
  buffer_load_dwordx4 a[70:73], v1, s[4:7], s36 offen offset:0 sc1
  v_max3_f32 v16, v16, v150, v151
  v_max3_f32 v16, v16, v152, v153
  v_max3_f32 v16, v16, v154, v155
  v_max3_f32 v16, v16, v156, v157
  v_max3_f32 v16, v16, v158, v159
  v_max3_f32 v16, v16, v160, v161
  v_max3_f32 v16, v16, v162, v163
  v_mov_b32 v17, v16
  s_nop 1
  v_permlane32_swap_b32 v16, v17
  v_max_f32 v16, v16, v17
  v_sub_f32 v20, v20, v16
  v_sub_f32 v21, v21, v16
  v_sub_f32 v22, v22, v16
  v_sub_f32 v23, v23, v16
  v_sub_f32 v24, v24, v16
  v_sub_f32 v25, v25, v16
  v_sub_f32 v26, v26, v16
  v_sub_f32 v27, v27, v16
  v_sub_f32 v28, v28, v16
  v_sub_f32 v29, v29, v16
  v_sub_f32 v30, v30, v16
  v_sub_f32 v31, v31, v16
  v_sub_f32 v32, v32, v16
  v_sub_f32 v33, v33, v16
  v_sub_f32 v34, v34, v16
  v_sub_f32 v35, v35, v16
  buffer_load_dwordx2 a[74:75], v3, s[4:7], s36 offen offset:1024 sc1
  v_exp_f32 v20, v20
  v_exp_f32 v21, v21
  v_exp_f32 v22, v22
  v_exp_f32 v23, v23
  v_exp_f32 v24, v24
  v_exp_f32 v25, v25
  v_exp_f32 v26, v26
  v_exp_f32 v27, v27
  s_add_u32 s36, s50, s32
  s_add_u32 s36, s36, 70257152
  buffer_load_dwordx4 a[84:87], v1, s[4:7], s36 offen offset:0 sc1
  v_exp_f32 v28, v28
  v_exp_f32 v29, v29
  v_exp_f32 v30, v30
  v_exp_f32 v31, v31
  v_exp_f32 v32, v32
  v_exp_f32 v33, v33
  v_exp_f32 v34, v34
  v_exp_f32 v35, v35
  buffer_load_dwordx2 a[88:89], v3, s[4:7], s36 offen offset:1024 sc1
  v_cvt_pk_bf16_f32 v224, v20, v24
  v_cvt_pk_bf16_f32 v225, v28, v32
  v_cvt_pk_bf16_f32 v226, v21, v25
  v_cvt_pk_bf16_f32 v227, v29, v33
  v_cvt_pk_bf16_f32 v228, v22, v26
  v_cvt_pk_bf16_f32 v229, v30, v34
  v_cvt_pk_bf16_f32 v230, v23, v27
  v_cvt_pk_bf16_f32 v231, v31, v35
  v_mfma_f32_32x32x16_bf16 v[196:211], a[132:135], v[224:227], 0
  s_nop 0
  v_mfma_f32_32x32x16_bf16 v[196:211], a[136:139], v[228:231], v[196:211]
  s_add_u32 s36, s51, s32
  s_add_u32 s36, s36, 70257152
  buffer_load_dwordx4 a[98:101], v1, s[4:7], s36 offen offset:0 sc1
  v_sub_f32 v36, v36, v16
  v_sub_f32 v37, v37, v16
  v_sub_f32 v38, v38, v16
  v_sub_f32 v39, v39, v16
  v_sub_f32 v40, v40, v16
  v_sub_f32 v41, v41, v16
  v_sub_f32 v42, v42, v16
  v_sub_f32 v43, v43, v16
  v_sub_f32 v44, v44, v16
  v_sub_f32 v45, v45, v16
  v_sub_f32 v46, v46, v16
  v_sub_f32 v47, v47, v16
  v_sub_f32 v48, v48, v16
  v_sub_f32 v49, v49, v16
  v_sub_f32 v50, v50, v16
  v_sub_f32 v51, v51, v16
  buffer_load_dwordx2 a[102:103], v3, s[4:7], s36 offen offset:1024 sc1
  v_exp_f32 v36, v36
  v_exp_f32 v37, v37
  v_exp_f32 v38, v38
  v_exp_f32 v39, v39
  v_exp_f32 v40, v40
  v_exp_f32 v41, v41
  v_exp_f32 v42, v42
  v_exp_f32 v43, v43
  s_add_u32 s36, s52, s32
  s_add_u32 s36, s36, 70257152
  buffer_load_dwordx4 a[112:115], v1, s[4:7], s36 offen offset:0 sc1
  v_exp_f32 v44, v44
  v_exp_f32 v45, v45
  v_exp_f32 v46, v46
  v_exp_f32 v47, v47
  v_exp_f32 v48, v48
  v_exp_f32 v49, v49
  v_exp_f32 v50, v50
  v_exp_f32 v51, v51
  buffer_load_dwordx2 a[116:117], v3, s[4:7], s36 offen offset:1024 sc1
  v_cvt_pk_bf16_f32 v232, v36, v40
  v_cvt_pk_bf16_f32 v233, v44, v48
  v_cvt_pk_bf16_f32 v234, v37, v41
  v_cvt_pk_bf16_f32 v235, v45, v49
  v_cvt_pk_bf16_f32 v236, v38, v42
  v_cvt_pk_bf16_f32 v237, v46, v50
  v_cvt_pk_bf16_f32 v238, v39, v43
  v_cvt_pk_bf16_f32 v239, v47, v51
  v_mfma_f32_32x32x16_bf16 v[196:211], a[146:149], v[232:235], v[196:211]
  s_nop 0
  v_mfma_f32_32x32x16_bf16 v[196:211], a[150:153], v[236:239], v[196:211]
  s_add_u32 s36, s44, s33
  s_mov_b64 exec, s[34:35]
  buffer_load_dwordx4 a[6:9], v4, s[4:7], s36 offen offset:640 sc1
  s_mov_b64 exec, -1
  v_sub_f32 v52, v52, v16
  v_sub_f32 v53, v53, v16
  v_sub_f32 v54, v54, v16
  v_sub_f32 v55, v55, v16
  v_sub_f32 v56, v56, v16
  v_sub_f32 v57, v57, v16
  v_sub_f32 v58, v58, v16
  v_sub_f32 v59, v59, v16
  v_sub_f32 v60, v60, v16
  v_sub_f32 v61, v61, v16
  v_sub_f32 v62, v62, v16
  v_sub_f32 v63, v63, v16
  v_sub_f32 v64, v64, v16
  v_sub_f32 v65, v65, v16
  v_sub_f32 v66, v66, v16
  v_sub_f32 v67, v67, v16
  s_mov_b64 exec, s[34:35]
  buffer_load_dwordx4 a[10:13], v5, s[4:7], s36 offen offset:640 sc1
  s_mov_b64 exec, -1
  v_exp_f32 v52, v52
  v_exp_f32 v53, v53
  v_exp_f32 v54, v54
  v_exp_f32 v55, v55
  v_exp_f32 v56, v56
  v_exp_f32 v57, v57
  v_exp_f32 v58, v58
  v_exp_f32 v59, v59
  s_add_u32 s36, s45, s33
  s_mov_b64 exec, s[34:35]
  buffer_load_dwordx4 a[20:23], v4, s[4:7], s36 offen offset:640 sc1
  s_mov_b64 exec, -1
  v_exp_f32 v60, v60
  v_exp_f32 v61, v61
  v_exp_f32 v62, v62
  v_exp_f32 v63, v63
  v_exp_f32 v64, v64
  v_exp_f32 v65, v65
  v_exp_f32 v66, v66
  v_exp_f32 v67, v67
  s_mov_b64 exec, s[34:35]
  buffer_load_dwordx4 a[24:27], v5, s[4:7], s36 offen offset:640 sc1
  s_mov_b64 exec, -1
  v_cvt_pk_bf16_f32 v224, v52, v56
  v_cvt_pk_bf16_f32 v225, v60, v64
  v_cvt_pk_bf16_f32 v226, v53, v57
  v_cvt_pk_bf16_f32 v227, v61, v65
  v_cvt_pk_bf16_f32 v228, v54, v58
  v_cvt_pk_bf16_f32 v229, v62, v66
  v_cvt_pk_bf16_f32 v230, v55, v59
  v_cvt_pk_bf16_f32 v231, v63, v67
  v_mfma_f32_32x32x16_bf16 v[196:211], a[160:163], v[224:227], v[196:211]
  s_nop 0
  v_mfma_f32_32x32x16_bf16 v[196:211], a[164:167], v[228:231], v[196:211]
  s_add_u32 s36, s46, s33
  s_mov_b64 exec, s[34:35]
  buffer_load_dwordx4 a[34:37], v4, s[4:7], s36 offen offset:640 sc1
  s_mov_b64 exec, -1
  v_sub_f32 v68, v68, v16
  v_sub_f32 v69, v69, v16
  v_sub_f32 v70, v70, v16
  v_sub_f32 v71, v71, v16
  v_sub_f32 v72, v72, v16
  v_sub_f32 v73, v73, v16
  v_sub_f32 v74, v74, v16
  v_sub_f32 v75, v75, v16
  v_sub_f32 v76, v76, v16
  v_sub_f32 v77, v77, v16
  v_sub_f32 v78, v78, v16
  v_sub_f32 v79, v79, v16
  v_sub_f32 v80, v80, v16
  v_sub_f32 v81, v81, v16
  v_sub_f32 v82, v82, v16
  v_sub_f32 v83, v83, v16
  s_mov_b64 exec, s[34:35]
  buffer_load_dwordx4 a[38:41], v5, s[4:7], s36 offen offset:640 sc1
  s_mov_b64 exec, -1
  v_exp_f32 v68, v68
  v_exp_f32 v69, v69
  v_exp_f32 v70, v70
  v_exp_f32 v71, v71
  v_exp_f32 v72, v72
  v_exp_f32 v73, v73
  v_exp_f32 v74, v74
  v_exp_f32 v75, v75
  s_add_u32 s36, s47, s33
  s_mov_b64 exec, s[34:35]
  buffer_load_dwordx4 a[48:51], v4, s[4:7], s36 offen offset:640 sc1
  s_mov_b64 exec, -1
  v_exp_f32 v76, v76
  v_exp_f32 v77, v77
  v_exp_f32 v78, v78
  v_exp_f32 v79, v79
  v_exp_f32 v80, v80
  v_exp_f32 v81, v81
  v_exp_f32 v82, v82
  v_exp_f32 v83, v83
  s_mov_b64 exec, s[34:35]
  buffer_load_dwordx4 a[52:55], v5, s[4:7], s36 offen offset:640 sc1
  s_mov_b64 exec, -1
  v_cvt_pk_bf16_f32 v232, v68, v72
  v_cvt_pk_bf16_f32 v233, v76, v80
  v_cvt_pk_bf16_f32 v234, v69, v73
  v_cvt_pk_bf16_f32 v235, v77, v81
  v_cvt_pk_bf16_f32 v236, v70, v74
  v_cvt_pk_bf16_f32 v237, v78, v82
  v_cvt_pk_bf16_f32 v238, v71, v75
  v_cvt_pk_bf16_f32 v239, v79, v83
  v_mfma_f32_32x32x16_bf16 v[196:211], a[174:177], v[232:235], v[196:211]
  s_nop 0
  v_mfma_f32_32x32x16_bf16 v[196:211], a[178:181], v[236:239], v[196:211]
  s_add_u32 s36, s48, s33
  s_mov_b64 exec, s[34:35]
  buffer_load_dwordx4 a[62:65], v4, s[4:7], s36 offen offset:640 sc1
  s_mov_b64 exec, -1
  v_sub_f32 v84, v84, v16
  v_sub_f32 v85, v85, v16
  v_sub_f32 v86, v86, v16
  v_sub_f32 v87, v87, v16
  v_sub_f32 v88, v88, v16
  v_sub_f32 v89, v89, v16
  v_sub_f32 v90, v90, v16
  v_sub_f32 v91, v91, v16
  v_sub_f32 v92, v92, v16
  v_sub_f32 v93, v93, v16
  v_sub_f32 v94, v94, v16
  v_sub_f32 v95, v95, v16
  v_sub_f32 v96, v96, v16
  v_sub_f32 v97, v97, v16
  v_sub_f32 v98, v98, v16
  v_sub_f32 v99, v99, v16
  s_mov_b64 exec, s[34:35]
  buffer_load_dwordx4 a[66:69], v5, s[4:7], s36 offen offset:640 sc1
  s_mov_b64 exec, -1
  v_exp_f32 v84, v84
  v_exp_f32 v85, v85
  v_exp_f32 v86, v86
  v_exp_f32 v87, v87
  v_exp_f32 v88, v88
  v_exp_f32 v89, v89
  v_exp_f32 v90, v90
  v_exp_f32 v91, v91
  s_add_u32 s36, s49, s33
  s_mov_b64 exec, s[34:35]
  buffer_load_dwordx4 a[76:79], v4, s[4:7], s36 offen offset:640 sc1
  s_mov_b64 exec, -1
  v_exp_f32 v92, v92
  v_exp_f32 v93, v93
  v_exp_f32 v94, v94
  v_exp_f32 v95, v95
  v_exp_f32 v96, v96
  v_exp_f32 v97, v97
  v_exp_f32 v98, v98
  v_exp_f32 v99, v99
  s_mov_b64 exec, s[34:35]
  buffer_load_dwordx4 a[80:83], v5, s[4:7], s36 offen offset:640 sc1
  s_mov_b64 exec, -1
  v_cvt_pk_bf16_f32 v224, v84, v88
  v_cvt_pk_bf16_f32 v225, v92, v96
  v_cvt_pk_bf16_f32 v226, v85, v89
  v_cvt_pk_bf16_f32 v227, v93, v97
  v_cvt_pk_bf16_f32 v228, v86, v90
  v_cvt_pk_bf16_f32 v229, v94, v98
  v_cvt_pk_bf16_f32 v230, v87, v91
  v_cvt_pk_bf16_f32 v231, v95, v99
  v_mfma_f32_32x32x16_bf16 v[196:211], a[188:191], v[224:227], v[196:211]
  s_nop 0
  v_mfma_f32_32x32x16_bf16 v[196:211], a[192:195], v[228:231], v[196:211]
  s_add_u32 s36, s50, s33
  s_mov_b64 exec, s[34:35]
  buffer_load_dwordx4 a[90:93], v4, s[4:7], s36 offen offset:640 sc1
  s_mov_b64 exec, -1
  v_sub_f32 v100, v100, v16
  v_sub_f32 v101, v101, v16
  v_sub_f32 v102, v102, v16
  v_sub_f32 v103, v103, v16
  v_sub_f32 v104, v104, v16
  v_sub_f32 v105, v105, v16
  v_sub_f32 v106, v106, v16
  v_sub_f32 v107, v107, v16
  v_sub_f32 v108, v108, v16
  v_sub_f32 v109, v109, v16
  v_sub_f32 v110, v110, v16
  v_sub_f32 v111, v111, v16
  v_sub_f32 v112, v112, v16
  v_sub_f32 v113, v113, v16
  v_sub_f32 v114, v114, v16
  v_sub_f32 v115, v115, v16
  s_mov_b64 exec, s[34:35]
  buffer_load_dwordx4 a[94:97], v5, s[4:7], s36 offen offset:640 sc1
  s_mov_b64 exec, -1
  v_exp_f32 v100, v100
  v_exp_f32 v101, v101
  v_exp_f32 v102, v102
  v_exp_f32 v103, v103
  v_exp_f32 v104, v104
  v_exp_f32 v105, v105
  v_exp_f32 v106, v106
  v_exp_f32 v107, v107
  s_add_u32 s36, s51, s33
  s_mov_b64 exec, s[34:35]
  buffer_load_dwordx4 a[104:107], v4, s[4:7], s36 offen offset:640 sc1
  s_mov_b64 exec, -1
  v_exp_f32 v108, v108
  v_exp_f32 v109, v109
  v_exp_f32 v110, v110
  v_exp_f32 v111, v111
  v_exp_f32 v112, v112
  v_exp_f32 v113, v113
  v_exp_f32 v114, v114
  v_exp_f32 v115, v115
  s_mov_b64 exec, s[34:35]
  buffer_load_dwordx4 a[108:111], v5, s[4:7], s36 offen offset:640 sc1
  s_mov_b64 exec, -1
  v_cvt_pk_bf16_f32 v232, v100, v104
  v_cvt_pk_bf16_f32 v233, v108, v112
  v_cvt_pk_bf16_f32 v234, v101, v105
  v_cvt_pk_bf16_f32 v235, v109, v113
  v_cvt_pk_bf16_f32 v236, v102, v106
  v_cvt_pk_bf16_f32 v237, v110, v114
  v_cvt_pk_bf16_f32 v238, v103, v107
  v_cvt_pk_bf16_f32 v239, v111, v115
  v_mfma_f32_32x32x16_bf16 v[196:211], a[202:205], v[232:235], v[196:211]
  s_nop 0
  v_mfma_f32_32x32x16_bf16 v[196:211], a[206:209], v[236:239], v[196:211]
  s_add_u32 s36, s52, s33
  s_mov_b64 exec, s[34:35]
  buffer_load_dwordx4 a[118:121], v4, s[4:7], s36 offen offset:640 sc1
  s_mov_b64 exec, -1
  v_sub_f32 v116, v116, v16
  v_sub_f32 v117, v117, v16
  v_sub_f32 v118, v118, v16
  v_sub_f32 v119, v119, v16
  v_sub_f32 v120, v120, v16
  v_sub_f32 v121, v121, v16
  v_sub_f32 v122, v122, v16
  v_sub_f32 v123, v123, v16
  v_sub_f32 v124, v124, v16
  v_sub_f32 v125, v125, v16
  v_sub_f32 v126, v126, v16
  v_sub_f32 v127, v127, v16
  v_sub_f32 v128, v128, v16
  v_sub_f32 v129, v129, v16
  v_sub_f32 v130, v130, v16
  v_sub_f32 v131, v131, v16
  s_mov_b64 exec, s[34:35]
  buffer_load_dwordx4 a[122:125], v5, s[4:7], s36 offen offset:640 sc1
  s_mov_b64 exec, -1
  v_exp_f32 v116, v116
  v_exp_f32 v117, v117
  v_exp_f32 v118, v118
  v_exp_f32 v119, v119
  v_exp_f32 v120, v120
  v_exp_f32 v121, v121
  v_exp_f32 v122, v122
  v_exp_f32 v123, v123
  v_exp_f32 v124, v124
  v_exp_f32 v125, v125
  v_exp_f32 v126, v126
  v_exp_f32 v127, v127
  v_exp_f32 v128, v128
  v_exp_f32 v129, v129
  v_exp_f32 v130, v130
  v_exp_f32 v131, v131
  v_cvt_pk_bf16_f32 v224, v116, v120
  v_cvt_pk_bf16_f32 v225, v124, v128
  v_cvt_pk_bf16_f32 v226, v117, v121
  v_cvt_pk_bf16_f32 v227, v125, v129
  v_cvt_pk_bf16_f32 v228, v118, v122
  v_cvt_pk_bf16_f32 v229, v126, v130
  v_cvt_pk_bf16_f32 v230, v119, v123
  v_cvt_pk_bf16_f32 v231, v127, v131
  v_mfma_f32_32x32x16_bf16 v[196:211], a[216:219], v[224:227], v[196:211]
  s_nop 0
  v_mfma_f32_32x32x16_bf16 v[196:211], a[220:223], v[228:231], v[196:211]
  v_sub_f32 v132, v132, v16
  v_sub_f32 v133, v133, v16
  v_sub_f32 v134, v134, v16
  v_sub_f32 v135, v135, v16
  v_sub_f32 v136, v136, v16
  v_sub_f32 v137, v137, v16
  v_sub_f32 v138, v138, v16
  v_sub_f32 v139, v139, v16
  v_sub_f32 v140, v140, v16
  v_sub_f32 v141, v141, v16
  v_sub_f32 v142, v142, v16
  v_sub_f32 v143, v143, v16
  v_sub_f32 v144, v144, v16
  v_sub_f32 v145, v145, v16
  v_sub_f32 v146, v146, v16
  v_sub_f32 v147, v147, v16
  v_exp_f32 v132, v132
  v_exp_f32 v133, v133
  v_exp_f32 v134, v134
  v_exp_f32 v135, v135
  v_exp_f32 v136, v136
  v_exp_f32 v137, v137
  v_exp_f32 v138, v138
  v_exp_f32 v139, v139
  v_exp_f32 v140, v140
  v_exp_f32 v141, v141
  v_exp_f32 v142, v142
  v_exp_f32 v143, v143
  v_exp_f32 v144, v144
  v_exp_f32 v145, v145
  v_exp_f32 v146, v146
  v_exp_f32 v147, v147
  v_cvt_pk_bf16_f32 v232, v132, v136
  v_cvt_pk_bf16_f32 v233, v140, v144
  v_cvt_pk_bf16_f32 v234, v133, v137
  v_cvt_pk_bf16_f32 v235, v141, v145
  v_cvt_pk_bf16_f32 v236, v134, v138
  v_cvt_pk_bf16_f32 v237, v142, v146
  v_cvt_pk_bf16_f32 v238, v135, v139
  v_cvt_pk_bf16_f32 v239, v143, v147
  v_mfma_f32_32x32x16_bf16 v[196:211], a[230:233], v[232:235], v[196:211]
  s_nop 0
  v_mfma_f32_32x32x16_bf16 v[196:211], a[234:237], v[236:239], v[196:211]
  v_sub_f32 v148, v148, v16
  v_sub_f32 v149, v149, v16
  v_sub_f32 v150, v150, v16
  v_sub_f32 v151, v151, v16
  v_sub_f32 v152, v152, v16
  v_sub_f32 v153, v153, v16
  v_sub_f32 v154, v154, v16
  v_sub_f32 v155, v155, v16
  v_sub_f32 v156, v156, v16
  v_sub_f32 v157, v157, v16
  v_sub_f32 v158, v158, v16
  v_sub_f32 v159, v159, v16
  v_sub_f32 v160, v160, v16
  v_sub_f32 v161, v161, v16
  v_sub_f32 v162, v162, v16
  v_sub_f32 v163, v163, v16
  v_exp_f32 v148, v148
  v_exp_f32 v149, v149
  v_exp_f32 v150, v150
  v_exp_f32 v151, v151
  v_exp_f32 v152, v152
  v_exp_f32 v153, v153
  v_exp_f32 v154, v154
  v_exp_f32 v155, v155
  v_exp_f32 v156, v156
  v_exp_f32 v157, v157
  v_exp_f32 v158, v158
  v_exp_f32 v159, v159
  v_exp_f32 v160, v160
  v_exp_f32 v161, v161
  v_exp_f32 v162, v162
  v_exp_f32 v163, v163
  v_cvt_pk_bf16_f32 v224, v148, v152
  v_cvt_pk_bf16_f32 v225, v156, v160
  v_cvt_pk_bf16_f32 v226, v149, v153
  v_cvt_pk_bf16_f32 v227, v157, v161
  v_cvt_pk_bf16_f32 v228, v150, v154
  v_cvt_pk_bf16_f32 v229, v158, v162
  v_cvt_pk_bf16_f32 v230, v151, v155
  v_cvt_pk_bf16_f32 v231, v159, v163
  v_mfma_f32_32x32x16_bf16 v[196:211], a[244:247], v[224:227], v[196:211]
  s_nop 0
  v_mfma_f32_32x32x16_bf16 v[196:211], a[248:251], v[228:231], v[196:211]
  s_nop 11
  v_rcp_f32 v16, v208
  s_nop 0
  v_mul_f32 v196, v196, v16
  v_mul_f32 v197, v197, v16
  v_mul_f32 v198, v198, v16
  v_mul_f32 v199, v199, v16
  v_mul_f32 v200, v200, v16
  v_mul_f32 v201, v201, v16
  v_mul_f32 v202, v202, v16
  v_mul_f32 v203, v203, v16
  v_mul_f32 v204, v204, v16
  v_mul_f32 v205, v205, v16
  v_mul_f32 v206, v206, v16
  v_mul_f32 v207, v207, v16
  v_cvt_pk_bf16_f32 v240, v196, v197
  v_cvt_pk_bf16_f32 v241, v198, v199
  v_cvt_pk_bf16_f32 v242, v200, v201
  v_cvt_pk_bf16_f32 v243, v202, v203
  s_mov_b64 exec, s[26:27]
  v_cvt_pk_bf16_f32 v244, v204, v205
  v_cvt_pk_bf16_f32 v245, v206, v207
  s_mov_b64 exec, -1
  buffer_store_dwordx4 v[240:243], v1, s[4:7], s16 offen offset:1024 sc1
  s_waitcnt vmcnt(1)
  v_mfma_f32_32x32x16_bf16 v[20:35], a[0:3], v[212:215], v[180:195]
  v_mfma_f32_32x32x8_bf16 v[20:35], a[4:5], v[216:217], v[20:35]
  s_add_u32 s36, s52, s32
  s_add_u32 s36, s36, 67112448
  buffer_load_dwordx4 v[218:221], v1, s[4:7], s36 offen offset:512 sc1
  v_mfma_f32_32x32x16_bf16 v[36:51], a[14:17], v[212:215], 0
  v_mfma_f32_32x32x8_bf16 v[36:51], a[18:19], v[216:217], v[36:51]
  buffer_load_dwordx2 v[222:223], v3, s[4:7], s36 offen offset:8 sc1
  v_mfma_f32_32x32x16_bf16 v[52:67], a[28:31], v[212:215], 0
  v_mfma_f32_32x32x8_bf16 v[52:67], a[32:33], v[216:217], v[52:67]
  s_add_u32 s36, s44, s32
  s_add_u32 s36, s36, 70258176
  buffer_load_dwordx4 a[126:129], v1, s[4:7], s36 offen offset:512 sc1
  v_mfma_f32_32x32x16_bf16 v[68:83], a[42:45], v[212:215], 0
  v_mfma_f32_32x32x8_bf16 v[68:83], a[46:47], v[216:217], v[68:83]
  buffer_load_dwordx2 a[130:131], v3, s[4:7], s36 offen offset:8 sc1
  v_mfma_f32_32x32x16_bf16 v[84:99], a[56:59], v[212:215], 0
  v_mfma_f32_32x32x8_bf16 v[84:99], a[60:61], v[216:217], v[84:99]
  s_add_u32 s36, s45, s32
  s_add_u32 s36, s36, 70258176
  buffer_load_dwordx4 a[140:143], v1, s[4:7], s36 offen offset:512 sc1
  v_mfma_f32_32x32x16_bf16 v[100:115], a[70:73], v[212:215], 0
  v_mfma_f32_32x32x8_bf16 v[100:115], a[74:75], v[216:217], v[100:115]
  buffer_load_dwordx2 a[144:145], v3, s[4:7], s36 offen offset:8 sc1
  v_mfma_f32_32x32x16_bf16 v[116:131], a[84:87], v[212:215], 0
  v_mfma_f32_32x32x8_bf16 v[116:131], a[88:89], v[216:217], v[116:131]
  s_add_u32 s36, s46, s32
  s_add_u32 s36, s36, 70258176
  buffer_load_dwordx4 a[154:157], v1, s[4:7], s36 offen offset:512 sc1
  v_mfma_f32_32x32x16_bf16 v[132:147], a[98:101], v[212:215], 0
  v_mfma_f32_32x32x8_bf16 v[132:147], a[102:103], v[216:217], v[132:147]
  buffer_load_dwordx2 a[158:159], v3, s[4:7], s36 offen offset:8 sc1
  v_mfma_f32_32x32x16_bf16 v[148:163], a[112:115], v[212:215], v[164:179]
  v_mfma_f32_32x32x8_bf16 v[148:163], a[116:117], v[216:217], v[148:163]
  s_add_u32 s36, s47, s32
  s_add_u32 s36, s36, 70258176
  buffer_load_dwordx4 a[168:171], v1, s[4:7], s36 offen offset:512 sc1
  s_cmp_ge_u32 s28, 8
  s_cbranch_scc1 L_full_80
  v_mov_b32 v20, 0xf149f2ca
  v_mov_b32 v21, 0xf149f2ca
  v_mov_b32 v22, 0xf149f2ca
  v_mov_b32 v23, 0xf149f2ca
  v_mov_b32 v24, 0xf149f2ca
  v_mov_b32 v25, 0xf149f2ca
  v_mov_b32 v26, 0xf149f2ca
  v_mov_b32 v27, 0xf149f2ca
  v_mov_b32 v28, 0xf149f2ca
  v_mov_b32 v29, 0xf149f2ca
  v_mov_b32 v30, 0xf149f2ca
  v_mov_b32 v31, 0xf149f2ca
  v_mov_b32 v32, 0xf149f2ca
  v_mov_b32 v33, 0xf149f2ca
  v_mov_b32 v34, 0xf149f2ca
  v_mov_b32 v35, 0xf149f2ca
  s_cmp_ge_u32 s28, 7
  s_cbranch_scc1 L_full_80
  v_mov_b32 v36, 0xf149f2ca
  v_mov_b32 v37, 0xf149f2ca
  v_mov_b32 v38, 0xf149f2ca
  v_mov_b32 v39, 0xf149f2ca
  v_mov_b32 v40, 0xf149f2ca
  v_mov_b32 v41, 0xf149f2ca
  v_mov_b32 v42, 0xf149f2ca
  v_mov_b32 v43, 0xf149f2ca
  v_mov_b32 v44, 0xf149f2ca
  v_mov_b32 v45, 0xf149f2ca
  v_mov_b32 v46, 0xf149f2ca
  v_mov_b32 v47, 0xf149f2ca
  v_mov_b32 v48, 0xf149f2ca
  v_mov_b32 v49, 0xf149f2ca
  v_mov_b32 v50, 0xf149f2ca
  v_mov_b32 v51, 0xf149f2ca
  s_cmp_ge_u32 s28, 6
  s_cbranch_scc1 L_full_80
  v_mov_b32 v52, 0xf149f2ca
  v_mov_b32 v53, 0xf149f2ca
  v_mov_b32 v54, 0xf149f2ca
  v_mov_b32 v55, 0xf149f2ca
  v_mov_b32 v56, 0xf149f2ca
  v_mov_b32 v57, 0xf149f2ca
  v_mov_b32 v58, 0xf149f2ca
  v_mov_b32 v59, 0xf149f2ca
  v_mov_b32 v60, 0xf149f2ca
  v_mov_b32 v61, 0xf149f2ca
  v_mov_b32 v62, 0xf149f2ca
  v_mov_b32 v63, 0xf149f2ca
  v_mov_b32 v64, 0xf149f2ca
  v_mov_b32 v65, 0xf149f2ca
  v_mov_b32 v66, 0xf149f2ca
  v_mov_b32 v67, 0xf149f2ca
  s_cmp_ge_u32 s28, 5
  s_cbranch_scc1 L_full_80
  v_mov_b32 v68, 0xf149f2ca
  v_mov_b32 v69, 0xf149f2ca
  v_mov_b32 v70, 0xf149f2ca
  v_mov_b32 v71, 0xf149f2ca
  v_mov_b32 v72, 0xf149f2ca
  v_mov_b32 v73, 0xf149f2ca
  v_mov_b32 v74, 0xf149f2ca
  v_mov_b32 v75, 0xf149f2ca
  v_mov_b32 v76, 0xf149f2ca
  v_mov_b32 v77, 0xf149f2ca
  v_mov_b32 v78, 0xf149f2ca
  v_mov_b32 v79, 0xf149f2ca
  v_mov_b32 v80, 0xf149f2ca
  v_mov_b32 v81, 0xf149f2ca
  v_mov_b32 v82, 0xf149f2ca
  v_mov_b32 v83, 0xf149f2ca
  s_cmp_ge_u32 s28, 4
  s_cbranch_scc1 L_full_80
  v_mov_b32 v84, 0xf149f2ca
  v_mov_b32 v85, 0xf149f2ca
  v_mov_b32 v86, 0xf149f2ca
  v_mov_b32 v87, 0xf149f2ca
  v_mov_b32 v88, 0xf149f2ca
  v_mov_b32 v89, 0xf149f2ca
  v_mov_b32 v90, 0xf149f2ca
  v_mov_b32 v91, 0xf149f2ca
  v_mov_b32 v92, 0xf149f2ca
  v_mov_b32 v93, 0xf149f2ca
  v_mov_b32 v94, 0xf149f2ca
  v_mov_b32 v95, 0xf149f2ca
  v_mov_b32 v96, 0xf149f2ca
  v_mov_b32 v97, 0xf149f2ca
  v_mov_b32 v98, 0xf149f2ca
  v_mov_b32 v99, 0xf149f2ca
  s_cmp_ge_u32 s28, 3
  s_cbranch_scc1 L_full_80
  v_mov_b32 v100, 0xf149f2ca
  v_mov_b32 v101, 0xf149f2ca
  v_mov_b32 v102, 0xf149f2ca
  v_mov_b32 v103, 0xf149f2ca
  v_mov_b32 v104, 0xf149f2ca
  v_mov_b32 v105, 0xf149f2ca
  v_mov_b32 v106, 0xf149f2ca
  v_mov_b32 v107, 0xf149f2ca
  v_mov_b32 v108, 0xf149f2ca
  v_mov_b32 v109, 0xf149f2ca
  v_mov_b32 v110, 0xf149f2ca
  v_mov_b32 v111, 0xf149f2ca
  v_mov_b32 v112, 0xf149f2ca
  v_mov_b32 v113, 0xf149f2ca
  v_mov_b32 v114, 0xf149f2ca
  v_mov_b32 v115, 0xf149f2ca
  s_cmp_ge_u32 s28, 2
  s_cbranch_scc1 L_full_80
  v_mov_b32 v116, 0xf149f2ca
  v_mov_b32 v117, 0xf149f2ca
  v_mov_b32 v118, 0xf149f2ca
  v_mov_b32 v119, 0xf149f2ca
  v_mov_b32 v120, 0xf149f2ca
  v_mov_b32 v121, 0xf149f2ca
  v_mov_b32 v122, 0xf149f2ca
  v_mov_b32 v123, 0xf149f2ca
  v_mov_b32 v124, 0xf149f2ca
  v_mov_b32 v125, 0xf149f2ca
  v_mov_b32 v126, 0xf149f2ca
  v_mov_b32 v127, 0xf149f2ca
  v_mov_b32 v128, 0xf149f2ca
  v_mov_b32 v129, 0xf149f2ca
  v_mov_b32 v130, 0xf149f2ca
  v_mov_b32 v131, 0xf149f2ca
  s_cmp_ge_u32 s28, 1
  s_cbranch_scc1 L_full_80
  v_mov_b32 v132, 0xf149f2ca
  v_mov_b32 v133, 0xf149f2ca
  v_mov_b32 v134, 0xf149f2ca
  v_mov_b32 v135, 0xf149f2ca
  v_mov_b32 v136, 0xf149f2ca
  v_mov_b32 v137, 0xf149f2ca
  v_mov_b32 v138, 0xf149f2ca
  v_mov_b32 v139, 0xf149f2ca
  v_mov_b32 v140, 0xf149f2ca
  v_mov_b32 v141, 0xf149f2ca
  v_mov_b32 v142, 0xf149f2ca
  v_mov_b32 v143, 0xf149f2ca
  v_mov_b32 v144, 0xf149f2ca
  v_mov_b32 v145, 0xf149f2ca
  v_mov_b32 v146, 0xf149f2ca
  v_mov_b32 v147, 0xf149f2ca
L_full_80:
  v_max_f32 v16, v20, v21
  v_max3_f32 v16, v16, v22, v23
  v_max3_f32 v16, v16, v24, v25
  v_max3_f32 v16, v16, v26, v27
  v_max3_f32 v16, v16, v28, v29
  v_max3_f32 v16, v16, v30, v31
  v_max3_f32 v16, v16, v32, v33
  v_max3_f32 v16, v16, v34, v35
  v_max3_f32 v16, v16, v36, v37
  v_max3_f32 v16, v16, v38, v39
  v_max3_f32 v16, v16, v40, v41
  v_max3_f32 v16, v16, v42, v43
  v_max3_f32 v16, v16, v44, v45
  v_max3_f32 v16, v16, v46, v47
  v_max3_f32 v16, v16, v48, v49
  v_max3_f32 v16, v16, v50, v51
  v_max3_f32 v16, v16, v52, v53
  buffer_load_dwordx2 a[172:173], v3, s[4:7], s36 offen offset:8 sc1
  v_max3_f32 v16, v16, v54, v55
  v_max3_f32 v16, v16, v56, v57
  v_max3_f32 v16, v16, v58, v59
  v_max3_f32 v16, v16, v60, v61
  v_max3_f32 v16, v16, v62, v63
  v_max3_f32 v16, v16, v64, v65
  v_max3_f32 v16, v16, v66, v67
  v_max3_f32 v16, v16, v68, v69
  v_max3_f32 v16, v16, v70, v71
  v_max3_f32 v16, v16, v72, v73
  v_max3_f32 v16, v16, v74, v75
  v_max3_f32 v16, v16, v76, v77
  v_max3_f32 v16, v16, v78, v79
  v_max3_f32 v16, v16, v80, v81
  v_max3_f32 v16, v16, v82, v83
  v_max3_f32 v16, v16, v84, v85
  s_add_u32 s36, s48, s32
  s_add_u32 s36, s36, 70258176
  buffer_load_dwordx4 a[182:185], v1, s[4:7], s36 offen offset:512 sc1
  v_max3_f32 v16, v16, v86, v87
  v_max3_f32 v16, v16, v88, v89
  v_max3_f32 v16, v16, v90, v91
  v_max3_f32 v16, v16, v92, v93
  v_max3_f32 v16, v16, v94, v95
  v_max3_f32 v16, v16, v96, v97
  v_max3_f32 v16, v16, v98, v99
  v_max3_f32 v16, v16, v100, v101
  v_max3_f32 v16, v16, v102, v103
  v_max3_f32 v16, v16, v104, v105
  v_max3_f32 v16, v16, v106, v107
  v_max3_f32 v16, v16, v108, v109
  v_max3_f32 v16, v16, v110, v111
  v_max3_f32 v16, v16, v112, v113
  v_max3_f32 v16, v16, v114, v115
  v_max3_f32 v16, v16, v116, v117
  buffer_load_dwordx2 a[186:187], v3, s[4:7], s36 offen offset:8 sc1
  v_max3_f32 v16, v16, v118, v119
  v_max3_f32 v16, v16, v120, v121
  v_max3_f32 v16, v16, v122, v123
  v_max3_f32 v16, v16, v124, v125
  v_max3_f32 v16, v16, v126, v127
  v_max3_f32 v16, v16, v128, v129
  v_max3_f32 v16, v16, v130, v131
  v_max3_f32 v16, v16, v132, v133
  v_max3_f32 v16, v16, v134, v135
  v_max3_f32 v16, v16, v136, v137
  v_max3_f32 v16, v16, v138, v139
  v_max3_f32 v16, v16, v140, v141
  v_max3_f32 v16, v16, v142, v143
  v_max3_f32 v16, v16, v144, v145
  v_max3_f32 v16, v16, v146, v147
  v_max3_f32 v16, v16, v148, v149
  s_add_u32 s36, s49, s32
  s_add_u32 s36, s36, 70258176
  buffer_load_dwordx4 a[196:199], v1, s[4:7], s36 offen offset:512 sc1
  v_max3_f32 v16, v16, v150, v151
  v_max3_f32 v16, v16, v152, v153
  v_max3_f32 v16, v16, v154, v155
  v_max3_f32 v16, v16, v156, v157
  v_max3_f32 v16, v16, v158, v159
  v_max3_f32 v16, v16, v160, v161
  v_max3_f32 v16, v16, v162, v163
  v_mov_b32 v17, v16
  s_nop 1
  v_permlane32_swap_b32 v16, v17
  v_max_f32 v16, v16, v17
  v_sub_f32 v20, v20, v16
  v_sub_f32 v21, v21, v16
  v_sub_f32 v22, v22, v16
  v_sub_f32 v23, v23, v16
  v_sub_f32 v24, v24, v16
  v_sub_f32 v25, v25, v16
  v_sub_f32 v26, v26, v16
  v_sub_f32 v27, v27, v16
  v_sub_f32 v28, v28, v16
  v_sub_f32 v29, v29, v16
  v_sub_f32 v30, v30, v16
  v_sub_f32 v31, v31, v16
  v_sub_f32 v32, v32, v16
  v_sub_f32 v33, v33, v16
  v_sub_f32 v34, v34, v16
  v_sub_f32 v35, v35, v16
  buffer_load_dwordx2 a[200:201], v3, s[4:7], s36 offen offset:8 sc1
  v_exp_f32 v20, v20
  v_exp_f32 v21, v21
  v_exp_f32 v22, v22
  v_exp_f32 v23, v23
  v_exp_f32 v24, v24
  v_exp_f32 v25, v25
  v_exp_f32 v26, v26
  v_exp_f32 v27, v27
  s_add_u32 s36, s50, s32
  s_add_u32 s36, s36, 70258176
  buffer_load_dwordx4 a[210:213], v1, s[4:7], s36 offen offset:512 sc1
  v_exp_f32 v28, v28
  v_exp_f32 v29, v29
  v_exp_f32 v30, v30
  v_exp_f32 v31, v31
  v_exp_f32 v32, v32
  v_exp_f32 v33, v33
  v_exp_f32 v34, v34
  v_exp_f32 v35, v35
  buffer_load_dwordx2 a[214:215], v3, s[4:7], s36 offen offset:8 sc1
  v_cvt_pk_bf16_f32 v224, v20, v24
  v_cvt_pk_bf16_f32 v225, v28, v32
  v_cvt_pk_bf16_f32 v226, v21, v25
  v_cvt_pk_bf16_f32 v227, v29, v33
  v_cvt_pk_bf16_f32 v228, v22, v26
  v_cvt_pk_bf16_f32 v229, v30, v34
  v_cvt_pk_bf16_f32 v230, v23, v27
  v_cvt_pk_bf16_f32 v231, v31, v35
  v_mfma_f32_32x32x16_bf16 v[196:211], a[6:9], v[224:227], 0
  s_nop 0
  v_mfma_f32_32x32x16_bf16 v[196:211], a[10:13], v[228:231], v[196:211]
  s_add_u32 s36, s51, s32
  s_add_u32 s36, s36, 70258176
  buffer_load_dwordx4 a[224:227], v1, s[4:7], s36 offen offset:512 sc1
  v_sub_f32 v36, v36, v16
  v_sub_f32 v37, v37, v16
  v_sub_f32 v38, v38, v16
  v_sub_f32 v39, v39, v16
  v_sub_f32 v40, v40, v16
  v_sub_f32 v41, v41, v16
  v_sub_f32 v42, v42, v16
  v_sub_f32 v43, v43, v16
  v_sub_f32 v44, v44, v16
  v_sub_f32 v45, v45, v16
  v_sub_f32 v46, v46, v16
  v_sub_f32 v47, v47, v16
  v_sub_f32 v48, v48, v16
  v_sub_f32 v49, v49, v16
  v_sub_f32 v50, v50, v16
  v_sub_f32 v51, v51, v16
  buffer_load_dwordx2 a[228:229], v3, s[4:7], s36 offen offset:8 sc1
  v_exp_f32 v36, v36
  v_exp_f32 v37, v37
  v_exp_f32 v38, v38
  v_exp_f32 v39, v39
  v_exp_f32 v40, v40
  v_exp_f32 v41, v41
  v_exp_f32 v42, v42
  v_exp_f32 v43, v43
  s_add_u32 s36, s52, s32
  s_add_u32 s36, s36, 70258176
  buffer_load_dwordx4 a[238:241], v1, s[4:7], s36 offen offset:512 sc1
  v_exp_f32 v44, v44
  v_exp_f32 v45, v45
  v_exp_f32 v46, v46
  v_exp_f32 v47, v47
  v_exp_f32 v48, v48
  v_exp_f32 v49, v49
  v_exp_f32 v50, v50
  v_exp_f32 v51, v51
  buffer_load_dwordx2 a[242:243], v3, s[4:7], s36 offen offset:8 sc1
  v_cvt_pk_bf16_f32 v232, v36, v40
  v_cvt_pk_bf16_f32 v233, v44, v48
  v_cvt_pk_bf16_f32 v234, v37, v41
  v_cvt_pk_bf16_f32 v235, v45, v49
  v_cvt_pk_bf16_f32 v236, v38, v42
  v_cvt_pk_bf16_f32 v237, v46, v50
  v_cvt_pk_bf16_f32 v238, v39, v43
  v_cvt_pk_bf16_f32 v239, v47, v51
  v_mfma_f32_32x32x16_bf16 v[196:211], a[20:23], v[232:235], v[196:211]
  s_nop 0
  v_mfma_f32_32x32x16_bf16 v[196:211], a[24:27], v[236:239], v[196:211]
  s_add_u32 s36, s44, s33
  s_mov_b64 exec, s[34:35]
  buffer_load_dwordx4 a[132:135], v4, s[4:7], s36 offen offset:960 sc1
  s_mov_b64 exec, -1
  v_sub_f32 v52, v52, v16
  v_sub_f32 v53, v53, v16
  v_sub_f32 v54, v54, v16
  v_sub_f32 v55, v55, v16
  v_sub_f32 v56, v56, v16
  v_sub_f32 v57, v57, v16
  v_sub_f32 v58, v58, v16
  v_sub_f32 v59, v59, v16
  v_sub_f32 v60, v60, v16
  v_sub_f32 v61, v61, v16
  v_sub_f32 v62, v62, v16
  v_sub_f32 v63, v63, v16
  v_sub_f32 v64, v64, v16
  v_sub_f32 v65, v65, v16
  v_sub_f32 v66, v66, v16
  v_sub_f32 v67, v67, v16
  s_mov_b64 exec, s[34:35]
  buffer_load_dwordx4 a[136:139], v5, s[4:7], s36 offen offset:960 sc1
  s_mov_b64 exec, -1
  v_exp_f32 v52, v52
  v_exp_f32 v53, v53
  v_exp_f32 v54, v54
  v_exp_f32 v55, v55
  v_exp_f32 v56, v56
  v_exp_f32 v57, v57
  v_exp_f32 v58, v58
  v_exp_f32 v59, v59
  s_add_u32 s36, s45, s33
  s_mov_b64 exec, s[34:35]
  buffer_load_dwordx4 a[146:149], v4, s[4:7], s36 offen offset:960 sc1
  s_mov_b64 exec, -1
  v_exp_f32 v60, v60
  v_exp_f32 v61, v61
  v_exp_f32 v62, v62
  v_exp_f32 v63, v63
  v_exp_f32 v64, v64
  v_exp_f32 v65, v65
  v_exp_f32 v66, v66
  v_exp_f32 v67, v67
  s_mov_b64 exec, s[34:35]
  buffer_load_dwordx4 a[150:153], v5, s[4:7], s36 offen offset:960 sc1
  s_mov_b64 exec, -1
  v_cvt_pk_bf16_f32 v224, v52, v56
  v_cvt_pk_bf16_f32 v225, v60, v64
  v_cvt_pk_bf16_f32 v226, v53, v57
  v_cvt_pk_bf16_f32 v227, v61, v65
  v_cvt_pk_bf16_f32 v228, v54, v58
  v_cvt_pk_bf16_f32 v229, v62, v66
  v_cvt_pk_bf16_f32 v230, v55, v59
  v_cvt_pk_bf16_f32 v231, v63, v67
  v_mfma_f32_32x32x16_bf16 v[196:211], a[34:37], v[224:227], v[196:211]
  s_nop 0
  v_mfma_f32_32x32x16_bf16 v[196:211], a[38:41], v[228:231], v[196:211]
  s_add_u32 s36, s46, s33
  s_mov_b64 exec, s[34:35]
  buffer_load_dwordx4 a[160:163], v4, s[4:7], s36 offen offset:960 sc1
  s_mov_b64 exec, -1
  v_sub_f32 v68, v68, v16
  v_sub_f32 v69, v69, v16
  v_sub_f32 v70, v70, v16
  v_sub_f32 v71, v71, v16
  v_sub_f32 v72, v72, v16
  v_sub_f32 v73, v73, v16
  v_sub_f32 v74, v74, v16
  v_sub_f32 v75, v75, v16
  v_sub_f32 v76, v76, v16
  v_sub_f32 v77, v77, v16
  v_sub_f32 v78, v78, v16
  v_sub_f32 v79, v79, v16
  v_sub_f32 v80, v80, v16
  v_sub_f32 v81, v81, v16
  v_sub_f32 v82, v82, v16
  v_sub_f32 v83, v83, v16
  s_mov_b64 exec, s[34:35]
  buffer_load_dwordx4 a[164:167], v5, s[4:7], s36 offen offset:960 sc1
  s_mov_b64 exec, -1
  v_exp_f32 v68, v68
  v_exp_f32 v69, v69
  v_exp_f32 v70, v70
  v_exp_f32 v71, v71
  v_exp_f32 v72, v72
  v_exp_f32 v73, v73
  v_exp_f32 v74, v74
  v_exp_f32 v75, v75
  s_add_u32 s36, s47, s33
  s_mov_b64 exec, s[34:35]
  buffer_load_dwordx4 a[174:177], v4, s[4:7], s36 offen offset:960 sc1
  s_mov_b64 exec, -1
  v_exp_f32 v76, v76
  v_exp_f32 v77, v77
  v_exp_f32 v78, v78
  v_exp_f32 v79, v79
  v_exp_f32 v80, v80
  v_exp_f32 v81, v81
  v_exp_f32 v82, v82
  v_exp_f32 v83, v83
  s_mov_b64 exec, s[34:35]
  buffer_load_dwordx4 a[178:181], v5, s[4:7], s36 offen offset:960 sc1
  s_mov_b64 exec, -1
  v_cvt_pk_bf16_f32 v232, v68, v72
  v_cvt_pk_bf16_f32 v233, v76, v80
  v_cvt_pk_bf16_f32 v234, v69, v73
  v_cvt_pk_bf16_f32 v235, v77, v81
  v_cvt_pk_bf16_f32 v236, v70, v74
  v_cvt_pk_bf16_f32 v237, v78, v82
  v_cvt_pk_bf16_f32 v238, v71, v75
  v_cvt_pk_bf16_f32 v239, v79, v83
  v_mfma_f32_32x32x16_bf16 v[196:211], a[48:51], v[232:235], v[196:211]
  s_nop 0
  v_mfma_f32_32x32x16_bf16 v[196:211], a[52:55], v[236:239], v[196:211]
  s_add_u32 s36, s48, s33
  s_mov_b64 exec, s[34:35]
  buffer_load_dwordx4 a[188:191], v4, s[4:7], s36 offen offset:960 sc1
  s_mov_b64 exec, -1
  v_sub_f32 v84, v84, v16
  v_sub_f32 v85, v85, v16
  v_sub_f32 v86, v86, v16
  v_sub_f32 v87, v87, v16
  v_sub_f32 v88, v88, v16
  v_sub_f32 v89, v89, v16
  v_sub_f32 v90, v90, v16
  v_sub_f32 v91, v91, v16
  v_sub_f32 v92, v92, v16
  v_sub_f32 v93, v93, v16
  v_sub_f32 v94, v94, v16
  v_sub_f32 v95, v95, v16
  v_sub_f32 v96, v96, v16
  v_sub_f32 v97, v97, v16
  v_sub_f32 v98, v98, v16
  v_sub_f32 v99, v99, v16
  s_mov_b64 exec, s[34:35]
  buffer_load_dwordx4 a[192:195], v5, s[4:7], s36 offen offset:960 sc1
  s_mov_b64 exec, -1
  v_exp_f32 v84, v84
  v_exp_f32 v85, v85
  v_exp_f32 v86, v86
  v_exp_f32 v87, v87
  v_exp_f32 v88, v88
  v_exp_f32 v89, v89
  v_exp_f32 v90, v90
  v_exp_f32 v91, v91
  s_add_u32 s36, s49, s33
  s_mov_b64 exec, s[34:35]
  buffer_load_dwordx4 a[202:205], v4, s[4:7], s36 offen offset:960 sc1
  s_mov_b64 exec, -1
  v_exp_f32 v92, v92
  v_exp_f32 v93, v93
  v_exp_f32 v94, v94
  v_exp_f32 v95, v95
  v_exp_f32 v96, v96
  v_exp_f32 v97, v97
  v_exp_f32 v98, v98
  v_exp_f32 v99, v99
  s_mov_b64 exec, s[34:35]
  buffer_load_dwordx4 a[206:209], v5, s[4:7], s36 offen offset:960 sc1
  s_mov_b64 exec, -1
  v_cvt_pk_bf16_f32 v224, v84, v88
  v_cvt_pk_bf16_f32 v225, v92, v96
  v_cvt_pk_bf16_f32 v226, v85, v89
  v_cvt_pk_bf16_f32 v227, v93, v97
  v_cvt_pk_bf16_f32 v228, v86, v90
  v_cvt_pk_bf16_f32 v229, v94, v98
  v_cvt_pk_bf16_f32 v230, v87, v91
  v_cvt_pk_bf16_f32 v231, v95, v99
  v_mfma_f32_32x32x16_bf16 v[196:211], a[62:65], v[224:227], v[196:211]
  s_nop 0
  v_mfma_f32_32x32x16_bf16 v[196:211], a[66:69], v[228:231], v[196:211]
  s_add_u32 s36, s50, s33
  s_mov_b64 exec, s[34:35]
  buffer_load_dwordx4 a[216:219], v4, s[4:7], s36 offen offset:960 sc1
  s_mov_b64 exec, -1
  v_sub_f32 v100, v100, v16
  v_sub_f32 v101, v101, v16
  v_sub_f32 v102, v102, v16
  v_sub_f32 v103, v103, v16
  v_sub_f32 v104, v104, v16
  v_sub_f32 v105, v105, v16
  v_sub_f32 v106, v106, v16
  v_sub_f32 v107, v107, v16
  v_sub_f32 v108, v108, v16
  v_sub_f32 v109, v109, v16
  v_sub_f32 v110, v110, v16
  v_sub_f32 v111, v111, v16
  v_sub_f32 v112, v112, v16
  v_sub_f32 v113, v113, v16
  v_sub_f32 v114, v114, v16
  v_sub_f32 v115, v115, v16
  s_mov_b64 exec, s[34:35]
  buffer_load_dwordx4 a[220:223], v5, s[4:7], s36 offen offset:960 sc1
  s_mov_b64 exec, -1
  v_exp_f32 v100, v100
  v_exp_f32 v101, v101
  v_exp_f32 v102, v102
  v_exp_f32 v103, v103
  v_exp_f32 v104, v104
  v_exp_f32 v105, v105
  v_exp_f32 v106, v106
  v_exp_f32 v107, v107
  s_add_u32 s36, s51, s33
  s_mov_b64 exec, s[34:35]
  buffer_load_dwordx4 a[230:233], v4, s[4:7], s36 offen offset:960 sc1
  s_mov_b64 exec, -1
  v_exp_f32 v108, v108
  v_exp_f32 v109, v109
  v_exp_f32 v110, v110
  v_exp_f32 v111, v111
  v_exp_f32 v112, v112
  v_exp_f32 v113, v113
  v_exp_f32 v114, v114
  v_exp_f32 v115, v115
  s_mov_b64 exec, s[34:35]
  buffer_load_dwordx4 a[234:237], v5, s[4:7], s36 offen offset:960 sc1
  s_mov_b64 exec, -1
  v_cvt_pk_bf16_f32 v232, v100, v104
  v_cvt_pk_bf16_f32 v233, v108, v112
  v_cvt_pk_bf16_f32 v234, v101, v105
  v_cvt_pk_bf16_f32 v235, v109, v113
  v_cvt_pk_bf16_f32 v236, v102, v106
  v_cvt_pk_bf16_f32 v237, v110, v114
  v_cvt_pk_bf16_f32 v238, v103, v107
  v_cvt_pk_bf16_f32 v239, v111, v115
  v_mfma_f32_32x32x16_bf16 v[196:211], a[76:79], v[232:235], v[196:211]
  s_nop 0
  v_mfma_f32_32x32x16_bf16 v[196:211], a[80:83], v[236:239], v[196:211]
  s_add_u32 s36, s52, s33
  s_mov_b64 exec, s[34:35]
  buffer_load_dwordx4 a[244:247], v4, s[4:7], s36 offen offset:960 sc1
  s_mov_b64 exec, -1
  v_sub_f32 v116, v116, v16
  v_sub_f32 v117, v117, v16
  v_sub_f32 v118, v118, v16
  v_sub_f32 v119, v119, v16
  v_sub_f32 v120, v120, v16
  v_sub_f32 v121, v121, v16
  v_sub_f32 v122, v122, v16
  v_sub_f32 v123, v123, v16
  v_sub_f32 v124, v124, v16
  v_sub_f32 v125, v125, v16
  v_sub_f32 v126, v126, v16
  v_sub_f32 v127, v127, v16
  v_sub_f32 v128, v128, v16
  v_sub_f32 v129, v129, v16
  v_sub_f32 v130, v130, v16
  v_sub_f32 v131, v131, v16
  s_mov_b64 exec, s[34:35]
  buffer_load_dwordx4 a[248:251], v5, s[4:7], s36 offen offset:960 sc1
  s_mov_b64 exec, -1
  v_exp_f32 v116, v116
  v_exp_f32 v117, v117
  v_exp_f32 v118, v118
  v_exp_f32 v119, v119
  v_exp_f32 v120, v120
  v_exp_f32 v121, v121
  v_exp_f32 v122, v122
  v_exp_f32 v123, v123
  v_exp_f32 v124, v124
  v_exp_f32 v125, v125
  v_exp_f32 v126, v126
  v_exp_f32 v127, v127
  v_exp_f32 v128, v128
  v_exp_f32 v129, v129
  v_exp_f32 v130, v130
  v_exp_f32 v131, v131
  v_cvt_pk_bf16_f32 v224, v116, v120
  v_cvt_pk_bf16_f32 v225, v124, v128
  v_cvt_pk_bf16_f32 v226, v117, v121
  v_cvt_pk_bf16_f32 v227, v125, v129
  v_cvt_pk_bf16_f32 v228, v118, v122
  v_cvt_pk_bf16_f32 v229, v126, v130
  v_cvt_pk_bf16_f32 v230, v119, v123
  v_cvt_pk_bf16_f32 v231, v127, v131
  v_mfma_f32_32x32x16_bf16 v[196:211], a[90:93], v[224:227], v[196:211]
  s_nop 0
  v_mfma_f32_32x32x16_bf16 v[196:211], a[94:97], v[228:231], v[196:211]
  v_sub_f32 v132, v132, v16
  v_sub_f32 v133, v133, v16
  v_sub_f32 v134, v134, v16
  v_sub_f32 v135, v135, v16
  v_sub_f32 v136, v136, v16
  v_sub_f32 v137, v137, v16
  v_sub_f32 v138, v138, v16
  v_sub_f32 v139, v139, v16
  v_sub_f32 v140, v140, v16
  v_sub_f32 v141, v141, v16
  v_sub_f32 v142, v142, v16
  v_sub_f32 v143, v143, v16
  v_sub_f32 v144, v144, v16
  v_sub_f32 v145, v145, v16
  v_sub_f32 v146, v146, v16
  v_sub_f32 v147, v147, v16
  v_exp_f32 v132, v132
  v_exp_f32 v133, v133
  v_exp_f32 v134, v134
  v_exp_f32 v135, v135
  v_exp_f32 v136, v136
  v_exp_f32 v137, v137
  v_exp_f32 v138, v138
  v_exp_f32 v139, v139
  v_exp_f32 v140, v140
  v_exp_f32 v141, v141
  v_exp_f32 v142, v142
  v_exp_f32 v143, v143
  v_exp_f32 v144, v144
  v_exp_f32 v145, v145
  v_exp_f32 v146, v146
  v_exp_f32 v147, v147
  v_cvt_pk_bf16_f32 v232, v132, v136
  v_cvt_pk_bf16_f32 v233, v140, v144
  v_cvt_pk_bf16_f32 v234, v133, v137
  v_cvt_pk_bf16_f32 v235, v141, v145
  v_cvt_pk_bf16_f32 v236, v134, v138
  v_cvt_pk_bf16_f32 v237, v142, v146
  v_cvt_pk_bf16_f32 v238, v135, v139
  v_cvt_pk_bf16_f32 v239, v143, v147
  v_mfma_f32_32x32x16_bf16 v[196:211], a[104:107], v[232:235], v[196:211]
  s_nop 0
  v_mfma_f32_32x32x16_bf16 v[196:211], a[108:111], v[236:239], v[196:211]
  v_sub_f32 v148, v148, v16
  v_sub_f32 v149, v149, v16
  v_sub_f32 v150, v150, v16
  v_sub_f32 v151, v151, v16
  v_sub_f32 v152, v152, v16
  v_sub_f32 v153, v153, v16
  v_sub_f32 v154, v154, v16
  v_sub_f32 v155, v155, v16
  v_sub_f32 v156, v156, v16
  v_sub_f32 v157, v157, v16
  v_sub_f32 v158, v158, v16
  v_sub_f32 v159, v159, v16
  v_sub_f32 v160, v160, v16
  v_sub_f32 v161, v161, v16
  v_sub_f32 v162, v162, v16
  v_sub_f32 v163, v163, v16
  v_exp_f32 v148, v148
  v_exp_f32 v149, v149
  v_exp_f32 v150, v150
  v_exp_f32 v151, v151
  v_exp_f32 v152, v152
  v_exp_f32 v153, v153
  v_exp_f32 v154, v154
  v_exp_f32 v155, v155
  v_exp_f32 v156, v156
  v_exp_f32 v157, v157
  v_exp_f32 v158, v158
  v_exp_f32 v159, v159
  v_exp_f32 v160, v160
  v_exp_f32 v161, v161
  v_exp_f32 v162, v162
  v_exp_f32 v163, v163
  v_cvt_pk_bf16_f32 v224, v148, v152
  v_cvt_pk_bf16_f32 v225, v156, v160
  v_cvt_pk_bf16_f32 v226, v149, v153
  v_cvt_pk_bf16_f32 v227, v157, v161
  v_cvt_pk_bf16_f32 v228, v150, v154
  v_cvt_pk_bf16_f32 v229, v158, v162
  v_cvt_pk_bf16_f32 v230, v151, v155
  v_cvt_pk_bf16_f32 v231, v159, v163
  v_mfma_f32_32x32x16_bf16 v[196:211], a[118:121], v[224:227], v[196:211]
  s_nop 0
  v_mfma_f32_32x32x16_bf16 v[196:211], a[122:125], v[228:231], v[196:211]
  s_nop 11
  v_rcp_f32 v16, v208
  s_nop 0
  v_mul_f32 v196, v196, v16
  v_mul_f32 v197, v197, v16
  v_mul_f32 v198, v198, v16
  v_mul_f32 v199, v199, v16
  v_mul_f32 v200, v200, v16
  v_mul_f32 v201, v201, v16
  v_mul_f32 v202, v202, v16
  v_mul_f32 v203, v203, v16
  v_mul_f32 v204, v204, v16
  v_mul_f32 v205, v205, v16
  v_mul_f32 v206, v206, v16
  v_mul_f32 v207, v207, v16
  v_cvt_pk_bf16_f32 v240, v196, v197
  v_cvt_pk_bf16_f32 v241, v198, v199
  v_cvt_pk_bf16_f32 v242, v200, v201
  v_cvt_pk_bf16_f32 v243, v202, v203
  v_cvt_pk_bf16_f32 v246, v204, v205
  v_cvt_pk_bf16_f32 v247, v206, v207
  buffer_store_dwordx4 v[240:243], v1, s[4:7], s16 offen offset:2048 sc1
  s_waitcnt vmcnt(1)
  v_mfma_f32_32x32x16_bf16 v[20:35], a[126:129], v[218:221], v[180:195]
  v_mfma_f32_32x32x8_bf16 v[20:35], a[130:131], v[222:223], v[20:35]
  v_mfma_f32_32x32x16_bf16 v[36:51], a[140:143], v[218:221], 0
  v_mfma_f32_32x32x8_bf16 v[36:51], a[144:145], v[222:223], v[36:51]
  v_mfma_f32_32x32x16_bf16 v[52:67], a[154:157], v[218:221], 0
  v_mfma_f32_32x32x8_bf16 v[52:67], a[158:159], v[222:223], v[52:67]
  v_mfma_f32_32x32x16_bf16 v[68:83], a[168:171], v[218:221], 0
  v_mfma_f32_32x32x8_bf16 v[68:83], a[172:173], v[222:223], v[68:83]
  v_mfma_f32_32x32x16_bf16 v[84:99], a[182:185], v[218:221], 0
  v_mfma_f32_32x32x8_bf16 v[84:99], a[186:187], v[222:223], v[84:99]
  v_mfma_f32_32x32x16_bf16 v[100:115], a[196:199], v[218:221], 0
  v_mfma_f32_32x32x8_bf16 v[100:115], a[200:201], v[222:223], v[100:115]
  v_mfma_f32_32x32x16_bf16 v[116:131], a[210:213], v[218:221], 0
  v_mfma_f32_32x32x8_bf16 v[116:131], a[214:215], v[222:223], v[116:131]
  v_mfma_f32_32x32x16_bf16 v[132:147], a[224:227], v[218:221], 0
  v_mfma_f32_32x32x8_bf16 v[132:147], a[228:229], v[222:223], v[132:147]
  v_mfma_f32_32x32x16_bf16 v[148:163], a[238:241], v[218:221], v[164:179]
  v_mfma_f32_32x32x8_bf16 v[148:163], a[242:243], v[222:223], v[148:163]
  s_cmp_ge_u32 s28, 8
  s_cbranch_scc1 L_full_81
  v_mov_b32 v20, 0xf149f2ca
  v_mov_b32 v21, 0xf149f2ca
  v_mov_b32 v22, 0xf149f2ca
  v_mov_b32 v23, 0xf149f2ca
  v_mov_b32 v24, 0xf149f2ca
  v_mov_b32 v25, 0xf149f2ca
  v_mov_b32 v26, 0xf149f2ca
  v_mov_b32 v27, 0xf149f2ca
  v_mov_b32 v28, 0xf149f2ca
  v_mov_b32 v29, 0xf149f2ca
  v_mov_b32 v30, 0xf149f2ca
  v_mov_b32 v31, 0xf149f2ca
  v_mov_b32 v32, 0xf149f2ca
  v_mov_b32 v33, 0xf149f2ca
  v_mov_b32 v34, 0xf149f2ca
  v_mov_b32 v35, 0xf149f2ca
  s_cmp_ge_u32 s28, 7
  s_cbranch_scc1 L_full_81
  v_mov_b32 v36, 0xf149f2ca
  v_mov_b32 v37, 0xf149f2ca
  v_mov_b32 v38, 0xf149f2ca
  v_mov_b32 v39, 0xf149f2ca
  v_mov_b32 v40, 0xf149f2ca
  v_mov_b32 v41, 0xf149f2ca
  v_mov_b32 v42, 0xf149f2ca
  v_mov_b32 v43, 0xf149f2ca
  v_mov_b32 v44, 0xf149f2ca
  v_mov_b32 v45, 0xf149f2ca
  v_mov_b32 v46, 0xf149f2ca
  v_mov_b32 v47, 0xf149f2ca
  v_mov_b32 v48, 0xf149f2ca
  v_mov_b32 v49, 0xf149f2ca
  v_mov_b32 v50, 0xf149f2ca
  v_mov_b32 v51, 0xf149f2ca
  s_cmp_ge_u32 s28, 6
  s_cbranch_scc1 L_full_81
  v_mov_b32 v52, 0xf149f2ca
  v_mov_b32 v53, 0xf149f2ca
  v_mov_b32 v54, 0xf149f2ca
  v_mov_b32 v55, 0xf149f2ca
  v_mov_b32 v56, 0xf149f2ca
  v_mov_b32 v57, 0xf149f2ca
  v_mov_b32 v58, 0xf149f2ca
  v_mov_b32 v59, 0xf149f2ca
  v_mov_b32 v60, 0xf149f2ca
  v_mov_b32 v61, 0xf149f2ca
  v_mov_b32 v62, 0xf149f2ca
  v_mov_b32 v63, 0xf149f2ca
  v_mov_b32 v64, 0xf149f2ca
  v_mov_b32 v65, 0xf149f2ca
  v_mov_b32 v66, 0xf149f2ca
  v_mov_b32 v67, 0xf149f2ca
  s_cmp_ge_u32 s28, 5
  s_cbranch_scc1 L_full_81
  v_mov_b32 v68, 0xf149f2ca
  v_mov_b32 v69, 0xf149f2ca
  v_mov_b32 v70, 0xf149f2ca
  v_mov_b32 v71, 0xf149f2ca
  v_mov_b32 v72, 0xf149f2ca
  v_mov_b32 v73, 0xf149f2ca
  v_mov_b32 v74, 0xf149f2ca
  v_mov_b32 v75, 0xf149f2ca
  v_mov_b32 v76, 0xf149f2ca
  v_mov_b32 v77, 0xf149f2ca
  v_mov_b32 v78, 0xf149f2ca
  v_mov_b32 v79, 0xf149f2ca
  v_mov_b32 v80, 0xf149f2ca
  v_mov_b32 v81, 0xf149f2ca
  v_mov_b32 v82, 0xf149f2ca
  v_mov_b32 v83, 0xf149f2ca
  s_cmp_ge_u32 s28, 4
  s_cbranch_scc1 L_full_81
  v_mov_b32 v84, 0xf149f2ca
  v_mov_b32 v85, 0xf149f2ca
  v_mov_b32 v86, 0xf149f2ca
  v_mov_b32 v87, 0xf149f2ca
  v_mov_b32 v88, 0xf149f2ca
  v_mov_b32 v89, 0xf149f2ca
  v_mov_b32 v90, 0xf149f2ca
  v_mov_b32 v91, 0xf149f2ca
  v_mov_b32 v92, 0xf149f2ca
  v_mov_b32 v93, 0xf149f2ca
  v_mov_b32 v94, 0xf149f2ca
  v_mov_b32 v95, 0xf149f2ca
  v_mov_b32 v96, 0xf149f2ca
  v_mov_b32 v97, 0xf149f2ca
  v_mov_b32 v98, 0xf149f2ca
  v_mov_b32 v99, 0xf149f2ca
  s_cmp_ge_u32 s28, 3
  s_cbranch_scc1 L_full_81
  v_mov_b32 v100, 0xf149f2ca
  v_mov_b32 v101, 0xf149f2ca
  v_mov_b32 v102, 0xf149f2ca
  v_mov_b32 v103, 0xf149f2ca
  v_mov_b32 v104, 0xf149f2ca
  v_mov_b32 v105, 0xf149f2ca
  v_mov_b32 v106, 0xf149f2ca
  v_mov_b32 v107, 0xf149f2ca
  v_mov_b32 v108, 0xf149f2ca
  v_mov_b32 v109, 0xf149f2ca
  v_mov_b32 v110, 0xf149f2ca
  v_mov_b32 v111, 0xf149f2ca
  v_mov_b32 v112, 0xf149f2ca
  v_mov_b32 v113, 0xf149f2ca
  v_mov_b32 v114, 0xf149f2ca
  v_mov_b32 v115, 0xf149f2ca
  s_cmp_ge_u32 s28, 2
  s_cbranch_scc1 L_full_81
  v_mov_b32 v116, 0xf149f2ca
  v_mov_b32 v117, 0xf149f2ca
  v_mov_b32 v118, 0xf149f2ca
  v_mov_b32 v119, 0xf149f2ca
  v_mov_b32 v120, 0xf149f2ca
  v_mov_b32 v121, 0xf149f2ca
  v_mov_b32 v122, 0xf149f2ca
  v_mov_b32 v123, 0xf149f2ca
  v_mov_b32 v124, 0xf149f2ca
  v_mov_b32 v125, 0xf149f2ca
  v_mov_b32 v126, 0xf149f2ca
  v_mov_b32 v127, 0xf149f2ca
  v_mov_b32 v128, 0xf149f2ca
  v_mov_b32 v129, 0xf149f2ca
  v_mov_b32 v130, 0xf149f2ca
  v_mov_b32 v131, 0xf149f2ca
  s_cmp_ge_u32 s28, 1
  s_cbranch_scc1 L_full_81
  v_mov_b32 v132, 0xf149f2ca
  v_mov_b32 v133, 0xf149f2ca
  v_mov_b32 v134, 0xf149f2ca
  v_mov_b32 v135, 0xf149f2ca
  v_mov_b32 v136, 0xf149f2ca
  v_mov_b32 v137, 0xf149f2ca
  v_mov_b32 v138, 0xf149f2ca
  v_mov_b32 v139, 0xf149f2ca
  v_mov_b32 v140, 0xf149f2ca
  v_mov_b32 v141, 0xf149f2ca
  v_mov_b32 v142, 0xf149f2ca
  v_mov_b32 v143, 0xf149f2ca
  v_mov_b32 v144, 0xf149f2ca
  v_mov_b32 v145, 0xf149f2ca
  v_mov_b32 v146, 0xf149f2ca
  v_mov_b32 v147, 0xf149f2ca
L_full_81:
  v_max_f32 v16, v20, v21
  v_max3_f32 v16, v16, v22, v23
  v_max3_f32 v16, v16, v24, v25
  v_max3_f32 v16, v16, v26, v27
  v_max3_f32 v16, v16, v28, v29
  v_max3_f32 v16, v16, v30, v31
  v_max3_f32 v16, v16, v32, v33
  v_max3_f32 v16, v16, v34, v35
  v_max3_f32 v16, v16, v36, v37
  v_max3_f32 v16, v16, v38, v39
  v_max3_f32 v16, v16, v40, v41
  v_max3_f32 v16, v16, v42, v43
  v_max3_f32 v16, v16, v44, v45
  v_max3_f32 v16, v16, v46, v47
  v_max3_f32 v16, v16, v48, v49
  v_max3_f32 v16, v16, v50, v51
  v_max3_f32 v16, v16, v52, v53
  v_max3_f32 v16, v16, v54, v55
  v_max3_f32 v16, v16, v56, v57
  v_max3_f32 v16, v16, v58, v59
  v_max3_f32 v16, v16, v60, v61
  v_max3_f32 v16, v16, v62, v63
  v_max3_f32 v16, v16, v64, v65
  v_max3_f32 v16, v16, v66, v67
  v_max3_f32 v16, v16, v68, v69
  v_max3_f32 v16, v16, v70, v71
  v_max3_f32 v16, v16, v72, v73
  v_max3_f32 v16, v16, v74, v75
  v_max3_f32 v16, v16, v76, v77
  v_max3_f32 v16, v16, v78, v79
  v_max3_f32 v16, v16, v80, v81
  v_max3_f32 v16, v16, v82, v83
  v_max3_f32 v16, v16, v84, v85
  v_max3_f32 v16, v16, v86, v87
  v_max3_f32 v16, v16, v88, v89
  v_max3_f32 v16, v16, v90, v91
  v_max3_f32 v16, v16, v92, v93
  v_max3_f32 v16, v16, v94, v95
  v_max3_f32 v16, v16, v96, v97
  v_max3_f32 v16, v16, v98, v99
  v_max3_f32 v16, v16, v100, v101
  v_max3_f32 v16, v16, v102, v103
  v_max3_f32 v16, v16, v104, v105
  v_max3_f32 v16, v16, v106, v107
  v_max3_f32 v16, v16, v108, v109
  v_max3_f32 v16, v16, v110, v111
  v_max3_f32 v16, v16, v112, v113
  v_max3_f32 v16, v16, v114, v115
  v_max3_f32 v16, v16, v116, v117
  v_max3_f32 v16, v16, v118, v119
  v_max3_f32 v16, v16, v120, v121
  v_max3_f32 v16, v16, v122, v123
  v_max3_f32 v16, v16, v124, v125
  v_max3_f32 v16, v16, v126, v127
  v_max3_f32 v16, v16, v128, v129
  v_max3_f32 v16, v16, v130, v131
  v_max3_f32 v16, v16, v132, v133
  v_max3_f32 v16, v16, v134, v135
  v_max3_f32 v16, v16, v136, v137
  v_max3_f32 v16, v16, v138, v139
  v_max3_f32 v16, v16, v140, v141
  v_max3_f32 v16, v16, v142, v143
  v_max3_f32 v16, v16, v144, v145
  v_max3_f32 v16, v16, v146, v147
  v_max3_f32 v16, v16, v148, v149
  v_max3_f32 v16, v16, v150, v151
  v_max3_f32 v16, v16, v152, v153
  v_max3_f32 v16, v16, v154, v155
  v_max3_f32 v16, v16, v156, v157
  v_max3_f32 v16, v16, v158, v159
  v_max3_f32 v16, v16, v160, v161
  v_max3_f32 v16, v16, v162, v163
  v_mov_b32 v17, v16
  s_nop 1
  v_permlane32_swap_b32 v16, v17
  v_max_f32 v16, v16, v17
  v_sub_f32 v20, v20, v16
  v_sub_f32 v21, v21, v16
  v_sub_f32 v22, v22, v16
  v_sub_f32 v23, v23, v16
  v_sub_f32 v24, v24, v16
  v_sub_f32 v25, v25, v16
  v_sub_f32 v26, v26, v16
  v_sub_f32 v27, v27, v16
  v_sub_f32 v28, v28, v16
  v_sub_f32 v29, v29, v16
  v_sub_f32 v30, v30, v16
  v_sub_f32 v31, v31, v16
  v_sub_f32 v32, v32, v16
  v_sub_f32 v33, v33, v16
  v_sub_f32 v34, v34, v16
  v_sub_f32 v35, v35, v16
  v_exp_f32 v20, v20
  v_exp_f32 v21, v21
  v_exp_f32 v22, v22
  v_exp_f32 v23, v23
  v_exp_f32 v24, v24
  v_exp_f32 v25, v25
  v_exp_f32 v26, v26
  v_exp_f32 v27, v27
  v_exp_f32 v28, v28
  v_exp_f32 v29, v29
  v_exp_f32 v30, v30
  v_exp_f32 v31, v31
  v_exp_f32 v32, v32
  v_exp_f32 v33, v33
  v_exp_f32 v34, v34
  v_exp_f32 v35, v35
  v_cvt_pk_bf16_f32 v224, v20, v24
  v_cvt_pk_bf16_f32 v225, v28, v32
  v_cvt_pk_bf16_f32 v226, v21, v25
  v_cvt_pk_bf16_f32 v227, v29, v33
  v_cvt_pk_bf16_f32 v228, v22, v26
  v_cvt_pk_bf16_f32 v229, v30, v34
  v_cvt_pk_bf16_f32 v230, v23, v27
  v_cvt_pk_bf16_f32 v231, v31, v35
  v_mfma_f32_32x32x16_bf16 v[196:211], a[132:135], v[224:227], 0
  s_nop 0
  v_mfma_f32_32x32x16_bf16 v[196:211], a[136:139], v[228:231], v[196:211]
  v_sub_f32 v36, v36, v16
  v_sub_f32 v37, v37, v16
  v_sub_f32 v38, v38, v16
  v_sub_f32 v39, v39, v16
  v_sub_f32 v40, v40, v16
  v_sub_f32 v41, v41, v16
  v_sub_f32 v42, v42, v16
  v_sub_f32 v43, v43, v16
  v_sub_f32 v44, v44, v16
  v_sub_f32 v45, v45, v16
  v_sub_f32 v46, v46, v16
  v_sub_f32 v47, v47, v16
  v_sub_f32 v48, v48, v16
  v_sub_f32 v49, v49, v16
  v_sub_f32 v50, v50, v16
  v_sub_f32 v51, v51, v16
  v_exp_f32 v36, v36
  v_exp_f32 v37, v37
  v_exp_f32 v38, v38
  v_exp_f32 v39, v39
  v_exp_f32 v40, v40
  v_exp_f32 v41, v41
  v_exp_f32 v42, v42
  v_exp_f32 v43, v43
  v_exp_f32 v44, v44
  v_exp_f32 v45, v45
  v_exp_f32 v46, v46
  v_exp_f32 v47, v47
  v_exp_f32 v48, v48
  v_exp_f32 v49, v49
  v_exp_f32 v50, v50
  v_exp_f32 v51, v51
  v_cvt_pk_bf16_f32 v232, v36, v40
  v_cvt_pk_bf16_f32 v233, v44, v48
  v_cvt_pk_bf16_f32 v234, v37, v41
  v_cvt_pk_bf16_f32 v235, v45, v49
  v_cvt_pk_bf16_f32 v236, v38, v42
  v_cvt_pk_bf16_f32 v237, v46, v50
  v_cvt_pk_bf16_f32 v238, v39, v43
  v_cvt_pk_bf16_f32 v239, v47, v51
  v_mfma_f32_32x32x16_bf16 v[196:211], a[146:149], v[232:235], v[196:211]
  s_nop 0
  v_mfma_f32_32x32x16_bf16 v[196:211], a[150:153], v[236:239], v[196:211]
  v_sub_f32 v52, v52, v16
  v_sub_f32 v53, v53, v16
  v_sub_f32 v54, v54, v16
  v_sub_f32 v55, v55, v16
  v_sub_f32 v56, v56, v16
  v_sub_f32 v57, v57, v16
  v_sub_f32 v58, v58, v16
  v_sub_f32 v59, v59, v16
  v_sub_f32 v60, v60, v16
  v_sub_f32 v61, v61, v16
  v_sub_f32 v62, v62, v16
  v_sub_f32 v63, v63, v16
  v_sub_f32 v64, v64, v16
  v_sub_f32 v65, v65, v16
  v_sub_f32 v66, v66, v16
  v_sub_f32 v67, v67, v16
  v_exp_f32 v52, v52
  v_exp_f32 v53, v53
  v_exp_f32 v54, v54
  v_exp_f32 v55, v55
  v_exp_f32 v56, v56
  v_exp_f32 v57, v57
  v_exp_f32 v58, v58
  v_exp_f32 v59, v59
  v_exp_f32 v60, v60
  v_exp_f32 v61, v61
  v_exp_f32 v62, v62
  v_exp_f32 v63, v63
  v_exp_f32 v64, v64
  v_exp_f32 v65, v65
  v_exp_f32 v66, v66
  v_exp_f32 v67, v67
  v_cvt_pk_bf16_f32 v224, v52, v56
  v_cvt_pk_bf16_f32 v225, v60, v64
  v_cvt_pk_bf16_f32 v226, v53, v57
  v_cvt_pk_bf16_f32 v227, v61, v65
  v_cvt_pk_bf16_f32 v228, v54, v58
  v_cvt_pk_bf16_f32 v229, v62, v66
  v_cvt_pk_bf16_f32 v230, v55, v59
  v_cvt_pk_bf16_f32 v231, v63, v67
  v_mfma_f32_32x32x16_bf16 v[196:211], a[160:163], v[224:227], v[196:211]
  s_nop 0
  v_mfma_f32_32x32x16_bf16 v[196:211], a[164:167], v[228:231], v[196:211]
  v_sub_f32 v68, v68, v16
  v_sub_f32 v69, v69, v16
  v_sub_f32 v70, v70, v16
  v_sub_f32 v71, v71, v16
  v_sub_f32 v72, v72, v16
  v_sub_f32 v73, v73, v16
  v_sub_f32 v74, v74, v16
  v_sub_f32 v75, v75, v16
  v_sub_f32 v76, v76, v16
  v_sub_f32 v77, v77, v16
  v_sub_f32 v78, v78, v16
  v_sub_f32 v79, v79, v16
  v_sub_f32 v80, v80, v16
  v_sub_f32 v81, v81, v16
  v_sub_f32 v82, v82, v16
  v_sub_f32 v83, v83, v16
  v_exp_f32 v68, v68
  v_exp_f32 v69, v69
  v_exp_f32 v70, v70
  v_exp_f32 v71, v71
  v_exp_f32 v72, v72
  v_exp_f32 v73, v73
  v_exp_f32 v74, v74
  v_exp_f32 v75, v75
  v_exp_f32 v76, v76
  v_exp_f32 v77, v77
  v_exp_f32 v78, v78
  v_exp_f32 v79, v79
  v_exp_f32 v80, v80
  v_exp_f32 v81, v81
  v_exp_f32 v82, v82
  v_exp_f32 v83, v83
  v_cvt_pk_bf16_f32 v232, v68, v72
  v_cvt_pk_bf16_f32 v233, v76, v80
  v_cvt_pk_bf16_f32 v234, v69, v73
  v_cvt_pk_bf16_f32 v235, v77, v81
  v_cvt_pk_bf16_f32 v236, v70, v74
  v_cvt_pk_bf16_f32 v237, v78, v82
  v_cvt_pk_bf16_f32 v238, v71, v75
  v_cvt_pk_bf16_f32 v239, v79, v83
  v_mfma_f32_32x32x16_bf16 v[196:211], a[174:177], v[232:235], v[196:211]
  s_nop 0
  v_mfma_f32_32x32x16_bf16 v[196:211], a[178:181], v[236:239], v[196:211]
  v_sub_f32 v84, v84, v16
  v_sub_f32 v85, v85, v16
  v_sub_f32 v86, v86, v16
  v_sub_f32 v87, v87, v16
  v_sub_f32 v88, v88, v16
  v_sub_f32 v89, v89, v16
  v_sub_f32 v90, v90, v16
  v_sub_f32 v91, v91, v16
  v_sub_f32 v92, v92, v16
  v_sub_f32 v93, v93, v16
  v_sub_f32 v94, v94, v16
  v_sub_f32 v95, v95, v16
  v_sub_f32 v96, v96, v16
  v_sub_f32 v97, v97, v16
  v_sub_f32 v98, v98, v16
  v_sub_f32 v99, v99, v16
  v_exp_f32 v84, v84
  v_exp_f32 v85, v85
  v_exp_f32 v86, v86
  v_exp_f32 v87, v87
  v_exp_f32 v88, v88
  v_exp_f32 v89, v89
  v_exp_f32 v90, v90
  v_exp_f32 v91, v91
  v_exp_f32 v92, v92
  v_exp_f32 v93, v93
  v_exp_f32 v94, v94
  v_exp_f32 v95, v95
  v_exp_f32 v96, v96
  v_exp_f32 v97, v97
  v_exp_f32 v98, v98
  v_exp_f32 v99, v99
  v_cvt_pk_bf16_f32 v224, v84, v88
  v_cvt_pk_bf16_f32 v225, v92, v96
  v_cvt_pk_bf16_f32 v226, v85, v89
  v_cvt_pk_bf16_f32 v227, v93, v97
  v_cvt_pk_bf16_f32 v228, v86, v90
  v_cvt_pk_bf16_f32 v229, v94, v98
  v_cvt_pk_bf16_f32 v230, v87, v91
  v_cvt_pk_bf16_f32 v231, v95, v99
  v_mfma_f32_32x32x16_bf16 v[196:211], a[188:191], v[224:227], v[196:211]
  s_nop 0
  v_mfma_f32_32x32x16_bf16 v[196:211], a[192:195], v[228:231], v[196:211]
  v_sub_f32 v100, v100, v16
  v_sub_f32 v101, v101, v16
  v_sub_f32 v102, v102, v16
  v_sub_f32 v103, v103, v16
  v_sub_f32 v104, v104, v16
  v_sub_f32 v105, v105, v16
  v_sub_f32 v106, v106, v16
  v_sub_f32 v107, v107, v16
  v_sub_f32 v108, v108, v16
  v_sub_f32 v109, v109, v16
  v_sub_f32 v110, v110, v16
  v_sub_f32 v111, v111, v16
  v_sub_f32 v112, v112, v16
  v_sub_f32 v113, v113, v16
  v_sub_f32 v114, v114, v16
  v_sub_f32 v115, v115, v16
  v_exp_f32 v100, v100
  v_exp_f32 v101, v101
  v_exp_f32 v102, v102
  v_exp_f32 v103, v103
  v_exp_f32 v104, v104
  v_exp_f32 v105, v105
  v_exp_f32 v106, v106
  v_exp_f32 v107, v107
  v_exp_f32 v108, v108
  v_exp_f32 v109, v109
  v_exp_f32 v110, v110
  v_exp_f32 v111, v111
  v_exp_f32 v112, v112
  v_exp_f32 v113, v113
  v_exp_f32 v114, v114
  v_exp_f32 v115, v115
  v_cvt_pk_bf16_f32 v232, v100, v104
  v_cvt_pk_bf16_f32 v233, v108, v112
  v_cvt_pk_bf16_f32 v234, v101, v105
  v_cvt_pk_bf16_f32 v235, v109, v113
  v_cvt_pk_bf16_f32 v236, v102, v106
  v_cvt_pk_bf16_f32 v237, v110, v114
  v_cvt_pk_bf16_f32 v238, v103, v107
  v_cvt_pk_bf16_f32 v239, v111, v115
  v_mfma_f32_32x32x16_bf16 v[196:211], a[202:205], v[232:235], v[196:211]
  s_nop 0
  v_mfma_f32_32x32x16_bf16 v[196:211], a[206:209], v[236:239], v[196:211]
  v_sub_f32 v116, v116, v16
  v_sub_f32 v117, v117, v16
  v_sub_f32 v118, v118, v16
  v_sub_f32 v119, v119, v16
  v_sub_f32 v120, v120, v16
  v_sub_f32 v121, v121, v16
  v_sub_f32 v122, v122, v16
  v_sub_f32 v123, v123, v16
  v_sub_f32 v124, v124, v16
  v_sub_f32 v125, v125, v16
  v_sub_f32 v126, v126, v16
  v_sub_f32 v127, v127, v16
  v_sub_f32 v128, v128, v16
  v_sub_f32 v129, v129, v16
  v_sub_f32 v130, v130, v16
  v_sub_f32 v131, v131, v16
  v_exp_f32 v116, v116
  v_exp_f32 v117, v117
  v_exp_f32 v118, v118
  v_exp_f32 v119, v119
  v_exp_f32 v120, v120
  v_exp_f32 v121, v121
  v_exp_f32 v122, v122
  v_exp_f32 v123, v123
  v_exp_f32 v124, v124
  v_exp_f32 v125, v125
  v_exp_f32 v126, v126
  v_exp_f32 v127, v127
  v_exp_f32 v128, v128
  v_exp_f32 v129, v129
  v_exp_f32 v130, v130
  v_exp_f32 v131, v131
  v_cvt_pk_bf16_f32 v224, v116, v120
  v_cvt_pk_bf16_f32 v225, v124, v128
  v_cvt_pk_bf16_f32 v226, v117, v121
  v_cvt_pk_bf16_f32 v227, v125, v129
  v_cvt_pk_bf16_f32 v228, v118, v122
  v_cvt_pk_bf16_f32 v229, v126, v130
  v_cvt_pk_bf16_f32 v230, v119, v123
  v_cvt_pk_bf16_f32 v231, v127, v131
  v_mfma_f32_32x32x16_bf16 v[196:211], a[216:219], v[224:227], v[196:211]
  s_nop 0
  v_mfma_f32_32x32x16_bf16 v[196:211], a[220:223], v[228:231], v[196:211]
  v_sub_f32 v132, v132, v16
  v_sub_f32 v133, v133, v16
  v_sub_f32 v134, v134, v16
  v_sub_f32 v135, v135, v16
  v_sub_f32 v136, v136, v16
  v_sub_f32 v137, v137, v16
  v_sub_f32 v138, v138, v16
  v_sub_f32 v139, v139, v16
  v_sub_f32 v140, v140, v16
  v_sub_f32 v141, v141, v16
  v_sub_f32 v142, v142, v16
  v_sub_f32 v143, v143, v16
  v_sub_f32 v144, v144, v16
  v_sub_f32 v145, v145, v16
  v_sub_f32 v146, v146, v16
  v_sub_f32 v147, v147, v16
  v_exp_f32 v132, v132
  v_exp_f32 v133, v133
  v_exp_f32 v134, v134
  v_exp_f32 v135, v135
  v_exp_f32 v136, v136
  v_exp_f32 v137, v137
  v_exp_f32 v138, v138
  v_exp_f32 v139, v139
  v_exp_f32 v140, v140
  v_exp_f32 v141, v141
  v_exp_f32 v142, v142
  v_exp_f32 v143, v143
  v_exp_f32 v144, v144
  v_exp_f32 v145, v145
  v_exp_f32 v146, v146
  v_exp_f32 v147, v147
  v_cvt_pk_bf16_f32 v232, v132, v136
  v_cvt_pk_bf16_f32 v233, v140, v144
  v_cvt_pk_bf16_f32 v234, v133, v137
  v_cvt_pk_bf16_f32 v235, v141, v145
  v_cvt_pk_bf16_f32 v236, v134, v138
  v_cvt_pk_bf16_f32 v237, v142, v146
  v_cvt_pk_bf16_f32 v238, v135, v139
  v_cvt_pk_bf16_f32 v239, v143, v147
  v_mfma_f32_32x32x16_bf16 v[196:211], a[230:233], v[232:235], v[196:211]
  s_nop 0
  v_mfma_f32_32x32x16_bf16 v[196:211], a[234:237], v[236:239], v[196:211]
  v_sub_f32 v148, v148, v16
  v_sub_f32 v149, v149, v16
  v_sub_f32 v150, v150, v16
  v_sub_f32 v151, v151, v16
  v_sub_f32 v152, v152, v16
  v_sub_f32 v153, v153, v16
  v_sub_f32 v154, v154, v16
  v_sub_f32 v155, v155, v16
  v_sub_f32 v156, v156, v16
  v_sub_f32 v157, v157, v16
  v_sub_f32 v158, v158, v16
  v_sub_f32 v159, v159, v16
  v_sub_f32 v160, v160, v16
  v_sub_f32 v161, v161, v16
  v_sub_f32 v162, v162, v16
  v_sub_f32 v163, v163, v16
  v_exp_f32 v148, v148
  v_exp_f32 v149, v149
  v_exp_f32 v150, v150
  v_exp_f32 v151, v151
  v_exp_f32 v152, v152
  v_exp_f32 v153, v153
  v_exp_f32 v154, v154
  v_exp_f32 v155, v155
  v_exp_f32 v156, v156
  v_exp_f32 v157, v157
  v_exp_f32 v158, v158
  v_exp_f32 v159, v159
  v_exp_f32 v160, v160
  v_exp_f32 v161, v161
  v_exp_f32 v162, v162
  v_exp_f32 v163, v163
  v_cvt_pk_bf16_f32 v224, v148, v152
  v_cvt_pk_bf16_f32 v225, v156, v160
  v_cvt_pk_bf16_f32 v226, v149, v153
  v_cvt_pk_bf16_f32 v227, v157, v161
  v_cvt_pk_bf16_f32 v228, v150, v154
  v_cvt_pk_bf16_f32 v229, v158, v162
  v_cvt_pk_bf16_f32 v230, v151, v155
  v_cvt_pk_bf16_f32 v231, v159, v163
  v_mfma_f32_32x32x16_bf16 v[196:211], a[244:247], v[224:227], v[196:211]
  s_nop 0
  v_mfma_f32_32x32x16_bf16 v[196:211], a[248:251], v[228:231], v[196:211]
  s_nop 11
  v_rcp_f32 v16, v208
  s_nop 0
  v_mul_f32 v196, v196, v16
  v_mul_f32 v197, v197, v16
  v_mul_f32 v198, v198, v16
  v_mul_f32 v199, v199, v16
  v_mul_f32 v200, v200, v16
  v_mul_f32 v201, v201, v16
  v_mul_f32 v202, v202, v16
  v_mul_f32 v203, v203, v16
  v_mul_f32 v204, v204, v16
  v_mul_f32 v205, v205, v16
  v_mul_f32 v206, v206, v16
  v_mul_f32 v207, v207, v16
  v_cvt_pk_bf16_f32 v240, v196, v197
  v_cvt_pk_bf16_f32 v241, v198, v199
  v_cvt_pk_bf16_f32 v242, v200, v201
  v_cvt_pk_bf16_f32 v243, v202, v203
  s_mov_b64 exec, s[26:27]
  v_cvt_pk_bf16_f32 v246, v204, v205
  v_cvt_pk_bf16_f32 v247, v206, v207
  s_mov_b64 exec, -1
  buffer_store_dwordx4 v[240:243], v1, s[4:7], s16 offen offset:3072 sc1
  s_add_u32 s16, s16, 4096
  buffer_store_dwordx4 v[244:247], v1, s[4:7], s16 offen sc1
  s_waitcnt vmcnt(0)
  s_barrier
  s_cmp_lg_u32 s10, 0
  s_cbranch_scc1 L_arr_82
  v_mov_b32 v16, 1
  s_mov_b64 exec, 1
  buffer_atomic_add v16, v1, s[84:87], 48 offen
  s_mov_b64 exec, -1
L_arr_82:
  s_cmp_ge_u32 s9, 96
  s_cbranch_scc1 L_third
  s_mul_i32 s30, s9, 171
  s_lshr_b32 s30, s30, 10
  s_mul_i32 s36, s30, 6
  s_sub_u32 s28, s9, s36
  s_load_dwordx2 s[92:93], s[0:1], 40
  s_waitcnt lgkmcnt(0)
  s_mov_b32 s94, 5242880
  s_mov_b32 s95, 0x20000
  s_mul_i32 s13, s30, 327680
  s_mul_i32 s36, s10, 320
  s_add_u32 s13, s13, s36
  v_lshrrev_b32 v16, 5, v0
  v_lshlrev_b32 v16, 9, v16
  v_and_b32 v17, 12, v0
  v_lshl_add_u32 v16, v17, 4, v16
  v_lshrrev_b32 v17, 2, v0
  v_and_b32 v17, 4, v17
  v_and_or_b32 v17, v0, 3, v17
  v_and_b32 v18, 1, v17
  v_lshrrev_b32 v17, 1, v17
  v_lshl_add_u32 v17, v18, 2, v17
  v_lshl_add_u32 v16, v17, 3, v16
  v_add_u32 v2, s24, v16
  v_bfe_u32 v16, v0, 2, 2
  v_bfe_u32 v17, v0, 4, 1
  v_mad_u32_u24 v16, v17, 8, v16
  v_lshrrev_b32 v17, 5, v0
  v_mad_u32_u24 v16, v17, 4, v16
  v_mul_u32_u24 v16, 1280, v16
  v_and_b32 v17, 3, v0
  v_lshl_add_u32 v3, v17, 4, v16
  s_waitcnt vmcnt(0) lgkmcnt(0)
  s_barrier
  s_add_u32 m0, s24, 0
  s_add_u32 s36, s13, 0
  buffer_load_dwordx4 v3, s[92:95], s36 offen lds
  s_add_u32 m0, s24, 1024
  s_add_u32 s36, s13, 64
  buffer_load_dwordx4 v3, s[92:95], s36 offen lds
  s_add_u32 m0, s24, 2048
  s_add_u32 s36, s13, 128
  buffer_load_dwordx4 v3, s[92:95], s36 offen lds
  s_add_u32 m0, s24, 3072
  s_add_u32 s36, s13, 192
  buffer_load_dwordx4 v3, s[92:95], s36 offen lds
  s_add_u32 m0, s24, 4096
  s_add_u32 s36, s13, 256
  buffer_load_dwordx4 v3, s[92:95], s36 offen lds
  s_add_u32 m0, s24, 5120
  s_add_u32 s36, s13, 20480
  buffer_load_dwordx4 v3, s[92:95], s36 offen lds
  s_add_u32 m0, s24, 6144
  s_add_u32 s36, s13, 20544
  buffer_load_dwordx4 v3, s[92:95], s36 offen lds
  s_add_u32 m0, s24, 7168
  s_add_u32 s36, s13, 20608
  buffer_load_dwordx4 v3, s[92:95], s36 offen lds
  s_add_u32 m0, s24, 8192
  s_add_u32 s36, s13, 20672
  buffer_load_dwordx4 v3, s[92:95], s36 offen lds
  s_add_u32 m0, s24, 9216
  s_add_u32 s36, s13, 20736
  buffer_load_dwordx4 v3, s[92:95], s36 offen lds
  s_add_u32 m0, s24, 10240
  s_add_u32 s36, s13, 40960
  buffer_load_dwordx4 v3, s[92:95], s36 offen lds
  s_add_u32 m0, s24, 11264
  s_add_u32 s36, s13, 41024
  buffer_load_dwordx4 v3, s[92:95], s36 offen lds
  s_add_u32 m0, s24, 12288
  s_add_u32 s36, s13, 41088
  buffer_load_dwordx4 v3, s[92:95], s36 offen lds
  s_add_u32 m0, s24, 13312
  s_add_u32 s36, s13, 41152
  buffer_load_dwordx4 v3, s[92:95], s36 offen lds
  s_add_u32 m0, s24, 14336
  s_add_u32 s36, s13, 41216
  buffer_load_dwordx4 v3, s[92:95], s36 offen lds
  s_add_u32 m0, s24, 15360
  s_add_u32 s36, s13, 61440
  buffer_load_dwordx4 v3, s[92:95], s36 offen lds
  s_add_u32 m0, s24, 16384
  s_add_u32 s36, s13, 61504
  buffer_load_dwordx4 v3, s[92:95], s36 offen lds
  s_add_u32 m0, s24, 17408
  s_add_u32 s36, s13, 61568
  buffer_load_dwordx4 v3, s[92:95], s36 offen lds
  s_add_u32 m0, s24, 18432
  s_add_u32 s36, s13, 61632
  buffer_load_dwordx4 v3, s[92:95], s36 offen lds
  s_add_u32 m0, s24, 19456
  s_add_u32 s36, s13, 61696
  buffer_load_dwordx4 v3, s[92:95], s36 offen lds
  s_add_u32 m0, s24, 20480
  s_add_u32 s36, s13, 81920
  buffer_load_dwordx4 v3, s[92:95], s36 offen lds
  s_add_u32 m0, s24, 21504
  s_add_u32 s36, s13, 81984
  buffer_load_dwordx4 v3, s[92:95], s36 offen lds
  s_add_u32 m0, s24, 22528
  s_add_u32 s36, s13, 82048
  buffer_load_dwordx4 v3, s[92:95], s36 offen lds
  s_add_u32 m0, s24, 23552
  s_add_u32 s36, s13, 82112
  buffer_load_dwordx4 v3, s[92:95], s36 offen lds
  s_add_u32 m0, s24, 24576
  s_add_u32 s36, s13, 82176
  buffer_load_dwordx4 v3, s[92:95], s36 offen lds
  s_add_u32 m0, s24, 25600
  s_add_u32 s36, s13, 102400
  buffer_load_dwordx4 v3, s[92:95], s36 offen lds
  s_add_u32 m0, s24, 26624
  s_add_u32 s36, s13, 102464
  buffer_load_dwordx4 v3, s[92:95], s36 offen lds
  s_add_u32 m0, s24, 27648
  s_add_u32 s36, s13, 102528
  buffer_load_dwordx4 v3, s[92:95], s36 offen lds
  s_add_u32 m0, s24, 28672
  s_add_u32 s36, s13, 102592
  buffer_load_dwordx4 v3, s[92:95], s36 offen lds
  s_add_u32 m0, s24, 29696
  s_add_u32 s36, s13, 102656
  buffer_load_dwordx4 v3, s[92:95], s36 offen lds
  s_add_u32 m0, s24, 30720
  s_add_u32 s36, s13, 122880
  buffer_load_dwordx4 v3, s[92:95], s36 offen lds
  s_add_u32 m0, s24, 31744
  s_add_u32 s36, s13, 122944
  buffer_load_dwordx4 v3, s[92:95], s36 offen lds
  s_waitcnt vmcnt(24)
  ds_read_b64_tr_b16 v[192:193], v2 offset:0
  ds_read_b64_tr_b16 v[194:195], v2 offset:256
  ds_read_b64_tr_b16 a[0:1], v2 offset:1024
  ds_read_b64_tr_b16 a[2:3], v2 offset:1280
  ds_read_b64_tr_b16 a[64:65], v2 offset:2048
  ds_read_b64_tr_b16 a[66:67], v2 offset:2304
  ds_read_b64_tr_b16 a[128:129], v2 offset:3072
  ds_read_b64_tr_b16 a[130:131], v2 offset:3328
  s_waitcnt lgkmcnt(0)
  ds_read_b64_tr_b16 a[192:193], v2 offset:4096
  ds_read_b64_tr_b16 a[194:195], v2 offset:4352
  ds_read_b64_tr_b16 v[196:197], v2 offset:5120
  ds_read_b64_tr_b16 v[198:199], v2 offset:5376
  ds_read_b64_tr_b16 a[4:5], v2 offset:6144
  ds_read_b64_tr_b16 a[6:7], v2 offset:6400
  ds_read_b64_tr_b16 a[68:69], v2 offset:7168
  ds_read_b64_tr_b16 a[70:71], v2 offset:7424
  s_waitcnt lgkmcnt(0)
  s_add_u32 m0, s24, 0
  s_add_u32 s36, s13, 123008
  buffer_load_dwordx4 v3, s[92:95], s36 offen lds
  s_add_u32 m0, s24, 1024
  s_add_u32 s36, s13, 123072
  buffer_load_dwordx4 v3, s[92:95], s36 offen lds
  s_add_u32 m0, s24, 2048
  s_add_u32 s36, s13, 123136
  buffer_load_dwordx4 v3, s[92:95], s36 offen lds
  s_add_u32 m0, s24, 3072
  s_add_u32 s36, s13, 143360
  buffer_load_dwordx4 v3, s[92:95], s36 offen lds
  s_add_u32 m0, s24, 4096
  s_add_u32 s36, s13, 143424
  buffer_load_dwordx4 v3, s[92:95], s36 offen lds
  s_add_u32 m0, s24, 5120
  s_add_u32 s36, s13, 143488
  buffer_load_dwordx4 v3, s[92:95], s36 offen lds
  s_add_u32 m0, s24, 6144
  s_add_u32 s36, s13, 143552
  buffer_load_dwordx4 v3, s[92:95], s36 offen lds
  s_add_u32 m0, s24, 7168
  s_add_u32 s36, s13, 143616
  buffer_load_dwordx4 v3, s[92:95], s36 offen lds
  s_waitcnt vmcnt(24)
  ds_read_b64_tr_b16 a[132:133], v2 offset:8192
  ds_read_b64_tr_b16 a[134:135], v2 offset:8448
  ds_read_b64_tr_b16 a[196:197], v2 offset:9216
  ds_read_b64_tr_b16 a[198:199], v2 offset:9472
  ds_read_b64_tr_b16 v[200:201], v2 offset:10240
  ds_read_b64_tr_b16 v[202:203], v2 offset:10496
  ds_read_b64_tr_b16 a[8:9], v2 offset:11264
  ds_read_b64_tr_b16 a[10:11], v2 offset:11520
  s_waitcnt lgkmcnt(0)
  ds_read_b64_tr_b16 a[72:73], v2 offset:12288
  ds_read_b64_tr_b16 a[74:75], v2 offset:12544
  ds_read_b64_tr_b16 a[136:137], v2 offset:13312
  ds_read_b64_tr_b16 a[138:139], v2 offset:13568
  ds_read_b64_tr_b16 a[200:201], v2 offset:14336
  ds_read_b64_tr_b16 a[202:203], v2 offset:14592
  ds_read_b64_tr_b16 v[204:205], v2 offset:15360
  ds_read_b64_tr_b16 v[206:207], v2 offset:15616
  s_waitcnt lgkmcnt(0)
  s_add_u32 m0, s24, 8192
  s_add_u32 s36, s13, 163840
  buffer_load_dwordx4 v3, s[92:95], s36 offen lds
  s_add_u32 m0, s24, 9216
  s_add_u32 s36, s13, 163904
  buffer_load_dwordx4 v3, s[92:95], s36 offen lds
  s_add_u32 m0, s24, 10240
  s_add_u32 s36, s13, 163968
  buffer_load_dwordx4 v3, s[92:95], s36 offen lds
  s_add_u32 m0, s24, 11264
  s_add_u32 s36, s13, 164032
  buffer_load_dwordx4 v3, s[92:95], s36 offen lds
  s_add_u32 m0, s24, 12288
  s_add_u32 s36, s13, 164096
  buffer_load_dwordx4 v3, s[92:95], s36 offen lds
  s_add_u32 m0, s24, 13312
  s_add_u32 s36, s13, 184320
  buffer_load_dwordx4 v3, s[92:95], s36 offen lds
  s_add_u32 m0, s24, 14336
  s_add_u32 s36, s13, 184384
  buffer_load_dwordx4 v3, s[92:95], s36 offen lds
  s_add_u32 m0, s24, 15360
  s_add_u32 s36, s13, 184448
  buffer_load_dwordx4 v3, s[92:95], s36 offen lds
  s_waitcnt vmcnt(24)
  ds_read_b64_tr_b16 a[12:13], v2 offset:16384
  ds_read_b64_tr_b16 a[14:15], v2 offset:16640
  ds_read_b64_tr_b16 a[76:77], v2 offset:17408
  ds_read_b64_tr_b16 a[78:79], v2 offset:17664
  ds_read_b64_tr_b16 a[140:141], v2 offset:18432
  ds_read_b64_tr_b16 a[142:143], v2 offset:18688
  ds_read_b64_tr_b16 a[204:205], v2 offset:19456
  ds_read_b64_tr_b16 a[206:207], v2 offset:19712
  s_waitcnt lgkmcnt(0)
  ds_read_b64_tr_b16 v[208:209], v2 offset:20480
  ds_read_b64_tr_b16 v[210:211], v2 offset:20736
  ds_read_b64_tr_b16 a[16:17], v2 offset:21504
  ds_read_b64_tr_b16 a[18:19], v2 offset:21760
  ds_read_b64_tr_b16 a[80:81], v2 offset:22528
  ds_read_b64_tr_b16 a[82:83], v2 offset:22784
  ds_read_b64_tr_b16 a[144:145], v2 offset:23552
  ds_read_b64_tr_b16 a[146:147], v2 offset:23808
  s_waitcnt lgkmcnt(0)
  s_add_u32 m0, s24, 16384
  s_add_u32 s36, s13, 184512
  buffer_load_dwordx4 v3, s[92:95], s36 offen lds
  s_add_u32 m0, s24, 17408
  s_add_u32 s36, s13, 184576
  buffer_load_dwordx4 v3, s[92:95], s36 offen lds
  s_add_u32 m0, s24, 18432
  s_add_u32 s36, s13, 204800
  buffer_load_dwordx4 v3, s[92:95], s36 offen lds
  s_add_u32 m0, s24, 19456
  s_add_u32 s36, s13, 204864
  buffer_load_dwordx4 v3, s[92:95], s36 offen lds
  s_add_u32 m0, s24, 20480
  s_add_u32 s36, s13, 204928
  buffer_load_dwordx4 v3, s[92:95], s36 offen lds
  s_add_u32 m0, s24, 21504
  s_add_u32 s36, s13, 204992
  buffer_load_dwordx4 v3, s[92:95], s36 offen lds
  s_add_u32 m0, s24, 22528
  s_add_u32 s36, s13, 205056
  buffer_load_dwordx4 v3, s[92:95], s36 offen lds
  s_add_u32 m0, s24, 23552
  s_add_u32 s36, s13, 225280
  buffer_load_dwordx4 v3, s[92:95], s36 offen lds
  s_waitcnt vmcnt(24)
  ds_read_b64_tr_b16 a[208:209], v2 offset:24576
  ds_read_b64_tr_b16 a[210:211], v2 offset:24832
  ds_read_b64_tr_b16 v[212:213], v2 offset:25600
  ds_read_b64_tr_b16 v[214:215], v2 offset:25856
  ds_read_b64_tr_b16 a[20:21], v2 offset:26624
  ds_read_b64_tr_b16 a[22:23], v2 offset:26880
  ds_read_b64_tr_b16 a[84:85], v2 offset:27648
  ds_read_b64_tr_b16 a[86:87], v2 offset:27904
  s_waitcnt lgkmcnt(0)
  ds_read_b64_tr_b16 a[148:149], v2 offset:28672
  ds_read_b64_tr_b16 a[150:151], v2 offset:28928
  ds_read_b64_tr_b16 a[212:213], v2 offset:29696
  ds_read_b64_tr_b16 a[214:215], v2 offset:29952
  ds_read_b64_tr_b16 v[216:217], v2 offset:30720
  ds_read_b64_tr_b16 v[218:219], v2 offset:30976
  ds_read_b64_tr_b16 a[24:25], v2 offset:31744
  ds_read_b64_tr_b16 a[26:27], v2 offset:32000
  s_waitcnt lgkmcnt(0)
  s_add_u32 m0, s24, 24576
  s_add_u32 s36, s13, 225344
  buffer_load_dwordx4 v3, s[92:95], s36 offen lds
  s_add_u32 m0, s24, 25600
  s_add_u32 s36, s13, 225408
  buffer_load_dwordx4 v3, s[92:95], s36 offen lds
  s_add_u32 m0, s24, 26624
  s_add_u32 s36, s13, 225472
  buffer_load_dwordx4 v3, s[92:95], s36 offen lds
  s_add_u32 m0, s24, 27648
  s_add_u32 s36, s13, 225536
  buffer_load_dwordx4 v3, s[92:95], s36 offen lds
  s_add_u32 m0, s24, 28672
  s_add_u32 s36, s13, 245760
  buffer_load_dwordx4 v3, s[92:95], s36 offen lds
  s_add_u32 m0, s24, 29696
  s_add_u32 s36, s13, 245824
  buffer_load_dwordx4 v3, s[92:95], s36 offen lds
  s_add_u32 m0, s24, 30720
  s_add_u32 s36, s13, 245888
  buffer_load_dwordx4 v3, s[92:95], s36 offen lds
  s_add_u32 m0, s24, 31744
  s_add_u32 s36, s13, 245952
  buffer_load_dwordx4 v3, s[92:95], s36 offen lds
  s_waitcnt vmcnt(24)
  ds_read_b64_tr_b16 a[88:89], v2 offset:0
  ds_read_b64_tr_b16 a[90:91], v2 offset:256
  ds_read_b64_tr_b16 a[152:153], v2 offset:1024
  ds_read_b64_tr_b16 a[154:155], v2 offset:1280
  ds_read_b64_tr_b16 a[216:217], v2 offset:2048
  ds_read_b64_tr_b16 a[218:219], v2 offset:2304
  ds_read_b64_tr_b16 v[220:221], v2 offset:3072
  ds_read_b64_tr_b16 v[222:223], v2 offset:3328
  s_waitcnt lgkmcnt(0)
  ds_read_b64_tr_b16 a[28:29], v2 offset:4096
  ds_read_b64_tr_b16 a[30:31], v2 offset:4352
  ds_read_b64_tr_b16 a[92:93], v2 offset:5120
  ds_read_b64_tr_b16 a[94:95], v2 offset:5376
  ds_read_b64_tr_b16 a[156:157], v2 offset:6144
  ds_read_b64_tr_b16 a[158:159], v2 offset:6400
  ds_read_b64_tr_b16 a[220:221], v2 offset:7168
  ds_read_b64_tr_b16 a[222:223], v2 offset:7424
  s_waitcnt lgkmcnt(0)
  s_add_u32 m0, s24, 0
  s_add_u32 s36, s13, 246016
  buffer_load_dwordx4 v3, s[92:95], s36 offen lds
  s_add_u32 m0, s24, 1024
  s_add_u32 s36, s13, 266240
  buffer_load_dwordx4 v3, s[92:95], s36 offen lds
  s_add_u32 m0, s24, 2048
  s_add_u32 s36, s13, 266304
  buffer_load_dwordx4 v3, s[92:95], s36 offen lds
  s_add_u32 m0, s24, 3072
  s_add_u32 s36, s13, 266368
  buffer_load_dwordx4 v3, s[92:95], s36 offen lds
  s_add_u32 m0, s24, 4096
  s_add_u32 s36, s13, 266432
  buffer_load_dwordx4 v3, s[92:95], s36 offen lds
  s_add_u32 m0, s24, 5120
  s_add_u32 s36, s13, 266496
  buffer_load_dwordx4 v3, s[92:95], s36 offen lds
  s_add_u32 m0, s24, 6144
  s_add_u32 s36, s13, 286720
  buffer_load_dwordx4 v3, s[92:95], s36 offen lds
  s_add_u32 m0, s24, 7168
  s_add_u32 s36, s13, 286784
  buffer_load_dwordx4 v3, s[92:95], s36 offen lds
  s_waitcnt vmcnt(24)
  ds_read_b64_tr_b16 v[224:225], v2 offset:8192
  ds_read_b64_tr_b16 v[226:227], v2 offset:8448
  ds_read_b64_tr_b16 a[32:33], v2 offset:9216
  ds_read_b64_tr_b16 a[34:35], v2 offset:9472
  ds_read_b64_tr_b16 a[96:97], v2 offset:10240
  ds_read_b64_tr_b16 a[98:99], v2 offset:10496
  ds_read_b64_tr_b16 a[160:161], v2 offset:11264
  ds_read_b64_tr_b16 a[162:163], v2 offset:11520
  s_waitcnt lgkmcnt(0)
  ds_read_b64_tr_b16 a[224:225], v2 offset:12288
  ds_read_b64_tr_b16 a[226:227], v2 offset:12544
  ds_read_b64_tr_b16 v[228:229], v2 offset:13312
  ds_read_b64_tr_b16 v[230:231], v2 offset:13568
  ds_read_b64_tr_b16 a[36:37], v2 offset:14336
  ds_read_b64_tr_b16 a[38:39], v2 offset:14592
  ds_read_b64_tr_b16 a[100:101], v2 offset:15360
  ds_read_b64_tr_b16 a[102:103], v2 offset:15616
  s_waitcnt lgkmcnt(0)
  s_add_u32 m0, s24, 8192
  s_add_u32 s36, s13, 286848
  buffer_load_dwordx4 v3, s[92:95], s36 offen lds
  s_add_u32 m0, s24, 9216
  s_add_u32 s36, s13, 286912
  buffer_load_dwordx4 v3, s[92:95], s36 offen lds
  s_add_u32 m0, s24, 10240
  s_add_u32 s36, s13, 286976
  buffer_load_dwordx4 v3, s[92:95], s36 offen lds
  s_add_u32 m0, s24, 11264
  s_add_u32 s36, s13, 307200
  buffer_load_dwordx4 v3, s[92:95], s36 offen lds
  s_add_u32 m0, s24, 12288
  s_add_u32 s36, s13, 307264
  buffer_load_dwordx4 v3, s[92:95], s36 offen lds
  s_add_u32 m0, s24, 13312
  s_add_u32 s36, s13, 307328
  buffer_load_dwordx4 v3, s[92:95], s36 offen lds
  s_add_u32 m0, s24, 14336
  s_add_u32 s36, s13, 307392
  buffer_load_dwordx4 v3, s[92:95], s36 offen lds
  s_add_u32 m0, s24, 15360
  s_add_u32 s36, s13, 307456
  buffer_load_dwordx4 v3, s[92:95], s36 offen lds
  s_waitcnt vmcnt(24)
  ds_read_b64_tr_b16 a[164:165], v2 offset:16384
  ds_read_b64_tr_b16 a[166:167], v2 offset:16640
  ds_read_b64_tr_b16 a[228:229], v2 offset:17408
  ds_read_b64_tr_b16 a[230:231], v2 offset:17664
  ds_read_b64_tr_b16 v[232:233], v2 offset:18432
  ds_read_b64_tr_b16 v[234:235], v2 offset:18688
  ds_read_b64_tr_b16 a[40:41], v2 offset:19456
  ds_read_b64_tr_b16 a[42:43], v2 offset:19712
  s_waitcnt lgkmcnt(0)
  ds_read_b64_tr_b16 a[104:105], v2 offset:20480
  ds_read_b64_tr_b16 a[106:107], v2 offset:20736
  ds_read_b64_tr_b16 a[168:169], v2 offset:21504
  ds_read_b64_tr_b16 a[170:171], v2 offset:21760
  ds_read_b64_tr_b16 a[232:233], v2 offset:22528
  ds_read_b64_tr_b16 a[234:235], v2 offset:22784
  ds_read_b64_tr_b16 v[236:237], v2 offset:23552
  ds_read_b64_tr_b16 v[238:239], v2 offset:23808
  s_waitcnt lgkmcnt(0)
  s_waitcnt vmcnt(16)
  ds_read_b64_tr_b16 a[44:45], v2 offset:24576
  ds_read_b64_tr_b16 a[46:47], v2 offset:24832
  ds_read_b64_tr_b16 a[108:109], v2 offset:25600
  ds_read_b64_tr_b16 a[110:111], v2 offset:25856
  ds_read_b64_tr_b16 a[172:173], v2 offset:26624
  ds_read_b64_tr_b16 a[174:175], v2 offset:26880
  ds_read_b64_tr_b16 a[236:237], v2 offset:27648
  ds_read_b64_tr_b16 a[238:239], v2 offset:27904
  s_waitcnt lgkmcnt(0)
  ds_read_b64_tr_b16 v[240:241], v2 offset:28672
  ds_read_b64_tr_b16 v[242:243], v2 offset:28928
  ds_read_b64_tr_b16 a[48:49], v2 offset:29696
  ds_read_b64_tr_b16 a[50:51], v2 offset:29952
  ds_read_b64_tr_b16 a[112:113], v2 offset:30720
  ds_read_b64_tr_b16 a[114:115], v2 offset:30976
  ds_read_b64_tr_b16 a[176:177], v2 offset:31744
  ds_read_b64_tr_b16 a[178:179], v2 offset:32000
  s_waitcnt lgkmcnt(0)
  s_waitcnt vmcnt(8)
  ds_read_b64_tr_b16 a[240:241], v2 offset:0
  ds_read_b64_tr_b16 a[242:243], v2 offset:256
  ds_read_b64_tr_b16 v[244:245], v2 offset:1024
  ds_read_b64_tr_b16 v[246:247], v2 offset:1280
  ds_read_b64_tr_b16 a[52:53], v2 offset:2048
  ds_read_b64_tr_b16 a[54:55], v2 offset:2304
  ds_read_b64_tr_b16 a[116:117], v2 offset:3072
  ds_read_b64_tr_b16 a[118:119], v2 offset:3328
  s_waitcnt lgkmcnt(0)
  ds_read_b64_tr_b16 a[180:181], v2 offset:4096
  ds_read_b64_tr_b16 a[182:183], v2 offset:4352
  ds_read_b64_tr_b16 a[244:245], v2 offset:5120
  ds_read_b64_tr_b16 a[246:247], v2 offset:5376
  ds_read_b64_tr_b16 v[248:249], v2 offset:6144
  ds_read_b64_tr_b16 v[250:251], v2 offset:6400
  ds_read_b64_tr_b16 a[56:57], v2 offset:7168
  ds_read_b64_tr_b16 a[58:59], v2 offset:7424
  s_waitcnt lgkmcnt(0)
  s_waitcnt vmcnt(0)
  ds_read_b64_tr_b16 a[120:121], v2 offset:8192
  ds_read_b64_tr_b16 a[122:123], v2 offset:8448
  ds_read_b64_tr_b16 a[184:185], v2 offset:9216
  ds_read_b64_tr_b16 a[186:187], v2 offset:9472
  ds_read_b64_tr_b16 a[248:249], v2 offset:10240
  ds_read_b64_tr_b16 a[250:251], v2 offset:10496
  ds_read_b64_tr_b16 v[252:253], v2 offset:11264
  ds_read_b64_tr_b16 v[254:255], v2 offset:11520
  s_waitcnt lgkmcnt(0)
  ds_read_b64_tr_b16 a[60:61], v2 offset:12288
  ds_read_b64_tr_b16 a[62:63], v2 offset:12544
  ds_read_b64_tr_b16 a[124:125], v2 offset:13312
  ds_read_b64_tr_b16 a[126:127], v2 offset:13568
  ds_read_b64_tr_b16 a[188:189], v2 offset:14336
  ds_read_b64_tr_b16 a[190:191], v2 offset:14592
  ds_read_b64_tr_b16 a[252:253], v2 offset:15360
  ds_read_b64_tr_b16 a[254:255], v2 offset:15616
  s_waitcnt lgkmcnt(0)
  s_barrier
  v_and_b32 v16, 31, v0
  v_and_b32 v17, 32, v0
  v_lshlrev_b32 v18, 4, v16
  v_lshl_add_u32 v19, v17, 2, v18
  v_cmp_gt_u32 vcc, 8, v16
  v_mov_b32 v10, 0x40000000
  s_nop 0
  v_cndmask_b32 v10, v10, v19, vcc
  v_lshrrev_b32 v17, 2, v17
  v_add_u32 v11, v17, v18
  s_lshl_b32 s36, s10, 12
  v_add_u32 v12, s36, v1
  s_lshl_b32 s19, s30, 7
  s_bitcmp1_b32 s77, 8
  s_cselect_b32 s36, 8192, 0
  s_add_u32 s19, s19, s36
  s_add_u32 s73, s19, 218107904
  s_mul_i32 s36, s30, 384
  s_add_u32 s19, s19, s36
  s_add_u32 s19, s19, 218120192
  s_and_b32 s34, s10, 1
  s_cmp_lg_u32 s10, 0
  s_cbranch_scc1 L_polled_84
  v_and_b32 v17, 0, v0
  v_lshlrev_b32 v17, 2, v17
L_poll_83:
  buffer_load_dword v16, v17, s[84:87], 40 offen sc1
  s_waitcnt vmcnt(0)
  v_cmp_gt_u32 vcc, 192, v16
  s_cbranch_vccz L_polled_84
  s_sub_u32 s12, s12, 1
  s_cbranch_scc1 L_abort
  s_sleep 2
  s_branch L_poll_83
L_polled_84:
  s_barrier
  s_cmp_lg_u32 s10, 0
  s_cbranch_scc1 L_polled_86
  v_and_b32 v17, 0, v0
  v_lshlrev_b32 v17, 2, v17
L_poll_85:
  buffer_load_dword v16, v17, s[84:87], 52 offen sc1
  s_waitcnt vmcnt(0)
  v_cmp_gt_u32 vcc, 96, v16
  s_cbranch_vccz L_polled_86
  s_sub_u32 s12, s12, 1
  s_cbranch_scc1 L_abort
  s_sleep 2
  s_branch L_poll_85
L_polled_86:
  s_barrier
  s_mov_b32 s72, 0
  s_cmp_lg_u32 s10, 0
  s_cbranch_scc1 L_qok_88
L_qr_87:
  s_cmp_lt_u32 s28, s72
  s_cbranch_scc1 L_qok_88
  s_sub_u32 s12, s12, 1
  s_cbranch_scc1 L_abort
  v_mov_b32 v17, 0
  buffer_load_dwordx2 v[18:19], v17, s[4:7], s73 offen sc1
  s_waitcnt vmcnt(0)
  v_lshlrev_b32 v18, 1, v18
  v_lshl_add_u32 v19, v19, 1, 1
  v_min_u32 v18, v18, v19
  s_nop 0
  v_readfirstlane_b32 s72, v18
  s_cmp_ge_u32 s72, 64
  s_cselect_b32 s72, 128, s72
  s_branch L_qr_87
L_qok_88:
  s_barrier
  s_lshl_b32 s35, s28, 4
  s_add_u32 s35, s35, s30
  s_lshl_b32 s35, s35, 1
  s_lshr_b32 s37, s10, 1
  s_add_u32 s35, s35, s37
  s_lshl_b32 s15, s35, 15
  s_add_u32 s15, s15, 134217728
  s_and_b32 s14, s35, 31
  s_lshl_b32 s14, s14, 14
  s_sub_u32 s14, s15, s14
  s_lshr_b32 s37, s35, 6
  s_bitcmp1_b32 s76, s37
  s_cselect_b32 s37, 8192, 0
  s_add_u32 s15, s15, s37
  s_xor_b32 s37, s37, 8192
  s_add_u32 s14, s14, s37
  s_cmp_lt_u32 s35, 2048
  s_cselect_b32 s14, s14, 0x80000000
  s_cselect_b32 s15, s15, 0x80000000
  buffer_load_dwordx4 v[20:23], v1, s[4:7], s14 offen offset:0 sc1
  buffer_load_dwordx4 v[52:55], v1, s[4:7], s15 offen offset:0 sc1
  buffer_load_dwordx4 v[24:27], v1, s[4:7], s14 offen offset:1024 sc1
  buffer_load_dwordx4 v[56:59], v1, s[4:7], s15 offen offset:1024 sc1
  buffer_load_dwordx4 v[28:31], v1, s[4:7], s14 offen offset:2048 sc1
  buffer_load_dwordx4 v[60:63], v1, s[4:7], s15 offen offset:2048 sc1
  buffer_load_dwordx4 v[32:35], v1, s[4:7], s14 offen offset:3072 sc1
  buffer_load_dwordx4 v[64:67], v1, s[4:7], s15 offen offset:3072 sc1
  s_add_u32 s14, s14, 4096
  s_add_u32 s15, s15, 4096
  buffer_load_dwordx4 v[36:39], v1, s[4:7], s14 offen offset:0 sc1
  buffer_load_dwordx4 v[68:71], v1, s[4:7], s15 offen offset:0 sc1
  buffer_load_dwordx4 v[40:43], v1, s[4:7], s14 offen offset:1024 sc1
  buffer_load_dwordx4 v[72:75], v1, s[4:7], s15 offen offset:1024 sc1
  buffer_load_dwordx4 v[44:47], v1, s[4:7], s14 offen offset:2048 sc1
  buffer_load_dwordx4 v[76:79], v1, s[4:7], s15 offen offset:2048 sc1
  buffer_load_dwordx4 v[48:51], v1, s[4:7], s14 offen offset:3072 sc1
  buffer_load_dwordx4 v[80:83], v1, s[4:7], s15 offen offset:3072 sc1
  s_lshl_b32 s37, s34, 12
  s_add_u32 s15, s15, s37
  s_add_u32 s15, s15, 12288
  buffer_load_dwordx4 v[84:87], v1, s[4:7], s15 offen offset:0 sc1
  buffer_load_dwordx4 v[88:91], v1, s[4:7], s15 offen offset:1024 sc1
  buffer_load_dwordx4 v[92:95], v1, s[4:7], s15 offen offset:2048 sc1
  buffer_load_dwordx4 v[96:99], v1, s[4:7], s15 offen offset:3072 sc1
  v_and_b32 v16, 31, v0
  v_lshrrev_b32 v17, 5, v0
  v_lshlrev_b32 v17, 2, v17
  v_sub_u32 v16, v16, v17
  v_mov_b32 v17, 0xf149f2ca
  v_cmp_le_i32 vcc, 0, v16
  s_nop 1
  v_cndmask_b32 v176, v17, 0, vcc
  v_cmp_le_i32 vcc, 1, v16
  s_nop 1
  v_cndmask_b32 v177, v17, 0, vcc
  v_cmp_le_i32 vcc, 2, v16
  s_nop 1
  v_cndmask_b32 v178, v17, 0, vcc
  v_cmp_le_i32 vcc, 3, v16
  s_nop 1
  v_cndmask_b32 v179, v17, 0, vcc
  v_cmp_le_i32 vcc, 8, v16
  s_nop 1
  v_cndmask_b32 v180, v17, 0, vcc
  v_cmp_le_i32 vcc, 9, v16
  s_nop 1
  v_cndmask_b32 v181, v17, 0, vcc
  v_cmp_le_i32 vcc, 10, v16
  s_nop 1
  v_cndmask_b32 v182, v17, 0, vcc
  v_cmp_le_i32 vcc, 11, v16
  s_nop 1
  v_cndmask_b32 v183, v17, 0, vcc
  v_cmp_le_i32 vcc, 16, v16
  s_nop 1
  v_cndmask_b32 v184, v17, 0, vcc
  v_cmp_le_i32 vcc, 17, v16
  s_nop 1
  v_cndmask_b32 v185, v17, 0, vcc
  v_cmp_le_i32 vcc, 18, v16
  s_nop 1
  v_cndmask_b32 v186, v17, 0, vcc
  v_cmp_le_i32 vcc, 19, v16
  s_nop 1
  v_cndmask_b32 v187, v17, 0, vcc
  v_cmp_le_i32 vcc, 24, v16
  s_nop 1
  v_cndmask_b32 v188, v17, 0, vcc
  v_cmp_le_i32 vcc, 25, v16
  s_nop 1
  v_cndmask_b32 v189, v17, 0, vcc
  v_cmp_le_i32 vcc, 26, v16
  s_nop 1
  v_cndmask_b32 v190, v17, 0, vcc
  v_cmp_le_i32 vcc, 27, v16
  s_nop 1
  v_cndmask_b32 v191, v17, 0, vcc
  s_waitcnt vmcnt(0)
L_ao_89:
  s_mov_b32 s32, s35
  s_lshl_b32 s33, s28, 18
  s_bfe_u32 s36, s32, 0x30002
  s_lshl_b32 s36, s36, 14
  s_add_u32 s33, s33, s36
  s_and_b32 s36, s32, 3
  s_lshl_b32 s36, s36, 11
  s_add_u32 s33, s33, s36
  s_lshr_b32 s36, s28, 3
  s_bitcmp1_b32 s77, s36
  s_cselect_b32 s36, 8192, 0
  s_add_u32 s33, s33, s36
  s_add_u32 s33, s33, 201326592
  v_mfma_f32_32x32x16_bf16 v[112:127], v[52:55], v[20:23], v[176:191]
  v_mfma_f32_32x32x16_bf16 v[112:127], v[56:59], v[24:27], v[112:127]
  v_mfma_f32_32x32x16_bf16 v[112:127], v[60:63], v[28:31], v[112:127]
  v_mfma_f32_32x32x16_bf16 v[112:127], v[64:67], v[32:35], v[112:127]
  v_mfma_f32_32x32x16_bf16 v[112:127], v[68:71], v[36:39], v[112:127]
  v_mfma_f32_32x32x16_bf16 v[112:127], v[72:75], v[40:43], v[112:127]
  v_mfma_f32_32x32x16_bf16 v[112:127], v[76:79], v[44:47], v[112:127]
  v_mfma_f32_32x32x16_bf16 v[112:127], v[80:83], v[48:51], v[112:127]
  s_add_u32 s38, s28, 6
  s_cmp_lg_u32 s10, 0
  s_cbranch_scc1 L_qok_91
L_qr_90:
  s_cmp_lt_u32 s38, s72
  s_cbranch_scc1 L_qok_91
  s_sub_u32 s12, s12, 1
  s_cbranch_scc1 L_abort
  v_mov_b32 v17, 0
  buffer_load_dwordx2 v[18:19], v17, s[4:7], s73 offen sc1
  s_waitcnt vmcnt(0)
  v_lshlrev_b32 v18, 1, v18
  v_lshl_add_u32 v19, v19, 1, 1
  v_min_u32 v18, v18, v19
  s_nop 0
  v_readfirstlane_b32 s72, v18
  s_cmp_ge_u32 s72, 64
  s_cselect_b32 s72, 128, s72
  s_branch L_qr_90
L_qok_91:
  s_add_u32 s38, s28, 1
  s_cmp_lg_u32 s10, 0
  s_cbranch_scc1 L_polled_93
  v_and_b32 v17, 3, v0
  v_lshlrev_b32 v17, 7, v17
L_poll_92:
  buffer_load_dword v16, v17, s[4:7], s19 offen sc1
  s_waitcnt vmcnt(0)
  v_cmp_gt_u32 vcc, s38, v16
  s_cbranch_vccz L_polled_93
  s_sub_u32 s12, s12, 1
  s_cbranch_scc1 L_abort
  s_sleep 2
  s_branch L_poll_92
L_polled_93:
  s_barrier
  s_add_u32 s37, s33, 131072
  s_mov_b32 s36, s33
  s_lshl_b32 s38, s34, 10
  s_add_u32 s37, s37, s38
  buffer_load_dwordx4 v[52:55], v10, s[4:7], s36 offen offset:0 sc1
  buffer_load_dwordx4 v[56:59], v10, s[4:7], s36 offen offset:256 sc1
  buffer_load_dwordx4 v[60:63], v10, s[4:7], s36 offen offset:512 sc1
  buffer_load_dwordx4 v[64:67], v10, s[4:7], s36 offen offset:768 sc1
  buffer_load_dwordx4 v[68:71], v10, s[4:7], s36 offen offset:1024 sc1
  buffer_load_dwordx4 v[72:75], v10, s[4:7], s36 offen offset:1280 sc1
  buffer_load_dwordx4 v[76:79], v10, s[4:7], s36 offen offset:1536 sc1
  buffer_load_dwordx4 v[80:83], v10, s[4:7], s36 offen offset:1792 sc1
  buffer_load_dwordx2 v[2:3], v11, s[4:7], s37 offen offset:0 sc1
  buffer_load_dwordx2 v[4:5], v11, s[4:7], s37 offen offset:512 sc1
  v_max_f32 v16, v112, v113
  v_max3_f32 v16, v16, v114, v115
  v_max3_f32 v16, v16, v116, v117
  v_max3_f32 v16, v16, v118, v119
  v_max3_f32 v16, v16, v120, v121
  v_max3_f32 v16, v16, v122, v123
  v_max3_f32 v16, v16, v124, v125
  v_max3_f32 v16, v16, v126, v127
  s_waitcnt vmcnt(9)
  v_mfma_f32_32x32x16_bf16 v[128:143], v[52:55], v[20:23], 0
  s_waitcnt vmcnt(8)
  v_mfma_f32_32x32x16_bf16 v[128:143], v[56:59], v[24:27], v[128:143]
  s_waitcnt vmcnt(7)
  v_mfma_f32_32x32x16_bf16 v[128:143], v[60:63], v[28:31], v[128:143]
  s_waitcnt vmcnt(6)
  v_mfma_f32_32x32x16_bf16 v[128:143], v[64:67], v[32:35], v[128:143]
  s_waitcnt vmcnt(5)
  v_mfma_f32_32x32x16_bf16 v[128:143], v[68:71], v[36:39], v[128:143]
  s_waitcnt vmcnt(4)
  v_mfma_f32_32x32x16_bf16 v[128:143], v[72:75], v[40:43], v[128:143]
  s_waitcnt vmcnt(3)
  v_mfma_f32_32x32x16_bf16 v[128:143], v[76:79], v[44:47], v[128:143]
  s_waitcnt vmcnt(2)
  v_mfma_f32_32x32x16_bf16 v[128:143], v[80:83], v[48:51], v[128:143]
  s_nop 11
  v_mul_f32 v128, 0x3e0293ee, v128
  v_mul_f32 v129, 0x3e0293ee, v129
  v_mul_f32 v130, 0x3e0293ee, v130
  v_mul_f32 v131, 0x3e0293ee, v131
  v_max3_f32 v16, v16, v128, v129
  v_max3_f32 v16, v16, v130, v131
  v_mov_b32 v17, v16
  s_nop 1
  v_permlane32_swap_b32 v16, v17
  v_max_f32 v16, v16, v17
  v_sub_f32 v112, v112, v16
  v_sub_f32 v113, v113, v16
  v_sub_f32 v114, v114, v16
  v_sub_f32 v115, v115, v16
  v_sub_f32 v116, v116, v16
  v_sub_f32 v117, v117, v16
  v_sub_f32 v118, v118, v16
  v_sub_f32 v119, v119, v16
  v_sub_f32 v120, v120, v16
  v_sub_f32 v121, v121, v16
  v_sub_f32 v122, v122, v16
  v_sub_f32 v123, v123, v16
  v_sub_f32 v124, v124, v16
  v_sub_f32 v125, v125, v16
  v_sub_f32 v126, v126, v16
  v_sub_f32 v127, v127, v16
  v_sub_f32 v128, v128, v16
  v_sub_f32 v129, v129, v16
  v_sub_f32 v130, v130, v16
  v_sub_f32 v131, v131, v16
  v_exp_f32 v112, v112
  v_exp_f32 v113, v113
  v_exp_f32 v114, v114
  v_exp_f32 v115, v115
  v_exp_f32 v116, v116
  v_exp_f32 v117, v117
  v_exp_f32 v118, v118
  v_exp_f32 v119, v119
  v_exp_f32 v120, v120
  v_exp_f32 v121, v121
  v_exp_f32 v122, v122
  v_exp_f32 v123, v123
  v_exp_f32 v124, v124
  v_exp_f32 v125, v125
  v_exp_f32 v126, v126
  v_exp_f32 v127, v127
  v_exp_f32 v128, v128
  v_exp_f32 v129, v129
  v_exp_f32 v130, v130
  v_exp_f32 v131, v131
  v_cvt_pk_bf16_f32 v100, v112, v116
  v_cvt_pk_bf16_f32 v101, v120, v124
  v_cvt_pk_bf16_f32 v102, v113, v117
  v_cvt_pk_bf16_f32 v103, v121, v125
  v_cvt_pk_bf16_f32 v104, v114, v118
  v_cvt_pk_bf16_f32 v105, v122, v126
  v_cvt_pk_bf16_f32 v106, v115, v119
  v_cvt_pk_bf16_f32 v107, v123, v127
  v_cvt_pk_bf16_f32 v108, v128, v129
  v_cvt_pk_bf16_f32 v109, v130, v131
  s_waitcnt vmcnt(0)
  v_mfma_f32_32x32x16_bf16 v[144:159], v[84:87], v[100:103], 0
  v_add_f32 v16, v112, v113
  v_add_f32 v16, v16, v114
  v_add_f32 v16, v16, v115
  v_add_f32 v16, v16, v116
  v_add_f32 v16, v16, v117
  v_mfma_f32_32x32x16_bf16 v[144:159], v[88:91], v[104:107], v[144:159]
  v_add_f32 v16, v16, v118
  v_add_f32 v16, v16, v119
  v_add_f32 v16, v16, v120
  v_add_f32 v16, v16, v121
  v_add_f32 v16, v16, v122
  v_mfma_f32_32x32x8_bf16 v[144:159], v[2:3], v[108:109], v[144:159]
  v_add_f32 v16, v16, v123
  v_add_f32 v16, v16, v124
  v_add_f32 v16, v16, v125
  v_add_f32 v16, v16, v126
  v_add_f32 v16, v16, v127
  v_mfma_f32_32x32x16_bf16 v[160:175], v[92:95], v[100:103], 0
  v_add_f32 v16, v16, v128
  v_add_f32 v16, v16, v129
  v_add_f32 v16, v16, v130
  v_add_f32 v16, v16, v131
  v_mfma_f32_32x32x16_bf16 v[160:175], v[96:99], v[104:107], v[160:175]
  v_mfma_f32_32x32x8_bf16 v[160:175], v[4:5], v[108:109], v[160:175]
  v_mov_b32 v17, v16
  s_nop 1
  v_permlane32_swap_b32 v16, v17
  v_add_f32 v16, v16, v17
  v_rcp_f32 v16, v16
  s_nop 0
  v_mul_f32 v144, v144, v16
  v_mul_f32 v145, v145, v16
  v_mul_f32 v146, v146, v16
  v_mul_f32 v147, v147, v16
  v_mul_f32 v148, v148, v16
  v_mul_f32 v149, v149, v16
  v_mul_f32 v150, v150, v16
  v_mul_f32 v151, v151, v16
  v_cvt_pk_bf16_f32 v20, v144, v145
  v_cvt_pk_bf16_f32 v21, v146, v147
  v_cvt_pk_bf16_f32 v22, v148, v149
  v_cvt_pk_bf16_f32 v23, v150, v151
  ds_write_b128 v12, v[20:23] offset:0
  v_mul_f32 v152, v152, v16
  v_mul_f32 v153, v153, v16
  v_mul_f32 v154, v154, v16
  v_mul_f32 v155, v155, v16
  v_mul_f32 v156, v156, v16
  v_mul_f32 v157, v157, v16
  v_mul_f32 v158, v158, v16
  v_mul_f32 v159, v159, v16
  v_cvt_pk_bf16_f32 v24, v152, v153
  v_cvt_pk_bf16_f32 v25, v154, v155
  v_cvt_pk_bf16_f32 v26, v156, v157
  v_cvt_pk_bf16_f32 v27, v158, v159
  ds_write_b128 v12, v[24:27] offset:1024
  v_mul_f32 v160, v160, v16
  v_mul_f32 v161, v161, v16
  v_mul_f32 v162, v162, v16
  v_mul_f32 v163, v163, v16
  v_mul_f32 v164, v164, v16
  v_mul_f32 v165, v165, v16
  v_mul_f32 v166, v166, v16
  v_mul_f32 v167, v167, v16
  v_cvt_pk_bf16_f32 v28, v160, v161
  v_cvt_pk_bf16_f32 v29, v162, v163
  v_cvt_pk_bf16_f32 v30, v164, v165
  v_cvt_pk_bf16_f32 v31, v166, v167
  ds_write_b128 v12, v[28:31] offset:2048
  v_mul_f32 v168, v168, v16
  v_mul_f32 v169, v169, v16
  v_mul_f32 v170, v170, v16
  v_mul_f32 v171, v171, v16
  v_mul_f32 v172, v172, v16
  v_mul_f32 v173, v173, v16
  v_mul_f32 v174, v174, v16
  v_mul_f32 v175, v175, v16
  v_cvt_pk_bf16_f32 v32, v168, v169
  v_cvt_pk_bf16_f32 v33, v170, v171
  v_cvt_pk_bf16_f32 v34, v172, v173
  v_cvt_pk_bf16_f32 v35, v174, v175
  ds_write_b128 v12, v[32:35] offset:3072
  s_waitcnt lgkmcnt(0)
  s_barrier
  ds_read_b128 v[160:163], v1 offset:0
  ds_read_b128 v[164:167], v1 offset:1024
  ds_read_b128 v[168:171], v1 offset:2048
  s_add_u32 s38, s28, 6
  s_lshl_b32 s35, s38, 4
  s_add_u32 s35, s35, s30
  s_lshl_b32 s35, s35, 1
  s_lshr_b32 s37, s10, 1
  s_add_u32 s35, s35, s37
  s_lshr_b32 s36, s32, 1
  s_mul_i32 s36, s36, 40960
  s_mul_i32 s37, s10, 10240
  s_add_u32 s36, s36, s37
  s_add_u32 s36, s36, 83886080
  s_waitcnt lgkmcnt(2)
  v_mfma_f32_32x32x16_bf16 v[112:127], v[192:195], v[160:163], 0
  ds_read_b128 v[172:175], v1 offset:3072
  s_lshl_b32 s15, s35, 15
  s_add_u32 s15, s15, 134217728
  s_and_b32 s14, s35, 31
  s_lshl_b32 s14, s14, 14
  s_sub_u32 s14, s15, s14
  s_lshr_b32 s37, s35, 6
  s_bitcmp1_b32 s76, s37
  s_cselect_b32 s37, 8192, 0
  s_add_u32 s15, s15, s37
  s_xor_b32 s37, s37, 8192
  s_add_u32 s14, s14, s37
  s_cmp_lt_u32 s35, 2048
  s_cselect_b32 s14, s14, 0x80000000
  s_cselect_b32 s15, s15, 0x80000000
  s_waitcnt lgkmcnt(2)
  v_mfma_f32_32x32x16_bf16 v[112:127], v[196:199], v[164:167], v[112:127]
  ds_read_b128 v[160:163], v1 offset:4096
  s_waitcnt lgkmcnt(2)
  v_mfma_f32_32x32x16_bf16 v[112:127], v[200:203], v[168:171], v[112:127]
  ds_read_b128 v[164:167], v1 offset:5120
  buffer_load_dwordx4 v[20:23], v1, s[4:7], s14 offen offset:0 sc1
  s_waitcnt lgkmcnt(2)
  v_mfma_f32_32x32x16_bf16 v[112:127], v[204:207], v[172:175], v[112:127]
  ds_read_b128 v[168:171], v1 offset:6144
  s_waitcnt lgkmcnt(2)
  v_mfma_f32_32x32x16_bf16 v[112:127], v[208:211], v[160:163], v[112:127]
  ds_read_b128 v[172:175], v1 offset:7168
  buffer_load_dwordx4 v[52:55], v1, s[4:7], s15 offen offset:0 sc1
  s_waitcnt lgkmcnt(2)
  v_mfma_f32_32x32x16_bf16 v[112:127], v[212:215], v[164:167], v[112:127]
  ds_read_b128 v[160:163], v1 offset:8192
  s_waitcnt lgkmcnt(2)
  v_mfma_f32_32x32x16_bf16 v[112:127], v[216:219], v[168:171], v[112:127]
  ds_read_b128 v[164:167], v1 offset:9216
  buffer_load_dwordx4 v[24:27], v1, s[4:7], s14 offen offset:1024 sc1
  s_waitcnt lgkmcnt(2)
  v_mfma_f32_32x32x16_bf16 v[112:127], v[220:223], v[172:175], v[112:127]
  ds_read_b128 v[168:171], v1 offset:10240
  s_waitcnt lgkmcnt(2)
  v_mfma_f32_32x32x16_bf16 v[112:127], v[224:227], v[160:163], v[112:127]
  ds_read_b128 v[172:175], v1 offset:11264
  buffer_load_dwordx4 v[56:59], v1, s[4:7], s15 offen offset:1024 sc1
  s_waitcnt lgkmcnt(2)
  v_mfma_f32_32x32x16_bf16 v[112:127], v[228:231], v[164:167], v[112:127]
  ds_read_b128 v[160:163], v1 offset:12288
  s_waitcnt lgkmcnt(2)
  v_mfma_f32_32x32x16_bf16 v[112:127], v[232:235], v[168:171], v[112:127]
  ds_read_b128 v[164:167], v1 offset:13312
  buffer_load_dwordx4 v[28:31], v1, s[4:7], s14 offen offset:2048 sc1
  s_waitcnt lgkmcnt(2)
  v_mfma_f32_32x32x16_bf16 v[112:127], v[236:239], v[172:175], v[112:127]
  ds_read_b128 v[168:171], v1 offset:14336
  s_waitcnt lgkmcnt(2)
  v_mfma_f32_32x32x16_bf16 v[112:127], v[240:243], v[160:163], v[112:127]
  ds_read_b128 v[172:175], v1 offset:15360
  buffer_load_dwordx4 v[60:63], v1, s[4:7], s15 offen offset:2048 sc1
  s_waitcnt lgkmcnt(2)
  v_mfma_f32_32x32x16_bf16 v[112:127], v[244:247], v[164:167], v[112:127]
  ds_read_b128 v[160:163], v1 offset:0
  s_waitcnt lgkmcnt(2)
  v_mfma_f32_32x32x16_bf16 v[112:127], v[248:251], v[168:171], v[112:127]
  ds_read_b128 v[164:167], v1 offset:1024
  buffer_load_dwordx4 v[32:35], v1, s[4:7], s14 offen offset:3072 sc1
  s_waitcnt lgkmcnt(2)
  v_mfma_f32_32x32x16_bf16 v[112:127], v[252:255], v[172:175], v[112:127]
  ds_read_b128 v[168:171], v1 offset:2048
  s_waitcnt lgkmcnt(2)
  v_mfma_f32_32x32x16_bf16 v[128:143], a[0:3], v[160:163], 0
  ds_read_b128 v[172:175], v1 offset:3072
  buffer_load_dwordx4 v[64:67], v1, s[4:7], s15 offen offset:3072 sc1
  s_waitcnt lgkmcnt(2)
  v_mfma_f32_32x32x16_bf16 v[128:143], a[4:7], v[164:167], v[128:143]
  ds_read_b128 v[160:163], v1 offset:4096
  s_waitcnt lgkmcnt(2)
  v_mfma_f32_32x32x16_bf16 v[128:143], a[8:11], v[168:171], v[128:143]
  ds_read_b128 v[164:167], v1 offset:5120
  s_add_u32 s14, s14, 4096
  s_add_u32 s15, s15, 4096
  buffer_load_dwordx4 v[36:39], v1, s[4:7], s14 offen offset:0 sc1
  s_waitcnt lgkmcnt(2)
  v_mfma_f32_32x32x16_bf16 v[128:143], a[12:15], v[172:175], v[128:143]
  ds_read_b128 v[168:171], v1 offset:6144
  s_waitcnt lgkmcnt(2)
  v_mfma_f32_32x32x16_bf16 v[128:143], a[16:19], v[160:163], v[128:143]
  ds_read_b128 v[172:175], v1 offset:7168
  v_cvt_pk_bf16_f32 v144, v112, v113
  v_cvt_pk_bf16_f32 v145, v114, v115
  v_cvt_pk_bf16_f32 v146, v116, v117
  v_cvt_pk_bf16_f32 v147, v118, v119
  s_waitcnt lgkmcnt(2)
  v_mfma_f32_32x32x16_bf16 v[128:143], a[20:23], v[164:167], v[128:143]
  ds_read_b128 v[160:163], v1 offset:8192
  v_cvt_pk_bf16_f32 v148, v120, v121
  v_cvt_pk_bf16_f32 v149, v122, v123
  v_cvt_pk_bf16_f32 v150, v124, v125
  v_cvt_pk_bf16_f32 v151, v126, v127
  s_waitcnt lgkmcnt(2)
  v_mfma_f32_32x32x16_bf16 v[128:143], a[24:27], v[168:171], v[128:143]
  ds_read_b128 v[164:167], v1 offset:9216
  buffer_load_dwordx4 v[68:71], v1, s[4:7], s15 offen offset:0 sc1
  s_waitcnt lgkmcnt(2)
  v_mfma_f32_32x32x16_bf16 v[128:143], a[28:31], v[172:175], v[128:143]
  ds_read_b128 v[168:171], v1 offset:10240
  s_waitcnt lgkmcnt(2)
  v_mfma_f32_32x32x16_bf16 v[128:143], a[32:35], v[160:163], v[128:143]
  ds_read_b128 v[172:175], v1 offset:11264
  buffer_store_dwordx4 v[144:147], v1, s[4:7], s36 offen offset:0 sc1
  s_waitcnt lgkmcnt(2)
  v_mfma_f32_32x32x16_bf16 v[128:143], a[36:39], v[164:167], v[128:143]
  ds_read_b128 v[160:163], v1 offset:12288
  s_waitcnt lgkmcnt(2)
  v_mfma_f32_32x32x16_bf16 v[128:143], a[40:43], v[168:171], v[128:143]
  ds_read_b128 v[164:167], v1 offset:13312
  buffer_load_dwordx4 v[40:43], v1, s[4:7], s14 offen offset:1024 sc1
  s_waitcnt lgkmcnt(2)
  v_mfma_f32_32x32x16_bf16 v[128:143], a[44:47], v[172:175], v[128:143]
  ds_read_b128 v[168:171], v1 offset:14336
  s_waitcnt lgkmcnt(2)
  v_mfma_f32_32x32x16_bf16 v[128:143], a[48:51], v[160:163], v[128:143]
  ds_read_b128 v[172:175], v1 offset:15360
  buffer_store_dwordx4 v[148:151], v1, s[4:7], s36 offen offset:1024 sc1
  s_add_u32 s36, s36, 2048
  s_waitcnt lgkmcnt(2)
  v_mfma_f32_32x32x16_bf16 v[128:143], a[52:55], v[164:167], v[128:143]
  ds_read_b128 v[160:163], v1 offset:0
  s_waitcnt lgkmcnt(2)
  v_mfma_f32_32x32x16_bf16 v[128:143], a[56:59], v[168:171], v[128:143]
  ds_read_b128 v[164:167], v1 offset:1024
  buffer_load_dwordx4 v[72:75], v1, s[4:7], s15 offen offset:1024 sc1
  s_waitcnt lgkmcnt(2)
  v_mfma_f32_32x32x16_bf16 v[128:143], a[60:63], v[172:175], v[128:143]
  ds_read_b128 v[168:171], v1 offset:2048
  s_waitcnt lgkmcnt(2)
  v_mfma_f32_32x32x16_bf16 v[112:127], a[64:67], v[160:163], 0
  ds_read_b128 v[172:175], v1 offset:3072
  buffer_load_dwordx4 v[44:47], v1, s[4:7], s14 offen offset:2048 sc1
  s_waitcnt lgkmcnt(2)
  v_mfma_f32_32x32x16_bf16 v[112:127], a[68:71], v[164:167], v[112:127]
  ds_read_b128 v[160:163], v1 offset:4096
  s_waitcnt lgkmcnt(2)
  v_mfma_f32_32x32x16_bf16 v[112:127], a[72:75], v[168:171], v[112:127]
  ds_read_b128 v[164:167], v1 offset:5120
  buffer_load_dwordx4 v[76:79], v1, s[4:7], s15 offen offset:2048 sc1
  s_waitcnt lgkmcnt(2)
  v_mfma_f32_32x32x16_bf16 v[112:127], a[76:79], v[172:175], v[112:127]
  ds_read_b128 v[168:171], v1 offset:6144
  s_waitcnt lgkmcnt(2)
  v_mfma_f32_32x32x16_bf16 v[112:127], a[80:83], v[160:163], v[112:127]
  ds_read_b128 v[172:175], v1 offset:7168
  v_cvt_pk_bf16_f32 v152, v128, v129
  v_cvt_pk_bf16_f32 v153, v130, v131
  v_cvt_pk_bf16_f32 v154, v132, v133
  v_cvt_pk_bf16_f32 v155, v134, v135
  s_waitcnt lgkmcnt(2)
  v_mfma_f32_32x32x16_bf16 v[112:127], a[84:87], v[164:167], v[112:127]
  ds_read_b128 v[160:163], v1 offset:8192
  v_cvt_pk_bf16_f32 v156, v136, v137
  v_cvt_pk_bf16_f32 v157, v138, v139
  v_cvt_pk_bf16_f32 v158, v140, v141
  v_cvt_pk_bf16_f32 v159, v142, v143
  s_waitcnt lgkmcnt(2)
  v_mfma_f32_32x32x16_bf16 v[112:127], a[88:91], v[168:171], v[112:127]
  ds_read_b128 v[164:167], v1 offset:9216
  buffer_load_dwordx4 v[48:51], v1, s[4:7], s14 offen offset:3072 sc1
  s_waitcnt lgkmcnt(2)
  v_mfma_f32_32x32x16_bf16 v[112:127], a[92:95], v[172:175], v[112:127]
  ds_read_b128 v[168:171], v1 offset:10240
  s_waitcnt lgkmcnt(2)
  v_mfma_f32_32x32x16_bf16 v[112:127], a[96:99], v[160:163], v[112:127]
  ds_read_b128 v[172:175], v1 offset:11264
  buffer_store_dwordx4 v[152:155], v1, s[4:7], s36 offen offset:0 sc1
  s_waitcnt lgkmcnt(2)
  v_mfma_f32_32x32x16_bf16 v[112:127], a[100:103], v[164:167], v[112:127]
  ds_read_b128 v[160:163], v1 offset:12288
  s_waitcnt lgkmcnt(2)
  v_mfma_f32_32x32x16_bf16 v[112:127], a[104:107], v[168:171], v[112:127]
  ds_read_b128 v[164:167], v1 offset:13312
  buffer_load_dwordx4 v[80:83], v1, s[4:7], s15 offen offset:3072 sc1
  s_waitcnt lgkmcnt(2)
  v_mfma_f32_32x32x16_bf16 v[112:127], a[108:111], v[172:175], v[112:127]
  ds_read_b128 v[168:171], v1 offset:14336
  s_waitcnt lgkmcnt(2)
  v_mfma_f32_32x32x16_bf16 v[112:127], a[112:115], v[160:163], v[112:127]
  ds_read_b128 v[172:175], v1 offset:15360
  buffer_store_dwordx4 v[156:159], v1, s[4:7], s36 offen offset:1024 sc1
  s_add_u32 s36, s36, 2048
  s_waitcnt lgkmcnt(2)
  v_mfma_f32_32x32x16_bf16 v[112:127], a[116:119], v[164:167], v[112:127]
  ds_read_b128 v[160:163], v1 offset:0
  s_waitcnt lgkmcnt(2)
  v_mfma_f32_32x32x16_bf16 v[112:127], a[120:123], v[168:171], v[112:127]
  ds_read_b128 v[164:167], v1 offset:1024
  s_lshl_b32 s37, s34, 12
  s_add_u32 s15, s15, s37
  s_add_u32 s15, s15, 12288
  buffer_load_dwordx4 v[84:87], v1, s[4:7], s15 offen offset:0 sc1
  s_waitcnt lgkmcnt(2)
  v_mfma_f32_32x32x16_bf16 v[112:127], a[124:127], v[172:175], v[112:127]
  ds_read_b128 v[168:171], v1 offset:2048
  s_waitcnt lgkmcnt(2)
  v_mfma_f32_32x32x16_bf16 v[128:143], a[128:131], v[160:163], 0
  ds_read_b128 v[172:175], v1 offset:3072
  buffer_load_dwordx4 v[88:91], v1, s[4:7], s15 offen offset:1024 sc1
  s_waitcnt lgkmcnt(2)
  v_mfma_f32_32x32x16_bf16 v[128:143], a[132:135], v[164:167], v[128:143]
  ds_read_b128 v[160:163], v1 offset:4096
  s_waitcnt lgkmcnt(2)
  v_mfma_f32_32x32x16_bf16 v[128:143], a[136:139], v[168:171], v[128:143]
  ds_read_b128 v[164:167], v1 offset:5120
  buffer_load_dwordx4 v[92:95], v1, s[4:7], s15 offen offset:2048 sc1
  s_waitcnt lgkmcnt(2)
  v_mfma_f32_32x32x16_bf16 v[128:143], a[140:143], v[172:175], v[128:143]
  ds_read_b128 v[168:171], v1 offset:6144
  s_waitcnt lgkmcnt(2)
  v_mfma_f32_32x32x16_bf16 v[128:143], a[144:147], v[160:163], v[128:143]
  ds_read_b128 v[172:175], v1 offset:7168
  v_cvt_pk_bf16_f32 v144, v112, v113
  v_cvt_pk_bf16_f32 v145, v114, v115
  v_cvt_pk_bf16_f32 v146, v116, v117
  v_cvt_pk_bf16_f32 v147, v118, v119
  s_waitcnt lgkmcnt(2)
  v_mfma_f32_32x32x16_bf16 v[128:143], a[148:151], v[164:167], v[128:143]
  ds_read_b128 v[160:163], v1 offset:8192
  v_cvt_pk_bf16_f32 v148, v120, v121
  v_cvt_pk_bf16_f32 v149, v122, v123
  v_cvt_pk_bf16_f32 v150, v124, v125
  v_cvt_pk_bf16_f32 v151, v126, v127
  s_waitcnt lgkmcnt(2)
  v_mfma_f32_32x32x16_bf16 v[128:143], a[152:155], v[168:171], v[128:143]
  ds_read_b128 v[164:167], v1 offset:9216
  buffer_load_dwordx4 v[96:99], v1, s[4:7], s15 offen offset:3072 sc1
  s_waitcnt lgkmcnt(2)
  v_mfma_f32_32x32x16_bf16 v[128:143], a[156:159], v[172:175], v[128:143]
  ds_read_b128 v[168:171], v1 offset:10240
  s_waitcnt lgkmcnt(2)
  v_mfma_f32_32x32x16_bf16 v[128:143], a[160:163], v[160:163], v[128:143]
  ds_read_b128 v[172:175], v1 offset:11264
  buffer_store_dwordx4 v[144:147], v1, s[4:7], s36 offen offset:0 sc1
  s_waitcnt lgkmcnt(2)
  v_mfma_f32_32x32x16_bf16 v[128:143], a[164:167], v[164:167], v[128:143]
  ds_read_b128 v[160:163], v1 offset:12288
  s_waitcnt lgkmcnt(2)
  v_mfma_f32_32x32x16_bf16 v[128:143], a[168:171], v[168:171], v[128:143]
  ds_read_b128 v[164:167], v1 offset:13312
  s_waitcnt lgkmcnt(2)
  v_mfma_f32_32x32x16_bf16 v[128:143], a[172:175], v[172:175], v[128:143]
  ds_read_b128 v[168:171], v1 offset:14336
  s_waitcnt lgkmcnt(2)
  v_mfma_f32_32x32x16_bf16 v[128:143], a[176:179], v[160:163], v[128:143]
  ds_read_b128 v[172:175], v1 offset:15360
  buffer_store_dwordx4 v[148:151], v1, s[4:7], s36 offen offset:1024 sc1
  s_add_u32 s36, s36, 2048
  s_waitcnt lgkmcnt(2)
  v_mfma_f32_32x32x16_bf16 v[128:143], a[180:183], v[164:167], v[128:143]
  ds_read_b128 v[160:163], v1 offset:0
  s_waitcnt lgkmcnt(2)
  v_mfma_f32_32x32x16_bf16 v[128:143], a[184:187], v[168:171], v[128:143]
  ds_read_b128 v[164:167], v1 offset:1024
  s_waitcnt lgkmcnt(2)
  v_mfma_f32_32x32x16_bf16 v[128:143], a[188:191], v[172:175], v[128:143]
  ds_read_b128 v[168:171], v1 offset:2048
  s_waitcnt lgkmcnt(2)
  v_mfma_f32_32x32x16_bf16 v[112:127], a[192:195], v[160:163], 0
  ds_read_b128 v[172:175], v1 offset:3072
  s_waitcnt lgkmcnt(2)
  v_mfma_f32_32x32x16_bf16 v[112:127], a[196:199], v[164:167], v[112:127]
  ds_read_b128 v[160:163], v1 offset:4096
  s_waitcnt lgkmcnt(2)
  v_mfma_f32_32x32x16_bf16 v[112:127], a[200:203], v[168:171], v[112:127]
  ds_read_b128 v[164:167], v1 offset:5120
  s_waitcnt lgkmcnt(2)
  v_mfma_f32_32x32x16_bf16 v[112:127], a[204:207], v[172:175], v[112:127]
  ds_read_b128 v[168:171], v1 offset:6144
  s_waitcnt lgkmcnt(2)
  v_mfma_f32_32x32x16_bf16 v[112:127], a[208:211], v[160:163], v[112:127]
  ds_read_b128 v[172:175], v1 offset:7168
  v_cvt_pk_bf16_f32 v152, v128, v129
  v_cvt_pk_bf16_f32 v153, v130, v131
  v_cvt_pk_bf16_f32 v154, v132, v133
  v_cvt_pk_bf16_f32 v155, v134, v135
  s_waitcnt lgkmcnt(2)
  v_mfma_f32_32x32x16_bf16 v[112:127], a[212:215], v[164:167], v[112:127]
  ds_read_b128 v[160:163], v1 offset:8192
  v_cvt_pk_bf16_f32 v156, v136, v137
  v_cvt_pk_bf16_f32 v157, v138, v139
  v_cvt_pk_bf16_f32 v158, v140, v141
  v_cvt_pk_bf16_f32 v159, v142, v143
  s_waitcnt lgkmcnt(2)
  v_mfma_f32_32x32x16_bf16 v[112:127], a[216:219], v[168:171], v[112:127]
  ds_read_b128 v[164:167], v1 offset:9216
  s_waitcnt lgkmcnt(2)
  v_mfma_f32_32x32x16_bf16 v[112:127], a[220:223], v[172:175], v[112:127]
  ds_read_b128 v[168:171], v1 offset:10240
  s_waitcnt lgkmcnt(2)
  v_mfma_f32_32x32x16_bf16 v[112:127], a[224:227], v[160:163], v[112:127]
  ds_read_b128 v[172:175], v1 offset:11264
  buffer_store_dwordx4 v[152:155], v1, s[4:7], s36 offen offset:0 sc1
  s_waitcnt lgkmcnt(2)
  v_mfma_f32_32x32x16_bf16 v[112:127], a[228:231], v[164:167], v[112:127]
  ds_read_b128 v[160:163], v1 offset:12288
  s_waitcnt lgkmcnt(2)
  v_mfma_f32_32x32x16_bf16 v[112:127], a[232:235], v[168:171], v[112:127]
  ds_read_b128 v[164:167], v1 offset:13312
  s_waitcnt lgkmcnt(2)
  v_mfma_f32_32x32x16_bf16 v[112:127], a[236:239], v[172:175], v[112:127]
  ds_read_b128 v[168:171], v1 offset:14336
  s_waitcnt lgkmcnt(2)
  v_mfma_f32_32x32x16_bf16 v[112:127], a[240:243], v[160:163], v[112:127]
  ds_read_b128 v[172:175], v1 offset:15360
  buffer_store_dwordx4 v[156:159], v1, s[4:7], s36 offen offset:1024 sc1
  s_add_u32 s36, s36, 2048
  s_waitcnt lgkmcnt(2)
  v_mfma_f32_32x32x16_bf16 v[112:127], a[244:247], v[164:167], v[112:127]
  s_waitcnt lgkmcnt(1)
  v_mfma_f32_32x32x16_bf16 v[112:127], a[248:251], v[168:171], v[112:127]
  s_waitcnt lgkmcnt(0)
  v_mfma_f32_32x32x16_bf16 v[112:127], a[252:255], v[172:175], v[112:127]
  s_nop 11
  v_cvt_pk_bf16_f32 v144, v112, v113
  v_cvt_pk_bf16_f32 v145, v114, v115
  v_cvt_pk_bf16_f32 v146, v116, v117
  v_cvt_pk_bf16_f32 v147, v118, v119
  v_cvt_pk_bf16_f32 v148, v120, v121
  v_cvt_pk_bf16_f32 v149, v122, v123
  v_cvt_pk_bf16_f32 v150, v124, v125
  v_cvt_pk_bf16_f32 v151, v126, v127
  buffer_store_dwordx4 v[144:147], v1, s[4:7], s36 offen offset:0 sc1
  buffer_store_dwordx4 v[148:151], v1, s[4:7], s36 offen offset:1024 sc1
  s_add_u32 s36, s36, 2048
  s_lshl_b32 s29, s28, 7
  s_add_u32 s29, s29, 63979520
  s_waitcnt vmcnt(0)
  s_barrier
  s_cmp_lg_u32 s10, 0
  s_cbranch_scc1 L_arr_94
  v_mov_b32 v16, 1
  s_mov_b64 exec, 1
  buffer_atomic_add v16, v1, s[4:7], s29 offen
  s_mov_b64 exec, -1
L_arr_94:
  s_add_u32 s28, s28, 6
  s_cmp_lt_u32 s28, 64
  s_cbranch_scc1 L_ao_89
  s_endpgm
L_third:
  s_sub_u32 s9, s9, 96
  s_cmp_ge_u32 s9, 30
  s_cbranch_scc1 L_abort
  s_load_dwordx2 s[92:93], s[0:1], 72
  s_waitcnt lgkmcnt(0)
  s_mov_b32 s94, 819200
  s_mov_b32 s95, 0x20000
  s_mul_i32 s36, s9, 26
  s_lshr_b32 s36, s36, 8
  s_mul_i32 s37, s36, 10
  s_sub_u32 s65, s9, s37
  s_lshl_b32 s36, s36, 2
  s_add_u32 s36, s36, s10
  s_lshl_b32 s13, s36, 7
  s_mov_b32 s37, s65
  s_mul_i32 s14, s37, 40960
  s_add_u32 s14, s14, 77594624
  s_mul_i32 s37, s37, 81920
  s_add_u32 s37, s37, s13
  s_add_u32 s37, s37, 1280
  s_cmp_lt_u32 s36, 10
  s_cselect_b32 s16, s37, 0x80000000
  s_mov_b32 s17, 819200
  s_mov_b32 s15, 409600
  s_cmp_lt_u32 s65, 4
  s_cselect_b32 s18, 7, 6
  v_and_b32 v16, 31, v0
  v_mul_u32_u24 v16, 2560, v16
  v_and_b32 v17, 32, v0
  v_add_u32 v14, v16, v17
  v_lshrrev_b32 v16, 5, v0
  v_lshlrev_b32 v16, 10, v16
  v_bfe_u32 v17, v0, 2, 2
  v_lshl_add_u32 v16, v17, 7, v16
  v_bfe_u32 v17, v0, 3, 1
  v_lshl_add_u32 v16, v17, 6, v16
  v_bfe_u32 v17, v0, 4, 1
  v_lshl_add_u32 v18, v17, 4, v16
  v_bfe_u32 v17, v0, 1, 1
  v_lshl_add_u32 v18, v17, 3, v18
  v_bfe_u32 v17, v0, 0, 1
  v_lshl_add_u32 v18, v17, 5, v18
  v_add_u32 v2, s24, v18
  v_xor_b32 v4, 64, v2
  v_bfe_u32 v16, v0, 3, 2
  v_lshrrev_b32 v17, 5, v0
  v_mad_u32_u24 v16, v17, 8, v16
  v_mul_u32_u24 v16, 1280, v16
  v_lshrrev_b32 v17, 2, v0
  v_and_b32 v17, 4, v17
  v_xor_b32 v17, v17, v0
  v_and_b32 v17, 7, v17
  v_lshl_add_u32 v3, v17, 4, v16
  v_bfe_u32 v16, v0, 3, 2
  v_lshrrev_b32 v17, 5, v0
  v_mad_u32_u24 v16, v17, 40, v16
  v_mul_u32_u24 v16, 1280, v16
  v_lshrrev_b32 v17, 2, v0
  v_and_b32 v17, 4, v17
  v_xor_b32 v17, v17, v0
  v_and_b32 v17, 7, v17
  v_lshl_add_u32 v15, v17, 4, v16
  s_lshl_b32 s36, s10, 10
  v_add_u32 v5, s36, v1
  v_add_u32 v6, 0, v1
  v_add_u32 v7, 1024, v1
  v_add_u32 v8, 2048, v1
  v_add_u32 v9, 3072, v1
  s_waitcnt vmcnt(0) lgkmcnt(0)
  s_barrier
  s_add_u32 m0, s24, 0
  s_add_u32 s36, s13, 0
  buffer_load_dwordx4 v3, s[92:95], s36 offen lds
  s_add_u32 m0, s24, 1024
  s_add_u32 s36, s13, 5120
  buffer_load_dwordx4 v3, s[92:95], s36 offen lds
  s_add_u32 m0, s24, 2048
  s_add_u32 s36, s13, 25600
  buffer_load_dwordx4 v3, s[92:95], s36 offen lds
  s_add_u32 m0, s24, 3072
  s_add_u32 s36, s13, 30720
  buffer_load_dwordx4 v3, s[92:95], s36 offen lds
  s_add_u32 m0, s24, 4096
  s_add_u32 s36, s13, 51200
  buffer_load_dwordx4 v3, s[92:95], s36 offen lds
  s_add_u32 m0, s24, 5120
  s_add_u32 s36, s13, 56320
  buffer_load_dwordx4 v3, s[92:95], s36 offen lds
  s_add_u32 m0, s24, 6144
  s_add_u32 s36, s13, 76800
  buffer_load_dwordx4 v3, s[92:95], s36 offen lds
  s_add_u32 m0, s24, 7168
  s_add_u32 s36, s13, 81920
  buffer_load_dwordx4 v3, s[92:95], s36 offen lds
  s_add_u32 m0, s24, 8192
  s_add_u32 s36, s13, 20480
  buffer_load_dwordx4 v15, s[92:95], s36 offen lds
  s_add_u32 m0, s24, 9216
  s_add_u32 s36, s13, 46080
  buffer_load_dwordx4 v15, s[92:95], s36 offen lds
  s_add_u32 m0, s24, 10240
  s_add_u32 s36, s13, 102400
  buffer_load_dwordx4 v3, s[92:95], s36 offen lds
  s_add_u32 m0, s24, 11264
  s_add_u32 s36, s13, 107520
  buffer_load_dwordx4 v3, s[92:95], s36 offen lds
  s_add_u32 m0, s24, 12288
  s_add_u32 s36, s13, 128000
  buffer_load_dwordx4 v3, s[92:95], s36 offen lds
  s_add_u32 m0, s24, 13312
  s_add_u32 s36, s13, 133120
  buffer_load_dwordx4 v3, s[92:95], s36 offen lds
  s_add_u32 m0, s24, 14336
  s_add_u32 s36, s13, 153600
  buffer_load_dwordx4 v3, s[92:95], s36 offen lds
  s_add_u32 m0, s24, 15360
  s_add_u32 s36, s13, 158720
  buffer_load_dwordx4 v3, s[92:95], s36 offen lds
  s_add_u32 m0, s24, 16384
  s_add_u32 s36, s13, 179200
  buffer_load_dwordx4 v3, s[92:95], s36 offen lds
  s_add_u32 m0, s24, 17408
  s_add_u32 s36, s13, 184320
  buffer_load_dwordx4 v3, s[92:95], s36 offen lds
  s_add_u32 m0, s24, 18432
  s_add_u32 s36, s13, 122880
  buffer_load_dwordx4 v15, s[92:95], s36 offen lds
  s_add_u32 m0, s24, 19456
  s_add_u32 s36, s13, 148480
  buffer_load_dwordx4 v15, s[92:95], s36 offen lds
  s_add_u32 m0, s24, 20480
  s_add_u32 s36, s13, 204800
  buffer_load_dwordx4 v3, s[92:95], s36 offen lds
  s_add_u32 m0, s24, 21504
  s_add_u32 s36, s13, 209920
  buffer_load_dwordx4 v3, s[92:95], s36 offen lds
  s_add_u32 m0, s24, 22528
  s_add_u32 s36, s13, 230400
  buffer_load_dwordx4 v3, s[92:95], s36 offen lds
  s_add_u32 m0, s24, 23552
  s_add_u32 s36, s13, 235520
  buffer_load_dwordx4 v3, s[92:95], s36 offen lds
  s_add_u32 m0, s24, 24576
  s_add_u32 s36, s13, 256000
  buffer_load_dwordx4 v3, s[92:95], s36 offen lds
  s_add_u32 m0, s24, 25600
  s_add_u32 s36, s13, 261120
  buffer_load_dwordx4 v3, s[92:95], s36 offen lds
  s_add_u32 m0, s24, 26624
  s_add_u32 s36, s13, 281600
  buffer_load_dwordx4 v3, s[92:95], s36 offen lds
  s_add_u32 m0, s24, 27648
  s_add_u32 s36, s13, 286720
  buffer_load_dwordx4 v3, s[92:95], s36 offen lds
  s_add_u32 m0, s24, 28672
  s_add_u32 s36, s13, 225280
  buffer_load_dwordx4 v15, s[92:95], s36 offen lds
  s_add_u32 m0, s24, 29696
  s_add_u32 s36, s13, 250880
  buffer_load_dwordx4 v15, s[92:95], s36 offen lds
  s_add_u32 m0, s24, 30720
  s_add_u32 s36, s13, 307200
  buffer_load_dwordx4 v3, s[92:95], s36 offen lds
  s_add_u32 m0, s24, 31744
  s_add_u32 s36, s13, 312320
  buffer_load_dwordx4 v3, s[92:95], s36 offen lds
  s_waitcnt vmcnt(24)
  ds_read_b64_tr_b16 v[192:193], v2 offset:0
  ds_read_b64_tr_b16 v[194:195], v2 offset:512
  ds_read_b64_tr_b16 a[96:97], v4 offset:0
  ds_read_b64_tr_b16 a[98:99], v4 offset:512
  ds_read_b64_tr_b16 v[196:197], v2 offset:2048
  ds_read_b64_tr_b16 v[198:199], v2 offset:2560
  ds_read_b64_tr_b16 a[100:101], v4 offset:2048
  ds_read_b64_tr_b16 a[102:103], v4 offset:2560
  s_waitcnt lgkmcnt(0)
  ds_read_b64_tr_b16 v[200:201], v2 offset:4096
  ds_read_b64_tr_b16 v[202:203], v2 offset:4608
  ds_read_b64_tr_b16 a[104:105], v4 offset:4096
  ds_read_b64_tr_b16 a[106:107], v4 offset:4608
  ds_read_b64_tr_b16 v[204:205], v2 offset:6144
  ds_read_b64_tr_b16 v[206:207], v2 offset:6656
  ds_read_b64_tr_b16 a[108:109], v4 offset:6144
  ds_read_b64_tr_b16 a[110:111], v4 offset:6656
  s_waitcnt lgkmcnt(0)
  s_add_u32 m0, s24, 0
  s_add_u32 s36, s13, 332800
  buffer_load_dwordx4 v3, s[92:95], s36 offen lds
  s_add_u32 m0, s24, 1024
  s_add_u32 s36, s13, 337920
  buffer_load_dwordx4 v3, s[92:95], s36 offen lds
  s_add_u32 m0, s24, 2048
  s_add_u32 s36, s13, 358400
  buffer_load_dwordx4 v3, s[92:95], s36 offen lds
  s_add_u32 m0, s24, 3072
  s_add_u32 s36, s13, 363520
  buffer_load_dwordx4 v3, s[92:95], s36 offen lds
  s_add_u32 m0, s24, 4096
  s_add_u32 s36, s13, 384000
  buffer_load_dwordx4 v3, s[92:95], s36 offen lds
  s_add_u32 m0, s24, 5120
  s_add_u32 s36, s13, 389120
  buffer_load_dwordx4 v3, s[92:95], s36 offen lds
  s_add_u32 m0, s24, 6144
  s_add_u32 s36, s13, 327680
  buffer_load_dwordx4 v15, s[92:95], s36 offen lds
  s_add_u32 m0, s24, 7168
  s_add_u32 s36, s13, 353280
  buffer_load_dwordx4 v15, s[92:95], s36 offen lds
  s_waitcnt vmcnt(24)
  ds_read_b64_tr_b16 v[208:209], v2 offset:8192
  ds_read_b64_tr_b16 v[210:211], v2 offset:8704
  ds_read_b64_tr_b16 a[112:113], v4 offset:8192
  ds_read_b64_tr_b16 a[114:115], v4 offset:8704
  ds_read_b64_tr_b16 v[212:213], v2 offset:10240
  ds_read_b64_tr_b16 v[214:215], v2 offset:10752
  ds_read_b64_tr_b16 a[116:117], v4 offset:10240
  ds_read_b64_tr_b16 a[118:119], v4 offset:10752
  s_waitcnt lgkmcnt(0)
  ds_read_b64_tr_b16 v[216:217], v2 offset:12288
  ds_read_b64_tr_b16 v[218:219], v2 offset:12800
  ds_read_b64_tr_b16 a[120:121], v4 offset:12288
  ds_read_b64_tr_b16 a[122:123], v4 offset:12800
  ds_read_b64_tr_b16 v[220:221], v2 offset:14336
  ds_read_b64_tr_b16 v[222:223], v2 offset:14848
  ds_read_b64_tr_b16 a[124:125], v4 offset:14336
  ds_read_b64_tr_b16 a[126:127], v4 offset:14848
  s_waitcnt lgkmcnt(0)
  s_add_u32 m0, s24, 8192
  s_add_u32 s36, s13, 409600
  buffer_load_dwordx4 v3, s[92:95], s36 offen lds
  s_add_u32 m0, s24, 9216
  s_add_u32 s36, s13, 414720
  buffer_load_dwordx4 v3, s[92:95], s36 offen lds
  s_add_u32 m0, s24, 10240
  s_add_u32 s36, s13, 435200
  buffer_load_dwordx4 v3, s[92:95], s36 offen lds
  s_add_u32 m0, s24, 11264
  s_add_u32 s36, s13, 440320
  buffer_load_dwordx4 v3, s[92:95], s36 offen lds
  s_add_u32 m0, s24, 12288
  s_add_u32 s36, s13, 460800
  buffer_load_dwordx4 v3, s[92:95], s36 offen lds
  s_add_u32 m0, s24, 13312
  s_add_u32 s36, s13, 465920
  buffer_load_dwordx4 v3, s[92:95], s36 offen lds
  s_add_u32 m0, s24, 14336
  s_add_u32 s36, s13, 486400
  buffer_load_dwordx4 v3, s[92:95], s36 offen lds
  s_add_u32 m0, s24, 15360
  s_add_u32 s36, s13, 491520
  buffer_load_dwordx4 v3, s[92:95], s36 offen lds
  s_waitcnt vmcnt(24)
  ds_read_b64_tr_b16 v[224:225], v2 offset:16384
  ds_read_b64_tr_b16 v[226:227], v2 offset:16896
  ds_read_b64_tr_b16 a[128:129], v4 offset:16384
  ds_read_b64_tr_b16 a[130:131], v4 offset:16896
  ds_read_b64_tr_b16 v[228:229], v2 offset:18432
  ds_read_b64_tr_b16 v[230:231], v2 offset:18944
  ds_read_b64_tr_b16 a[132:133], v4 offset:18432
  ds_read_b64_tr_b16 a[134:135], v4 offset:18944
  s_waitcnt lgkmcnt(0)
  ds_read_b64_tr_b16 v[232:233], v2 offset:20480
  ds_read_b64_tr_b16 v[234:235], v2 offset:20992
  ds_read_b64_tr_b16 a[136:137], v4 offset:20480
  ds_read_b64_tr_b16 a[138:139], v4 offset:20992
  ds_read_b64_tr_b16 v[236:237], v2 offset:22528
  ds_read_b64_tr_b16 v[238:239], v2 offset:23040
  ds_read_b64_tr_b16 a[140:141], v4 offset:22528
  ds_read_b64_tr_b16 a[142:143], v4 offset:23040
  s_waitcnt lgkmcnt(0)
  s_add_u32 m0, s24, 16384
  s_add_u32 s36, s13, 430080
  buffer_load_dwordx4 v15, s[92:95], s36 offen lds
  s_add_u32 m0, s24, 17408
  s_add_u32 s36, s13, 455680
  buffer_load_dwordx4 v15, s[92:95], s36 offen lds
  s_add_u32 m0, s24, 18432
  s_add_u32 s36, s13, 512000
  buffer_load_dwordx4 v3, s[92:95], s36 offen lds
  s_add_u32 m0, s24, 19456
  s_add_u32 s36, s13, 517120
  buffer_load_dwordx4 v3, s[92:95], s36 offen lds
  s_add_u32 m0, s24, 20480
  s_add_u32 s36, s13, 537600
  buffer_load_dwordx4 v3, s[92:95], s36 offen lds
  s_add_u32 m0, s24, 21504
  s_add_u32 s36, s13, 542720
  buffer_load_dwordx4 v3, s[92:95], s36 offen lds
  s_add_u32 m0, s24, 22528
  s_add_u32 s36, s13, 563200
  buffer_load_dwordx4 v3, s[92:95], s36 offen lds
  s_add_u32 m0, s24, 23552
  s_add_u32 s36, s13, 568320
  buffer_load_dwordx4 v3, s[92:95], s36 offen lds
  s_waitcnt vmcnt(24)
  ds_read_b64_tr_b16 v[240:241], v2 offset:24576
  ds_read_b64_tr_b16 v[242:243], v2 offset:25088
  ds_read_b64_tr_b16 a[144:145], v4 offset:24576
  ds_read_b64_tr_b16 a[146:147], v4 offset:25088
  ds_read_b64_tr_b16 v[244:245], v2 offset:26624
  ds_read_b64_tr_b16 v[246:247], v2 offset:27136
  ds_read_b64_tr_b16 a[148:149], v4 offset:26624
  ds_read_b64_tr_b16 a[150:151], v4 offset:27136
  s_waitcnt lgkmcnt(0)
  ds_read_b64_tr_b16 v[248:249], v2 offset:28672
  ds_read_b64_tr_b16 v[250:251], v2 offset:29184
  ds_read_b64_tr_b16 a[152:153], v4 offset:28672
  ds_read_b64_tr_b16 a[154:155], v4 offset:29184
  ds_read_b64_tr_b16 v[252:253], v2 offset:30720
  ds_read_b64_tr_b16 v[254:255], v2 offset:31232
  ds_read_b64_tr_b16 a[156:157], v4 offset:30720
  ds_read_b64_tr_b16 a[158:159], v4 offset:31232
  s_waitcnt lgkmcnt(0)
  s_add_u32 m0, s24, 24576
  s_add_u32 s36, s13, 588800
  buffer_load_dwordx4 v3, s[92:95], s36 offen lds
  s_add_u32 m0, s24, 25600
  s_add_u32 s36, s13, 593920
  buffer_load_dwordx4 v3, s[92:95], s36 offen lds
  s_add_u32 m0, s24, 26624
  s_add_u32 s36, s13, 532480
  buffer_load_dwordx4 v15, s[92:95], s36 offen lds
  s_add_u32 m0, s24, 27648
  s_add_u32 s36, s13, 558080
  buffer_load_dwordx4 v15, s[92:95], s36 offen lds
  s_add_u32 m0, s24, 28672
  s_add_u32 s36, s13, 614400
  buffer_load_dwordx4 v3, s[92:95], s36 offen lds
  s_add_u32 m0, s24, 29696
  s_add_u32 s36, s13, 619520
  buffer_load_dwordx4 v3, s[92:95], s36 offen lds
  s_add_u32 m0, s24, 30720
  s_add_u32 s36, s13, 640000
  buffer_load_dwordx4 v3, s[92:95], s36 offen lds
  s_add_u32 m0, s24, 31744
  s_add_u32 s36, s13, 645120
  buffer_load_dwordx4 v3, s[92:95], s36 offen lds
  s_waitcnt vmcnt(24)
  ds_read_b64_tr_b16 a[0:1], v2 offset:0
  ds_read_b64_tr_b16 a[2:3], v2 offset:512
  ds_read_b64_tr_b16 a[160:161], v4 offset:0
  ds_read_b64_tr_b16 a[162:163], v4 offset:512
  ds_read_b64_tr_b16 a[4:5], v2 offset:2048
  ds_read_b64_tr_b16 a[6:7], v2 offset:2560
  ds_read_b64_tr_b16 a[164:165], v4 offset:2048
  ds_read_b64_tr_b16 a[166:167], v4 offset:2560
  s_waitcnt lgkmcnt(0)
  ds_read_b64_tr_b16 a[8:9], v2 offset:4096
  ds_read_b64_tr_b16 a[10:11], v2 offset:4608
  ds_read_b64_tr_b16 a[168:169], v4 offset:4096
  ds_read_b64_tr_b16 a[170:171], v4 offset:4608
  ds_read_b64_tr_b16 a[12:13], v2 offset:6144
  ds_read_b64_tr_b16 a[14:15], v2 offset:6656
  ds_read_b64_tr_b16 a[172:173], v4 offset:6144
  ds_read_b64_tr_b16 a[174:175], v4 offset:6656
  s_waitcnt lgkmcnt(0)
  s_add_u32 m0, s24, 0
  s_add_u32 s36, s13, 665600
  buffer_load_dwordx4 v3, s[92:95], s36 offen lds
  s_add_u32 m0, s24, 1024
  s_add_u32 s36, s13, 670720
  buffer_load_dwordx4 v3, s[92:95], s36 offen lds
  s_add_u32 m0, s24, 2048
  s_add_u32 s36, s13, 691200
  buffer_load_dwordx4 v3, s[92:95], s36 offen lds
  s_add_u32 m0, s24, 3072
  s_add_u32 s36, s13, 696320
  buffer_load_dwordx4 v3, s[92:95], s36 offen lds
  s_add_u32 m0, s24, 4096
  s_add_u32 s36, s13, 634880
  buffer_load_dwordx4 v15, s[92:95], s36 offen lds
  s_add_u32 m0, s24, 5120
  s_add_u32 s36, s13, 660480
  buffer_load_dwordx4 v15, s[92:95], s36 offen lds
  s_add_u32 m0, s24, 6144
  s_add_u32 s36, s13, 716800
  buffer_load_dwordx4 v3, s[92:95], s36 offen lds
  s_add_u32 m0, s24, 7168
  s_add_u32 s36, s13, 721920
  buffer_load_dwordx4 v3, s[92:95], s36 offen lds
  s_waitcnt vmcnt(24)
  ds_read_b64_tr_b16 a[16:17], v2 offset:8192
  ds_read_b64_tr_b16 a[18:19], v2 offset:8704
  ds_read_b64_tr_b16 a[176:177], v4 offset:8192
  ds_read_b64_tr_b16 a[178:179], v4 offset:8704
  ds_read_b64_tr_b16 a[20:21], v2 offset:10240
  ds_read_b64_tr_b16 a[22:23], v2 offset:10752
  ds_read_b64_tr_b16 a[180:181], v4 offset:10240
  ds_read_b64_tr_b16 a[182:183], v4 offset:10752
  s_waitcnt lgkmcnt(0)
  ds_read_b64_tr_b16 a[24:25], v2 offset:12288
  ds_read_b64_tr_b16 a[26:27], v2 offset:12800
  ds_read_b64_tr_b16 a[184:185], v4 offset:12288
  ds_read_b64_tr_b16 a[186:187], v4 offset:12800
  ds_read_b64_tr_b16 a[28:29], v2 offset:14336
  ds_read_b64_tr_b16 a[30:31], v2 offset:14848
  ds_read_b64_tr_b16 a[188:189], v4 offset:14336
  ds_read_b64_tr_b16 a[190:191], v4 offset:14848
  s_waitcnt lgkmcnt(0)
  s_add_u32 m0, s24, 8192
  s_add_u32 s36, s13, 742400
  buffer_load_dwordx4 v3, s[92:95], s36 offen lds
  s_add_u32 m0, s24, 9216
  s_add_u32 s36, s13, 747520
  buffer_load_dwordx4 v3, s[92:95], s36 offen lds
  s_add_u32 m0, s24, 10240
  s_add_u32 s36, s13, 768000
  buffer_load_dwordx4 v3, s[92:95], s36 offen lds
  s_add_u32 m0, s24, 11264
  s_add_u32 s36, s13, 773120
  buffer_load_dwordx4 v3, s[92:95], s36 offen lds
  s_add_u32 m0, s24, 12288
  s_add_u32 s36, s13, 793600
  buffer_load_dwordx4 v3, s[92:95], s36 offen lds
  s_add_u32 m0, s24, 13312
  s_add_u32 s36, s13, 798720
  buffer_load_dwordx4 v3, s[92:95], s36 offen lds
  s_add_u32 m0, s24, 14336
  s_add_u32 s36, s13, 737280
  buffer_load_dwordx4 v15, s[92:95], s36 offen lds
  s_add_u32 m0, s24, 15360
  s_add_u32 s36, s13, 762880
  buffer_load_dwordx4 v15, s[92:95], s36 offen lds
  s_waitcnt vmcnt(24)
  ds_read_b64_tr_b16 a[32:33], v2 offset:16384
  ds_read_b64_tr_b16 a[34:35], v2 offset:16896
  ds_read_b64_tr_b16 a[192:193], v4 offset:16384
  ds_read_b64_tr_b16 a[194:195], v4 offset:16896
  ds_read_b64_tr_b16 a[36:37], v2 offset:18432
  ds_read_b64_tr_b16 a[38:39], v2 offset:18944
  ds_read_b64_tr_b16 a[196:197], v4 offset:18432
  ds_read_b64_tr_b16 a[198:199], v4 offset:18944
  s_waitcnt lgkmcnt(0)
  ds_read_b64_tr_b16 a[40:41], v2 offset:20480
  ds_read_b64_tr_b16 a[42:43], v2 offset:20992
  ds_read_b64_tr_b16 a[200:201], v4 offset:20480
  ds_read_b64_tr_b16 a[202:203], v4 offset:20992
  ds_read_b64_tr_b16 a[44:45], v2 offset:22528
  ds_read_b64_tr_b16 a[46:47], v2 offset:23040
  ds_read_b64_tr_b16 a[204:205], v4 offset:22528
  ds_read_b64_tr_b16 a[206:207], v4 offset:23040
  s_waitcnt lgkmcnt(0)
  s_waitcnt vmcnt(16)
  ds_read_b64_tr_b16 a[48:49], v2 offset:24576
  ds_read_b64_tr_b16 a[50:51], v2 offset:25088
  ds_read_b64_tr_b16 a[208:209], v4 offset:24576
  ds_read_b64_tr_b16 a[210:211], v4 offset:25088
  ds_read_b64_tr_b16 a[52:53], v2 offset:26624
  ds_read_b64_tr_b16 a[54:55], v2 offset:27136
  ds_read_b64_tr_b16 a[212:213], v4 offset:26624
  ds_read_b64_tr_b16 a[214:215], v4 offset:27136
  s_waitcnt lgkmcnt(0)
  ds_read_b64_tr_b16 a[56:57], v2 offset:28672
  ds_read_b64_tr_b16 a[58:59], v2 offset:29184
  ds_read_b64_tr_b16 a[216:217], v4 offset:28672
  ds_read_b64_tr_b16 a[218:219], v4 offset:29184
  ds_read_b64_tr_b16 a[60:61], v2 offset:30720
  ds_read_b64_tr_b16 a[62:63], v2 offset:31232
  ds_read_b64_tr_b16 a[220:221], v4 offset:30720
  ds_read_b64_tr_b16 a[222:223], v4 offset:31232
  s_waitcnt lgkmcnt(0)
  s_waitcnt vmcnt(8)
  ds_read_b64_tr_b16 a[64:65], v2 offset:0
  ds_read_b64_tr_b16 a[66:67], v2 offset:512
  ds_read_b64_tr_b16 a[224:225], v4 offset:0
  ds_read_b64_tr_b16 a[226:227], v4 offset:512
  ds_read_b64_tr_b16 a[68:69], v2 offset:2048
  ds_read_b64_tr_b16 a[70:71], v2 offset:2560
  ds_read_b64_tr_b16 a[228:229], v4 offset:2048
  ds_read_b64_tr_b16 a[230:231], v4 offset:2560
  s_waitcnt lgkmcnt(0)
  ds_read_b64_tr_b16 a[72:73], v2 offset:4096
  ds_read_b64_tr_b16 a[74:75], v2 offset:4608
  ds_read_b64_tr_b16 a[232:233], v4 offset:4096
  ds_read_b64_tr_b16 a[234:235], v4 offset:4608
  ds_read_b64_tr_b16 a[76:77], v2 offset:6144
  ds_read_b64_tr_b16 a[78:79], v2 offset:6656
  ds_read_b64_tr_b16 a[236:237], v4 offset:6144
  ds_read_b64_tr_b16 a[238:239], v4 offset:6656
  s_waitcnt lgkmcnt(0)
  s_waitcnt vmcnt(0)
  ds_read_b64_tr_b16 a[80:81], v2 offset:8192
  ds_read_b64_tr_b16 a[82:83], v2 offset:8704
  ds_read_b64_tr_b16 a[240:241], v4 offset:8192
  ds_read_b64_tr_b16 a[242:243], v4 offset:8704
  ds_read_b64_tr_b16 a[84:85], v2 offset:10240
  ds_read_b64_tr_b16 a[86:87], v2 offset:10752
  ds_read_b64_tr_b16 a[244:245], v4 offset:10240
  ds_read_b64_tr_b16 a[246:247], v4 offset:10752
  s_waitcnt lgkmcnt(0)
  ds_read_b64_tr_b16 a[88:89], v2 offset:12288
  ds_read_b64_tr_b16 a[90:91], v2 offset:12800
  ds_read_b64_tr_b16 a[248:249], v4 offset:12288
  ds_read_b64_tr_b16 a[250:251], v4 offset:12800
  ds_read_b64_tr_b16 a[92:93], v2 offset:14336
  ds_read_b64_tr_b16 a[94:95], v2 offset:14848
  ds_read_b64_tr_b16 a[252:253], v4 offset:14336
  ds_read_b64_tr_b16 a[254:255], v4 offset:14848
  s_waitcnt lgkmcnt(0)
  s_barrier
  s_cmp_lg_u32 s10, 0
  s_cbranch_scc1 L_polled_96
  v_and_b32 v17, 0, v0
  v_lshlrev_b32 v17, 2, v17
L_poll_95:
  buffer_load_dword v16, v17, s[84:87], 48 offen sc1
  s_waitcnt vmcnt(0)
  v_cmp_gt_u32 vcc, 128, v16
  s_cbranch_vccz L_polled_96
  s_sub_u32 s12, s12, 1
  s_cbranch_scc1 L_abort
  s_sleep 2
  s_branch L_poll_95
L_polled_96:
  s_barrier
  s_mov_b32 s23, s18
  s_lshl_b32 s32, s10, 10
  s_mov_b32 s22, s32
  s_mov_b32 s21, 0
  s_mov_b32 s20, 0
  s_mov_b32 s66, 0x80000000
  v_mov_b32 v16, 0
  s_cmp_gt_i32 s23, 0
  s_cselect_b32 s37, s14, 0x80000000
  s_sub_u32 s23, s23, 1
  s_add_u32 s14, s14, s15
  s_add_u32 m0, s22, 0
  s_add_u32 s36, s37, 0
  buffer_load_dwordx4 v5, s[4:7], s36 offen sc1 lds
  s_add_u32 m0, s22, 4096
  s_add_u32 s36, s37, 4096
  buffer_load_dwordx4 v5, s[4:7], s36 offen sc1 lds
  s_add_u32 m0, s22, 8192
  s_add_u32 s36, s37, 8192
  buffer_load_dwordx4 v5, s[4:7], s36 offen sc1 lds
  s_add_u32 m0, s22, 12288
  s_add_u32 s36, s37, 12288
  buffer_load_dwordx4 v5, s[4:7], s36 offen sc1 lds
  s_add_u32 m0, s22, 16384
  s_add_u32 s36, s37, 16384
  buffer_load_dwordx4 v5, s[4:7], s36 offen sc1 lds
  s_add_u32 m0, s22, 20480
  s_add_u32 s36, s37, 20480
  buffer_load_dwordx4 v5, s[4:7], s36 offen sc1 lds
  s_add_u32 m0, s22, 24576
  s_add_u32 s36, s37, 24576
  buffer_load_dwordx4 v5, s[4:7], s36 offen sc1 lds
  s_add_u32 m0, s22, 28672
  s_add_u32 s36, s37, 28672
  buffer_load_dwordx4 v5, s[4:7], s36 offen sc1 lds
  s_add_u32 m0, s22, 32768
  s_add_u32 s36, s37, 32768
  buffer_load_dwordx4 v5, s[4:7], s36 offen sc1 lds
  s_add_u32 m0, s22, 36864
  s_add_u32 s36, s37, 36864
  buffer_load_dwordx4 v5, s[4:7], s36 offen sc1 lds
  s_add_u32 s22, s22, 40960
  s_cmp_ge_u32 s22, 122880
  s_cselect_b32 s22, s32, s22
  s_cmp_gt_i32 s23, 0
  s_cselect_b32 s37, s14, 0x80000000
  s_sub_u32 s23, s23, 1
  s_add_u32 s14, s14, s15
  s_add_u32 m0, s22, 0
  s_add_u32 s36, s37, 0
  buffer_load_dwordx4 v5, s[4:7], s36 offen sc1 lds
  s_add_u32 m0, s22, 4096
  s_add_u32 s36, s37, 4096
  buffer_load_dwordx4 v5, s[4:7], s36 offen sc1 lds
  s_add_u32 m0, s22, 8192
  s_add_u32 s36, s37, 8192
  buffer_load_dwordx4 v5, s[4:7], s36 offen sc1 lds
  s_add_u32 m0, s22, 12288
  s_add_u32 s36, s37, 12288
  buffer_load_dwordx4 v5, s[4:7], s36 offen sc1 lds
  s_add_u32 m0, s22, 16384
  s_add_u32 s36, s37, 16384
  buffer_load_dwordx4 v5, s[4:7], s36 offen sc1 lds
  s_add_u32 m0, s22, 20480
  s_add_u32 s36, s37, 20480
  buffer_load_dwordx4 v5, s[4:7], s36 offen sc1 lds
  s_add_u32 m0, s22, 24576
  s_add_u32 s36, s37, 24576
  buffer_load_dwordx4 v5, s[4:7], s36 offen sc1 lds
  s_add_u32 m0, s22, 28672
  s_add_u32 s36, s37, 28672
  buffer_load_dwordx4 v5, s[4:7], s36 offen sc1 lds
  s_add_u32 m0, s22, 32768
  s_add_u32 s36, s37, 32768
  buffer_load_dwordx4 v5, s[4:7], s36 offen sc1 lds
  s_add_u32 m0, s22, 36864
  s_add_u32 s36, s37, 36864
  buffer_load_dwordx4 v5, s[4:7], s36 offen sc1 lds
  s_add_u32 s22, s22, 40960
  s_cmp_ge_u32 s22, 122880
  s_cselect_b32 s22, s32, s22
  v_add_u32 v10, s21, v6
  v_add_u32 v11, s21, v7
  v_add_u32 v12, s21, v8
  v_add_u32 v13, s21, v9
  s_waitcnt vmcnt(10)
  s_barrier
  ds_read_b128 v[160:163], v10 offset:0
  ds_read_b128 v[164:167], v11 offset:0
  ds_read_b128 v[168:171], v12 offset:0
L_gemm_97:
  s_cmp_gt_i32 s23, 0
  s_cselect_b32 s37, s14, 0x80000000
  s_sub_u32 s23, s23, 1
  s_add_u32 s14, s14, s15
  s_waitcnt lgkmcnt(2)
  v_mfma_f32_32x32x16_bf16 v[128:143], v[192:195], v[160:163], 0
  ds_read_b128 v[172:175], v13 offset:0
  v_mfma_f32_32x32x16_bf16 v[144:159], a[96:99], v[160:163], 0
  s_mov_b64 exec, 1
  buffer_store_dword v16, v1, s[4:7], s19 offen sc1
  s_mov_b64 exec, -1
  s_waitcnt lgkmcnt(2)
  v_mfma_f32_32x32x16_bf16 v[128:143], v[196:199], v[164:167], v[128:143]
  ds_read_b128 v[160:163], v10 offset:4096
  v_mfma_f32_32x32x16_bf16 v[144:159], a[100:103], v[164:167], v[144:159]
  s_waitcnt lgkmcnt(2)
  v_mfma_f32_32x32x16_bf16 v[128:143], v[200:203], v[168:171], v[128:143]
  ds_read_b128 v[164:167], v11 offset:4096
  v_mfma_f32_32x32x16_bf16 v[144:159], a[104:107], v[168:171], v[144:159]
  buffer_store_dwordx4 v[176:179], v14, s[88:91], s66 offen offset:0
  s_waitcnt lgkmcnt(2)
  v_mfma_f32_32x32x16_bf16 v[128:143], v[204:207], v[172:175], v[128:143]
  ds_read_b128 v[168:171], v12 offset:4096
  v_mfma_f32_32x32x16_bf16 v[144:159], a[108:111], v[172:175], v[144:159]
  s_waitcnt lgkmcnt(2)
  v_mfma_f32_32x32x16_bf16 v[128:143], v[208:211], v[160:163], v[128:143]
  ds_read_b128 v[172:175], v13 offset:4096
  v_mfma_f32_32x32x16_bf16 v[144:159], a[112:115], v[160:163], v[144:159]
  buffer_store_dwordx4 v[180:183], v14, s[88:91], s66 offen offset:16
  s_waitcnt lgkmcnt(2)
  v_mfma_f32_32x32x16_bf16 v[128:143], v[212:215], v[164:167], v[128:143]
  ds_read_b128 v[160:163], v10 offset:8192
  v_mfma_f32_32x32x16_bf16 v[144:159], a[116:119], v[164:167], v[144:159]
  s_waitcnt lgkmcnt(2)
  v_mfma_f32_32x32x16_bf16 v[128:143], v[216:219], v[168:171], v[128:143]
  ds_read_b128 v[164:167], v11 offset:8192
  v_mfma_f32_32x32x16_bf16 v[144:159], a[120:123], v[168:171], v[144:159]
  buffer_store_dwordx4 v[184:187], v14, s[88:91], s66 offen offset:64
  s_waitcnt lgkmcnt(2)
  v_mfma_f32_32x32x16_bf16 v[128:143], v[220:223], v[172:175], v[128:143]
  ds_read_b128 v[168:171], v12 offset:8192
  v_mfma_f32_32x32x16_bf16 v[144:159], a[124:127], v[172:175], v[144:159]
  s_waitcnt lgkmcnt(2)
  v_mfma_f32_32x32x16_bf16 v[128:143], v[224:227], v[160:163], v[128:143]
  ds_read_b128 v[172:175], v13 offset:8192
  v_mfma_f32_32x32x16_bf16 v[144:159], a[128:131], v[160:163], v[144:159]
  buffer_store_dwordx4 v[188:191], v14, s[88:91], s66 offen offset:80
  s_waitcnt lgkmcnt(2)
  v_mfma_f32_32x32x16_bf16 v[128:143], v[228:231], v[164:167], v[128:143]
  ds_read_b128 v[160:163], v10 offset:12288
  v_mfma_f32_32x32x16_bf16 v[144:159], a[132:135], v[164:167], v[144:159]
  s_waitcnt lgkmcnt(2)
  v_mfma_f32_32x32x16_bf16 v[128:143], v[232:235], v[168:171], v[128:143]
  ds_read_b128 v[164:167], v11 offset:12288
  v_mfma_f32_32x32x16_bf16 v[144:159], a[136:139], v[168:171], v[144:159]
  s_add_u32 m0, s22, 0
  s_add_u32 s36, s37, 0
  buffer_load_dwordx4 v5, s[4:7], s36 offen sc1 lds
  s_waitcnt lgkmcnt(2)
  v_mfma_f32_32x32x16_bf16 v[128:143], v[236:239], v[172:175], v[128:143]
  ds_read_b128 v[168:171], v12 offset:12288
  v_mfma_f32_32x32x16_bf16 v[144:159], a[140:143], v[172:175], v[144:159]
  s_waitcnt lgkmcnt(2)
  v_mfma_f32_32x32x16_bf16 v[128:143], v[240:243], v[160:163], v[128:143]
  ds_read_b128 v[172:175], v13 offset:12288
  v_mfma_f32_32x32x16_bf16 v[144:159], a[144:147], v[160:163], v[144:159]
  s_add_u32 m0, s22, 4096
  s_add_u32 s36, s37, 4096
  buffer_load_dwordx4 v5, s[4:7], s36 offen sc1 lds
  s_waitcnt lgkmcnt(2)
  v_mfma_f32_32x32x16_bf16 v[128:143], v[244:247], v[164:167], v[128:143]
  ds_read_b128 v[160:163], v10 offset:16384
  v_mfma_f32_32x32x16_bf16 v[144:159], a[148:151], v[164:167], v[144:159]
  s_waitcnt lgkmcnt(2)
  v_mfma_f32_32x32x16_bf16 v[128:143], v[248:251], v[168:171], v[128:143]
  ds_read_b128 v[164:167], v11 offset:16384
  v_mfma_f32_32x32x16_bf16 v[144:159], a[152:155], v[168:171], v[144:159]
  s_add_u32 m0, s22, 8192
  s_add_u32 s36, s37, 8192
  buffer_load_dwordx4 v5, s[4:7], s36 offen sc1 lds
  s_waitcnt lgkmcnt(2)
  v_mfma_f32_32x32x16_bf16 v[128:143], v[252:255], v[172:175], v[128:143]
  ds_read_b128 v[168:171], v12 offset:16384
  v_mfma_f32_32x32x16_bf16 v[144:159], a[156:159], v[172:175], v[144:159]
  s_waitcnt lgkmcnt(2)
  v_mfma_f32_32x32x16_bf16 v[128:143], a[0:3], v[160:163], v[128:143]
  ds_read_b128 v[172:175], v13 offset:16384
  v_mfma_f32_32x32x16_bf16 v[144:159], a[160:163], v[160:163], v[144:159]
  s_add_u32 m0, s22, 12288
  s_add_u32 s36, s37, 12288
  buffer_load_dwordx4 v5, s[4:7], s36 offen sc1 lds
  s_waitcnt lgkmcnt(2)
  v_mfma_f32_32x32x16_bf16 v[128:143], a[4:7], v[164:167], v[128:143]
  ds_read_b128 v[160:163], v10 offset:20480
  v_mfma_f32_32x32x16_bf16 v[144:159], a[164:167], v[164:167], v[144:159]
  s_waitcnt lgkmcnt(2)
  v_mfma_f32_32x32x16_bf16 v[128:143], a[8:11], v[168:171], v[128:143]
  ds_read_b128 v[164:167], v11 offset:20480
  v_mfma_f32_32x32x16_bf16 v[144:159], a[168:171], v[168:171], v[144:159]
  s_add_u32 m0, s22, 16384
  s_add_u32 s36, s37, 16384
  buffer_load_dwordx4 v5, s[4:7], s36 offen sc1 lds
  s_waitcnt lgkmcnt(2)
  v_mfma_f32_32x32x16_bf16 v[128:143], a[12:15], v[172:175], v[128:143]
  ds_read_b128 v[168:171], v12 offset:20480
  v_mfma_f32_32x32x16_bf16 v[144:159], a[172:175], v[172:175], v[144:159]
  s_waitcnt lgkmcnt(2)
  v_mfma_f32_32x32x16_bf16 v[128:143], a[16:19], v[160:163], v[128:143]
  ds_read_b128 v[172:175], v13 offset:20480
  v_mfma_f32_32x32x16_bf16 v[144:159], a[176:179], v[160:163], v[144:159]
  s_add_u32 m0, s22, 20480
  s_add_u32 s36, s37, 20480
  buffer_load_dwordx4 v5, s[4:7], s36 offen sc1 lds
  s_waitcnt lgkmcnt(2)
  v_mfma_f32_32x32x16_bf16 v[128:143], a[20:23], v[164:167], v[128:143]
  ds_read_b128 v[160:163], v10 offset:24576
  v_mfma_f32_32x32x16_bf16 v[144:159], a[180:183], v[164:167], v[144:159]
  s_waitcnt lgkmcnt(2)
  v_mfma_f32_32x32x16_bf16 v[128:143], a[24:27], v[168:171], v[128:143]
  ds_read_b128 v[164:167], v11 offset:24576
  v_mfma_f32_32x32x16_bf16 v[144:159], a[184:187], v[168:171], v[144:159]
  s_add_u32 m0, s22, 24576
  s_add_u32 s36, s37, 24576
  buffer_load_dwordx4 v5, s[4:7], s36 offen sc1 lds
  s_waitcnt lgkmcnt(2)
  v_mfma_f32_32x32x16_bf16 v[128:143], a[28:31], v[172:175], v[128:143]
  ds_read_b128 v[168:171], v12 offset:24576
  v_mfma_f32_32x32x16_bf16 v[144:159], a[188:191], v[172:175], v[144:159]
  s_waitcnt lgkmcnt(2)
  v_mfma_f32_32x32x16_bf16 v[128:143], a[32:35], v[160:163], v[128:143]
  ds_read_b128 v[172:175], v13 offset:24576
  v_mfma_f32_32x32x16_bf16 v[144:159], a[192:195], v[160:163], v[144:159]
  s_add_u32 m0, s22, 28672
  s_add_u32 s36, s37, 28672
  buffer_load_dwordx4 v5, s[4:7], s36 offen sc1 lds
  s_waitcnt lgkmcnt(2)
  v_mfma_f32_32x32x16_bf16 v[128:143], a[36:39], v[164:167], v[128:143]
  ds_read_b128 v[160:163], v10 offset:28672
  v_mfma_f32_32x32x16_bf16 v[144:159], a[196:199], v[164:167], v[144:159]
  s_waitcnt lgkmcnt(2)
  v_mfma_f32_32x32x16_bf16 v[128:143], a[40:43], v[168:171], v[128:143]
  ds_read_b128 v[164:167], v11 offset:28672
  v_mfma_f32_32x32x16_bf16 v[144:159], a[200:203], v[168:171], v[144:159]
  s_add_u32 m0, s22, 32768
  s_add_u32 s36, s37, 32768
  buffer_load_dwordx4 v5, s[4:7], s36 offen sc1 lds
  s_waitcnt lgkmcnt(2)
  v_mfma_f32_32x32x16_bf16 v[128:143], a[44:47], v[172:175], v[128:143]
  ds_read_b128 v[168:171], v12 offset:28672
  v_mfma_f32_32x32x16_bf16 v[144:159], a[204:207], v[172:175], v[144:159]
  s_waitcnt lgkmcnt(2)
  v_mfma_f32_32x32x16_bf16 v[128:143], a[48:51], v[160:163], v[128:143]
  ds_read_b128 v[172:175], v13 offset:28672
  v_mfma_f32_32x32x16_bf16 v[144:159], a[208:211], v[160:163], v[144:159]
  s_add_u32 m0, s22, 36864
  s_add_u32 s36, s37, 36864
  buffer_load_dwordx4 v5, s[4:7], s36 offen sc1 lds
  s_waitcnt lgkmcnt(2)
  v_mfma_f32_32x32x16_bf16 v[128:143], a[52:55], v[164:167], v[128:143]
  ds_read_b128 v[160:163], v10 offset:32768
  v_mfma_f32_32x32x16_bf16 v[144:159], a[212:215], v[164:167], v[144:159]
  s_waitcnt lgkmcnt(2)
  v_mfma_f32_32x32x16_bf16 v[128:143], a[56:59], v[168:171], v[128:143]
  ds_read_b128 v[164:167], v11 offset:32768
  v_mfma_f32_32x32x16_bf16 v[144:159], a[216:219], v[168:171], v[144:159]
  s_waitcnt lgkmcnt(2)
  v_mfma_f32_32x32x16_bf16 v[128:143], a[60:63], v[172:175], v[128:143]
  ds_read_b128 v[168:171], v12 offset:32768
  v_mfma_f32_32x32x16_bf16 v[144:159], a[220:223], v[172:175], v[144:159]
  s_waitcnt lgkmcnt(2)
  v_mfma_f32_32x32x16_bf16 v[128:143], a[64:67], v[160:163], v[128:143]
  ds_read_b128 v[172:175], v13 offset:32768
  v_mfma_f32_32x32x16_bf16 v[144:159], a[224:227], v[160:163], v[144:159]
  s_waitcnt lgkmcnt(2)
  v_mfma_f32_32x32x16_bf16 v[128:143], a[68:71], v[164:167], v[128:143]
  ds_read_b128 v[160:163], v10 offset:36864
  v_mfma_f32_32x32x16_bf16 v[144:159], a[228:231], v[164:167], v[144:159]
  s_waitcnt lgkmcnt(2)
  v_mfma_f32_32x32x16_bf16 v[128:143], a[72:75], v[168:171], v[128:143]
  ds_read_b128 v[164:167], v11 offset:36864
  v_mfma_f32_32x32x16_bf16 v[144:159], a[232:235], v[168:171], v[144:159]
  s_waitcnt lgkmcnt(2)
  v_mfma_f32_32x32x16_bf16 v[128:143], a[76:79], v[172:175], v[128:143]
  ds_read_b128 v[168:171], v12 offset:36864
  v_mfma_f32_32x32x16_bf16 v[144:159], a[236:239], v[172:175], v[144:159]
  s_waitcnt lgkmcnt(2)
  v_mfma_f32_32x32x16_bf16 v[128:143], a[80:83], v[160:163], v[128:143]
  ds_read_b128 v[172:175], v13 offset:36864
  v_mfma_f32_32x32x16_bf16 v[144:159], a[240:243], v[160:163], v[144:159]
  s_waitcnt lgkmcnt(2)
  v_mfma_f32_32x32x16_bf16 v[128:143], a[84:87], v[164:167], v[128:143]
  v_mfma_f32_32x32x16_bf16 v[144:159], a[244:247], v[164:167], v[144:159]
  s_waitcnt lgkmcnt(1)
  v_mfma_f32_32x32x16_bf16 v[128:143], a[88:91], v[168:171], v[128:143]
  s_add_u32 s22, s22, 40960
  s_cmp_ge_u32 s22, 122880
  s_cselect_b32 s22, s32, s22
  v_mov_b32 v16, s20
  v_mfma_f32_32x32x16_bf16 v[144:159], a[248:251], v[168:171], v[144:159]
  s_add_u32 s21, s21, 40960
  s_cmp_ge_u32 s21, 122880
  s_cselect_b32 s21, 0, s21
  s_add_u32 s20, s20, 1
  s_waitcnt lgkmcnt(0)
  v_mfma_f32_32x32x16_bf16 v[128:143], a[92:95], v[172:175], v[128:143]
  v_mfma_f32_32x32x16_bf16 v[144:159], a[252:255], v[172:175], v[144:159]
  v_add_u32 v10, s21, v6
  v_add_u32 v11, s21, v7
  v_add_u32 v12, s21, v8
  v_add_u32 v13, s21, v9
  s_waitcnt vmcnt(10)
  s_barrier
  ds_read_b128 v[160:163], v10 offset:0
  ds_read_b128 v[164:167], v11 offset:0
  ds_read_b128 v[168:171], v12 offset:0
  s_mov_b32 s66, s16
  s_add_u32 s16, s16, s17
  s_cmp_lt_u32 s20, s18
  v_cvt_pk_bf16_f32 v176, v128, v129
  v_cvt_pk_bf16_f32 v177, v130, v131
  v_cvt_pk_bf16_f32 v178, v132, v133
  v_cvt_pk_bf16_f32 v179, v134, v135
  v_cvt_pk_bf16_f32 v180, v136, v137
  v_cvt_pk_bf16_f32 v181, v138, v139
  v_cvt_pk_bf16_f32 v182, v140, v141
  v_cvt_pk_bf16_f32 v183, v142, v143
  v_cvt_pk_bf16_f32 v184, v144, v145
  v_cvt_pk_bf16_f32 v185, v146, v147
  v_cvt_pk_bf16_f32 v186, v148, v149
  v_cvt_pk_bf16_f32 v187, v150, v151
  v_cvt_pk_bf16_f32 v188, v152, v153
  v_cvt_pk_bf16_f32 v189, v154, v155
  v_cvt_pk_bf16_f32 v190, v156, v157
  v_cvt_pk_bf16_f32 v191, v158, v159
  s_cbranch_scc1 L_gemm_97
  buffer_store_dwordx4 v[176:179], v14, s[88:91], s66 offen offset:0
  buffer_store_dwordx4 v[180:183], v14, s[88:91], s66 offen offset:16
  buffer_store_dwordx4 v[184:187], v14, s[88:91], s66 offen offset:64
  buffer_store_dwordx4 v[188:191], v14, s[88:91], s66 offen offset:80
  s_waitcnt lgkmcnt(0)
  s_endpgm
L_second:
  s_sub_u32 s9, s8, 128
  s_lshr_b32 s64, s9, 3
  s_and_b32 s65, s9, 7
  s_cmp_lt_u32 s9, 56
  s_cbranch_scc1 L_nopr_98
  v_mov_b32 v19, 0
  s_bitcmp1_b32 s2, 31
  s_cbranch_scc1 L_cask_102
  s_cmp_lg_u32 s10, 0
  s_cbranch_scc1 L_cask_102
  s_lshr_b32 s38, s3, 5
  s_lshr_b32 s36, 160, s38
  s_and_b32 s36, s36, 1
  s_lshl_b32 s36, s36, 5
  s_add_u32 s38, s38, s36
  s_lshl_b32 s38, s38, 2
  s_and_b32 s37, s3, 31
  s_lshl_b32 s36, 1, s37
  v_mov_b32 v18, s36
  s_mov_b64 exec, 1
  buffer_atomic_or v18, v19, s[84:87], s38 offen sc0
  s_mov_b64 exec, -1
L_cask_102:
  s_cmp_lg_u32 s10, 0
  s_cbranch_scc1 L_noprw_99
  s_cmp_ge_u32 s9, 62
  s_cbranch_scc1 L_prwin_100
  s_lshl_b32 s32, s65, 3
  v_mov_b32 v40, 0
  s_mov_b64 exec, 1
  s_lshl_b32 s76, s32, 21
  s_mov_b32 s38, -1
  s_mov_b32 s39, -1
  s_add_u32 s36, s76, 134217728
  s_memtime s[40:41]
  s_waitcnt lgkmcnt(0)
  s_mov_b32 s37, s40
  buffer_atomic_or v40, v40, s[4:7], s36 offen
  s_waitcnt vmcnt(0)
  s_memtime s[40:41]
  s_waitcnt lgkmcnt(0)
  s_sub_u32 s37, s40, s37
  s_min_u32 s38, s38, s37
  s_add_u32 s36, s76, 134225920
  s_memtime s[40:41]
  s_waitcnt lgkmcnt(0)
  s_mov_b32 s37, s40
  buffer_atomic_or v40, v40, s[4:7], s36 offen
  s_waitcnt vmcnt(0)
  s_memtime s[40:41]
  s_waitcnt lgkmcnt(0)
  s_sub_u32 s37, s40, s37
  s_min_u32 s39, s39, s37
  s_add_u32 s36, s76, 134217728
  s_memtime s[40:41]
  s_waitcnt lgkmcnt(0)
  s_mov_b32 s37, s40
  buffer_atomic_or v40, v40, s[4:7], s36 offen
  s_waitcnt vmcnt(0)
  s_memtime s[40:41]
  s_waitcnt lgkmcnt(0)
  s_sub_u32 s37, s40, s37
  s_min_u32 s38, s38, s37
  s_add_u32 s36, s76, 134225920
  s_memtime s[40:41]
  s_waitcnt lgkmcnt(0)
  s_mov_b32 s37, s40
  buffer_atomic_or v40, v40, s[4:7], s36 offen
  s_waitcnt vmcnt(0)
  s_memtime s[40:41]
  s_waitcnt lgkmcnt(0)
  s_sub_u32 s37, s40, s37
  s_min_u32 s39, s39, s37
  s_add_u32 s36, s76, 134217728
  s_memtime s[40:41]
  s_waitcnt lgkmcnt(0)
  s_mov_b32 s37, s40
  buffer_atomic_or v40, v40, s[4:7], s36 offen
  s_waitcnt vmcnt(0)
  s_memtime s[40:41]
  s_waitcnt lgkmcnt(0)
  s_sub_u32 s37, s40, s37
  s_min_u32 s38, s38, s37
  s_add_u32 s36, s76, 134225920
  s_memtime s[40:41]
  s_waitcnt lgkmcnt(0)
  s_mov_b32 s37, s40
  buffer_atomic_or v40, v40, s[4:7], s36 offen
  s_waitcnt vmcnt(0)
  s_memtime s[40:41]
  s_waitcnt lgkmcnt(0)
  s_sub_u32 s37, s40, s37
  s_min_u32 s39, s39, s37
  s_add_u32 s36, s76, 134217728
  s_memtime s[40:41]
  s_waitcnt lgkmcnt(0)
  s_mov_b32 s37, s40
  buffer_atomic_or v40, v40, s[4:7], s36 offen
  s_waitcnt vmcnt(0)
  s_memtime s[40:41]
  s_waitcnt lgkmcnt(0)
  s_sub_u32 s37, s40, s37
  s_min_u32 s38, s38, s37
  s_add_u32 s36, s76, 134225920
  s_memtime s[40:41]
  s_waitcnt lgkmcnt(0)
  s_mov_b32 s37, s40
  buffer_atomic_or v40, v40, s[4:7], s36 offen
  s_waitcnt vmcnt(0)
  s_memtime s[40:41]
  s_waitcnt lgkmcnt(0)
  s_sub_u32 s37, s40, s37
  s_min_u32 s39, s39, s37
  s_mov_b64 exec, -1
  s_cmp_lt_u32 s39, s38
  s_cselect_b32 s76, 1, 0
  s_lshr_b32 s76, 0xaa, s76
  s_mov_b32 s77, 0
  s_lshl_b64 s[76:77], s[76:77], s32
  s_branch L_noprw_99
L_prwin_100:
  s_and_b32 s67, s9, 1
  v_mov_b32 v40, 0
  s_mov_b64 exec, 1
  s_lshl_b32 s39, s67, 21
  s_mov_b32 s44, -1
  s_mov_b32 s45, -1
  s_mov_b32 s46, -1
  s_mov_b32 s47, -1
  s_add_u32 s36, s39, 130031360
  s_memtime s[40:41]
  s_waitcnt lgkmcnt(0)
  s_mov_b32 s37, s40
  buffer_store_dword v40, v40, s[4:7], s36 offen sc1
  s_waitcnt vmcnt(0)
  s_memtime s[40:41]
  s_waitcnt lgkmcnt(0)
  s_sub_u32 s37, s40, s37
  s_min_u32 s44, s44, s37
  s_add_u32 s36, s39, 130039552
  s_memtime s[40:41]
  s_waitcnt lgkmcnt(0)
  s_mov_b32 s37, s40
  buffer_store_dword v40, v40, s[4:7], s36 offen sc1
  s_waitcnt vmcnt(0)
  s_memtime s[40:41]
  s_waitcnt lgkmcnt(0)
  s_sub_u32 s37, s40, s37
  s_min_u32 s45, s45, s37
  s_add_u32 s36, s39, 130047744
  s_memtime s[40:41]
  s_waitcnt lgkmcnt(0)
  s_mov_b32 s37, s40
  buffer_store_dword v40, v40, s[4:7], s36 offen sc1
  s_waitcnt vmcnt(0)
  s_memtime s[40:41]
  s_waitcnt lgkmcnt(0)
  s_sub_u32 s37, s40, s37
  s_min_u32 s46, s46, s37
  s_add_u32 s36, s39, 130055936
  s_memtime s[40:41]
  s_waitcnt lgkmcnt(0)
  s_mov_b32 s37, s40
  buffer_store_dword v40, v40, s[4:7], s36 offen sc1
  s_waitcnt vmcnt(0)
  s_memtime s[40:41]
  s_waitcnt lgkmcnt(0)
  s_sub_u32 s37, s40, s37
  s_min_u32 s47, s47, s37
  s_add_u32 s36, s39, 130031360
  s_memtime s[40:41]
  s_waitcnt lgkmcnt(0)
  s_mov_b32 s37, s40
  buffer_store_dword v40, v40, s[4:7], s36 offen sc1
  s_waitcnt vmcnt(0)
  s_memtime s[40:41]
  s_waitcnt lgkmcnt(0)
  s_sub_u32 s37, s40, s37
  s_min_u32 s44, s44, s37
  s_add_u32 s36, s39, 130039552
  s_memtime s[40:41]
  s_waitcnt lgkmcnt(0)
  s_mov_b32 s37, s40
  buffer_store_dword v40, v40, s[4:7], s36 offen sc1
  s_waitcnt vmcnt(0)
  s_memtime s[40:41]
  s_waitcnt lgkmcnt(0)
  s_sub_u32 s37, s40, s37
  s_min_u32 s45, s45, s37
  s_add_u32 s36, s39, 130047744
  s_memtime s[40:41]
  s_waitcnt lgkmcnt(0)
  s_mov_b32 s37, s40
  buffer_store_dword v40, v40, s[4:7], s36 offen sc1
  s_waitcnt vmcnt(0)
  s_memtime s[40:41]
  s_waitcnt lgkmcnt(0)
  s_sub_u32 s37, s40, s37
  s_min_u32 s46, s46, s37
  s_add_u32 s36, s39, 130055936
  s_memtime s[40:41]
  s_waitcnt lgkmcnt(0)
  s_mov_b32 s37, s40
  buffer_store_dword v40, v40, s[4:7], s36 offen sc1
  s_waitcnt vmcnt(0)
  s_memtime s[40:41]
  s_waitcnt lgkmcnt(0)
  s_sub_u32 s37, s40, s37
  s_min_u32 s47, s47, s37
  s_add_u32 s36, s39, 130031360
  s_memtime s[40:41]
  s_waitcnt lgkmcnt(0)
  s_mov_b32 s37, s40
  buffer_store_dword v40, v40, s[4:7], s36 offen sc1
  s_waitcnt vmcnt(0)
  s_memtime s[40:41]
  s_waitcnt lgkmcnt(0)
  s_sub_u32 s37, s40, s37
  s_min_u32 s44, s44, s37
  s_add_u32 s36, s39, 130039552
  s_memtime s[40:41]
  s_waitcnt lgkmcnt(0)
  s_mov_b32 s37, s40
  buffer_store_dword v40, v40, s[4:7], s36 offen sc1
  s_waitcnt vmcnt(0)
  s_memtime s[40:41]
  s_waitcnt lgkmcnt(0)
  s_sub_u32 s37, s40, s37
  s_min_u32 s45, s45, s37
  s_add_u32 s36, s39, 130047744
  s_memtime s[40:41]
  s_waitcnt lgkmcnt(0)
  s_mov_b32 s37, s40
  buffer_store_dword v40, v40, s[4:7], s36 offen sc1
  s_waitcnt vmcnt(0)
  s_memtime s[40:41]
  s_waitcnt lgkmcnt(0)
  s_sub_u32 s37, s40, s37
  s_min_u32 s46, s46, s37
  s_add_u32 s36, s39, 130055936
  s_memtime s[40:41]
  s_waitcnt lgkmcnt(0)
  s_mov_b32 s37, s40
  buffer_store_dword v40, v40, s[4:7], s36 offen sc1
  s_waitcnt vmcnt(0)
  s_memtime s[40:41]
  s_waitcnt lgkmcnt(0)
  s_sub_u32 s37, s40, s37
  s_min_u32 s47, s47, s37
  s_add_u32 s36, s39, 130031360
  s_memtime s[40:41]
  s_waitcnt lgkmcnt(0)
  s_mov_b32 s37, s40
  buffer_store_dword v40, v40, s[4:7], s36 offen sc1
  s_waitcnt vmcnt(0)
  s_memtime s[40:41]
  s_waitcnt lgkmcnt(0)
  s_sub_u32 s37, s40, s37
  s_min_u32 s44, s44, s37
  s_add_u32 s36, s39, 130039552
  s_memtime s[40:41]
  s_waitcnt lgkmcnt(0)
  s_mov_b32 s37, s40
  buffer_store_dword v40, v40, s[4:7], s36 offen sc1
  s_waitcnt vmcnt(0)
  s_memtime s[40:41]
  s_waitcnt lgkmcnt(0)
  s_sub_u32 s37, s40, s37
  s_min_u32 s45, s45, s37
  s_add_u32 s36, s39, 130047744
  s_memtime s[40:41]
  s_waitcnt lgkmcnt(0)
  s_mov_b32 s37, s40
  buffer_store_dword v40, v40, s[4:7], s36 offen sc1
  s_waitcnt vmcnt(0)
  s_memtime s[40:41]
  s_waitcnt lgkmcnt(0)
  s_sub_u32 s37, s40, s37
  s_min_u32 s46, s46, s37
  s_add_u32 s36, s39, 130055936
  s_memtime s[40:41]
  s_waitcnt lgkmcnt(0)
  s_mov_b32 s37, s40
  buffer_store_dword v40, v40, s[4:7], s36 offen sc1
  s_waitcnt vmcnt(0)
  s_memtime s[40:41]
  s_waitcnt lgkmcnt(0)
  s_sub_u32 s37, s40, s37
  s_min_u32 s47, s47, s37
  s_mov_b32 s38, 0
  s_cmp_lt_u32 s45, s44
  s_cselect_b32 s38, 1, s38
  s_min_u32 s44, s44, s45
  s_cmp_lt_u32 s46, s44
  s_cselect_b32 s38, 2, s38
  s_min_u32 s44, s44, s46
  s_cmp_lt_u32 s47, s44
  s_cselect_b32 s38, 3, s38
  s_min_u32 s44, s44, s47
  s_xor_b32 s38, s38, 2
  s_lshl_b32 s39, s67, 1
  s_lshl_b32 s67, s38, s39
  s_mov_b64 exec, -1
  s_lshl_b32 s77, s67, 16
  s_mov_b32 s76, 0
L_noprw_99:
  s_bitcmp1_b32 s2, 31
  s_cbranch_scc1 L_cdone_103
  s_cmp_lg_u32 s10, 0
  s_cbranch_scc1 L_cwait_104
  s_lshr_b32 s38, s3, 5
  s_lshr_b32 s36, 160, s38
  s_and_b32 s36, s36, 1
  s_lshl_b32 s36, s36, 5
  s_add_u32 s38, s38, s36
  s_lshl_b32 s38, s38, 2
  s_and_b32 s37, s3, 31
  s_lshl_b32 s36, 1, s37
  s_mov_b64 exec, 1
  s_waitcnt vmcnt(0)
  s_branch L_cans_111
L_ctry_105:
  s_lshl_b32 s36, 1, s37
  v_mov_b32 v18, s36
  s_mov_b64 exec, 1
  buffer_atomic_or v18, v19, s[84:87], s38 offen sc0
  s_waitcnt vmcnt(0)
L_cans_111:
  v_readfirstlane_b32 s39, v18
  s_mov_b64 exec, -1
  s_and_b32 s36, s36, s39
  s_cbranch_scc0 L_cgot_106
  s_cmp_eq_u32 s39, -1
  s_cbranch_scc1 L_covf_107
  s_mul_i32 s37, s2, 37
  s_lshr_b32 s37, s37, 3
  s_and_b32 s37, s37, 31
  s_mov_b32 vcc_lo, s39
  s_mov_b32 vcc_hi, s39
  s_lshr_b64 vcc, vcc, s37
  s_ff0_i32_b32 s36, vcc_lo
  s_add_u32 s37, s37, s36
  s_and_b32 s37, s37, 31
  s_branch L_ctry_105
L_cgot_106:
  s_and_b32 s36, s3, 0xe0
  s_add_u32 s37, s37, s36
  s_branch L_chave_110
L_covf_107:
  v_mov_b32 v18, 1
  s_mov_b64 exec, 1
  buffer_atomic_add v18, v19, s[84:87], 36 offen sc0
  s_waitcnt vmcnt(0)
  v_readfirstlane_b32 s38, v18
  s_mov_b64 exec, -1
  v_lshlrev_b32 v19, 2, v0
L_clp_108:
  s_sub_u32 s12, s12, 1
  s_cbranch_scc1 L_abort
  buffer_load_dword v18, v19, s[84:87], 0 offen sc1
  s_waitcnt vmcnt(0)
  v_readlane_b32 s37, v18, 9
  v_readlane_b32 s36, v18, 0
  s_bcnt1_i32_b32 s36, s36
  s_add_u32 s37, s37, s36
  v_readlane_b32 s36, v18, 1
  s_bcnt1_i32_b32 s36, s36
  s_add_u32 s37, s37, s36
  v_readlane_b32 s36, v18, 2
  s_bcnt1_i32_b32 s36, s36
  s_add_u32 s37, s37, s36
  v_readlane_b32 s36, v18, 3
  s_bcnt1_i32_b32 s36, s36
  s_add_u32 s37, s37, s36
  v_readlane_b32 s36, v18, 4
  s_bcnt1_i32_b32 s36, s36
  s_add_u32 s37, s37, s36
  v_readlane_b32 s36, v18, 37
  s_bcnt1_i32_b32 s36, s36
  s_add_u32 s37, s37, s36
  v_readlane_b32 s36, v18, 6
  s_bcnt1_i32_b32 s36, s36
  s_add_u32 s37, s37, s36
  v_readlane_b32 s36, v18, 39
  s_bcnt1_i32_b32 s36, s36
  s_add_u32 s37, s37, s36
  s_cmp_lt_u32 s37, 256
  s_cbranch_scc1 L_clp_108
  v_readlane_b32 s39, v18, 0
  s_mov_b32 s37, 0
  s_bcnt0_i32_b32 s36, s39
  s_cmp_lt_u32 s38, s36
  s_cbranch_scc1 L_csel_109
  s_sub_u32 s38, s38, s36
  v_readlane_b32 s39, v18, 1
  s_mov_b32 s37, 32
  s_bcnt0_i32_b32 s36, s39
  s_cmp_lt_u32 s38, s36
  s_cbranch_scc1 L_csel_109
  s_sub_u32 s38, s38, s36
  v_readlane_b32 s39, v18, 2
  s_mov_b32 s37, 64
  s_bcnt0_i32_b32 s36, s39
  s_cmp_lt_u32 s38, s36
  s_cbranch_scc1 L_csel_109
  s_sub_u32 s38, s38, s36
  v_readlane_b32 s39, v18, 3
  s_mov_b32 s37, 96
  s_bcnt0_i32_b32 s36, s39
  s_cmp_lt_u32 s38, s36
  s_cbranch_scc1 L_csel_109
  s_sub_u32 s38, s38, s36
  v_readlane_b32 s39, v18, 4
  s_mov_b32 s37, 128
  s_bcnt0_i32_b32 s36, s39
  s_cmp_lt_u32 s38, s36
  s_cbranch_scc1 L_csel_109
  s_sub_u32 s38, s38, s36
  v_readlane_b32 s39, v18, 37
  s_mov_b32 s37, 160
  s_bcnt0_i32_b32 s36, s39
  s_cmp_lt_u32 s38, s36
  s_cbranch_scc1 L_csel_109
  s_sub_u32 s38, s38, s36
  v_readlane_b32 s39, v18, 6
  s_mov_b32 s37, 192
  s_bcnt0_i32_b32 s36, s39
  s_cmp_lt_u32 s38, s36
  s_cbranch_scc1 L_csel_109
  s_sub_u32 s38, s38, s36
  v_readlane_b32 s39, v18, 39
  s_mov_b32 s37, 224
  s_bcnt0_i32_b32 s36, s39
  s_cmp_lt_u32 s38, s36
  s_cbranch_scc1 L_csel_109
  s_sub_u32 s38, s38, s36
  s_branch L_abort
L_csel_109:
  s_ff0_i32_b32 s36, s39
  s_bitset1_b32 s39, s36
  s_sub_u32 s38, s38, 1
  s_cbranch_scc0 L_csel_109
  s_add_u32 s37, s37, s36
L_chave_110:
  v_mov_b32 v18, s37
  v_mov_b32 v19, 163836
  ds_write_b32 v19, v18
  s_waitcnt lgkmcnt(0)
L_cwait_104:
  s_barrier
  v_mov_b32 v19, 163836
  ds_read_b32 v18, v19
  s_waitcnt lgkmcnt(0)
  v_readfirstlane_b32 s36, v18
  s_bitset1_b32 s2, 31
  s_and_b32 s36, s36, 255
  s_cmp_eq_u32 s36, s3
  s_cbranch_scc1 L_cdone_103
  s_mov_b32 s3, s36
  s_waitcnt vmcnt(0)
  s_barrier
  s_branch L_dispatch
L_cdone_103:
  s_cmp_lg_u32 s10, 0
  s_cbranch_scc1 L_norep_101
  s_add_u32 s77, s77, 0x1000000
  v_mov_b32 v32, s76
  v_mov_b32 v33, s77
  s_mov_b64 exec, 1
  buffer_atomic_add_x2 v[32:33], v1, s[84:87], 0 offen offset:192
  s_mov_b64 exec, -1
L_norep_101:
  s_barrier
L_nopr_98:
L_ct3:
  s_load_dwordx2 s[96:97], s[0:1], 56
  s_waitcnt lgkmcnt(0)
  s_mov_b32 s98, 2621440
  s_mov_b32 s99, 0x20000
  s_load_dwordx2 s[92:93], s[0:1], 64
  s_waitcnt lgkmcnt(0)
  s_mov_b32 s94, 2457600
  s_mov_b32 s95, 0x20000
  s_lshl_b32 s37, s64, 2
  s_add_u32 s37, s37, s10
  s_lshl_b32 s13, s37, 7
  s_mul_i32 s28, s37, 26
  s_lshr_b32 s28, s28, 8
  s_mul_i32 s38, s28, 10
  s_sub_u32 s37, s37, s38
  s_mul_i32 s14, s65, 40960
  s_mov_b32 s15, 327680
  s_mov_b32 s17, 327680
  s_mov_b32 s18, 8
  s_cmp_eq_u32 s28, 1
  s_cselect_b32 s26, 0x3ea52b5c, 1.0
  s_mov_b32 s27, s26
  s_cmp_eq_u32 s28, 2
  s_cselect_b32 s38, 10, 12
  s_lshl_b32 s37, s37, s38
  s_mul_i32 s39, s28, 3145728
  s_add_u32 s37, s37, s39
  s_add_u32 s37, s37, s14
  s_add_u32 s16, s37, 67108864
  s_cmp_lt_u32 s28, 3
  s_cselect_b32 s16, s16, 0x80000000
  s_cselect_b32 s13, s13, 0x80000000
  v_mul_u32_u24 v16, 8, v0
  v_add_u32 v16, s65, v16
  v_mul_u32_u24 v16, 3840, v16
  s_mul_i32 s37, 8, 245760
  s_mov_b32 s36, s13
  buffer_load_dword v27, v16, s[92:95], s36 offen
  s_add_u32 s36, s36, s37
  buffer_load_dword v28, v16, s[92:95], s36 offen
  s_add_u32 s36, s36, s37
  v_lshrrev_b32 v16, 3, v0
  v_mul_u32_u24 v16, 3840, v16
  v_lshrrev_b32 v17, 2, v0
  v_and_b32 v17, 4, v17
  v_xor_b32 v17, v17, v0
  v_and_b32 v17, 7, v17
  v_lshl_add_u32 v3, v17, 4, v16
  s_add_u32 m0, s24, 0
  s_add_u32 s36, s13, 0
  buffer_load_dwordx4 v3, s[92:95], s36 offen lds
  s_add_u32 m0, s24, 1024
  s_add_u32 s36, s13, 30720
  buffer_load_dwordx4 v3, s[92:95], s36 offen lds
  s_add_u32 m0, s24, 2048
  s_add_u32 s36, s13, 61440
  buffer_load_dwordx4 v3, s[92:95], s36 offen lds
  s_add_u32 m0, s24, 3072
  s_add_u32 s36, s13, 92160
  buffer_load_dwordx4 v3, s[92:95], s36 offen lds
  v_mov_b32 v19, 0
  s_bitcmp1_b32 s2, 31
  s_cbranch_scc1 L_cask_112
  s_cmp_lg_u32 s10, 0
  s_cbranch_scc1 L_cask_112
  s_lshr_b32 s38, s3, 5
  s_lshr_b32 s36, 160, s38
  s_and_b32 s36, s36, 1
  s_lshl_b32 s36, s36, 5
  s_add_u32 s38, s38, s36
  s_lshl_b32 s38, s38, 2
  s_and_b32 s37, s3, 31
  s_lshl_b32 s36, 1, s37
  v_mov_b32 v18, s36
  s_mov_b64 exec, 1
  buffer_atomic_or v18, v19, s[84:87], s38 offen sc0
  s_mov_b64 exec, -1
L_cask_112:
  s_add_u32 m0, s24, 4096
  s_add_u32 s36, s13, 122880
  buffer_load_dwordx4 v3, s[92:95], s36 offen lds
  s_add_u32 m0, s24, 5120
  s_add_u32 s36, s13, 153600
  buffer_load_dwordx4 v3, s[92:95], s36 offen lds
  s_add_u32 m0, s24, 6144
  s_add_u32 s36, s13, 184320
  buffer_load_dwordx4 v3, s[92:95], s36 offen lds
  s_add_u32 m0, s24, 7168
  s_add_u32 s36, s13, 215040
  buffer_load_dwordx4 v3, s[92:95], s36 offen lds
  s_add_u32 m0, s24, 8192
  s_add_u32 s36, s13, 245760
  buffer_load_dwordx4 v3, s[92:95], s36 offen lds
  s_add_u32 m0, s24, 9216
  s_add_u32 s36, s13, 276480
  buffer_load_dwordx4 v3, s[92:95], s36 offen lds
  s_add_u32 m0, s24, 10240
  s_add_u32 s36, s13, 307200
  buffer_load_dwordx4 v3, s[92:95], s36 offen lds
  s_add_u32 m0, s24, 11264
  s_add_u32 s36, s13, 337920
  buffer_load_dwordx4 v3, s[92:95], s36 offen lds
  s_add_u32 m0, s24, 12288
  s_add_u32 s36, s13, 368640
  buffer_load_dwordx4 v3, s[92:95], s36 offen lds
  s_add_u32 m0, s24, 13312
  s_add_u32 s36, s13, 399360
  buffer_load_dwordx4 v3, s[92:95], s36 offen lds
  s_add_u32 m0, s24, 14336
  s_add_u32 s36, s13, 430080
  buffer_load_dwordx4 v3, s[92:95], s36 offen lds
  s_add_u32 m0, s24, 15360
  s_add_u32 s36, s13, 460800
  buffer_load_dwordx4 v3, s[92:95], s36 offen lds
  s_add_u32 m0, s24, 16384
  s_add_u32 s36, s13, 491520
  buffer_load_dwordx4 v3, s[92:95], s36 offen lds
  s_add_u32 m0, s24, 17408
  s_add_u32 s36, s13, 522240
  buffer_load_dwordx4 v3, s[92:95], s36 offen lds
  s_add_u32 m0, s24, 18432
  s_add_u32 s36, s13, 552960
  buffer_load_dwordx4 v3, s[92:95], s36 offen lds
  s_add_u32 m0, s24, 19456
  s_add_u32 s36, s13, 583680
  buffer_load_dwordx4 v3, s[92:95], s36 offen lds
  s_add_u32 m0, s24, 20480
  s_add_u32 s36, s13, 614400
  buffer_load_dwordx4 v3, s[92:95], s36 offen lds
  s_add_u32 m0, s24, 21504
  s_add_u32 s36, s13, 645120
  buffer_load_dwordx4 v3, s[92:95], s36 offen lds
  s_add_u32 m0, s24, 22528
  s_add_u32 s36, s13, 675840
  buffer_load_dwordx4 v3, s[92:95], s36 offen lds
  s_add_u32 m0, s24, 23552
  s_add_u32 s36, s13, 706560
  buffer_load_dwordx4 v3, s[92:95], s36 offen lds
  s_add_u32 m0, s24, 24576
  s_add_u32 s36, s13, 737280
  buffer_load_dwordx4 v3, s[92:95], s36 offen lds
  s_add_u32 m0, s24, 25600
  s_add_u32 s36, s13, 768000
  buffer_load_dwordx4 v3, s[92:95], s36 offen lds
  s_add_u32 m0, s24, 26624
  s_add_u32 s36, s13, 798720
  buffer_load_dwordx4 v3, s[92:95], s36 offen lds
  s_add_u32 m0, s24, 27648
  s_add_u32 s36, s13, 829440
  buffer_load_dwordx4 v3, s[92:95], s36 offen lds
  s_add_u32 m0, s24, 28672
  s_add_u32 s36, s13, 860160
  buffer_load_dwordx4 v3, s[92:95], s36 offen lds
  s_add_u32 m0, s24, 29696
  s_add_u32 s36, s13, 890880
  buffer_load_dwordx4 v3, s[92:95], s36 offen lds
  s_add_u32 m0, s24, 30720
  s_add_u32 s36, s13, 921600
  buffer_load_dwordx4 v3, s[92:95], s36 offen lds
  s_add_u32 m0, s24, 31744
  s_add_u32 s36, s13, 952320
  buffer_load_dwordx4 v3, s[92:95], s36 offen lds
  s_bitcmp1_b32 s2, 31
  s_cbranch_scc1 L_cdone_113
  s_cmp_lg_u32 s10, 0
  s_cbranch_scc1 L_cwait_114
  s_lshr_b32 s38, s3, 5
  s_lshr_b32 s36, 160, s38
  s_and_b32 s36, s36, 1
  s_lshl_b32 s36, s36, 5
  s_add_u32 s38, s38, s36
  s_lshl_b32 s38, s38, 2
  s_and_b32 s37, s3, 31
  s_lshl_b32 s36, 1, s37
  s_mov_b64 exec, 1
  s_waitcnt vmcnt(28)
  s_branch L_cans_121
L_ctry_115:
  s_lshl_b32 s36, 1, s37
  v_mov_b32 v18, s36
  s_mov_b64 exec, 1
  buffer_atomic_or v18, v19, s[84:87], s38 offen sc0
  s_waitcnt vmcnt(0)
L_cans_121:
  v_readfirstlane_b32 s39, v18
  s_mov_b64 exec, -1
  s_and_b32 s36, s36, s39
  s_cbranch_scc0 L_cgot_116
  s_cmp_eq_u32 s39, -1
  s_cbranch_scc1 L_covf_117
  s_mul_i32 s37, s2, 37
  s_lshr_b32 s37, s37, 3
  s_and_b32 s37, s37, 31
  s_mov_b32 vcc_lo, s39
  s_mov_b32 vcc_hi, s39
  s_lshr_b64 vcc, vcc, s37
  s_ff0_i32_b32 s36, vcc_lo
  s_add_u32 s37, s37, s36
  s_and_b32 s37, s37, 31
  s_branch L_ctry_115
L_cgot_116:
  s_and_b32 s36, s3, 0xe0
  s_add_u32 s37, s37, s36
  s_branch L_chave_120
L_covf_117:
  v_mov_b32 v18, 1
  s_mov_b64 exec, 1
  buffer_atomic_add v18, v19, s[84:87], 36 offen sc0
  s_waitcnt vmcnt(0)
  v_readfirstlane_b32 s38, v18
  s_mov_b64 exec, -1
  v_lshlrev_b32 v19, 2, v0
L_clp_118:
  s_sub_u32 s12, s12, 1
  s_cbranch_scc1 L_abort
  buffer_load_dword v18, v19, s[84:87], 0 offen sc1
  s_waitcnt vmcnt(0)
  v_readlane_b32 s37, v18, 9
  v_readlane_b32 s36, v18, 0
  s_bcnt1_i32_b32 s36, s36
  s_add_u32 s37, s37, s36
  v_readlane_b32 s36, v18, 1
  s_bcnt1_i32_b32 s36, s36
  s_add_u32 s37, s37, s36
  v_readlane_b32 s36, v18, 2
  s_bcnt1_i32_b32 s36, s36
  s_add_u32 s37, s37, s36
  v_readlane_b32 s36, v18, 3
  s_bcnt1_i32_b32 s36, s36
  s_add_u32 s37, s37, s36
  v_readlane_b32 s36, v18, 4
  s_bcnt1_i32_b32 s36, s36
  s_add_u32 s37, s37, s36
  v_readlane_b32 s36, v18, 37
  s_bcnt1_i32_b32 s36, s36
  s_add_u32 s37, s37, s36
  v_readlane_b32 s36, v18, 6
  s_bcnt1_i32_b32 s36, s36
  s_add_u32 s37, s37, s36
  v_readlane_b32 s36, v18, 39
  s_bcnt1_i32_b32 s36, s36
  s_add_u32 s37, s37, s36
  s_cmp_lt_u32 s37, 256
  s_cbranch_scc1 L_clp_118
  v_readlane_b32 s39, v18, 0
  s_mov_b32 s37, 0
  s_bcnt0_i32_b32 s36, s39
  s_cmp_lt_u32 s38, s36
  s_cbranch_scc1 L_csel_119
  s_sub_u32 s38, s38, s36
  v_readlane_b32 s39, v18, 1
  s_mov_b32 s37, 32
  s_bcnt0_i32_b32 s36, s39
  s_cmp_lt_u32 s38, s36
  s_cbranch_scc1 L_csel_119
  s_sub_u32 s38, s38, s36
  v_readlane_b32 s39, v18, 2
  s_mov_b32 s37, 64
  s_bcnt0_i32_b32 s36, s39
  s_cmp_lt_u32 s38, s36
  s_cbranch_scc1 L_csel_119
  s_sub_u32 s38, s38, s36
  v_readlane_b32 s39, v18, 3
  s_mov_b32 s37, 96
  s_bcnt0_i32_b32 s36, s39
  s_cmp_lt_u32 s38, s36
  s_cbranch_scc1 L_csel_119
  s_sub_u32 s38, s38, s36
  v_readlane_b32 s39, v18, 4
  s_mov_b32 s37, 128
  s_bcnt0_i32_b32 s36, s39
  s_cmp_lt_u32 s38, s36
  s_cbranch_scc1 L_csel_119
  s_sub_u32 s38, s38, s36
  v_readlane_b32 s39, v18, 37
  s_mov_b32 s37, 160
  s_bcnt0_i32_b32 s36, s39
  s_cmp_lt_u32 s38, s36
  s_cbranch_scc1 L_csel_119
  s_sub_u32 s38, s38, s36
  v_readlane_b32 s39, v18, 6
  s_mov_b32 s37, 192
  s_bcnt0_i32_b32 s36, s39
  s_cmp_lt_u32 s38, s36
  s_cbranch_scc1 L_csel_119
  s_sub_u32 s38, s38, s36
  v_readlane_b32 s39, v18, 39
  s_mov_b32 s37, 224
  s_bcnt0_i32_b32 s36, s39
  s_cmp_lt_u32 s38, s36
  s_cbranch_scc1 L_csel_119
  s_sub_u32 s38, s38, s36
  s_branch L_abort
L_csel_119:
  s_ff0_i32_b32 s36, s39
  s_bitset1_b32 s39, s36
  s_sub_u32 s38, s38, 1
  s_cbranch_scc0 L_csel_119
  s_add_u32 s37, s37, s36
L_chave_120:
  v_mov_b32 v18, s37
  v_mov_b32 v19, 163836
  ds_write_b32 v19, v18
  s_waitcnt lgkmcnt(0)
L_cwait_114:
  s_barrier
  v_mov_b32 v19, 163836
  ds_read_b32 v18, v19
  s_waitcnt lgkmcnt(0)
  v_readfirstlane_b32 s36, v18
  s_bitset1_b32 s2, 31
  s_and_b32 s36, s36, 255
  s_cmp_eq_u32 s36, s3
  s_cbranch_scc1 L_cdone_113
  s_mov_b32 s3, s36
  s_waitcnt vmcnt(0)
  s_barrier
  s_branch L_dispatch
L_cdone_113:
  v_and_b32 v16, 31, v0
  v_lshrrev_b32 v17, 5, v0
  v_mul_u32_u24 v17, 10240, v17
  v_lshl_add_u32 v14, v16, 4, v17
  v_add_u32 v15, 20480, v14
  s_cmp_lg_u32 s28, 2
  s_cselect_b64 vcc, -1, 0
  v_lshrrev_b32 v16, 5, v0
  v_lshlrev_b32 v16, 10, v16
  v_bfe_u32 v17, v0, 2, 2
  v_lshl_add_u32 v16, v17, 7, v16
  v_bfe_u32 v17, v0, 3, 1
  v_lshl_add_u32 v16, v17, 6, v16
  v_bfe_u32 v17, v0, 4, 1
  v_lshl_add_u32 v18, v17, 5, v16
  v_bfe_u32 v17, v0, 1, 1
  v_lshl_add_u32 v18, v17, 3, v18
  v_bfe_u32 v17, v0, 0, 1
  v_lshl_add_u32 v18, v17, 4, v18
  v_bfe_u32 v17, v0, 4, 1
  v_lshl_add_u32 v19, v17, 5, v16
  v_bfe_u32 v17, v0, 1, 1
  v_lshl_add_u32 v19, v17, 4, v19
  v_bfe_u32 v17, v0, 0, 1
  v_lshl_add_u32 v19, v17, 3, v19
  v_cndmask_b32 v18, v19, v18, vcc
  v_add_u32 v2, s24, v18
  v_xor_b32 v4, 64, v2
  s_lshl_b32 s36, s10, 3
  v_lshrrev_b32 v16, 3, v0
  v_add_u32 v16, s36, v16
  v_lshrrev_b32 v17, 1, v16
  v_xor_b32 v17, v17, v0
  v_and_b32 v17, 7, v17
  v_mul_u32_u24 v16, 1280, v16
  v_lshl_add_u32 v5, v17, 4, v16
  v_and_b32 v16, 31, v0
  v_bfe_u32 v17, v0, 1, 3
  v_lshrrev_b32 v18, 5, v0
  v_xor_b32 v17, v17, v18
  v_lshlrev_b32 v16, 7, v16
  v_xor_b32 v18, 0, v17
  v_lshl_add_u32 v6, v18, 4, v16
  v_xor_b32 v18, 2, v17
  v_lshl_add_u32 v7, v18, 4, v16
  v_xor_b32 v18, 4, v17
  v_lshl_add_u32 v8, v18, 4, v16
  v_xor_b32 v18, 6, v17
  v_lshl_add_u32 v9, v18, 4, v16
  s_mov_b32 s19, 0x80000000
  v_mov_b32 v16, 0
  s_mov_b64 exec, 1
  s_add_u32 s37, s19, 8192
  buffer_store_dword v16, v1, s[4:7], s19 offen sc1
  buffer_store_dword v16, v1, s[4:7], s37 offen sc1
  s_mov_b64 exec, -1
  s_lshl_b32 s36, s8, 2
  s_add_u32 s32, s36, s10
  s_lshl_b32 s37, s32, 13
  s_add_u32 s37, s37, 130023424
  s_sub_u32 s38, s32, 512
  s_mul_i32 s39, s38, 5120
  s_add_u32 s39, s39, 60817408
  s_cmp_lt_u32 s32, 512
  s_cselect_b32 s37, s37, s39
  s_sub_u32 s38, s32, 640
  s_lshl_b32 s39, s38, 13
  s_add_u32 s39, s39, 61865984
  s_cmp_lt_u32 s32, 640
  s_cselect_b32 s37, s37, s39
  s_cmp_lt_u32 s32, 648
  s_cselect_b32 s37, s37, 0x80000000
  v_mov_b32 v20, 0x7f817f81
  v_mov_b32 v21, 0x7f817f81
  v_mov_b32 v22, 0x7f817f81
  v_mov_b32 v23, 0x7f817f81
  buffer_store_dwordx4 v[20:23], v1, s[4:7], s37 offen offset:0 sc1
  buffer_store_dwordx4 v[20:23], v1, s[4:7], s37 offen offset:1024 sc1
  buffer_store_dwordx4 v[20:23], v1, s[4:7], s37 offen offset:2048 sc1
  buffer_store_dwordx4 v[20:23], v1, s[4:7], s37 offen offset:3072 sc1
  s_add_u32 s37, s37, 4096
  buffer_store_dwordx4 v[20:23], v1, s[4:7], s37 offen sc1
  v_lshlrev_b32 v17, 7, v0
  s_sub_u32 s38, s32, 648
  s_lshl_b32 s39, s38, 13
  s_add_u32 s39, s39, 218120192
  s_cmp_lt_u32 s38, 2
  s_cselect_b32 s37, s39, 0x80000000
  buffer_store_dword v16, v17, s[4:7], s37 offen sc1
  s_mov_b32 s39, 63979520
  s_cmp_eq_u32 s38, 2
  s_cselect_b32 s37, s39, 0x80000000
  buffer_store_dword v16, v17, s[4:7], s37 offen sc1
  s_mul_i32 s36, s10, 10240
  s_add_u32 s36, s36, s14
  buffer_load_dword v25, v17, s[96:99], s36 offen
  buffer_load_dword v26, v17, s[96:99], s36 offen offset:2048
  s_waitcnt vmcnt(24)
  ds_read_b64_tr_b16 v[192:193], v2 offset:0
  ds_read_b64_tr_b16 v[194:195], v2 offset:512
  ds_read_b64_tr_b16 a[96:97], v4 offset:0
  ds_read_b64_tr_b16 a[98:99], v4 offset:512
  ds_read_b64_tr_b16 v[196:197], v2 offset:2048
  ds_read_b64_tr_b16 v[198:199], v2 offset:2560
  ds_read_b64_tr_b16 a[100:101], v4 offset:2048
  ds_read_b64_tr_b16 a[102:103], v4 offset:2560
  s_waitcnt lgkmcnt(0)
  ds_read_b64_tr_b16 v[200:201], v2 offset:4096
  ds_read_b64_tr_b16 v[202:203], v2 offset:4608
  ds_read_b64_tr_b16 a[104:105], v4 offset:4096
  ds_read_b64_tr_b16 a[106:107], v4 offset:4608
  ds_read_b64_tr_b16 v[204:205], v2 offset:6144
  ds_read_b64_tr_b16 v[206:207], v2 offset:6656
  ds_read_b64_tr_b16 a[108:109], v4 offset:6144
  ds_read_b64_tr_b16 a[110:111], v4 offset:6656
  s_waitcnt lgkmcnt(0)
  s_add_u32 m0, s24, 0
  s_add_u32 s36, s13, 983040
  buffer_load_dwordx4 v3, s[92:95], s36 offen lds
  s_add_u32 m0, s24, 1024
  s_add_u32 s36, s13, 1013760
  buffer_load_dwordx4 v3, s[92:95], s36 offen lds
  s_add_u32 m0, s24, 2048
  s_add_u32 s36, s13, 1044480
  buffer_load_dwordx4 v3, s[92:95], s36 offen lds
  s_add_u32 m0, s24, 3072
  s_add_u32 s36, s13, 1075200
  buffer_load_dwordx4 v3, s[92:95], s36 offen lds
  s_add_u32 m0, s24, 4096
  s_add_u32 s36, s13, 1105920
  buffer_load_dwordx4 v3, s[92:95], s36 offen lds
  s_add_u32 m0, s24, 5120
  s_add_u32 s36, s13, 1136640
  buffer_load_dwordx4 v3, s[92:95], s36 offen lds
  s_add_u32 m0, s24, 6144
  s_add_u32 s36, s13, 1167360
  buffer_load_dwordx4 v3, s[92:95], s36 offen lds
  s_add_u32 m0, s24, 7168
  s_add_u32 s36, s13, 1198080
  buffer_load_dwordx4 v3, s[92:95], s36 offen lds
  s_waitcnt vmcnt(24)
  ds_read_b64_tr_b16 v[208:209], v2 offset:8192
  ds_read_b64_tr_b16 v[210:211], v2 offset:8704
  ds_read_b64_tr_b16 a[112:113], v4 offset:8192
  ds_read_b64_tr_b16 a[114:115], v4 offset:8704
  ds_read_b64_tr_b16 v[212:213], v2 offset:10240
  ds_read_b64_tr_b16 v[214:215], v2 offset:10752
  ds_read_b64_tr_b16 a[116:117], v4 offset:10240
  ds_read_b64_tr_b16 a[118:119], v4 offset:10752
  s_waitcnt lgkmcnt(0)
  ds_read_b64_tr_b16 v[216:217], v2 offset:12288
  ds_read_b64_tr_b16 v[218:219], v2 offset:12800
  ds_read_b64_tr_b16 a[120:121], v4 offset:12288
  ds_read_b64_tr_b16 a[122:123], v4 offset:12800
  ds_read_b64_tr_b16 v[220:221], v2 offset:14336
  ds_read_b64_tr_b16 v[222:223], v2 offset:14848
  ds_read_b64_tr_b16 a[124:125], v4 offset:14336
  ds_read_b64_tr_b16 a[126:127], v4 offset:14848
  s_waitcnt lgkmcnt(0)
  s_add_u32 m0, s24, 8192
  s_add_u32 s36, s13, 1228800
  buffer_load_dwordx4 v3, s[92:95], s36 offen lds
  s_add_u32 m0, s24, 9216
  s_add_u32 s36, s13, 1259520
  buffer_load_dwordx4 v3, s[92:95], s36 offen lds
  s_add_u32 m0, s24, 10240
  s_add_u32 s36, s13, 1290240
  buffer_load_dwordx4 v3, s[92:95], s36 offen lds
  s_add_u32 m0, s24, 11264
  s_add_u32 s36, s13, 1320960
  buffer_load_dwordx4 v3, s[92:95], s36 offen lds
  s_add_u32 m0, s24, 12288
  s_add_u32 s36, s13, 1351680
  buffer_load_dwordx4 v3, s[92:95], s36 offen lds
  s_add_u32 m0, s24, 13312
  s_add_u32 s36, s13, 1382400
  buffer_load_dwordx4 v3, s[92:95], s36 offen lds
  s_add_u32 m0, s24, 14336
  s_add_u32 s36, s13, 1413120
  buffer_load_dwordx4 v3, s[92:95], s36 offen lds
  s_add_u32 m0, s24, 15360
  s_add_u32 s36, s13, 1443840
  buffer_load_dwordx4 v3, s[92:95], s36 offen lds
  s_waitcnt vmcnt(24)
  ds_read_b64_tr_b16 v[224:225], v2 offset:16384
  ds_read_b64_tr_b16 v[226:227], v2 offset:16896
  ds_read_b64_tr_b16 a[128:129], v4 offset:16384
  ds_read_b64_tr_b16 a[130:131], v4 offset:16896
  ds_read_b64_tr_b16 v[228:229], v2 offset:18432
  ds_read_b64_tr_b16 v[230:231], v2 offset:18944
  ds_read_b64_tr_b16 a[132:133], v4 offset:18432
  ds_read_b64_tr_b16 a[134:135], v4 offset:18944
  s_waitcnt lgkmcnt(0)
  ds_read_b64_tr_b16 v[232:233], v2 offset:20480
  ds_read_b64_tr_b16 v[234:235], v2 offset:20992
  ds_read_b64_tr_b16 a[136:137], v4 offset:20480
  ds_read_b64_tr_b16 a[138:139], v4 offset:20992
  ds_read_b64_tr_b16 v[236:237], v2 offset:22528
  ds_read_b64_tr_b16 v[238:239], v2 offset:23040
  ds_read_b64_tr_b16 a[140:141], v4 offset:22528
  ds_read_b64_tr_b16 a[142:143], v4 offset:23040
  s_waitcnt lgkmcnt(0)
  s_add_u32 m0, s24, 16384
  s_add_u32 s36, s13, 1474560
  buffer_load_dwordx4 v3, s[92:95], s36 offen lds
  s_add_u32 m0, s24, 17408
  s_add_u32 s36, s13, 1505280
  buffer_load_dwordx4 v3, s[92:95], s36 offen lds
  s_add_u32 m0, s24, 18432
  s_add_u32 s36, s13, 1536000
  buffer_load_dwordx4 v3, s[92:95], s36 offen lds
  s_add_u32 m0, s24, 19456
  s_add_u32 s36, s13, 1566720
  buffer_load_dwordx4 v3, s[92:95], s36 offen lds
  s_add_u32 m0, s24, 20480
  s_add_u32 s36, s13, 1597440
  buffer_load_dwordx4 v3, s[92:95], s36 offen lds
  s_add_u32 m0, s24, 21504
  s_add_u32 s36, s13, 1628160
  buffer_load_dwordx4 v3, s[92:95], s36 offen lds
  s_add_u32 m0, s24, 22528
  s_add_u32 s36, s13, 1658880
  buffer_load_dwordx4 v3, s[92:95], s36 offen lds
  s_add_u32 m0, s24, 23552
  s_add_u32 s36, s13, 1689600
  buffer_load_dwordx4 v3, s[92:95], s36 offen lds
  s_waitcnt vmcnt(24)
  ds_read_b64_tr_b16 v[240:241], v2 offset:24576
  ds_read_b64_tr_b16 v[242:243], v2 offset:25088
  ds_read_b64_tr_b16 a[144:145], v4 offset:24576
  ds_read_b64_tr_b16 a[146:147], v4 offset:25088
  ds_read_b64_tr_b16 v[244:245], v2 offset:26624
  ds_read_b64_tr_b16 v[246:247], v2 offset:27136
  ds_read_b64_tr_b16 a[148:149], v4 offset:26624
  ds_read_b64_tr_b16 a[150:151], v4 offset:27136
  s_waitcnt lgkmcnt(0)
  ds_read_b64_tr_b16 v[248:249], v2 offset:28672
  ds_read_b64_tr_b16 v[250:251], v2 offset:29184
  ds_read_b64_tr_b16 a[152:153], v4 offset:28672
  ds_read_b64_tr_b16 a[154:155], v4 offset:29184
  ds_read_b64_tr_b16 v[252:253], v2 offset:30720
  ds_read_b64_tr_b16 v[254:255], v2 offset:31232
  ds_read_b64_tr_b16 a[156:157], v4 offset:30720
  ds_read_b64_tr_b16 a[158:159], v4 offset:31232
  s_waitcnt lgkmcnt(0)
  s_add_u32 m0, s24, 24576
  s_add_u32 s36, s13, 1720320
  buffer_load_dwordx4 v3, s[92:95], s36 offen lds
  s_add_u32 m0, s24, 25600
  s_add_u32 s36, s13, 1751040
  buffer_load_dwordx4 v3, s[92:95], s36 offen lds
  s_add_u32 m0, s24, 26624
  s_add_u32 s36, s13, 1781760
  buffer_load_dwordx4 v3, s[92:95], s36 offen lds
  s_add_u32 m0, s24, 27648
  s_add_u32 s36, s13, 1812480
  buffer_load_dwordx4 v3, s[92:95], s36 offen lds
  s_add_u32 m0, s24, 28672
  s_add_u32 s36, s13, 1843200
  buffer_load_dwordx4 v3, s[92:95], s36 offen lds
  s_add_u32 m0, s24, 29696
  s_add_u32 s36, s13, 1873920
  buffer_load_dwordx4 v3, s[92:95], s36 offen lds
  s_add_u32 m0, s24, 30720
  s_add_u32 s36, s13, 1904640
  buffer_load_dwordx4 v3, s[92:95], s36 offen lds
  s_add_u32 m0, s24, 31744
  s_add_u32 s36, s13, 1935360
  buffer_load_dwordx4 v3, s[92:95], s36 offen lds
  s_waitcnt vmcnt(24)
  ds_read_b64_tr_b16 a[0:1], v2 offset:0
  ds_read_b64_tr_b16 a[2:3], v2 offset:512
  ds_read_b64_tr_b16 a[160:161], v4 offset:0
  ds_read_b64_tr_b16 a[162:163], v4 offset:512
  ds_read_b64_tr_b16 a[4:5], v2 offset:2048
  ds_read_b64_tr_b16 a[6:7], v2 offset:2560
  ds_read_b64_tr_b16 a[164:165], v4 offset:2048
  ds_read_b64_tr_b16 a[166:167], v4 offset:2560
  s_waitcnt lgkmcnt(0)
  ds_read_b64_tr_b16 a[8:9], v2 offset:4096
  ds_read_b64_tr_b16 a[10:11], v2 offset:4608
  ds_read_b64_tr_b16 a[168:169], v4 offset:4096
  ds_read_b64_tr_b16 a[170:171], v4 offset:4608
  ds_read_b64_tr_b16 a[12:13], v2 offset:6144
  ds_read_b64_tr_b16 a[14:15], v2 offset:6656
  ds_read_b64_tr_b16 a[172:173], v4 offset:6144
  ds_read_b64_tr_b16 a[174:175], v4 offset:6656
  s_waitcnt lgkmcnt(0)
  s_add_u32 m0, s24, 0
  s_add_u32 s36, s13, 1966080
  buffer_load_dwordx4 v3, s[92:95], s36 offen lds
  s_add_u32 m0, s24, 1024
  s_add_u32 s36, s13, 1996800
  buffer_load_dwordx4 v3, s[92:95], s36 offen lds
  s_add_u32 m0, s24, 2048
  s_add_u32 s36, s13, 2027520
  buffer_load_dwordx4 v3, s[92:95], s36 offen lds
  s_add_u32 m0, s24, 3072
  s_add_u32 s36, s13, 2058240
  buffer_load_dwordx4 v3, s[92:95], s36 offen lds
  s_add_u32 m0, s24, 4096
  s_add_u32 s36, s13, 2088960
  buffer_load_dwordx4 v3, s[92:95], s36 offen lds
  s_add_u32 m0, s24, 5120
  s_add_u32 s36, s13, 2119680
  buffer_load_dwordx4 v3, s[92:95], s36 offen lds
  s_add_u32 m0, s24, 6144
  s_add_u32 s36, s13, 2150400
  buffer_load_dwordx4 v3, s[92:95], s36 offen lds
  s_add_u32 m0, s24, 7168
  s_add_u32 s36, s13, 2181120
  buffer_load_dwordx4 v3, s[92:95], s36 offen lds
  s_load_dwordx2 s[88:89], s[0:1], 40
  s_waitcnt lgkmcnt(0)
  s_mov_b32 s90, 5242880
  s_mov_b32 s91, 0x20000
  v_lshlrev_b32 v17, 7, v0
  s_lshl_b32 s36, s32, 13
  buffer_load_dword v24, v17, s[88:91], s36 offen
  s_load_dwordx2 s[88:89], s[0:1], 80
  s_waitcnt lgkmcnt(0)
  s_mov_b32 s90, 5242880
  s_mov_b32 s91, 0x20000
  s_barrier
  s_cmp_lg_u32 s10, 0
  s_cbranch_scc1 L_noinit_122
  v_mov_b32 v16, 1
  s_mov_b64 exec, 1
  buffer_atomic_add v16, v1, s[84:87], 40 offen
  s_mov_b64 exec, -1
L_noinit_122:
  s_waitcnt vmcnt(24)
  ds_read_b64_tr_b16 a[16:17], v2 offset:8192
  ds_read_b64_tr_b16 a[18:19], v2 offset:8704
  ds_read_b64_tr_b16 a[176:177], v4 offset:8192
  ds_read_b64_tr_b16 a[178:179], v4 offset:8704
  ds_read_b64_tr_b16 a[20:21], v2 offset:10240
  ds_read_b64_tr_b16 a[22:23], v2 offset:10752
  ds_read_b64_tr_b16 a[180:181], v4 offset:10240
  ds_read_b64_tr_b16 a[182:183], v4 offset:10752
  s_waitcnt lgkmcnt(0)
  ds_read_b64_tr_b16 a[24:25], v2 offset:12288
  ds_read_b64_tr_b16 a[26:27], v2 offset:12800
  ds_read_b64_tr_b16 a[184:185], v4 offset:12288
  ds_read_b64_tr_b16 a[186:187], v4 offset:12800
  ds_read_b64_tr_b16 a[28:29], v2 offset:14336
  ds_read_b64_tr_b16 a[30:31], v2 offset:14848
  ds_read_b64_tr_b16 a[188:189], v4 offset:14336
  ds_read_b64_tr_b16 a[190:191], v4 offset:14848
  s_waitcnt lgkmcnt(0)
  s_add_u32 m0, s24, 8192
  s_add_u32 s36, s13, 2211840
  buffer_load_dwordx4 v3, s[92:95], s36 offen lds
  s_add_u32 m0, s24, 9216
  s_add_u32 s36, s13, 2242560
  buffer_load_dwordx4 v3, s[92:95], s36 offen lds
  s_add_u32 m0, s24, 10240
  s_add_u32 s36, s13, 2273280
  buffer_load_dwordx4 v3, s[92:95], s36 offen lds
  s_add_u32 m0, s24, 11264
  s_add_u32 s36, s13, 2304000
  buffer_load_dwordx4 v3, s[92:95], s36 offen lds
  s_add_u32 m0, s24, 12288
  s_add_u32 s36, s13, 2334720
  buffer_load_dwordx4 v3, s[92:95], s36 offen lds
  s_add_u32 m0, s24, 13312
  s_add_u32 s36, s13, 2365440
  buffer_load_dwordx4 v3, s[92:95], s36 offen lds
  s_add_u32 m0, s24, 14336
  s_add_u32 s36, s13, 2396160
  buffer_load_dwordx4 v3, s[92:95], s36 offen lds
  s_add_u32 m0, s24, 15360
  s_add_u32 s36, s13, 2426880
  buffer_load_dwordx4 v3, s[92:95], s36 offen lds
  s_waitcnt vmcnt(24)
  ds_read_b64_tr_b16 a[32:33], v2 offset:16384
  ds_read_b64_tr_b16 a[34:35], v2 offset:16896
  ds_read_b64_tr_b16 a[192:193], v4 offset:16384
  ds_read_b64_tr_b16 a[194:195], v4 offset:16896
  ds_read_b64_tr_b16 a[36:37], v2 offset:18432
  ds_read_b64_tr_b16 a[38:39], v2 offset:18944
  ds_read_b64_tr_b16 a[196:197], v4 offset:18432
  ds_read_b64_tr_b16 a[198:199], v4 offset:18944
  s_waitcnt lgkmcnt(0)
  ds_read_b64_tr_b16 a[40:41], v2 offset:20480
  ds_read_b64_tr_b16 a[42:43], v2 offset:20992
  ds_read_b64_tr_b16 a[200:201], v4 offset:20480
  ds_read_b64_tr_b16 a[202:203], v4 offset:20992
  ds_read_b64_tr_b16 a[44:45], v2 offset:22528
  ds_read_b64_tr_b16 a[46:47], v2 offset:23040
  ds_read_b64_tr_b16 a[204:205], v4 offset:22528
  ds_read_b64_tr_b16 a[206:207], v4 offset:23040
  s_waitcnt lgkmcnt(0)
  s_waitcnt vmcnt(16)
  ds_read_b64_tr_b16 a[48:49], v2 offset:24576
  ds_read_b64_tr_b16 a[50:51], v2 offset:25088
  ds_read_b64_tr_b16 a[208:209], v4 offset:24576
  ds_read_b64_tr_b16 a[210:211], v4 offset:25088
  ds_read_b64_tr_b16 a[52:53], v2 offset:26624
  ds_read_b64_tr_b16 a[54:55], v2 offset:27136
  ds_read_b64_tr_b16 a[212:213], v4 offset:26624
  ds_read_b64_tr_b16 a[214:215], v4 offset:27136
  s_waitcnt lgkmcnt(0)
  ds_read_b64_tr_b16 a[56:57], v2 offset:28672
  ds_read_b64_tr_b16 a[58:59], v2 offset:29184
  ds_read_b64_tr_b16 a[216:217], v4 offset:28672
  ds_read_b64_tr_b16 a[218:219], v4 offset:29184
  ds_read_b64_tr_b16 a[60:61], v2 offset:30720
  ds_read_b64_tr_b16 a[62:63], v2 offset:31232
  ds_read_b64_tr_b16 a[220:221], v4 offset:30720
  ds_read_b64_tr_b16 a[222:223], v4 offset:31232
  s_waitcnt lgkmcnt(0)
  s_waitcnt vmcnt(8)
  ds_read_b64_tr_b16 a[64:65], v2 offset:0
  ds_read_b64_tr_b16 a[66:67], v2 offset:512
  ds_read_b64_tr_b16 a[224:225], v4 offset:0
  ds_read_b64_tr_b16 a[226:227], v4 offset:512
  ds_read_b64_tr_b16 a[68:69], v2 offset:2048
  ds_read_b64_tr_b16 a[70:71], v2 offset:2560
  ds_read_b64_tr_b16 a[228:229], v4 offset:2048
  ds_read_b64_tr_b16 a[230:231], v4 offset:2560
  s_waitcnt lgkmcnt(0)
  ds_read_b64_tr_b16 a[72:73], v2 offset:4096
  ds_read_b64_tr_b16 a[74:75], v2 offset:4608
  ds_read_b64_tr_b16 a[232:233], v4 offset:4096
  ds_read_b64_tr_b16 a[234:235], v4 offset:4608
  ds_read_b64_tr_b16 a[76:77], v2 offset:6144
  ds_read_b64_tr_b16 a[78:79], v2 offset:6656
  ds_read_b64_tr_b16 a[236:237], v4 offset:6144
  ds_read_b64_tr_b16 a[238:239], v4 offset:6656
  s_waitcnt lgkmcnt(0)
  s_waitcnt vmcnt(0)
  ds_read_b64_tr_b16 a[80:81], v2 offset:8192
  ds_read_b64_tr_b16 a[82:83], v2 offset:8704
  ds_read_b64_tr_b16 a[240:241], v4 offset:8192
  ds_read_b64_tr_b16 a[242:243], v4 offset:8704
  ds_read_b64_tr_b16 a[84:85], v2 offset:10240
  ds_read_b64_tr_b16 a[86:87], v2 offset:10752
  ds_read_b64_tr_b16 a[244:245], v4 offset:10240
  ds_read_b64_tr_b16 a[246:247], v4 offset:10752
  s_waitcnt lgkmcnt(0)
  ds_read_b64_tr_b16 a[88:89], v2 offset:12288
  ds_read_b64_tr_b16 a[90:91], v2 offset:12800
  ds_read_b64_tr_b16 a[248:249], v4 offset:12288
  ds_read_b64_tr_b16 a[250:251], v4 offset:12800
  ds_read_b64_tr_b16 a[92:93], v2 offset:14336
  ds_read_b64_tr_b16 a[94:95], v2 offset:14848
  ds_read_b64_tr_b16 a[252:253], v4 offset:14336
  ds_read_b64_tr_b16 a[254:255], v4 offset:14848
  s_waitcnt lgkmcnt(0)
  s_barrier
  s_mov_b32 s23, s18
  s_lshl_b32 s32, s10, 10
  s_mov_b32 s22, s32
  s_mov_b32 s21, 0
  s_mov_b32 s20, 0
  s_mov_b32 s66, 0x80000000
  v_mov_b32 v16, 0
  s_cmp_gt_i32 s23, 0
  s_cselect_b32 s37, s14, 0x80000000
  s_sub_u32 s23, s23, 1
  s_add_u32 s14, s14, s15
  s_add_u32 m0, s22, 0
  s_add_u32 s36, s37, 0
  buffer_load_dwordx4 v5, s[96:99], s36 offen lds
  s_add_u32 m0, s22, 4096
  s_add_u32 s36, s37, 128
  buffer_load_dwordx4 v5, s[96:99], s36 offen lds
  s_add_u32 m0, s22, 8192
  s_add_u32 s36, s37, 256
  buffer_load_dwordx4 v5, s[96:99], s36 offen lds
  s_add_u32 m0, s22, 12288
  s_add_u32 s36, s37, 384
  buffer_load_dwordx4 v5, s[96:99], s36 offen lds
  s_add_u32 m0, s22, 16384
  s_add_u32 s36, s37, 512
  buffer_load_dwordx4 v5, s[96:99], s36 offen lds
  s_add_u32 m0, s22, 20480
  s_add_u32 s36, s37, 640
  buffer_load_dwordx4 v5, s[96:99], s36 offen lds
  s_add_u32 m0, s22, 24576
  s_add_u32 s36, s37, 768
  buffer_load_dwordx4 v5, s[96:99], s36 offen lds
  s_add_u32 m0, s22, 28672
  s_add_u32 s36, s37, 896
  buffer_load_dwordx4 v5, s[96:99], s36 offen lds
  s_add_u32 m0, s22, 32768
  s_add_u32 s36, s37, 1024
  buffer_load_dwordx4 v5, s[96:99], s36 offen lds
  s_add_u32 m0, s22, 36864
  s_add_u32 s36, s37, 1152
  buffer_load_dwordx4 v5, s[96:99], s36 offen lds
  s_add_u32 s22, s22, 40960
  s_cmp_ge_u32 s22, 122880
  s_cselect_b32 s22, s32, s22
  s_cmp_gt_i32 s23, 0
  s_cselect_b32 s37, s14, 0x80000000
  s_sub_u32 s23, s23, 1
  s_add_u32 s14, s14, s15
  s_add_u32 m0, s22, 0
  s_add_u32 s36, s37, 0
  buffer_load_dwordx4 v5, s[96:99], s36 offen lds
  s_add_u32 m0, s22, 4096
  s_add_u32 s36, s37, 128
  buffer_load_dwordx4 v5, s[96:99], s36 offen lds
  s_add_u32 m0, s22, 8192
  s_add_u32 s36, s37, 256
  buffer_load_dwordx4 v5, s[96:99], s36 offen lds
  s_add_u32 m0, s22, 12288
  s_add_u32 s36, s37, 384
  buffer_load_dwordx4 v5, s[96:99], s36 offen lds
  s_add_u32 m0, s22, 16384
  s_add_u32 s36, s37, 512
  buffer_load_dwordx4 v5, s[96:99], s36 offen lds
  s_add_u32 m0, s22, 20480
  s_add_u32 s36, s37, 640
  buffer_load_dwordx4 v5, s[96:99], s36 offen lds
  s_add_u32 m0, s22, 24576
  s_add_u32 s36, s37, 768
  buffer_load_dwordx4 v5, s[96:99], s36 offen lds
  s_add_u32 m0, s22, 28672
  s_add_u32 s36, s37, 896
  buffer_load_dwordx4 v5, s[96:99], s36 offen lds
  s_add_u32 m0, s22, 32768
  s_add_u32 s36, s37, 1024
  buffer_load_dwordx4 v5, s[96:99], s36 offen lds
  s_add_u32 m0, s22, 36864
  s_add_u32 s36, s37, 1152
  buffer_load_dwordx4 v5, s[96:99], s36 offen lds
  s_add_u32 s22, s22, 40960
  s_cmp_ge_u32 s22, 122880
  s_cselect_b32 s22, s32, s22
  v_add_u32 v10, s21, v6
  v_add_u32 v11, s21, v7
  v_add_u32 v12, s21, v8
  v_add_u32 v13, s21, v9
  s_waitcnt vmcnt(10)
  s_barrier
  ds_read_b128 v[160:163], v10 offset:0
  ds_read_b128 v[164:167], v11 offset:0
  ds_read_b128 v[168:171], v12 offset:0
  s_cmp_eq_u32 s28, 2
  s_cbranch_scc1 L_bq_v_123
L_gemm_125:
  s_cmp_gt_i32 s23, 0
  s_cselect_b32 s37, s14, 0x80000000
  s_sub_u32 s23, s23, 1
  s_add_u32 s14, s14, s15
  s_waitcnt lgkmcnt(2)
  v_mfma_f32_32x32x16_bf16 v[128:143], v[192:195], v[160:163], 0
  ds_read_b128 v[172:175], v13 offset:0
  v_mfma_f32_32x32x16_bf16 v[144:159], a[96:99], v[160:163], 0
  s_mov_b64 exec, 1
  buffer_store_dword v16, v1, s[4:7], s19 offen sc1
  s_mov_b64 exec, -1
  s_waitcnt lgkmcnt(2)
  v_mfma_f32_32x32x16_bf16 v[128:143], v[196:199], v[164:167], v[128:143]
  ds_read_b128 v[160:163], v10 offset:4096
  v_mfma_f32_32x32x16_bf16 v[144:159], a[100:103], v[164:167], v[144:159]
  s_waitcnt lgkmcnt(2)
  v_mfma_f32_32x32x16_bf16 v[128:143], v[200:203], v[168:171], v[128:143]
  ds_read_b128 v[164:167], v11 offset:4096
  v_mfma_f32_32x32x16_bf16 v[144:159], a[104:107], v[168:171], v[144:159]
  buffer_store_dwordx4 v[176:179], v1, s[4:7], s66 offen offset:0 sc1
  s_waitcnt lgkmcnt(2)
  v_mfma_f32_32x32x16_bf16 v[128:143], v[204:207], v[172:175], v[128:143]
  ds_read_b128 v[168:171], v12 offset:4096
  v_mfma_f32_32x32x16_bf16 v[144:159], a[108:111], v[172:175], v[144:159]
  s_waitcnt lgkmcnt(2)
  v_mfma_f32_32x32x16_bf16 v[128:143], v[208:211], v[160:163], v[128:143]
  ds_read_b128 v[172:175], v13 offset:4096
  v_mfma_f32_32x32x16_bf16 v[144:159], a[112:115], v[160:163], v[144:159]
  buffer_store_dwordx4 v[180:183], v1, s[4:7], s66 offen offset:1024 sc1
  s_waitcnt lgkmcnt(2)
  v_mfma_f32_32x32x16_bf16 v[128:143], v[212:215], v[164:167], v[128:143]
  ds_read_b128 v[160:163], v10 offset:8192
  v_mfma_f32_32x32x16_bf16 v[144:159], a[116:119], v[164:167], v[144:159]
  s_waitcnt lgkmcnt(2)
  v_mfma_f32_32x32x16_bf16 v[128:143], v[216:219], v[168:171], v[128:143]
  ds_read_b128 v[164:167], v11 offset:8192
  v_mfma_f32_32x32x16_bf16 v[144:159], a[120:123], v[168:171], v[144:159]
  buffer_store_dwordx4 v[184:187], v1, s[4:7], s66 offen offset:2048 sc1
  s_waitcnt lgkmcnt(2)
  v_mfma_f32_32x32x16_bf16 v[128:143], v[220:223], v[172:175], v[128:143]
  ds_read_b128 v[168:171], v12 offset:8192
  v_mfma_f32_32x32x16_bf16 v[144:159], a[124:127], v[172:175], v[144:159]
  s_waitcnt lgkmcnt(2)
  v_mfma_f32_32x32x16_bf16 v[128:143], v[224:227], v[160:163], v[128:143]
  ds_read_b128 v[172:175], v13 offset:8192
  v_mfma_f32_32x32x16_bf16 v[144:159], a[128:131], v[160:163], v[144:159]
  buffer_store_dwordx4 v[188:191], v1, s[4:7], s66 offen offset:3072 sc1
  s_waitcnt lgkmcnt(2)
  v_mfma_f32_32x32x16_bf16 v[128:143], v[228:231], v[164:167], v[128:143]
  ds_read_b128 v[160:163], v10 offset:12288
  v_mfma_f32_32x32x16_bf16 v[144:159], a[132:135], v[164:167], v[144:159]
  s_waitcnt lgkmcnt(2)
  v_mfma_f32_32x32x16_bf16 v[128:143], v[232:235], v[168:171], v[128:143]
  ds_read_b128 v[164:167], v11 offset:12288
  v_mfma_f32_32x32x16_bf16 v[144:159], a[136:139], v[168:171], v[144:159]
  s_add_u32 m0, s22, 0
  s_add_u32 s36, s37, 0
  buffer_load_dwordx4 v5, s[96:99], s36 offen lds
  s_waitcnt lgkmcnt(2)
  v_mfma_f32_32x32x16_bf16 v[128:143], v[236:239], v[172:175], v[128:143]
  ds_read_b128 v[168:171], v12 offset:12288
  v_mfma_f32_32x32x16_bf16 v[144:159], a[140:143], v[172:175], v[144:159]
  s_waitcnt lgkmcnt(2)
  v_mfma_f32_32x32x16_bf16 v[128:143], v[240:243], v[160:163], v[128:143]
  ds_read_b128 v[172:175], v13 offset:12288
  v_mfma_f32_32x32x16_bf16 v[144:159], a[144:147], v[160:163], v[144:159]
  s_add_u32 m0, s22, 4096
  s_add_u32 s36, s37, 128
  buffer_load_dwordx4 v5, s[96:99], s36 offen lds
  s_waitcnt lgkmcnt(2)
  v_mfma_f32_32x32x16_bf16 v[128:143], v[244:247], v[164:167], v[128:143]
  ds_read_b128 v[160:163], v10 offset:16384
  v_mfma_f32_32x32x16_bf16 v[144:159], a[148:151], v[164:167], v[144:159]
  s_waitcnt lgkmcnt(2)
  v_mfma_f32_32x32x16_bf16 v[128:143], v[248:251], v[168:171], v[128:143]
  ds_read_b128 v[164:167], v11 offset:16384
  v_mfma_f32_32x32x16_bf16 v[144:159], a[152:155], v[168:171], v[144:159]
  s_add_u32 m0, s22, 8192
  s_add_u32 s36, s37, 256
  buffer_load_dwordx4 v5, s[96:99], s36 offen lds
  s_waitcnt lgkmcnt(2)
  v_mfma_f32_32x32x16_bf16 v[128:143], v[252:255], v[172:175], v[128:143]
  ds_read_b128 v[168:171], v12 offset:16384
  v_mfma_f32_32x32x16_bf16 v[144:159], a[156:159], v[172:175], v[144:159]
  s_waitcnt lgkmcnt(2)
  v_mfma_f32_32x32x16_bf16 v[128:143], a[0:3], v[160:163], v[128:143]
  ds_read_b128 v[172:175], v13 offset:16384
  v_mfma_f32_32x32x16_bf16 v[144:159], a[160:163], v[160:163], v[144:159]
  s_add_u32 m0, s22, 12288
  s_add_u32 s36, s37, 384
  buffer_load_dwordx4 v5, s[96:99], s36 offen lds
  s_waitcnt lgkmcnt(2)
  v_mfma_f32_32x32x16_bf16 v[128:143], a[4:7], v[164:167], v[128:143]
  ds_read_b128 v[160:163], v10 offset:20480
  v_mfma_f32_32x32x16_bf16 v[144:159], a[164:167], v[164:167], v[144:159]
  s_waitcnt lgkmcnt(2)
  v_mfma_f32_32x32x16_bf16 v[128:143], a[8:11], v[168:171], v[128:143]
  ds_read_b128 v[164:167], v11 offset:20480
  v_mfma_f32_32x32x16_bf16 v[144:159], a[168:171], v[168:171], v[144:159]
  s_add_u32 m0, s22, 16384
  s_add_u32 s36, s37, 512
  buffer_load_dwordx4 v5, s[96:99], s36 offen lds
  s_waitcnt lgkmcnt(2)
  v_mfma_f32_32x32x16_bf16 v[128:143], a[12:15], v[172:175], v[128:143]
  ds_read_b128 v[168:171], v12 offset:20480
  v_mfma_f32_32x32x16_bf16 v[144:159], a[172:175], v[172:175], v[144:159]
  s_waitcnt lgkmcnt(2)
  v_mfma_f32_32x32x16_bf16 v[128:143], a[16:19], v[160:163], v[128:143]
  ds_read_b128 v[172:175], v13 offset:20480
  v_mfma_f32_32x32x16_bf16 v[144:159], a[176:179], v[160:163], v[144:159]
  s_add_u32 m0, s22, 20480
  s_add_u32 s36, s37, 640
  buffer_load_dwordx4 v5, s[96:99], s36 offen lds
  s_waitcnt lgkmcnt(2)
  v_mfma_f32_32x32x16_bf16 v[128:143], a[20:23], v[164:167], v[128:143]
  ds_read_b128 v[160:163], v10 offset:24576
  v_mfma_f32_32x32x16_bf16 v[144:159], a[180:183], v[164:167], v[144:159]
  s_waitcnt lgkmcnt(2)
  v_mfma_f32_32x32x16_bf16 v[128:143], a[24:27], v[168:171], v[128:143]
  ds_read_b128 v[164:167], v11 offset:24576
  v_mfma_f32_32x32x16_bf16 v[144:159], a[184:187], v[168:171], v[144:159]
  s_add_u32 m0, s22, 24576
  s_add_u32 s36, s37, 768
  buffer_load_dwordx4 v5, s[96:99], s36 offen lds
  s_waitcnt lgkmcnt(2)
  v_mfma_f32_32x32x16_bf16 v[128:143], a[28:31], v[172:175], v[128:143]
  ds_read_b128 v[168:171], v12 offset:24576
  v_mfma_f32_32x32x16_bf16 v[144:159], a[188:191], v[172:175], v[144:159]
  s_waitcnt lgkmcnt(2)
  v_mfma_f32_32x32x16_bf16 v[128:143], a[32:35], v[160:163], v[128:143]
  ds_read_b128 v[172:175], v13 offset:24576
  v_mfma_f32_32x32x16_bf16 v[144:159], a[192:195], v[160:163], v[144:159]
  s_add_u32 m0, s22, 28672
  s_add_u32 s36, s37, 896
  buffer_load_dwordx4 v5, s[96:99], s36 offen lds
  s_waitcnt lgkmcnt(2)
  v_mfma_f32_32x32x16_bf16 v[128:143], a[36:39], v[164:167], v[128:143]
  ds_read_b128 v[160:163], v10 offset:28672
  v_mfma_f32_32x32x16_bf16 v[144:159], a[196:199], v[164:167], v[144:159]
  s_waitcnt lgkmcnt(2)
  v_mfma_f32_32x32x16_bf16 v[128:143], a[40:43], v[168:171], v[128:143]
  ds_read_b128 v[164:167], v11 offset:28672
  v_mfma_f32_32x32x16_bf16 v[144:159], a[200:203], v[168:171], v[144:159]
  s_add_u32 m0, s22, 32768
  s_add_u32 s36, s37, 1024
  buffer_load_dwordx4 v5, s[96:99], s36 offen lds
  s_waitcnt lgkmcnt(2)
  v_mfma_f32_32x32x16_bf16 v[128:143], a[44:47], v[172:175], v[128:143]
  ds_read_b128 v[168:171], v12 offset:28672
  v_mfma_f32_32x32x16_bf16 v[144:159], a[204:207], v[172:175], v[144:159]
  s_waitcnt lgkmcnt(2)
  v_mfma_f32_32x32x16_bf16 v[128:143], a[48:51], v[160:163], v[128:143]
  ds_read_b128 v[172:175], v13 offset:28672
  v_mfma_f32_32x32x16_bf16 v[144:159], a[208:211], v[160:163], v[144:159]
  s_add_u32 m0, s22, 36864
  s_add_u32 s36, s37, 1152
  buffer_load_dwordx4 v5, s[96:99], s36 offen lds
  s_waitcnt lgkmcnt(2)
  v_mfma_f32_32x32x16_bf16 v[128:143], a[52:55], v[164:167], v[128:143]
  ds_read_b128 v[160:163], v10 offset:32768
  v_mfma_f32_32x32x16_bf16 v[144:159], a[212:215], v[164:167], v[144:159]
  s_waitcnt lgkmcnt(2)
  v_mfma_f32_32x32x16_bf16 v[128:143], a[56:59], v[168:171], v[128:143]
  ds_read_b128 v[164:167], v11 offset:32768
  v_mfma_f32_32x32x16_bf16 v[144:159], a[216:219], v[168:171], v[144:159]
  s_waitcnt lgkmcnt(2)
  v_mfma_f32_32x32x16_bf16 v[128:143], a[60:63], v[172:175], v[128:143]
  ds_read_b128 v[168:171], v12 offset:32768
  v_mfma_f32_32x32x16_bf16 v[144:159], a[220:223], v[172:175], v[144:159]
  s_waitcnt lgkmcnt(2)
  v_mfma_f32_32x32x16_bf16 v[128:143], a[64:67], v[160:163], v[128:143]
  ds_read_b128 v[172:175], v13 offset:32768
  v_mfma_f32_32x32x16_bf16 v[144:159], a[224:227], v[160:163], v[144:159]
  s_waitcnt lgkmcnt(2)
  v_mfma_f32_32x32x16_bf16 v[128:143], a[68:71], v[164:167], v[128:143]
  ds_read_b128 v[160:163], v10 offset:36864
  v_mfma_f32_32x32x16_bf16 v[144:159], a[228:231], v[164:167], v[144:159]
  s_waitcnt lgkmcnt(2)
  v_mfma_f32_32x32x16_bf16 v[128:143], a[72:75], v[168:171], v[128:143]
  ds_read_b128 v[164:167], v11 offset:36864
  v_mfma_f32_32x32x16_bf16 v[144:159], a[232:235], v[168:171], v[144:159]
  s_waitcnt lgkmcnt(2)
  v_mfma_f32_32x32x16_bf16 v[128:143], a[76:79], v[172:175], v[128:143]
  ds_read_b128 v[168:171], v12 offset:36864
  v_mfma_f32_32x32x16_bf16 v[144:159], a[236:239], v[172:175], v[144:159]
  s_waitcnt lgkmcnt(2)
  v_mfma_f32_32x32x16_bf16 v[128:143], a[80:83], v[160:163], v[128:143]
  ds_read_b128 v[172:175], v13 offset:36864
  v_mfma_f32_32x32x16_bf16 v[144:159], a[240:243], v[160:163], v[144:159]
  s_waitcnt lgkmcnt(2)
  v_mfma_f32_32x32x16_bf16 v[128:143], a[84:87], v[164:167], v[128:143]
  v_mfma_f32_32x32x16_bf16 v[144:159], a[244:247], v[164:167], v[144:159]
  s_waitcnt lgkmcnt(1)
  v_mfma_f32_32x32x16_bf16 v[128:143], a[88:91], v[168:171], v[128:143]
  s_add_u32 s22, s22, 40960
  s_cmp_ge_u32 s22, 122880
  s_cselect_b32 s22, s32, s22
  v_mov_b32 v16, s20
  v_mfma_f32_32x32x16_bf16 v[144:159], a[248:251], v[168:171], v[144:159]
  s_add_u32 s21, s21, 40960
  s_cmp_ge_u32 s21, 122880
  s_cselect_b32 s21, 0, s21
  s_add_u32 s20, s20, 1
  s_waitcnt lgkmcnt(0)
  v_mfma_f32_32x32x16_bf16 v[128:143], a[92:95], v[172:175], v[128:143]
  v_mfma_f32_32x32x16_bf16 v[144:159], a[252:255], v[172:175], v[144:159]
  v_add_u32 v10, s21, v6
  v_add_u32 v11, s21, v7
  v_add_u32 v12, s21, v8
  v_add_u32 v13, s21, v9
  s_waitcnt vmcnt(10)
  s_barrier
  ds_read_b128 v[160:163], v10 offset:0
  ds_read_b128 v[164:167], v11 offset:0
  ds_read_b128 v[168:171], v12 offset:0
  s_mov_b32 s66, s16
  s_add_u32 s16, s16, s17
  s_cmp_lt_u32 s20, s18
  v_pk_mul_f32 v[128:129], v[128:129], s[26:27]
  v_pk_mul_f32 v[130:131], v[130:131], s[26:27]
  v_pk_mul_f32 v[132:133], v[132:133], s[26:27]
  v_pk_mul_f32 v[134:135], v[134:135], s[26:27]
  v_pk_mul_f32 v[136:137], v[136:137], s[26:27]
  v_pk_mul_f32 v[138:139], v[138:139], s[26:27]
  v_pk_mul_f32 v[140:141], v[140:141], s[26:27]
  v_pk_mul_f32 v[142:143], v[142:143], s[26:27]
  v_cvt_pk_bf16_f32 v176, v128, v129
  v_cvt_pk_bf16_f32 v177, v130, v131
  v_cvt_pk_bf16_f32 v178, v132, v133
  v_cvt_pk_bf16_f32 v179, v134, v135
  v_cvt_pk_bf16_f32 v180, v136, v137
  v_cvt_pk_bf16_f32 v181, v138, v139
  v_cvt_pk_bf16_f32 v182, v140, v141
  v_cvt_pk_bf16_f32 v183, v142, v143
  v_pk_mul_f32 v[144:145], v[144:145], s[26:27]
  v_pk_mul_f32 v[146:147], v[146:147], s[26:27]
  v_pk_mul_f32 v[148:149], v[148:149], s[26:27]
  v_pk_mul_f32 v[150:151], v[150:151], s[26:27]
  v_pk_mul_f32 v[152:153], v[152:153], s[26:27]
  v_pk_mul_f32 v[154:155], v[154:155], s[26:27]
  v_pk_mul_f32 v[156:157], v[156:157], s[26:27]
  v_pk_mul_f32 v[158:159], v[158:159], s[26:27]
  v_cvt_pk_bf16_f32 v184, v144, v145
  v_cvt_pk_bf16_f32 v185, v146, v147
  v_cvt_pk_bf16_f32 v186, v148, v149
  v_cvt_pk_bf16_f32 v187, v150, v151
  v_cvt_pk_bf16_f32 v188, v152, v153
  v_cvt_pk_bf16_f32 v189, v154, v155
  v_cvt_pk_bf16_f32 v190, v156, v157
  v_cvt_pk_bf16_f32 v191, v158, v159
  s_cbranch_scc1 L_gemm_125
  buffer_store_dwordx4 v[176:179], v1, s[4:7], s66 offen offset:0 sc1
  buffer_store_dwordx4 v[180:183], v1, s[4:7], s66 offen offset:1024 sc1
  buffer_store_dwordx4 v[184:187], v1, s[4:7], s66 offen offset:2048 sc1
  buffer_store_dwordx4 v[188:191], v1, s[4:7], s66 offen offset:3072 sc1
  s_waitcnt lgkmcnt(0)
  s_branch L_bq_e_124
L_bq_v_123:
L_gemm_126:
  s_cmp_gt_i32 s23, 0
  s_cselect_b32 s37, s14, 0x80000000
  s_sub_u32 s23, s23, 1
  s_add_u32 s14, s14, s15
  s_waitcnt lgkmcnt(2)
  v_mfma_f32_32x32x16_bf16 v[128:143], v[160:163], v[192:195], 0
  ds_read_b128 v[172:175], v13 offset:0
  v_mfma_f32_32x32x16_bf16 v[144:159], v[160:163], a[96:99], 0
  s_mov_b64 exec, 1
  buffer_store_dword v16, v1, s[4:7], s19 offen sc1
  s_mov_b64 exec, -1
  s_waitcnt lgkmcnt(2)
  v_mfma_f32_32x32x16_bf16 v[128:143], v[164:167], v[196:199], v[128:143]
  ds_read_b128 v[160:163], v10 offset:4096
  v_mfma_f32_32x32x16_bf16 v[144:159], v[164:167], a[100:103], v[144:159]
  s_waitcnt lgkmcnt(2)
  v_mfma_f32_32x32x16_bf16 v[128:143], v[168:171], v[200:203], v[128:143]
  ds_read_b128 v[164:167], v11 offset:4096
  v_mfma_f32_32x32x16_bf16 v[144:159], v[168:171], a[104:107], v[144:159]
  buffer_store_dwordx4 v[176:179], v14, s[4:7], s66 offen offset:0 sc1
  s_waitcnt lgkmcnt(2)
  v_mfma_f32_32x32x16_bf16 v[128:143], v[172:175], v[204:207], v[128:143]
  ds_read_b128 v[168:171], v12 offset:4096
  v_mfma_f32_32x32x16_bf16 v[144:159], v[172:175], a[108:111], v[144:159]
  s_waitcnt lgkmcnt(2)
  v_mfma_f32_32x32x16_bf16 v[128:143], v[160:163], v[208:211], v[128:143]
  ds_read_b128 v[172:175], v13 offset:4096
  v_mfma_f32_32x32x16_bf16 v[144:159], v[160:163], a[112:115], v[144:159]
  buffer_store_dwordx4 v[180:183], v15, s[4:7], s66 offen offset:0 sc1
  s_waitcnt lgkmcnt(2)
  v_mfma_f32_32x32x16_bf16 v[128:143], v[164:167], v[212:215], v[128:143]
  ds_read_b128 v[160:163], v10 offset:8192
  v_mfma_f32_32x32x16_bf16 v[144:159], v[164:167], a[116:119], v[144:159]
  s_waitcnt lgkmcnt(2)
  v_mfma_f32_32x32x16_bf16 v[128:143], v[168:171], v[216:219], v[128:143]
  ds_read_b128 v[164:167], v11 offset:8192
  v_mfma_f32_32x32x16_bf16 v[144:159], v[168:171], a[120:123], v[144:159]
  buffer_store_dwordx4 v[184:187], v14, s[4:7], s66 offen offset:512 sc1
  s_waitcnt lgkmcnt(2)
  v_mfma_f32_32x32x16_bf16 v[128:143], v[172:175], v[220:223], v[128:143]
  ds_read_b128 v[168:171], v12 offset:8192
  v_mfma_f32_32x32x16_bf16 v[144:159], v[172:175], a[124:127], v[144:159]
  s_waitcnt lgkmcnt(2)
  v_mfma_f32_32x32x16_bf16 v[128:143], v[160:163], v[224:227], v[128:143]
  ds_read_b128 v[172:175], v13 offset:8192
  v_mfma_f32_32x32x16_bf16 v[144:159], v[160:163], a[128:131], v[144:159]
  buffer_store_dwordx4 v[188:191], v15, s[4:7], s66 offen offset:512 sc1
  s_waitcnt lgkmcnt(2)
  v_mfma_f32_32x32x16_bf16 v[128:143], v[164:167], v[228:231], v[128:143]
  ds_read_b128 v[160:163], v10 offset:12288
  v_mfma_f32_32x32x16_bf16 v[144:159], v[164:167], a[132:135], v[144:159]
  s_waitcnt lgkmcnt(2)
  v_mfma_f32_32x32x16_bf16 v[128:143], v[168:171], v[232:235], v[128:143]
  ds_read_b128 v[164:167], v11 offset:12288
  v_mfma_f32_32x32x16_bf16 v[144:159], v[168:171], a[136:139], v[144:159]
  s_add_u32 m0, s22, 0
  s_add_u32 s36, s37, 0
  buffer_load_dwordx4 v5, s[96:99], s36 offen lds
  s_waitcnt lgkmcnt(2)
  v_mfma_f32_32x32x16_bf16 v[128:143], v[172:175], v[236:239], v[128:143]
  ds_read_b128 v[168:171], v12 offset:12288
  v_mfma_f32_32x32x16_bf16 v[144:159], v[172:175], a[140:143], v[144:159]
  s_waitcnt lgkmcnt(2)
  v_mfma_f32_32x32x16_bf16 v[128:143], v[160:163], v[240:243], v[128:143]
  ds_read_b128 v[172:175], v13 offset:12288
  v_mfma_f32_32x32x16_bf16 v[144:159], v[160:163], a[144:147], v[144:159]
  s_add_u32 m0, s22, 4096
  s_add_u32 s36, s37, 128
  buffer_load_dwordx4 v5, s[96:99], s36 offen lds
  s_waitcnt lgkmcnt(2)
  v_mfma_f32_32x32x16_bf16 v[128:143], v[164:167], v[244:247], v[128:143]
  ds_read_b128 v[160:163], v10 offset:16384
  v_mfma_f32_32x32x16_bf16 v[144:159], v[164:167], a[148:151], v[144:159]
  s_waitcnt lgkmcnt(2)
  v_mfma_f32_32x32x16_bf16 v[128:143], v[168:171], v[248:251], v[128:143]
  ds_read_b128 v[164:167], v11 offset:16384
  v_mfma_f32_32x32x16_bf16 v[144:159], v[168:171], a[152:155], v[144:159]
  s_add_u32 m0, s22, 8192
  s_add_u32 s36, s37, 256
  buffer_load_dwordx4 v5, s[96:99], s36 offen lds
  s_waitcnt lgkmcnt(2)
  v_mfma_f32_32x32x16_bf16 v[128:143], v[172:175], v[252:255], v[128:143]
  ds_read_b128 v[168:171], v12 offset:16384
  v_mfma_f32_32x32x16_bf16 v[144:159], v[172:175], a[156:159], v[144:159]
  s_waitcnt lgkmcnt(2)
  v_mfma_f32_32x32x16_bf16 v[128:143], v[160:163], a[0:3], v[128:143]
  ds_read_b128 v[172:175], v13 offset:16384
  v_mfma_f32_32x32x16_bf16 v[144:159], v[160:163], a[160:163], v[144:159]
  s_add_u32 m0, s22, 12288
  s_add_u32 s36, s37, 384
  buffer_load_dwordx4 v5, s[96:99], s36 offen lds
  s_waitcnt lgkmcnt(2)
  v_mfma_f32_32x32x16_bf16 v[128:143], v[164:167], a[4:7], v[128:143]
  ds_read_b128 v[160:163], v10 offset:20480
  v_mfma_f32_32x32x16_bf16 v[144:159], v[164:167], a[164:167], v[144:159]
  s_waitcnt lgkmcnt(2)
  v_mfma_f32_32x32x16_bf16 v[128:143], v[168:171], a[8:11], v[128:143]
  ds_read_b128 v[164:167], v11 offset:20480
  v_mfma_f32_32x32x16_bf16 v[144:159], v[168:171], a[168:171], v[144:159]
  s_add_u32 m0, s22, 16384
  s_add_u32 s36, s37, 512
  buffer_load_dwordx4 v5, s[96:99], s36 offen lds
  s_waitcnt lgkmcnt(2)
  v_mfma_f32_32x32x16_bf16 v[128:143], v[172:175], a[12:15], v[128:143]
  ds_read_b128 v[168:171], v12 offset:20480
  v_mfma_f32_32x32x16_bf16 v[144:159], v[172:175], a[172:175], v[144:159]
  s_waitcnt lgkmcnt(2)
  v_mfma_f32_32x32x16_bf16 v[128:143], v[160:163], a[16:19], v[128:143]
  ds_read_b128 v[172:175], v13 offset:20480
  v_mfma_f32_32x32x16_bf16 v[144:159], v[160:163], a[176:179], v[144:159]
  s_add_u32 m0, s22, 20480
  s_add_u32 s36, s37, 640
  buffer_load_dwordx4 v5, s[96:99], s36 offen lds
  s_waitcnt lgkmcnt(2)
  v_mfma_f32_32x32x16_bf16 v[128:143], v[164:167], a[20:23], v[128:143]
  ds_read_b128 v[160:163], v10 offset:24576
  v_mfma_f32_32x32x16_bf16 v[144:159], v[164:167], a[180:183], v[144:159]
  s_waitcnt lgkmcnt(2)
  v_mfma_f32_32x32x16_bf16 v[128:143], v[168:171], a[24:27], v[128:143]
  ds_read_b128 v[164:167], v11 offset:24576
  v_mfma_f32_32x32x16_bf16 v[144:159], v[168:171], a[184:187], v[144:159]
  s_add_u32 m0, s22, 24576
  s_add_u32 s36, s37, 768
  buffer_load_dwordx4 v5, s[96:99], s36 offen lds
  s_waitcnt lgkmcnt(2)
  v_mfma_f32_32x32x16_bf16 v[128:143], v[172:175], a[28:31], v[128:143]
  ds_read_b128 v[168:171], v12 offset:24576
  v_mfma_f32_32x32x16_bf16 v[144:159], v[172:175], a[188:191], v[144:159]
  s_waitcnt lgkmcnt(2)
  v_mfma_f32_32x32x16_bf16 v[128:143], v[160:163], a[32:35], v[128:143]
  ds_read_b128 v[172:175], v13 offset:24576
  v_mfma_f32_32x32x16_bf16 v[144:159], v[160:163], a[192:195], v[144:159]
  s_add_u32 m0, s22, 28672
  s_add_u32 s36, s37, 896
  buffer_load_dwordx4 v5, s[96:99], s36 offen lds
  s_waitcnt lgkmcnt(2)
  v_mfma_f32_32x32x16_bf16 v[128:143], v[164:167], a[36:39], v[128:143]
  ds_read_b128 v[160:163], v10 offset:28672
  v_mfma_f32_32x32x16_bf16 v[144:159], v[164:167], a[196:199], v[144:159]
  s_waitcnt lgkmcnt(2)
  v_mfma_f32_32x32x16_bf16 v[128:143], v[168:171], a[40:43], v[128:143]
  ds_read_b128 v[164:167], v11 offset:28672
  v_mfma_f32_32x32x16_bf16 v[144:159], v[168:171], a[200:203], v[144:159]
  s_add_u32 m0, s22, 32768
  s_add_u32 s36, s37, 1024
  buffer_load_dwordx4 v5, s[96:99], s36 offen lds
  s_waitcnt lgkmcnt(2)
  v_mfma_f32_32x32x16_bf16 v[128:143], v[172:175], a[44:47], v[128:143]
  ds_read_b128 v[168:171], v12 offset:28672
  v_mfma_f32_32x32x16_bf16 v[144:159], v[172:175], a[204:207], v[144:159]
  s_waitcnt lgkmcnt(2)
  v_mfma_f32_32x32x16_bf16 v[128:143], v[160:163], a[48:51], v[128:143]
  ds_read_b128 v[172:175], v13 offset:28672
  v_mfma_f32_32x32x16_bf16 v[144:159], v[160:163], a[208:211], v[144:159]
  s_add_u32 m0, s22, 36864
  s_add_u32 s36, s37, 1152
  buffer_load_dwordx4 v5, s[96:99], s36 offen lds
  s_waitcnt lgkmcnt(2)
  v_mfma_f32_32x32x16_bf16 v[128:143], v[164:167], a[52:55], v[128:143]
  ds_read_b128 v[160:163], v10 offset:32768
  v_mfma_f32_32x32x16_bf16 v[144:159], v[164:167], a[212:215], v[144:159]
  s_waitcnt lgkmcnt(2)
  v_mfma_f32_32x32x16_bf16 v[128:143], v[168:171], a[56:59], v[128:143]
  ds_read_b128 v[164:167], v11 offset:32768
  v_mfma_f32_32x32x16_bf16 v[144:159], v[168:171], a[216:219], v[144:159]
  s_waitcnt lgkmcnt(2)
  v_mfma_f32_32x32x16_bf16 v[128:143], v[172:175], a[60:63], v[128:143]
  ds_read_b128 v[168:171], v12 offset:32768
  v_mfma_f32_32x32x16_bf16 v[144:159], v[172:175], a[220:223], v[144:159]
  s_waitcnt lgkmcnt(2)
  v_mfma_f32_32x32x16_bf16 v[128:143], v[160:163], a[64:67], v[128:143]
  ds_read_b128 v[172:175], v13 offset:32768
  v_mfma_f32_32x32x16_bf16 v[144:159], v[160:163], a[224:227], v[144:159]
  s_waitcnt lgkmcnt(2)
  v_mfma_f32_32x32x16_bf16 v[128:143], v[164:167], a[68:71], v[128:143]
  ds_read_b128 v[160:163], v10 offset:36864
  v_mfma_f32_32x32x16_bf16 v[144:159], v[164:167], a[228:231], v[144:159]
  s_waitcnt lgkmcnt(2)
  v_mfma_f32_32x32x16_bf16 v[128:143], v[168:171], a[72:75], v[128:143]
  ds_read_b128 v[164:167], v11 offset:36864
  v_mfma_f32_32x32x16_bf16 v[144:159], v[168:171], a[232:235], v[144:159]
  s_waitcnt lgkmcnt(2)
  v_mfma_f32_32x32x16_bf16 v[128:143], v[172:175], a[76:79], v[128:143]
  ds_read_b128 v[168:171], v12 offset:36864
  v_mfma_f32_32x32x16_bf16 v[144:159], v[172:175], a[236:239], v[144:159]
  s_waitcnt lgkmcnt(2)
  v_mfma_f32_32x32x16_bf16 v[128:143], v[160:163], a[80:83], v[128:143]
  ds_read_b128 v[172:175], v13 offset:36864
  v_mfma_f32_32x32x16_bf16 v[144:159], v[160:163], a[240:243], v[144:159]
  s_waitcnt lgkmcnt(2)
  v_mfma_f32_32x32x16_bf16 v[128:143], v[164:167], a[84:87], v[128:143]
  v_mfma_f32_32x32x16_bf16 v[144:159], v[164:167], a[244:247], v[144:159]
  s_waitcnt lgkmcnt(1)
  v_mfma_f32_32x32x16_bf16 v[128:143], v[168:171], a[88:91], v[128:143]
  s_add_u32 s22, s22, 40960
  s_cmp_ge_u32 s22, 122880
  s_cselect_b32 s22, s32, s22
  v_mov_b32 v16, s20
  v_mfma_f32_32x32x16_bf16 v[144:159], v[168:171], a[248:251], v[144:159]
  s_add_u32 s21, s21, 40960
  s_cmp_ge_u32 s21, 122880
  s_cselect_b32 s21, 0, s21
  s_add_u32 s20, s20, 1
  s_waitcnt lgkmcnt(0)
  v_mfma_f32_32x32x16_bf16 v[128:143], v[172:175], a[92:95], v[128:143]
  v_mfma_f32_32x32x16_bf16 v[144:159], v[172:175], a[252:255], v[144:159]
  v_add_u32 v10, s21, v6
  v_add_u32 v11, s21, v7
  v_add_u32 v12, s21, v8
  v_add_u32 v13, s21, v9
  s_waitcnt vmcnt(10)
  s_barrier
  ds_read_b128 v[160:163], v10 offset:0
  ds_read_b128 v[164:167], v11 offset:0
  ds_read_b128 v[168:171], v12 offset:0
  s_mov_b32 s66, s16
  s_add_u32 s16, s16, s17
  s_cmp_lt_u32 s20, s18
  v_cvt_pk_bf16_f32 v176, v128, v132
  v_cvt_pk_bf16_f32 v177, v136, v140
  v_cvt_pk_bf16_f32 v178, v129, v133
  v_cvt_pk_bf16_f32 v179, v137, v141
  v_cvt_pk_bf16_f32 v180, v130, v134
  v_cvt_pk_bf16_f32 v181, v138, v142
  v_cvt_pk_bf16_f32 v182, v131, v135
  v_cvt_pk_bf16_f32 v183, v139, v143
  v_cvt_pk_bf16_f32 v184, v144, v148
  v_cvt_pk_bf16_f32 v185, v152, v156
  v_cvt_pk_bf16_f32 v186, v145, v149
  v_cvt_pk_bf16_f32 v187, v153, v157
  v_cvt_pk_bf16_f32 v188, v146, v150
  v_cvt_pk_bf16_f32 v189, v154, v158
  v_cvt_pk_bf16_f32 v190, v147, v151
  v_cvt_pk_bf16_f32 v191, v155, v159
  s_cbranch_scc1 L_gemm_126
  buffer_store_dwordx4 v[176:179], v14, s[4:7], s66 offen offset:0 sc1
  buffer_store_dwordx4 v[180:183], v15, s[4:7], s66 offen offset:0 sc1
  buffer_store_dwordx4 v[184:187], v14, s[4:7], s66 offen offset:512 sc1
  buffer_store_dwordx4 v[188:191], v15, s[4:7], s66 offen offset:512 sc1
  s_waitcnt lgkmcnt(0)
L_bq_e_124:
  s_waitcnt vmcnt(0)
  s_barrier
  s_cmp_lg_u32 s10, 0
  s_cbranch_scc1 L_arr_127
  v_mov_b32 v16, 1
  s_mov_b64 exec, 1
  buffer_atomic_add v16, v1, s[84:87], 44 offen
  s_mov_b64 exec, -1
L_arr_127:
  s_and_b32 s36, s9, 31
  s_cmp_ge_u32 s36, 20
  s_cbranch_scc1 L_abort
  s_lshr_b32 s9, s9, 5
  s_mul_i32 s9, s9, 20
  s_add_u32 s9, s9, s36
  v_and_b32 v16, 31, v0
  v_mul_u32_u24 v16, 2560, v16
  v_and_b32 v17, 32, v0
  v_add_u32 v14, v16, v17
  v_lshrrev_b32 v17, 3, v0
  v_xor_b32 v17, v17, v0
  v_and_b32 v17, 4, v17
  v_and_or_b32 v17, v0, 16, v17
  v_bfe_u32 v18, v0, 3, 1
  v_bfe_u32 v19, v0, 1, 1
  v_lshl_add_u32 v18, v18, 1, v19
  v_add_u32 v17, v17, v18
  v_and_b32 v18, 1, v0
  v_lshlrev_b32 v18, 4, v18
  v_mov_b32 v19, 0x3f80
  v_lshlrev_b32 v18, v18, v19
  v_cmp_eq_u32 vcc, 0, v17
  s_nop 1
  v_cndmask_b32 v6, 0, v18, vcc
  v_cmp_eq_u32 vcc, 1, v17
  s_nop 1
  v_cndmask_b32 v7, 0, v18, vcc
  v_cmp_eq_u32 vcc, 2, v17
  s_nop 1
  v_cndmask_b32 v8, 0, v18, vcc
  v_cmp_eq_u32 vcc, 3, v17
  s_nop 1
  v_cndmask_b32 v9, 0, v18, vcc
  s_cmp_lg_u32 s10, 0
  s_cbranch_scc1 L_polled_129
  v_and_b32 v17, 0, v0
  v_lshlrev_b32 v17, 2, v17
L_poll_128:
  buffer_load_dword v16, v17, s[84:87], 40 offen sc1
  s_waitcnt vmcnt(0)
  v_cmp_gt_u32 vcc, 192, v16
  s_cbranch_vccz L_polled_129
  s_sub_u32 s12, s12, 1
  s_cbranch_scc1 L_abort
  s_sleep 2
  s_branch L_poll_128
L_polled_129:
  s_barrier
  s_mov_b32 s28, s10
  s_lshr_b32 s36, s9, 1
  s_lshl_b32 s36, s36, 6
  s_and_b32 s37, s9, 1
  s_lshl_b32 s37, s37, 4
  s_add_u32 s32, s36, s37
  v_mov_b32 v17, 0
L_sum_130:
  s_lshl_b32 s38, s28, 7
  s_add_u32 s38, s38, 63979520
  s_mul_i32 s36, s28, 655360
  s_lshl_b32 s37, s9, 10
  s_add_u32 s36, s36, s37
  s_add_u32 s36, s36, 83886080
L_sump_131:
  buffer_load_dword v16, v17, s[4:7], s38 offen sc1
  s_waitcnt vmcnt(0)
  v_cmp_gt_u32 vcc, 16, v16
  s_cbranch_vccz L_sumg_132
  s_sub_u32 s12, s12, 1
  s_cbranch_scc1 L_abort
  s_sleep 2
  s_branch L_sump_131
L_sumg_132:
  buffer_load_dwordx4 v[112:115], v1, s[4:7], s36 offen sc1
  s_add_u32 s36, s36, 40960
  buffer_load_dwordx4 v[116:119], v1, s[4:7], s36 offen sc1
  s_add_u32 s36, s36, 40960
  buffer_load_dwordx4 v[120:123], v1, s[4:7], s36 offen sc1
  s_add_u32 s36, s36, 40960
  buffer_load_dwordx4 v[124:127], v1, s[4:7], s36 offen sc1
  s_add_u32 s36, s36, 40960
  buffer_load_dwordx4 v[128:131], v1, s[4:7], s36 offen sc1
  s_add_u32 s36, s36, 40960
  buffer_load_dwordx4 v[132:135], v1, s[4:7], s36 offen sc1
  s_add_u32 s36, s36, 40960
  buffer_load_dwordx4 v[136:139], v1, s[4:7], s36 offen sc1
  s_add_u32 s36, s36, 40960
  buffer_load_dwordx4 v[140:143], v1, s[4:7], s36 offen sc1
  s_add_u32 s36, s36, 40960
  buffer_load_dwordx4 v[144:147], v1, s[4:7], s36 offen sc1
  s_add_u32 s36, s36, 40960
  buffer_load_dwordx4 v[148:151], v1, s[4:7], s36 offen sc1
  s_add_u32 s36, s36, 40960
  buffer_load_dwordx4 v[152:155], v1, s[4:7], s36 offen sc1
  s_add_u32 s36, s36, 40960
  buffer_load_dwordx4 v[156:159], v1, s[4:7], s36 offen sc1
  s_add_u32 s36, s36, 40960
  buffer_load_dwordx4 v[160:163], v1, s[4:7], s36 offen sc1
  s_add_u32 s36, s36, 40960
  buffer_load_dwordx4 v[164:167], v1, s[4:7], s36 offen sc1
  s_add_u32 s36, s36, 40960
  buffer_load_dwordx4 v[168:171], v1, s[4:7], s36 offen sc1
  s_add_u32 s36, s36, 40960
  buffer_load_dwordx4 v[172:175], v1, s[4:7], s36 offen sc1
  s_add_u32 s36, s36, 40960
  s_mul_i32 s37, s28, 81920
  s_add_u32 s36, s32, s37
  s_waitcnt vmcnt(15)
  v_mfma_f32_32x32x16_bf16 v[176:191], v[6:9], v[112:115], 0
  s_waitcnt vmcnt(14)
  v_mfma_f32_32x32x16_bf16 v[176:191], v[6:9], v[116:119], v[176:191]
  s_waitcnt vmcnt(13)
  v_mfma_f32_32x32x16_bf16 v[176:191], v[6:9], v[120:123], v[176:191]
  s_waitcnt vmcnt(12)
  v_mfma_f32_32x32x16_bf16 v[176:191], v[6:9], v[124:127], v[176:191]
  s_waitcnt vmcnt(11)
  v_mfma_f32_32x32x16_bf16 v[176:191], v[6:9], v[128:131], v[176:191]
  s_waitcnt vmcnt(10)
  v_mfma_f32_32x32x16_bf16 v[176:191], v[6:9], v[132:135], v[176:191]
  s_waitcnt vmcnt(9)
  v_mfma_f32_32x32x16_bf16 v[176:191], v[6:9], v[136:139], v[176:191]
  s_waitcnt vmcnt(8)
  v_mfma_f32_32x32x16_bf16 v[176:191], v[6:9], v[140:143], v[176:191]
  s_waitcnt vmcnt(7)
  v_mfma_f32_32x32x16_bf16 v[176:191], v[6:9], v[144:147], v[176:191]
  s_waitcnt vmcnt(6)
  v_mfma_f32_32x32x16_bf16 v[176:191], v[6:9], v[148:151], v[176:191]
  s_waitcnt vmcnt(5)
  v_mfma_f32_32x32x16_bf16 v[176:191], v[6:9], v[152:155], v[176:191]
  s_waitcnt vmcnt(4)
  v_mfma_f32_32x32x16_bf16 v[176:191], v[6:9], v[156:159], v[176:191]
  s_waitcnt vmcnt(3)
  v_mfma_f32_32x32x16_bf16 v[176:191], v[6:9], v[160:163], v[176:191]
  s_waitcnt vmcnt(2)
  v_mfma_f32_32x32x16_bf16 v[176:191], v[6:9], v[164:167], v[176:191]
  s_waitcnt vmcnt(1)
  v_mfma_f32_32x32x16_bf16 v[176:191], v[6:9], v[168:171], v[176:191]
  s_waitcnt vmcnt(0)
  v_mfma_f32_32x32x16_bf16 v[176:191], v[6:9], v[172:175], v[176:191]
  s_nop 11
  v_cvt_pk_bf16_f32 v100, v176, v177
  v_cvt_pk_bf16_f32 v101, v178, v179
  v_cvt_pk_bf16_f32 v102, v180, v181
  v_cvt_pk_bf16_f32 v103, v182, v183
  buffer_store_dwordx4 v[100:103], v14, s[88:91], s36 offen
  s_add_u32 s28, s28, 4
  s_cmp_lt_u32 s28, 64
  s_cbranch_scc1 L_sum_130
L_end:
  s_endpgm
.section .rodata,"a"
.p2align 6
.amdhsa_kernel concat_heads__memory_aug_recurrent_mem_tr__sliding_block__prompt_kernel
  .amdhsa_next_free_vgpr 512
  .amdhsa_next_free_sgpr 102
  .amdhsa_accum_offset 256
  .amdhsa_group_segment_fixed_size 0
  .amdhsa_kernarg_size 104
  .amdhsa_user_sgpr_count 2
  .amdhsa_user_sgpr_kernarg_segment_ptr 1
  .amdhsa_system_sgpr_workgroup_id_x 1
  .amdhsa_float_denorm_mode_32 3
.end_amdhsa_kernel
```
